```python
import torch

def _softmax(x, axis=-1):
    return torch.softmax(x, dim=axis)
def _gelu(x):
    return torch.nn.functional.gelu(x, approximate="tanh")
def _silu(x):
    return torch.nn.functional.silu(x)
def _sigmoid(x):
    return torch.sigmoid(x)
def _layernorm(x, axis=-1, eps=1e-5):
    m = x.mean(dim=axis, keepdim=True)
    v = x.var(dim=axis, keepdim=True, unbiased=False)
    return (x - m) / torch.sqrt(v + eps)
def _scatter_add(tgt, idx, src, axis=0):
    return tgt.clone().index_add_(axis, idx, src)
def _segment_sum(src, seg, n):
    out = torch.zeros((n,) + src.shape[1:], dtype=src.dtype)
    return out.index_add_(0, seg, src)
def _pad(x, pw):
    flat = tuple(v for pair in reversed(pw) for v in pair)
    return torch.nn.functional.pad(x, flat)

kernel_name = 'standalone__convnext_block__vision'

def setup_inputs():

    _w = (lambda a: (lambda t: t.to(torch.bfloat16) if t.is_floating_point() else t)(torch.as_tensor(a)))
    H = W = 384
    C = 192
    return {
        "x": _w((lambda *s: torch.randn(*s, dtype=torch.bfloat16) * 0.05)(1, H, W, C)),
        "dw": _w((lambda *s: torch.randn(*s, dtype=torch.bfloat16) * 0.05)(7, 7, C)),
        "w1": _w((lambda *s: torch.randn(*s, dtype=torch.bfloat16) * 0.05)(C, 4 * C)),
        "w2": _w((lambda *s: torch.randn(*s, dtype=torch.bfloat16) * 0.05)(4 * C, C)),
    }

def reference(x, dw, w1, w2):
    B, H, W, C = x.shape
    pad = 3
    xp = _pad(x, ((0,0),(pad,pad),(pad,pad),(0,0)))
    out = torch.zeros_like(x)
    for i in range(7):
        for j in range(7):
            out = out + xp[:, i:i+H, j:j+W, :] * dw[i, j][None, None, None, :]
    h = _layernorm(out, axis=-1)
    return x + _gelu(h @ w1) @ w2
```

```asm
; @launch kernel=fused_kernel grid=(256,1,1) block=(256,1,1) lds=163840
.amdgcn_target "amdgcn-amd-amdhsa--gfx950"
.text
.globl fused_kernel
.p2align 8
.type fused_kernel,@function
fused_kernel:
  s_cmp_ge_u32 s2, 256
  s_cbranch_scc1 fused_kernel_done
  s_load_dwordx4 s[4:7], s[0:1], 0
  s_load_dwordx2 s[38:39], s[0:1], 48
  s_load_dwordx4 s[52:55], s[0:1], 16
  v_lshrrev_b32 v1, 6, v0
  v_and_b32 v0, 63, v0
  s_nop 0
  v_readfirstlane_b32 s40, v1
  s_mov_b32 s30, 56623104
  s_mov_b32 s92, 0x3f803f80
  s_mov_b32 s33, 0x05040100
  s_mov_b32 s41, 0x07060302
  s_mov_b32 s93, 0x3eeff558
  s_mov_b32 s94, 0x3727c5ac
  s_mov_b32 s95, 0x3baaaaab
  v_lshlrev_b32 v2, 4, v0
  v_mov_b32 v3, 0
  s_waitcnt lgkmcnt(0)
  s_mov_b32 s16, s4
  s_mov_b32 s17, s5
  s_mov_b32 s18, 56623104
  s_mov_b32 s19, 0x20000
  s_mov_b32 s20, s6
  s_mov_b32 s21, s7
  s_mov_b32 s22, 18816
  s_mov_b32 s23, 0x20000
  s_add_u32 s12, s38, 1048576
  s_addc_u32 s13, s39, 0
  s_mov_b32 s14, 56623104
  s_mov_b32 s15, 0x20000
  s_load_dwordx2 s[4:5], s[0:1], 40
  s_mov_b32 s37, 0
  v_add_u32 v144, 0, v0
  v_mul_u32_u24 v145, 2622, v144
  v_lshrrev_b32 v145, 16, v145
  v_mul_u32_u24 v146, 25, v145
  v_sub_u32 v146, v144, v146
  v_subrev_u32 v145, 1, v145
  v_cmp_gt_u32 vcc, 7, v145
  v_cmp_gt_u32 s[44:45], 24, v146
  v_mul_u32_u24 v145, 384, v145
  v_lshl_add_u32 v145, v146, 4, v145
  s_and_b64 vcc, vcc, s[44:45]
  s_nop 0
  v_cndmask_b32 v152, 2.0, v145, vcc
  v_add_u32 v144, 64, v0
  v_mul_u32_u24 v145, 2622, v144
  v_lshrrev_b32 v145, 16, v145
  v_mul_u32_u24 v146, 25, v145
  v_sub_u32 v146, v144, v146
  v_subrev_u32 v145, 1, v145
  v_cmp_gt_u32 vcc, 7, v145
  v_cmp_gt_u32 s[44:45], 24, v146
  v_mul_u32_u24 v145, 384, v145
  v_lshl_add_u32 v145, v146, 4, v145
  s_and_b64 vcc, vcc, s[44:45]
  s_nop 0
  v_cndmask_b32 v153, 2.0, v145, vcc
  v_add_u32 v144, 128, v0
  v_mul_u32_u24 v145, 2622, v144
  v_lshrrev_b32 v145, 16, v145
  v_mul_u32_u24 v146, 25, v145
  v_sub_u32 v146, v144, v146
  v_subrev_u32 v145, 1, v145
  v_cmp_gt_u32 vcc, 7, v145
  v_cmp_gt_u32 s[44:45], 24, v146
  v_mul_u32_u24 v145, 384, v145
  v_lshl_add_u32 v145, v146, 4, v145
  s_and_b64 vcc, vcc, s[44:45]
  s_nop 0
  v_cndmask_b32 v154, 2.0, v145, vcc
  v_add_u32 v144, 192, v0
  v_mul_u32_u24 v145, 2622, v144
  v_lshrrev_b32 v145, 16, v145
  v_mul_u32_u24 v146, 25, v145
  v_sub_u32 v146, v144, v146
  v_subrev_u32 v145, 1, v145
  v_cmp_gt_u32 vcc, 7, v145
  v_cmp_gt_u32 s[44:45], 24, v146
  v_mul_u32_u24 v145, 384, v145
  v_lshl_add_u32 v145, v146, 4, v145
  s_and_b64 vcc, vcc, s[44:45]
  s_nop 0
  v_cndmask_b32 v155, 2.0, v145, vcc
  s_add_u32 s31, s40, 0
  s_sub_u32 s32, s31, 1
  s_cmp_lt_u32 s32, 7
  s_mul_i32 s32, s32, 2688
  s_cselect_b32 s32, s32, 0x70000000
  s_mul_i32 s31, s31, 3616
  s_add_u32 s31, s31, 107712
  s_add_u32 m0, s31, 0
  s_nop 0
  buffer_load_dwordx4 v152, s[20:23], s32 offen lds
  s_add_u32 m0, s31, 1024
  s_nop 0
  buffer_load_dwordx4 v153, s[20:23], s32 offen lds
  s_add_u32 m0, s31, 2048
  s_nop 0
  buffer_load_dwordx4 v154, s[20:23], s32 offen lds
  s_add_u32 m0, s31, 3072
  s_nop 0
  s_mov_b32 exec_hi, 3
  buffer_load_dwordx4 v155, s[20:23], s32 offen lds
  s_mov_b32 exec_hi, -1
  s_add_u32 s31, s40, 4
  s_sub_u32 s32, s31, 1
  s_cmp_lt_u32 s32, 7
  s_mul_i32 s32, s32, 2688
  s_cselect_b32 s32, s32, 0x70000000
  s_mul_i32 s31, s31, 3616
  s_add_u32 s31, s31, 107712
  s_add_u32 m0, s31, 0
  s_nop 0
  buffer_load_dwordx4 v152, s[20:23], s32 offen lds
  s_add_u32 m0, s31, 1024
  s_nop 0
  buffer_load_dwordx4 v153, s[20:23], s32 offen lds
  s_add_u32 m0, s31, 2048
  s_nop 0
  buffer_load_dwordx4 v154, s[20:23], s32 offen lds
  s_add_u32 m0, s31, 3072
  s_nop 0
  s_mov_b32 exec_hi, 3
  buffer_load_dwordx4 v155, s[20:23], s32 offen lds
  s_mov_b32 exec_hi, -1
  s_cmp_eq_u32 s40, 0
  s_cbranch_scc0 fused_kernel_nor8
  s_add_u32 s31, s40, 8
  s_sub_u32 s32, s31, 1
  s_cmp_lt_u32 s32, 7
  s_mul_i32 s32, s32, 2688
  s_cselect_b32 s32, s32, 0x70000000
  s_mul_i32 s31, s31, 3616
  s_add_u32 s31, s31, 107712
  s_add_u32 m0, s31, 0
  s_nop 0
  buffer_load_dwordx4 v152, s[20:23], s32 offen lds
  s_add_u32 m0, s31, 1024
  s_nop 0
  buffer_load_dwordx4 v153, s[20:23], s32 offen lds
  s_add_u32 m0, s31, 2048
  s_nop 0
  buffer_load_dwordx4 v154, s[20:23], s32 offen lds
  s_add_u32 m0, s31, 3072
  s_nop 0
  s_mov_b32 exec_hi, 3
  buffer_load_dwordx4 v155, s[20:23], s32 offen lds
  s_mov_b32 exec_hi, -1
fused_kernel_nor8:
  s_mov_b32 s42, -1
  s_cmp_lt_u32 s2, 72
  s_cbranch_scc0 fused_kernel_nopk
  s_lshl_b32 s44, s2, 3
  s_lshl_b32 s45, s40, 1
  s_add_u32 s42, s44, s45
  s_mul_hi_u32 s46, s42, 178956971
  s_mul_i32 s47, s46, 24
  s_sub_u32 s43, s42, s47
  v_and_b32 v120, 15, v0
  v_lshrrev_b32 v121, 4, v0
  s_cmp_lt_u32 s43, 12
  s_cbranch_scc0 fused_kernel_a_pk2
  s_add_u32 s48, s46, 1
  s_cmp_eq_u32 s48, 24
  s_cselect_b32 s48, 0, s48
  s_lshr_b32 s49, s43, 1
  s_and_b32 s50, s43, 1
  s_lshl_b32 s48, s48, 6
  s_lshl_b32 s50, s50, 5
  s_add_u32 s48, s48, s50
  s_mul_i32 s49, s49, 49152
  s_add_u32 s48, s48, s49
  v_mul_u32_u24 v122, 12288, v121
  v_lshl_add_u32 v122, v120, 1, v122
  s_mov_b32 s8, s52
  s_mov_b32 s9, s53
  s_mov_b32 s10, 294912
  s_mov_b32 s11, 0x20000
  s_add_u32 s49, s48, 0
  buffer_load_ushort v176, v122, s[8:11], s49 offen
  s_add_u32 s49, s48, 1536
  buffer_load_ushort v177, v122, s[8:11], s49 offen
  s_add_u32 s49, s48, 3072
  buffer_load_ushort v178, v122, s[8:11], s49 offen
  s_add_u32 s49, s48, 4608
  buffer_load_ushort v179, v122, s[8:11], s49 offen
  s_add_u32 s49, s48, 6144
  buffer_load_ushort v180, v122, s[8:11], s49 offen
  s_add_u32 s49, s48, 7680
  buffer_load_ushort v181, v122, s[8:11], s49 offen
  s_add_u32 s49, s48, 9216
  buffer_load_ushort v182, v122, s[8:11], s49 offen
  s_add_u32 s49, s48, 10752
  buffer_load_ushort v183, v122, s[8:11], s49 offen
  s_branch fused_kernel_a_pk3
fused_kernel_a_pk2:
  s_add_u32 s48, s46, 23
  s_cmp_ge_u32 s48, 24
  s_cselect_b32 s49, 24, 0
  s_sub_u32 s48, s48, s49
  s_sub_u32 s49, s43, 12
  s_lshr_b32 s50, s49, 1
  s_and_b32 s49, s49, 1
  s_mul_i32 s48, s48, 12288
  s_lshl_b32 s50, s50, 6
  s_lshl_b32 s49, s49, 3
  s_add_u32 s48, s48, s50
  s_add_u32 s48, s48, s49
  v_lshrrev_b32 v123, 2, v120
  v_lshlrev_b32 v123, 4, v123
  v_and_b32 v124, 3, v120
  v_lshl_add_u32 v123, v124, 1, v123
  v_mul_u32_u24 v122, 1536, v121
  v_add_u32 v122, v122, v123
  s_mov_b32 s8, s54
  s_mov_b32 s9, s55
  s_mov_b32 s10, 294912
  s_mov_b32 s11, 0x20000
  s_add_u32 s49, s48, 0
  buffer_load_ushort v176, v122, s[8:11], s49 offen
  s_add_u32 s49, s48, 384
  buffer_load_ushort v177, v122, s[8:11], s49 offen
  s_add_u32 s49, s48, 768
  buffer_load_ushort v178, v122, s[8:11], s49 offen
  s_add_u32 s49, s48, 1152
  buffer_load_ushort v179, v122, s[8:11], s49 offen
  s_add_u32 s49, s48, 6144
  buffer_load_ushort v180, v122, s[8:11], s49 offen
  s_add_u32 s49, s48, 6528
  buffer_load_ushort v181, v122, s[8:11], s49 offen
  s_add_u32 s49, s48, 6912
  buffer_load_ushort v182, v122, s[8:11], s49 offen
  s_add_u32 s49, s48, 7296
  buffer_load_ushort v183, v122, s[8:11], s49 offen
fused_kernel_a_pk3:
  s_add_u32 s42, s42, 1
  s_mul_hi_u32 s46, s42, 178956971
  s_mul_i32 s47, s46, 24
  s_sub_u32 s43, s42, s47
  v_and_b32 v120, 15, v0
  v_lshrrev_b32 v121, 4, v0
  s_cmp_lt_u32 s43, 12
  s_cbranch_scc0 fused_kernel_a2_pk2
  s_add_u32 s48, s46, 1
  s_cmp_eq_u32 s48, 24
  s_cselect_b32 s48, 0, s48
  s_lshr_b32 s49, s43, 1
  s_and_b32 s50, s43, 1
  s_lshl_b32 s48, s48, 6
  s_lshl_b32 s50, s50, 5
  s_add_u32 s48, s48, s50
  s_mul_i32 s49, s49, 49152
  s_add_u32 s48, s48, s49
  v_mul_u32_u24 v122, 12288, v121
  v_lshl_add_u32 v122, v120, 1, v122
  s_mov_b32 s8, s52
  s_mov_b32 s9, s53
  s_mov_b32 s10, 294912
  s_mov_b32 s11, 0x20000
  s_add_u32 s49, s48, 0
  buffer_load_ushort v185, v122, s[8:11], s49 offen
  s_add_u32 s49, s48, 1536
  buffer_load_ushort v186, v122, s[8:11], s49 offen
  s_add_u32 s49, s48, 3072
  buffer_load_ushort v187, v122, s[8:11], s49 offen
  s_add_u32 s49, s48, 4608
  buffer_load_ushort v188, v122, s[8:11], s49 offen
  s_add_u32 s49, s48, 6144
  buffer_load_ushort v189, v122, s[8:11], s49 offen
  s_add_u32 s49, s48, 7680
  buffer_load_ushort v190, v122, s[8:11], s49 offen
  s_add_u32 s49, s48, 9216
  buffer_load_ushort v191, v122, s[8:11], s49 offen
  s_add_u32 s49, s48, 10752
  buffer_load_ushort v192, v122, s[8:11], s49 offen
  s_branch fused_kernel_a2_pk3
fused_kernel_a2_pk2:
  s_add_u32 s48, s46, 23
  s_cmp_ge_u32 s48, 24
  s_cselect_b32 s49, 24, 0
  s_sub_u32 s48, s48, s49
  s_sub_u32 s49, s43, 12
  s_lshr_b32 s50, s49, 1
  s_and_b32 s49, s49, 1
  s_mul_i32 s48, s48, 12288
  s_lshl_b32 s50, s50, 6
  s_lshl_b32 s49, s49, 3
  s_add_u32 s48, s48, s50
  s_add_u32 s48, s48, s49
  v_lshrrev_b32 v123, 2, v120
  v_lshlrev_b32 v123, 4, v123
  v_and_b32 v124, 3, v120
  v_lshl_add_u32 v123, v124, 1, v123
  v_mul_u32_u24 v122, 1536, v121
  v_add_u32 v122, v122, v123
  s_mov_b32 s8, s54
  s_mov_b32 s9, s55
  s_mov_b32 s10, 294912
  s_mov_b32 s11, 0x20000
  s_add_u32 s49, s48, 0
  buffer_load_ushort v185, v122, s[8:11], s49 offen
  s_add_u32 s49, s48, 384
  buffer_load_ushort v186, v122, s[8:11], s49 offen
  s_add_u32 s49, s48, 768
  buffer_load_ushort v187, v122, s[8:11], s49 offen
  s_add_u32 s49, s48, 1152
  buffer_load_ushort v188, v122, s[8:11], s49 offen
  s_add_u32 s49, s48, 6144
  buffer_load_ushort v189, v122, s[8:11], s49 offen
  s_add_u32 s49, s48, 6528
  buffer_load_ushort v190, v122, s[8:11], s49 offen
  s_add_u32 s49, s48, 6912
  buffer_load_ushort v191, v122, s[8:11], s49 offen
  s_add_u32 s49, s48, 7296
  buffer_load_ushort v192, v122, s[8:11], s49 offen
fused_kernel_a2_pk3:
fused_kernel_nopk:
  v_and_b32 v144, 7, v0
  v_lshrrev_b32 v145, 3, v0
  s_lshl_b32 s31, s40, 3
  s_add_u32 s31, s31, 0
  v_add_u32 v146, s31, v145
  v_mul_u32_u24 v147, 745, v146
  v_lshrrev_b32 v147, 13, v147
  v_mul_u32_u24 v148, 11, v147
  v_sub_u32 v148, v146, v148
  v_mul_u32_u24 v149, 768, v147
  v_lshl_add_u32 v149, v148, 1, v149
  v_mul_u32_u24 v149, 384, v149
  v_lshl_add_u32 v4, v144, 4, v149
  v_lshl_add_u32 v150, v148, 1, 0
  v_cmp_lt_u32 s[44:45], 2, v150
  v_cmp_gt_u32 s[60:61], 19, v150
  v_lshl_add_u32 v150, v148, 1, 1
  v_cmp_lt_u32 s[46:47], 2, v150
  v_cmp_gt_u32 s[62:63], 19, v150
  v_mul_u32_u24 v8, 544, v146
  s_lshl_b32 s31, s40, 3
  s_add_u32 s31, s31, 32
  v_add_u32 v146, s31, v145
  v_mul_u32_u24 v147, 745, v146
  v_lshrrev_b32 v147, 13, v147
  v_mul_u32_u24 v148, 11, v147
  v_sub_u32 v148, v146, v148
  v_mul_u32_u24 v149, 768, v147
  v_lshl_add_u32 v149, v148, 1, v149
  v_mul_u32_u24 v149, 384, v149
  v_lshl_add_u32 v5, v144, 4, v149
  v_lshl_add_u32 v150, v148, 1, 0
  v_cmp_lt_u32 s[48:49], 2, v150
  v_cmp_gt_u32 s[64:65], 19, v150
  v_lshl_add_u32 v150, v148, 1, 1
  v_cmp_lt_u32 s[50:51], 2, v150
  v_cmp_gt_u32 s[66:67], 19, v150
  s_lshl_b32 s31, s40, 3
  s_add_u32 s31, s31, 64
  v_add_u32 v146, s31, v145
  v_mul_u32_u24 v147, 745, v146
  v_lshrrev_b32 v147, 13, v147
  v_mul_u32_u24 v148, 11, v147
  v_sub_u32 v148, v146, v148
  v_mul_u32_u24 v149, 768, v147
  v_lshl_add_u32 v149, v148, 1, v149
  v_mul_u32_u24 v149, 384, v149
  v_lshl_add_u32 v6, v144, 4, v149
  v_lshl_add_u32 v150, v148, 1, 0
  v_cmp_lt_u32 s[52:53], 2, v150
  v_cmp_gt_u32 s[68:69], 19, v150
  v_lshl_add_u32 v150, v148, 1, 1
  v_cmp_lt_u32 s[54:55], 2, v150
  v_cmp_gt_u32 s[70:71], 19, v150
  v_add_u32 v146, 96, v145
  v_cmp_gt_u32 s[100:101], 24, v0
  v_mul_u32_u24 v147, 745, v146
  v_lshrrev_b32 v147, 13, v147
  v_mul_u32_u24 v148, 11, v147
  v_sub_u32 v148, v146, v148
  v_mul_u32_u24 v149, 768, v147
  v_lshl_add_u32 v149, v148, 1, v149
  v_mul_u32_u24 v149, 384, v149
  v_lshl_add_u32 v7, v144, 4, v149
  v_lshl_add_u32 v150, v148, 1, 0
  v_cmp_lt_u32 s[56:57], 2, v150
  v_cmp_gt_u32 s[72:73], 19, v150
  s_nop 1
  s_and_b64 s[56:57], s[56:57], s[100:101]
  s_and_b64 s[72:73], s[72:73], s[100:101]
  v_lshl_add_u32 v150, v148, 1, 1
  v_cmp_lt_u32 s[58:59], 2, v150
  v_cmp_gt_u32 s[74:75], 19, v150
  s_nop 1
  s_and_b64 s[58:59], s[58:59], s[100:101]
  s_and_b64 s[74:75], s[74:75], s[100:101]
  s_lshl_b32 s31, s40, 2
  v_add_u32 v7, s31, v7
  v_cndmask_b32 v7, 2.0, v7, s[100:101]
  v_mul_u32_u24 v9, 544, v146
  v_xor_b32 v150, s40, v144
  v_lshl_add_u32 v9, v150, 4, v9
  s_lshl_b32 s31, s40, 7
  v_add_u32 v9, s31, v9
  v_lshrrev_b32 v144, 2, v0
  v_and_b32 v145, 3, v0
  v_lshrrev_b32 v146, 3, v144
  s_lshl_b32 s31, s40, 1
  v_add_u32 v146, s31, v146
  v_bfe_u32 v147, v144, 1, 2
  v_xor_b32 v148, v146, v147
  v_lshlrev_b32 v148, 1, v148
  v_lshl_add_u32 v148, v147, 4, v148
  v_and_b32 v149, 1, v144
  v_add_u32 v148, v148, v149
  v_lshlrev_b32 v148, 3, v148
  v_mul_u32_u24 v149, 1088, v145
  v_add_u32 v10, v148, v149
  s_lshl_b32 s32, s40, 4
  v_add_u32 v151, s32, v144
  v_bfe_u32 v152, v151, 3, 1
  v_lshlrev_b32 v152, 2, v152
  v_xor_b32 v151, v151, v152
  v_lshlrev_b32 v151, 5, v151
  v_lshl_add_u32 v151, v145, 3, v151
  v_add_u32 v11, 107712, v151
  v_lshrrev_b32 v144, 4, v0
  v_bfe_u32 v145, v0, 2, 2
  v_and_b32 v146, 3, v0
  s_mul_i32 s31, s40, 6144
  s_add_u32 s31, s31, 107712
  v_lshl_add_u32 v147, v144, 3, v145
  v_add_u32 v147, 0, v147
  v_and_b32 v148, 1, v144
  v_lshlrev_b32 v148, 2, v148
  v_xor_b32 v147, v147, v148
  v_lshlrev_b32 v147, 5, v147
  v_lshl_add_u32 v147, v146, 3, v147
  v_add_u32 v12, s31, v147
  v_lshl_add_u32 v147, v144, 3, v145
  v_add_u32 v147, 4, v147
  v_and_b32 v148, 1, v144
  v_lshlrev_b32 v148, 2, v148
  v_xor_b32 v147, v147, v148
  v_lshlrev_b32 v147, 5, v147
  v_lshl_add_u32 v147, v146, 3, v147
  v_add_u32 v13, s31, v147
  v_lshrrev_b32 v144, 2, v0
  s_lshl_b32 s31, s40, 5
  v_lshlrev_b32 v144, 1, v144
  v_add_u32 v144, s31, v144
  v_bfe_u32 v145, v0, 1, 1
  v_mul_u32_u24 v145, 3616, v145
  v_and_b32 v146, 1, v0
  v_mul_u32_u24 v146, 400, v146
  v_add_u32 v145, v145, v146
  v_sub_u32 v144, v144, v145
  v_add_u32 v232, 107712, v144
  v_and_b32 v0, 7, v0
  v_lshlrev_b32 v0, 4, v0
  s_mov_b32 s24, 0
  s_lshr_b32 s25, s2, 3
  s_lshl_b32 s24, s24, 5
  s_add_u32 s25, s25, s24
  s_and_b32 s26, s2, 7
  s_lshl_b32 s26, s26, 2
  s_and_b32 s27, s25, 3
  s_add_u32 s26, s26, s27
  s_lshr_b32 s27, s25, 2
  s_mul_i32 s24, s26, 4608
  s_lshl_b32 s25, s27, 4
  s_add_u32 s24, s24, s25
  s_sub_u32 s24, s24, 1155
  s_mul_i32 s28, s24, 384
  s_cmp_eq_u32 0, 3
  s_cselect_b32 s28, 0x60000000, s28
  s_sub_u32 s25, s27, 1
  s_cmp_lt_u32 s25, 22
  s_cselect_b32 s25, 1, 0
  s_cmp_eq_u32 s26, 0
  s_cselect_b32 s25, 0, s25
  s_cmp_eq_u32 s28, 0x60000000
  s_cselect_b32 s25, 1, s25
  s_cmp_eq_u32 s25, 0
  s_cbranch_scc1 fused_kernel_to1_slow
  s_add_u32 s24, s28, 0
  v_add_u32 v216, s24, v4
  v_add_u32 v220, s24, v5
  v_add_u32 v224, s24, v6
  v_add_u32 v228, s24, v7
  s_add_u32 s24, s28, 384
  v_add_u32 v217, s24, v4
  v_add_u32 v221, s24, v5
  v_add_u32 v225, s24, v6
  v_add_u32 v229, s24, v7
  s_add_u32 s24, s28, 147456
  v_add_u32 v218, s24, v4
  v_add_u32 v222, s24, v5
  v_add_u32 v226, s24, v6
  v_add_u32 v230, s24, v7
  s_add_u32 s24, s28, 147840
  v_add_u32 v219, s24, v4
  v_add_u32 v223, s24, v5
  v_add_u32 v227, s24, v6
  v_add_u32 v231, s24, v7
  s_branch fused_kernel_to1_done
fused_kernel_to1_slow:
  s_mov_b64 s[24:25], -1
  s_cmp_eq_u32 s27, 0
  s_cselect_b64 s[24:25], s[44:45], s[24:25]
  s_cmp_eq_u32 s27, 23
  s_cselect_b64 s[24:25], s[60:61], s[24:25]
  s_add_u32 s26, s28, 0
  v_add_u32 v216, s26, v4
  v_cmp_gt_u32 vcc, s30, v216
  s_and_b64 vcc, vcc, s[24:25]
  v_cndmask_b32 v216, 2.0, v216, vcc
  s_add_u32 s26, s28, 147456
  v_add_u32 v218, s26, v4
  v_cmp_gt_u32 vcc, s30, v218
  s_and_b64 vcc, vcc, s[24:25]
  v_cndmask_b32 v218, 2.0, v218, vcc
  s_mov_b64 s[24:25], -1
  s_cmp_eq_u32 s27, 0
  s_cselect_b64 s[24:25], s[48:49], s[24:25]
  s_cmp_eq_u32 s27, 23
  s_cselect_b64 s[24:25], s[64:65], s[24:25]
  s_add_u32 s26, s28, 0
  v_add_u32 v220, s26, v5
  v_cmp_gt_u32 vcc, s30, v220
  s_and_b64 vcc, vcc, s[24:25]
  v_cndmask_b32 v220, 2.0, v220, vcc
  s_add_u32 s26, s28, 147456
  v_add_u32 v222, s26, v5
  v_cmp_gt_u32 vcc, s30, v222
  s_and_b64 vcc, vcc, s[24:25]
  v_cndmask_b32 v222, 2.0, v222, vcc
  s_mov_b64 s[24:25], -1
  s_cmp_eq_u32 s27, 0
  s_cselect_b64 s[24:25], s[52:53], s[24:25]
  s_cmp_eq_u32 s27, 23
  s_cselect_b64 s[24:25], s[68:69], s[24:25]
  s_add_u32 s26, s28, 0
  v_add_u32 v224, s26, v6
  v_cmp_gt_u32 vcc, s30, v224
  s_and_b64 vcc, vcc, s[24:25]
  v_cndmask_b32 v224, 2.0, v224, vcc
  s_add_u32 s26, s28, 147456
  v_add_u32 v226, s26, v6
  v_cmp_gt_u32 vcc, s30, v226
  s_and_b64 vcc, vcc, s[24:25]
  v_cndmask_b32 v226, 2.0, v226, vcc
  s_or_b64 s[24:25], s[56:57], s[72:73]
  s_cmp_eq_u32 s27, 0
  s_cselect_b64 s[24:25], s[56:57], s[24:25]
  s_cmp_eq_u32 s27, 23
  s_cselect_b64 s[24:25], s[72:73], s[24:25]
  s_add_u32 s26, s28, 0
  v_add_u32 v228, s26, v7
  v_cmp_gt_u32 vcc, s30, v228
  s_and_b64 vcc, vcc, s[24:25]
  v_cndmask_b32 v228, 2.0, v228, vcc
  s_add_u32 s26, s28, 147456
  v_add_u32 v230, s26, v7
  v_cmp_gt_u32 vcc, s30, v230
  s_and_b64 vcc, vcc, s[24:25]
  v_cndmask_b32 v230, 2.0, v230, vcc
  s_mov_b64 s[24:25], -1
  s_cmp_eq_u32 s27, 0
  s_cselect_b64 s[24:25], s[46:47], s[24:25]
  s_cmp_eq_u32 s27, 23
  s_cselect_b64 s[24:25], s[62:63], s[24:25]
  s_add_u32 s26, s28, 384
  v_add_u32 v217, s26, v4
  v_cmp_gt_u32 vcc, s30, v217
  s_and_b64 vcc, vcc, s[24:25]
  v_cndmask_b32 v217, 2.0, v217, vcc
  s_add_u32 s26, s28, 147840
  v_add_u32 v219, s26, v4
  v_cmp_gt_u32 vcc, s30, v219
  s_and_b64 vcc, vcc, s[24:25]
  v_cndmask_b32 v219, 2.0, v219, vcc
  s_mov_b64 s[24:25], -1
  s_cmp_eq_u32 s27, 0
  s_cselect_b64 s[24:25], s[50:51], s[24:25]
  s_cmp_eq_u32 s27, 23
  s_cselect_b64 s[24:25], s[66:67], s[24:25]
  s_add_u32 s26, s28, 384
  v_add_u32 v221, s26, v5
  v_cmp_gt_u32 vcc, s30, v221
  s_and_b64 vcc, vcc, s[24:25]
  v_cndmask_b32 v221, 2.0, v221, vcc
  s_add_u32 s26, s28, 147840
  v_add_u32 v223, s26, v5
  v_cmp_gt_u32 vcc, s30, v223
  s_and_b64 vcc, vcc, s[24:25]
  v_cndmask_b32 v223, 2.0, v223, vcc
  s_mov_b64 s[24:25], -1
  s_cmp_eq_u32 s27, 0
  s_cselect_b64 s[24:25], s[54:55], s[24:25]
  s_cmp_eq_u32 s27, 23
  s_cselect_b64 s[24:25], s[70:71], s[24:25]
  s_add_u32 s26, s28, 384
  v_add_u32 v225, s26, v6
  v_cmp_gt_u32 vcc, s30, v225
  s_and_b64 vcc, vcc, s[24:25]
  v_cndmask_b32 v225, 2.0, v225, vcc
  s_add_u32 s26, s28, 147840
  v_add_u32 v227, s26, v6
  v_cmp_gt_u32 vcc, s30, v227
  s_and_b64 vcc, vcc, s[24:25]
  v_cndmask_b32 v227, 2.0, v227, vcc
  s_or_b64 s[24:25], s[58:59], s[74:75]
  s_cmp_eq_u32 s27, 0
  s_cselect_b64 s[24:25], s[58:59], s[24:25]
  s_cmp_eq_u32 s27, 23
  s_cselect_b64 s[24:25], s[74:75], s[24:25]
  s_add_u32 s26, s28, 384
  v_add_u32 v229, s26, v7
  v_cmp_gt_u32 vcc, s30, v229
  s_and_b64 vcc, vcc, s[24:25]
  v_cndmask_b32 v229, 2.0, v229, vcc
  s_add_u32 s26, s28, 147840
  v_add_u32 v231, s26, v7
  v_cmp_gt_u32 vcc, s30, v231
  s_and_b64 vcc, vcc, s[24:25]
  v_cndmask_b32 v231, 2.0, v231, vcc
fused_kernel_to1_done:
  buffer_load_dwordx4 v[16:19], v216, s[16:19], 0 offen offset:0
  buffer_load_dwordx4 v[20:23], v217, s[16:19], 0 offen offset:0
  buffer_load_dwordx4 v[24:27], v218, s[16:19], 0 offen offset:0
  buffer_load_dwordx4 v[28:31], v219, s[16:19], 0 offen offset:0
  buffer_load_dwordx4 v[32:35], v220, s[16:19], 0 offen offset:0
  buffer_load_dwordx4 v[36:39], v221, s[16:19], 0 offen offset:0
  buffer_load_dwordx4 v[40:43], v222, s[16:19], 0 offen offset:0
  buffer_load_dwordx4 v[44:47], v223, s[16:19], 0 offen offset:0
  buffer_load_dwordx4 v[48:51], v224, s[16:19], 0 offen offset:0
  buffer_load_dwordx4 v[52:55], v225, s[16:19], 0 offen offset:0
  buffer_load_dwordx4 v[56:59], v226, s[16:19], 0 offen offset:0
  buffer_load_dwordx4 v[60:63], v227, s[16:19], 0 offen offset:0
  buffer_load_dword v64, v228, s[16:19], 0 offen offset:0
  buffer_load_dword v65, v229, s[16:19], 0 offen offset:0
  buffer_load_dword v66, v230, s[16:19], 0 offen offset:0
  buffer_load_dword v67, v231, s[16:19], 0 offen offset:0
  s_waitcnt vmcnt(16) lgkmcnt(0)
  s_barrier
  s_cmp_eq_u32 s42, -1
  s_cbranch_scc1 fused_kernel_nops
  v_lshl_or_b32 v144, v186, 16, v185
  v_lshl_or_b32 v145, v188, 16, v187
  v_lshl_or_b32 v146, v190, 16, v189
  v_lshl_or_b32 v147, v192, 16, v191
  s_cmp_lt_u32 s43, 12
  s_cbranch_scc1 fused_kernel_b_pk5
  v_lshlrev_b32 v185, 16, v185
  v_lshlrev_b32 v186, 16, v186
  v_lshlrev_b32 v187, 16, v187
  v_lshlrev_b32 v188, 16, v188
  v_lshlrev_b32 v189, 16, v189
  v_lshlrev_b32 v190, 16, v190
  v_lshlrev_b32 v191, 16, v191
  v_lshlrev_b32 v192, 16, v192
  v_cvt_pk_f16_f32 v144, v185, v186
  v_cvt_pk_f16_f32 v145, v187, v188
  v_cvt_pk_f16_f32 v146, v189, v190
  v_cvt_pk_f16_f32 v147, v191, v192
fused_kernel_b_pk5:
  s_add_u32 s8, s38, 0
  s_addc_u32 s9, s39, 0
  s_mov_b32 s10, 589824
  s_mov_b32 s11, 0x20000
  s_lshl_b32 s3, s42, 10
  buffer_store_dwordx4 v[144:147], v2, s[8:11], s3 offen sc1
  s_sub_u32 s42, s42, 1
  s_sub_u32 s43, s43, 1
  v_lshl_or_b32 v148, v177, 16, v176
  v_lshl_or_b32 v149, v179, 16, v178
  v_lshl_or_b32 v150, v181, 16, v180
  v_lshl_or_b32 v151, v183, 16, v182
  s_cmp_lt_u32 s43, 12
  s_cbranch_scc1 fused_kernel_b2_pk5
  v_lshlrev_b32 v176, 16, v176
  v_lshlrev_b32 v177, 16, v177
  v_lshlrev_b32 v178, 16, v178
  v_lshlrev_b32 v179, 16, v179
  v_lshlrev_b32 v180, 16, v180
  v_lshlrev_b32 v181, 16, v181
  v_lshlrev_b32 v182, 16, v182
  v_lshlrev_b32 v183, 16, v183
  v_cvt_pk_f16_f32 v148, v176, v177
  v_cvt_pk_f16_f32 v149, v178, v179
  v_cvt_pk_f16_f32 v150, v180, v181
  v_cvt_pk_f16_f32 v151, v182, v183
fused_kernel_b2_pk5:
  s_add_u32 s8, s38, 0
  s_addc_u32 s9, s39, 0
  s_mov_b32 s10, 589824
  s_mov_b32 s11, 0x20000
  s_lshl_b32 s3, s42, 10
  buffer_store_dwordx4 v[148:151], v2, s[8:11], s3 offen sc1
  s_nop 1
fused_kernel_nops:
  ds_read_u16 v144, v232 offset:4016
  ds_read_u16 v145, v232 offset:4416
  ds_read_u16 v146, v232 offset:4816
  ds_read_u16 v147, v232 offset:5216
  ds_read_u16 v148, v232 offset:5616
  ds_read_u16 v149, v232 offset:6016
  ds_read_u16 v150, v232 offset:6416
  ds_read_u16 v151, v232 offset:6816
  ds_read_u16 v152, v232 offset:7632
  ds_read_u16 v153, v232 offset:8032
  ds_read_u16 v154, v232 offset:8432
  ds_read_u16 v155, v232 offset:8832
  ds_read_u16 v156, v232 offset:9232
  ds_read_u16 v157, v232 offset:9632
  ds_read_u16 v158, v232 offset:10032
  ds_read_u16 v159, v232 offset:10432
  ds_read_u16 v160, v232 offset:11248
  ds_read_u16 v161, v232 offset:11648
  ds_read_u16 v162, v232 offset:12048
  ds_read_u16 v163, v232 offset:12448
  ds_read_u16 v164, v232 offset:12848
  ds_read_u16 v165, v232 offset:13248
  ds_read_u16 v166, v232 offset:13648
  ds_read_u16 v167, v232 offset:14048
  ds_read_u16 v168, v232 offset:14864
  ds_read_u16 v169, v232 offset:15264
  ds_read_u16 v170, v232 offset:15664
  ds_read_u16 v171, v232 offset:16064
  ds_read_u16 v172, v232 offset:16464
  ds_read_u16 v173, v232 offset:16864
  ds_read_u16 v174, v232 offset:17264
  ds_read_u16 v175, v232 offset:17664
  ds_read_u16 v176, v232 offset:18480
  ds_read_u16 v177, v232 offset:18880
  ds_read_u16 v178, v232 offset:19280
  ds_read_u16 v179, v232 offset:19680
  ds_read_u16 v180, v232 offset:20080
  ds_read_u16 v181, v232 offset:20480
  ds_read_u16 v182, v232 offset:20880
  ds_read_u16 v183, v232 offset:21280
  ds_read_u16 v184, v232 offset:22096
  ds_read_u16 v185, v232 offset:22496
  ds_read_u16 v186, v232 offset:22896
  ds_read_u16 v187, v232 offset:23296
  ds_read_u16 v188, v232 offset:23696
  ds_read_u16 v189, v232 offset:24096
  ds_read_u16 v190, v232 offset:24496
  ds_read_u16 v191, v232 offset:24896
  ds_read_u16 v192, v232 offset:25712
  ds_read_u16 v193, v232 offset:26112
  ds_read_u16 v194, v232 offset:26512
  ds_read_u16 v195, v232 offset:26912
  ds_read_u16 v196, v232 offset:27312
  ds_read_u16 v197, v232 offset:27712
  ds_read_u16 v198, v232 offset:28112
  ds_read_u16 v199, v232 offset:28512
  ds_read_u16 v200, v232 offset:29328
  ds_read_u16 v201, v232 offset:29728
  ds_read_u16 v202, v232 offset:30128
  ds_read_u16 v203, v232 offset:30528
  ds_read_u16 v204, v232 offset:30928
  ds_read_u16 v205, v232 offset:31328
  ds_read_u16 v206, v232 offset:31728
  ds_read_u16 v207, v232 offset:32128
  s_waitcnt lgkmcnt(15)
  v_lshl_or_b32 v144, v145, 16, v144
  v_accvgpr_write_b32 a144, v144
  v_lshl_or_b32 v146, v147, 16, v146
  v_accvgpr_write_b32 a146, v146
  v_lshl_or_b32 v148, v149, 16, v148
  v_accvgpr_write_b32 a148, v148
  v_lshl_or_b32 v150, v151, 16, v150
  v_accvgpr_write_b32 a150, v150
  v_lshl_or_b32 v152, v153, 16, v152
  v_accvgpr_write_b32 a145, v152
  v_lshl_or_b32 v154, v155, 16, v154
  v_accvgpr_write_b32 a147, v154
  v_lshl_or_b32 v156, v157, 16, v156
  v_accvgpr_write_b32 a149, v156
  v_lshl_or_b32 v158, v159, 16, v158
  v_accvgpr_write_b32 a151, v158
  s_waitcnt lgkmcnt(15)
  v_lshl_or_b32 v160, v161, 16, v160
  v_accvgpr_write_b32 a152, v160
  v_lshl_or_b32 v162, v163, 16, v162
  v_accvgpr_write_b32 a154, v162
  v_lshl_or_b32 v164, v165, 16, v164
  v_accvgpr_write_b32 a156, v164
  v_lshl_or_b32 v166, v167, 16, v166
  v_accvgpr_write_b32 a158, v166
  v_lshl_or_b32 v168, v169, 16, v168
  v_accvgpr_write_b32 a153, v168
  v_lshl_or_b32 v170, v171, 16, v170
  v_accvgpr_write_b32 a155, v170
  v_lshl_or_b32 v172, v173, 16, v172
  v_accvgpr_write_b32 a157, v172
  v_lshl_or_b32 v174, v175, 16, v174
  v_accvgpr_write_b32 a159, v174
  s_waitcnt lgkmcnt(0)
  v_lshl_or_b32 v176, v177, 16, v176
  v_accvgpr_write_b32 a160, v176
  v_lshl_or_b32 v178, v179, 16, v178
  v_accvgpr_write_b32 a162, v178
  v_lshl_or_b32 v180, v181, 16, v180
  v_accvgpr_write_b32 a164, v180
  v_lshl_or_b32 v182, v183, 16, v182
  v_accvgpr_write_b32 a166, v182
  v_lshl_or_b32 v184, v185, 16, v184
  v_accvgpr_write_b32 a161, v184
  v_lshl_or_b32 v186, v187, 16, v186
  v_accvgpr_write_b32 a163, v186
  v_lshl_or_b32 v188, v189, 16, v188
  v_accvgpr_write_b32 a165, v188
  v_lshl_or_b32 v190, v191, 16, v190
  v_accvgpr_write_b32 a167, v190
  v_lshl_or_b32 v192, v193, 16, v192
  v_accvgpr_write_b32 a168, v192
  v_lshl_or_b32 v194, v195, 16, v194
  v_accvgpr_write_b32 a170, v194
  v_lshl_or_b32 v196, v197, 16, v196
  v_accvgpr_write_b32 a172, v196
  v_lshl_or_b32 v198, v199, 16, v198
  v_accvgpr_write_b32 a174, v198
  v_lshl_or_b32 v200, v201, 16, v200
  v_accvgpr_write_b32 a169, v200
  v_lshl_or_b32 v202, v203, 16, v202
  v_accvgpr_write_b32 a171, v202
  v_lshl_or_b32 v204, v205, 16, v204
  v_accvgpr_write_b32 a173, v204
  v_lshl_or_b32 v206, v207, 16, v206
  v_accvgpr_write_b32 a175, v206
  ds_read_u16 v144, v232 offset:4144
  ds_read_u16 v145, v232 offset:4544
  ds_read_u16 v146, v232 offset:4944
  ds_read_u16 v147, v232 offset:5344
  ds_read_u16 v148, v232 offset:5744
  ds_read_u16 v149, v232 offset:6144
  ds_read_u16 v150, v232 offset:6544
  ds_read_u16 v151, v232 offset:6944
  ds_read_u16 v152, v232 offset:7760
  ds_read_u16 v153, v232 offset:8160
  ds_read_u16 v154, v232 offset:8560
  ds_read_u16 v155, v232 offset:8960
  ds_read_u16 v156, v232 offset:9360
  ds_read_u16 v157, v232 offset:9760
  ds_read_u16 v158, v232 offset:10160
  ds_read_u16 v159, v232 offset:10560
  ds_read_u16 v160, v232 offset:11376
  ds_read_u16 v161, v232 offset:11776
  ds_read_u16 v162, v232 offset:12176
  ds_read_u16 v163, v232 offset:12576
  ds_read_u16 v164, v232 offset:12976
  ds_read_u16 v165, v232 offset:13376
  ds_read_u16 v166, v232 offset:13776
  ds_read_u16 v167, v232 offset:14176
  ds_read_u16 v168, v232 offset:14992
  ds_read_u16 v169, v232 offset:15392
  ds_read_u16 v170, v232 offset:15792
  ds_read_u16 v171, v232 offset:16192
  ds_read_u16 v172, v232 offset:16592
  ds_read_u16 v173, v232 offset:16992
  ds_read_u16 v174, v232 offset:17392
  ds_read_u16 v175, v232 offset:17792
  ds_read_u16 v176, v232 offset:18608
  ds_read_u16 v177, v232 offset:19008
  ds_read_u16 v178, v232 offset:19408
  ds_read_u16 v179, v232 offset:19808
  ds_read_u16 v180, v232 offset:20208
  ds_read_u16 v181, v232 offset:20608
  ds_read_u16 v182, v232 offset:21008
  ds_read_u16 v183, v232 offset:21408
  ds_read_u16 v184, v232 offset:22224
  ds_read_u16 v185, v232 offset:22624
  ds_read_u16 v186, v232 offset:23024
  ds_read_u16 v187, v232 offset:23424
  ds_read_u16 v188, v232 offset:23824
  ds_read_u16 v189, v232 offset:24224
  ds_read_u16 v190, v232 offset:24624
  ds_read_u16 v191, v232 offset:25024
  ds_read_u16 v192, v232 offset:25840
  ds_read_u16 v193, v232 offset:26240
  ds_read_u16 v194, v232 offset:26640
  ds_read_u16 v195, v232 offset:27040
  ds_read_u16 v196, v232 offset:27440
  ds_read_u16 v197, v232 offset:27840
  ds_read_u16 v198, v232 offset:28240
  ds_read_u16 v199, v232 offset:28640
  ds_read_u16 v200, v232 offset:29456
  ds_read_u16 v201, v232 offset:29856
  ds_read_u16 v202, v232 offset:30256
  ds_read_u16 v203, v232 offset:30656
  ds_read_u16 v204, v232 offset:31056
  ds_read_u16 v205, v232 offset:31456
  ds_read_u16 v206, v232 offset:31856
  ds_read_u16 v207, v232 offset:32256
  s_waitcnt lgkmcnt(15)
  v_lshl_or_b32 v144, v145, 16, v144
  v_accvgpr_write_b32 a176, v144
  v_lshl_or_b32 v146, v147, 16, v146
  v_accvgpr_write_b32 a178, v146
  v_lshl_or_b32 v148, v149, 16, v148
  v_accvgpr_write_b32 a180, v148
  v_lshl_or_b32 v150, v151, 16, v150
  v_accvgpr_write_b32 a182, v150
  v_lshl_or_b32 v152, v153, 16, v152
  v_accvgpr_write_b32 a177, v152
  v_lshl_or_b32 v154, v155, 16, v154
  v_accvgpr_write_b32 a179, v154
  v_lshl_or_b32 v156, v157, 16, v156
  v_accvgpr_write_b32 a181, v156
  v_lshl_or_b32 v158, v159, 16, v158
  v_accvgpr_write_b32 a183, v158
  s_waitcnt lgkmcnt(15)
  v_lshl_or_b32 v160, v161, 16, v160
  v_accvgpr_write_b32 a184, v160
  v_lshl_or_b32 v162, v163, 16, v162
  v_accvgpr_write_b32 a186, v162
  v_lshl_or_b32 v164, v165, 16, v164
  v_accvgpr_write_b32 a188, v164
  v_lshl_or_b32 v166, v167, 16, v166
  v_accvgpr_write_b32 a190, v166
  v_lshl_or_b32 v168, v169, 16, v168
  v_accvgpr_write_b32 a185, v168
  v_lshl_or_b32 v170, v171, 16, v170
  v_accvgpr_write_b32 a187, v170
  v_lshl_or_b32 v172, v173, 16, v172
  v_accvgpr_write_b32 a189, v172
  v_lshl_or_b32 v174, v175, 16, v174
  v_accvgpr_write_b32 a191, v174
  s_waitcnt lgkmcnt(0)
  v_lshl_or_b32 v176, v177, 16, v176
  v_accvgpr_write_b32 a192, v176
  v_lshl_or_b32 v178, v179, 16, v178
  v_accvgpr_write_b32 a194, v178
  v_lshl_or_b32 v180, v181, 16, v180
  v_accvgpr_write_b32 a196, v180
  v_lshl_or_b32 v182, v183, 16, v182
  v_accvgpr_write_b32 a198, v182
  v_lshl_or_b32 v184, v185, 16, v184
  v_accvgpr_write_b32 a193, v184
  v_lshl_or_b32 v186, v187, 16, v186
  v_accvgpr_write_b32 a195, v186
  v_lshl_or_b32 v188, v189, 16, v188
  v_accvgpr_write_b32 a197, v188
  v_lshl_or_b32 v190, v191, 16, v190
  v_accvgpr_write_b32 a199, v190
  v_lshl_or_b32 v192, v193, 16, v192
  v_accvgpr_write_b32 a200, v192
  v_lshl_or_b32 v194, v195, 16, v194
  v_accvgpr_write_b32 a202, v194
  v_lshl_or_b32 v196, v197, 16, v196
  v_accvgpr_write_b32 a204, v196
  v_lshl_or_b32 v198, v199, 16, v198
  v_accvgpr_write_b32 a206, v198
  v_lshl_or_b32 v200, v201, 16, v200
  v_accvgpr_write_b32 a201, v200
  v_lshl_or_b32 v202, v203, 16, v202
  v_accvgpr_write_b32 a203, v202
  v_lshl_or_b32 v204, v205, 16, v204
  v_accvgpr_write_b32 a205, v204
  v_lshl_or_b32 v206, v207, 16, v206
  v_accvgpr_write_b32 a207, v206
  ds_read_u16 v144, v232 offset:4272
  ds_read_u16 v145, v232 offset:4672
  ds_read_u16 v146, v232 offset:5072
  ds_read_u16 v147, v232 offset:5472
  ds_read_u16 v148, v232 offset:5872
  ds_read_u16 v149, v232 offset:6272
  ds_read_u16 v150, v232 offset:6672
  ds_read_u16 v151, v232 offset:7072
  ds_read_u16 v152, v232 offset:7888
  ds_read_u16 v153, v232 offset:8288
  ds_read_u16 v154, v232 offset:8688
  ds_read_u16 v155, v232 offset:9088
  ds_read_u16 v156, v232 offset:9488
  ds_read_u16 v157, v232 offset:9888
  ds_read_u16 v158, v232 offset:10288
  ds_read_u16 v159, v232 offset:10688
  ds_read_u16 v160, v232 offset:11504
  ds_read_u16 v161, v232 offset:11904
  ds_read_u16 v162, v232 offset:12304
  ds_read_u16 v163, v232 offset:12704
  ds_read_u16 v164, v232 offset:13104
  ds_read_u16 v165, v232 offset:13504
  ds_read_u16 v166, v232 offset:13904
  ds_read_u16 v167, v232 offset:14304
  ds_read_u16 v168, v232 offset:15120
  ds_read_u16 v169, v232 offset:15520
  ds_read_u16 v170, v232 offset:15920
  ds_read_u16 v171, v232 offset:16320
  ds_read_u16 v172, v232 offset:16720
  ds_read_u16 v173, v232 offset:17120
  ds_read_u16 v174, v232 offset:17520
  ds_read_u16 v175, v232 offset:17920
  ds_read_u16 v176, v232 offset:18736
  ds_read_u16 v177, v232 offset:19136
  ds_read_u16 v178, v232 offset:19536
  ds_read_u16 v179, v232 offset:19936
  ds_read_u16 v180, v232 offset:20336
  ds_read_u16 v181, v232 offset:20736
  ds_read_u16 v182, v232 offset:21136
  ds_read_u16 v183, v232 offset:21536
  ds_read_u16 v184, v232 offset:22352
  ds_read_u16 v185, v232 offset:22752
  ds_read_u16 v186, v232 offset:23152
  ds_read_u16 v187, v232 offset:23552
  ds_read_u16 v188, v232 offset:23952
  ds_read_u16 v189, v232 offset:24352
  ds_read_u16 v190, v232 offset:24752
  ds_read_u16 v191, v232 offset:25152
  ds_read_u16 v192, v232 offset:25968
  ds_read_u16 v193, v232 offset:26368
  ds_read_u16 v194, v232 offset:26768
  ds_read_u16 v195, v232 offset:27168
  ds_read_u16 v196, v232 offset:27568
  ds_read_u16 v197, v232 offset:27968
  ds_read_u16 v198, v232 offset:28368
  ds_read_u16 v199, v232 offset:28768
  ds_read_u16 v200, v232 offset:29584
  ds_read_u16 v201, v232 offset:29984
  ds_read_u16 v202, v232 offset:30384
  ds_read_u16 v203, v232 offset:30784
  ds_read_u16 v204, v232 offset:31184
  ds_read_u16 v205, v232 offset:31584
  ds_read_u16 v206, v232 offset:31984
  ds_read_u16 v207, v232 offset:32384
  s_waitcnt lgkmcnt(15)
  v_lshl_or_b32 v144, v145, 16, v144
  v_accvgpr_write_b32 a208, v144
  v_lshl_or_b32 v146, v147, 16, v146
  v_accvgpr_write_b32 a210, v146
  v_lshl_or_b32 v148, v149, 16, v148
  v_accvgpr_write_b32 a212, v148
  v_lshl_or_b32 v150, v151, 16, v150
  v_accvgpr_write_b32 a214, v150
  v_lshl_or_b32 v152, v153, 16, v152
  v_accvgpr_write_b32 a209, v152
  v_lshl_or_b32 v154, v155, 16, v154
  v_accvgpr_write_b32 a211, v154
  v_lshl_or_b32 v156, v157, 16, v156
  v_accvgpr_write_b32 a213, v156
  v_lshl_or_b32 v158, v159, 16, v158
  v_accvgpr_write_b32 a215, v158
  s_waitcnt lgkmcnt(15)
  v_lshl_or_b32 v160, v161, 16, v160
  v_accvgpr_write_b32 a216, v160
  v_lshl_or_b32 v162, v163, 16, v162
  v_accvgpr_write_b32 a218, v162
  v_lshl_or_b32 v164, v165, 16, v164
  v_accvgpr_write_b32 a220, v164
  v_lshl_or_b32 v166, v167, 16, v166
  v_accvgpr_write_b32 a222, v166
  v_lshl_or_b32 v168, v169, 16, v168
  v_accvgpr_write_b32 a217, v168
  v_lshl_or_b32 v170, v171, 16, v170
  v_accvgpr_write_b32 a219, v170
  v_lshl_or_b32 v172, v173, 16, v172
  v_accvgpr_write_b32 a221, v172
  v_lshl_or_b32 v174, v175, 16, v174
  v_accvgpr_write_b32 a223, v174
  s_waitcnt lgkmcnt(0)
  v_lshl_or_b32 v176, v177, 16, v176
  v_accvgpr_write_b32 a224, v176
  v_lshl_or_b32 v178, v179, 16, v178
  v_accvgpr_write_b32 a226, v178
  v_lshl_or_b32 v180, v181, 16, v180
  v_accvgpr_write_b32 a228, v180
  v_lshl_or_b32 v182, v183, 16, v182
  v_accvgpr_write_b32 a230, v182
  v_lshl_or_b32 v184, v185, 16, v184
  v_accvgpr_write_b32 a225, v184
  v_lshl_or_b32 v186, v187, 16, v186
  v_accvgpr_write_b32 a227, v186
  v_lshl_or_b32 v188, v189, 16, v188
  v_accvgpr_write_b32 a229, v188
  v_lshl_or_b32 v190, v191, 16, v190
  v_accvgpr_write_b32 a231, v190
  v_lshl_or_b32 v192, v193, 16, v192
  v_accvgpr_write_b32 a232, v192
  v_lshl_or_b32 v194, v195, 16, v194
  v_accvgpr_write_b32 a234, v194
  v_lshl_or_b32 v196, v197, 16, v196
  v_accvgpr_write_b32 a236, v196
  v_lshl_or_b32 v198, v199, 16, v198
  v_accvgpr_write_b32 a238, v198
  v_lshl_or_b32 v200, v201, 16, v200
  v_accvgpr_write_b32 a233, v200
  v_lshl_or_b32 v202, v203, 16, v202
  v_accvgpr_write_b32 a235, v202
  v_lshl_or_b32 v204, v205, 16, v204
  v_accvgpr_write_b32 a237, v204
  v_lshl_or_b32 v206, v207, 16, v206
  v_accvgpr_write_b32 a239, v206
  s_waitcnt vmcnt(0)
  v_add_u32 v8, 53856, v8
  v_add_u32 v9, 53856, v9
  v_add_u32 v10, 53856, v10
  v_xad_u32 v14, v0, 0, v8
  v_perm_b32 v136, v20, v16, s33
  v_perm_b32 v137, v28, v24, s33
  v_perm_b32 v138, v20, v16, s41
  v_perm_b32 v139, v28, v24, s41
  ds_write_b128 v14, v[136:139] offset:0
  v_xad_u32 v14, v0, 16, v8
  v_perm_b32 v136, v21, v17, s33
  v_perm_b32 v137, v29, v25, s33
  v_perm_b32 v138, v21, v17, s41
  v_perm_b32 v139, v29, v25, s41
  ds_write_b128 v14, v[136:139] offset:128
  v_xad_u32 v14, v0, 32, v8
  v_perm_b32 v136, v22, v18, s33
  v_perm_b32 v137, v30, v26, s33
  v_perm_b32 v138, v22, v18, s41
  v_perm_b32 v139, v30, v26, s41
  ds_write_b128 v14, v[136:139] offset:256
  v_xad_u32 v14, v0, 48, v8
  v_perm_b32 v136, v23, v19, s33
  v_perm_b32 v137, v31, v27, s33
  v_perm_b32 v138, v23, v19, s41
  v_perm_b32 v139, v31, v27, s41
  ds_write_b128 v14, v[136:139] offset:384
  v_xad_u32 v14, v0, 0, v8
  v_perm_b32 v136, v36, v32, s33
  v_perm_b32 v137, v44, v40, s33
  v_perm_b32 v138, v36, v32, s41
  v_perm_b32 v139, v44, v40, s41
  ds_write_b128 v14, v[136:139] offset:17408
  v_xad_u32 v14, v0, 16, v8
  v_perm_b32 v136, v37, v33, s33
  v_perm_b32 v137, v45, v41, s33
  v_perm_b32 v138, v37, v33, s41
  v_perm_b32 v139, v45, v41, s41
  ds_write_b128 v14, v[136:139] offset:17536
  v_xad_u32 v14, v0, 32, v8
  v_perm_b32 v136, v38, v34, s33
  v_perm_b32 v137, v46, v42, s33
  v_perm_b32 v138, v38, v34, s41
  v_perm_b32 v139, v46, v42, s41
  ds_write_b128 v14, v[136:139] offset:17664
  v_xad_u32 v14, v0, 48, v8
  v_perm_b32 v136, v39, v35, s33
  v_perm_b32 v137, v47, v43, s33
  v_perm_b32 v138, v39, v35, s41
  v_perm_b32 v139, v47, v43, s41
  ds_write_b128 v14, v[136:139] offset:17792
  v_xad_u32 v14, v0, 0, v8
  v_perm_b32 v136, v52, v48, s33
  v_perm_b32 v137, v60, v56, s33
  v_perm_b32 v138, v52, v48, s41
  v_perm_b32 v139, v60, v56, s41
  ds_write_b128 v14, v[136:139] offset:34816
  v_xad_u32 v14, v0, 16, v8
  v_perm_b32 v136, v53, v49, s33
  v_perm_b32 v137, v61, v57, s33
  v_perm_b32 v138, v53, v49, s41
  v_perm_b32 v139, v61, v57, s41
  ds_write_b128 v14, v[136:139] offset:34944
  v_xad_u32 v14, v0, 32, v8
  v_perm_b32 v136, v54, v50, s33
  v_perm_b32 v137, v62, v58, s33
  v_perm_b32 v138, v54, v50, s41
  v_perm_b32 v139, v62, v58, s41
  ds_write_b128 v14, v[136:139] offset:35072
  v_xad_u32 v14, v0, 48, v8
  v_perm_b32 v136, v55, v51, s33
  v_perm_b32 v137, v63, v59, s33
  v_perm_b32 v138, v55, v51, s41
  v_perm_b32 v139, v63, v59, s41
  ds_write_b128 v14, v[136:139] offset:35200
  v_perm_b32 v136, v65, v64, s33
  v_perm_b32 v137, v67, v66, s33
  v_perm_b32 v138, v65, v64, s41
  v_perm_b32 v139, v67, v66, s41
  s_mov_b64 exec, s[100:101]
  ds_write_b128 v9, v[136:139]
  s_mov_b64 exec, -1
  s_mov_b32 s31, 0x70000000
  buffer_load_dwordx4 v[16:19], v216, s[16:19], 0 offen offset:128
  buffer_load_dwordx4 v[20:23], v217, s[16:19], 0 offen offset:128
  buffer_load_dwordx4 v[24:27], v218, s[16:19], 0 offen offset:128
  buffer_load_dwordx4 v[28:31], v219, s[16:19], 0 offen offset:128
  buffer_load_dwordx4 v[32:35], v220, s[16:19], 0 offen offset:128
  buffer_load_dwordx4 v[36:39], v221, s[16:19], 0 offen offset:128
  buffer_load_dwordx4 v[40:43], v222, s[16:19], 0 offen offset:128
  buffer_load_dwordx4 v[44:47], v223, s[16:19], 0 offen offset:128
  buffer_load_dwordx4 v[48:51], v224, s[16:19], 0 offen offset:128
  buffer_load_dwordx4 v[52:55], v225, s[16:19], 0 offen offset:128
  buffer_load_dwordx4 v[56:59], v226, s[16:19], 0 offen offset:128
  buffer_load_dwordx4 v[60:63], v227, s[16:19], 0 offen offset:128
  buffer_load_dword v64, v228, s[16:19], 0 offen offset:128
  buffer_load_dword v65, v229, s[16:19], 0 offen offset:128
  buffer_load_dword v66, v230, s[16:19], 0 offen offset:128
  buffer_load_dword v67, v231, s[16:19], 0 offen offset:128
  v_subrev_u32 v8, 53856, v8
  v_subrev_u32 v9, 53856, v9
  s_mov_b32 s34, 4294913440
  s_mov_b32 s35, 24576
  s_mov_b32 s97, 24576
  s_waitcnt lgkmcnt(0)
  s_barrier
  s_cmp_eq_u32 s42, -1
  s_cbranch_scc1 fused_kernel_nopub
  s_cmp_eq_u32 s40, 0
  s_cbranch_scc0 fused_kernel_nopub
  v_mov_b32 v15, 1
  s_mov_b32 exec_lo, 1
  s_mov_b32 exec_hi, 0
  global_atomic_add v3, v15, s[4:5]
  s_mov_b64 exec, -1
fused_kernel_nopub:
  s_mov_b32 s37, 0
.p2align 6
fused_kernel_tile:
  ds_read_b64 v[80:81], v10 offset:0
  ds_read_b64 v[82:83], v10 offset:544
  ds_read_b64 v[84:85], v10 offset:1088
  ds_read_b64 v[86:87], v10 offset:1632
  ds_read_b64 v[88:89], v10 offset:2176
  ds_read_b64 v[90:91], v10 offset:5984
  ds_read_b64 v[92:93], v10 offset:6528
  ds_read_b64 v[94:95], v10 offset:7072
  ds_read_b64 v[96:97], v10 offset:7616
  ds_read_b64 v[98:99], v10 offset:8160
  ds_read_b64 v[100:101], v10 offset:11968
  ds_read_b64 v[102:103], v10 offset:12512
  ds_read_b64 v[104:105], v10 offset:13056
  ds_read_b64 v[106:107], v10 offset:13600
  ds_read_b64 v[108:109], v10 offset:14144
  ds_read_b64 v[110:111], v10 offset:17952
  ds_read_b64 v[112:113], v10 offset:18496
  ds_read_b64 v[114:115], v10 offset:19040
  ds_read_b64 v[116:117], v10 offset:19584
  ds_read_b64 v[118:119], v10 offset:20128
  s_waitcnt vmcnt(12)
  v_xad_u32 v14, v0, 0, v8
  v_perm_b32 v136, v20, v16, s33
  v_perm_b32 v137, v28, v24, s33
  v_perm_b32 v138, v20, v16, s41
  v_perm_b32 v139, v28, v24, s41
  ds_write_b128 v14, v[136:139] offset:0
  s_waitcnt lgkmcnt(15)
  v_mfma_f32_4x4x4_16b_bf16 v[120:123], a[144:145], v[80:81], 0
  v_mfma_f32_4x4x4_16b_bf16 v[124:127], a[144:145], v[82:83], 0
  s_nop 0
  v_mfma_f32_4x4x4_16b_bf16 v[120:123], a[146:147], v[82:83], v[120:123]
  v_mfma_f32_4x4x4_16b_bf16 v[124:127], a[146:147], v[84:85], v[124:127]
  s_nop 0
  v_mfma_f32_4x4x4_16b_bf16 v[120:123], a[148:149], v[84:85], v[120:123]
  v_mfma_f32_4x4x4_16b_bf16 v[124:127], a[148:149], v[86:87], v[124:127]
  s_nop 0
  v_mfma_f32_4x4x4_16b_bf16 v[120:123], a[150:151], v[86:87], v[120:123]
  v_mfma_f32_4x4x4_16b_bf16 v[124:127], a[150:151], v[88:89], v[124:127]
  s_waitcnt lgkmcnt(11)
  v_mfma_f32_4x4x4_16b_bf16 v[120:123], a[152:153], v[90:91], v[120:123]
  v_xad_u32 v14, v0, 16, v8
  v_mfma_f32_4x4x4_16b_bf16 v[124:127], a[152:153], v[92:93], v[124:127]
  v_perm_b32 v136, v21, v17, s33
  v_mfma_f32_4x4x4_16b_bf16 v[120:123], a[154:155], v[92:93], v[120:123]
  v_perm_b32 v137, v29, v25, s33
  v_mfma_f32_4x4x4_16b_bf16 v[124:127], a[154:155], v[94:95], v[124:127]
  v_perm_b32 v138, v21, v17, s41
  v_mfma_f32_4x4x4_16b_bf16 v[120:123], a[156:157], v[94:95], v[120:123]
  v_perm_b32 v139, v29, v25, s41
  v_mfma_f32_4x4x4_16b_bf16 v[124:127], a[156:157], v[96:97], v[124:127]
  ds_write_b128 v14, v[136:139] offset:128
  v_mfma_f32_4x4x4_16b_bf16 v[120:123], a[158:159], v[96:97], v[120:123]
  ds_read_b64 v[80:81], v10 offset:23936
  v_mfma_f32_4x4x4_16b_bf16 v[124:127], a[158:159], v[98:99], v[124:127]
  s_waitcnt lgkmcnt(8)
  v_mfma_f32_4x4x4_16b_bf16 v[120:123], a[160:161], v[100:101], v[120:123]
  ds_read_b64 v[82:83], v10 offset:24480
  v_mfma_f32_4x4x4_16b_bf16 v[124:127], a[160:161], v[102:103], v[124:127]
  v_mfma_f32_4x4x4_16b_bf16 v[120:123], a[162:163], v[102:103], v[120:123]
  ds_read_b64 v[84:85], v10 offset:25024
  v_mfma_f32_4x4x4_16b_bf16 v[124:127], a[162:163], v[104:105], v[124:127]
  v_mfma_f32_4x4x4_16b_bf16 v[120:123], a[164:165], v[104:105], v[120:123]
  ds_read_b64 v[86:87], v10 offset:25568
  v_mfma_f32_4x4x4_16b_bf16 v[124:127], a[164:165], v[106:107], v[124:127]
  v_mfma_f32_4x4x4_16b_bf16 v[120:123], a[166:167], v[106:107], v[120:123]
  ds_read_b64 v[88:89], v10 offset:26112
  v_mfma_f32_4x4x4_16b_bf16 v[124:127], a[166:167], v[108:109], v[124:127]
  s_waitcnt lgkmcnt(7)
  v_mfma_f32_4x4x4_16b_bf16 v[120:123], a[168:169], v[110:111], v[120:123]
  v_xad_u32 v14, v0, 32, v8
  v_mfma_f32_4x4x4_16b_bf16 v[124:127], a[168:169], v[112:113], v[124:127]
  v_perm_b32 v136, v22, v18, s33
  v_mfma_f32_4x4x4_16b_bf16 v[120:123], a[170:171], v[112:113], v[120:123]
  v_perm_b32 v137, v30, v26, s33
  v_mfma_f32_4x4x4_16b_bf16 v[124:127], a[170:171], v[114:115], v[124:127]
  v_perm_b32 v138, v22, v18, s41
  v_mfma_f32_4x4x4_16b_bf16 v[120:123], a[172:173], v[114:115], v[120:123]
  v_perm_b32 v139, v30, v26, s41
  v_mfma_f32_4x4x4_16b_bf16 v[124:127], a[172:173], v[116:117], v[124:127]
  ds_write_b128 v14, v[136:139] offset:256
  v_mfma_f32_4x4x4_16b_bf16 v[120:123], a[174:175], v[116:117], v[120:123]
  v_mfma_f32_4x4x4_16b_bf16 v[124:127], a[174:175], v[118:119], v[124:127]
  v_mfma_f32_4x4x4_16b_bf16 v[128:131], a[144:145], v[90:91], 0
  v_mfma_f32_4x4x4_16b_bf16 v[132:135], a[144:145], v[92:93], 0
  s_nop 0
  v_mfma_f32_4x4x4_16b_bf16 v[128:131], a[146:147], v[92:93], v[128:131]
  v_mfma_f32_4x4x4_16b_bf16 v[132:135], a[146:147], v[94:95], v[132:135]
  s_nop 0
  v_mfma_f32_4x4x4_16b_bf16 v[128:131], a[148:149], v[94:95], v[128:131]
  v_cvt_pk_bf16_f32 v140, v120, v121
  v_mfma_f32_4x4x4_16b_bf16 v[132:135], a[148:149], v[96:97], v[132:135]
  v_cvt_pk_bf16_f32 v141, v124, v125
  v_mfma_f32_4x4x4_16b_bf16 v[128:131], a[150:151], v[96:97], v[128:131]
  v_xad_u32 v14, v0, 48, v8
  v_mfma_f32_4x4x4_16b_bf16 v[132:135], a[150:151], v[98:99], v[132:135]
  v_perm_b32 v136, v23, v19, s33
  v_mfma_f32_4x4x4_16b_bf16 v[128:131], a[152:153], v[100:101], v[128:131]
  v_perm_b32 v137, v31, v27, s33
  v_mfma_f32_4x4x4_16b_bf16 v[132:135], a[152:153], v[102:103], v[132:135]
  v_perm_b32 v138, v23, v19, s41
  v_mfma_f32_4x4x4_16b_bf16 v[128:131], a[154:155], v[102:103], v[128:131]
  v_perm_b32 v139, v31, v27, s41
  v_mfma_f32_4x4x4_16b_bf16 v[132:135], a[154:155], v[104:105], v[132:135]
  ds_write_b128 v14, v[136:139] offset:384
  v_mfma_f32_4x4x4_16b_bf16 v[128:131], a[156:157], v[104:105], v[128:131]
  ds_write_b64 v11, v[140:141] offset:0
  v_mfma_f32_4x4x4_16b_bf16 v[132:135], a[156:157], v[106:107], v[132:135]
  v_cvt_pk_bf16_f32 v142, v122, v123
  v_mfma_f32_4x4x4_16b_bf16 v[128:131], a[158:159], v[106:107], v[128:131]
  v_cvt_pk_bf16_f32 v143, v126, v127
  v_mfma_f32_4x4x4_16b_bf16 v[132:135], a[158:159], v[108:109], v[132:135]
  ds_write_b64 v11, v[142:143] offset:2048
  v_mfma_f32_4x4x4_16b_bf16 v[128:131], a[160:161], v[110:111], v[128:131]
  buffer_load_dwordx4 v[16:19], v216, s[16:19], 0 offen offset:256
  v_mfma_f32_4x4x4_16b_bf16 v[132:135], a[160:161], v[112:113], v[132:135]
  ds_read_b64 v[90:91], v10 offset:29920
  v_mfma_f32_4x4x4_16b_bf16 v[128:131], a[162:163], v[112:113], v[128:131]
  ds_read_b64 v[92:93], v10 offset:30464
  v_mfma_f32_4x4x4_16b_bf16 v[132:135], a[162:163], v[114:115], v[132:135]
  buffer_load_dwordx4 v[20:23], v217, s[16:19], 0 offen offset:256
  v_mfma_f32_4x4x4_16b_bf16 v[128:131], a[164:165], v[114:115], v[128:131]
  ds_read_b64 v[94:95], v10 offset:31008
  v_mfma_f32_4x4x4_16b_bf16 v[132:135], a[164:165], v[116:117], v[132:135]
  ds_read_b64 v[96:97], v10 offset:31552
  v_mfma_f32_4x4x4_16b_bf16 v[128:131], a[166:167], v[116:117], v[128:131]
  buffer_load_dwordx4 v[24:27], v218, s[16:19], 0 offen offset:256
  v_mfma_f32_4x4x4_16b_bf16 v[132:135], a[166:167], v[118:119], v[132:135]
  ds_read_b64 v[98:99], v10 offset:32096
  s_waitcnt lgkmcnt(9)
  v_mfma_f32_4x4x4_16b_bf16 v[128:131], a[168:169], v[80:81], v[128:131]
  buffer_load_dwordx4 v[28:31], v219, s[16:19], 0 offen offset:256
  v_mfma_f32_4x4x4_16b_bf16 v[132:135], a[168:169], v[82:83], v[132:135]
  v_mfma_f32_4x4x4_16b_bf16 v[128:131], a[170:171], v[82:83], v[128:131]
  s_nop 0
  v_mfma_f32_4x4x4_16b_bf16 v[132:135], a[170:171], v[84:85], v[132:135]
  v_mfma_f32_4x4x4_16b_bf16 v[128:131], a[172:173], v[84:85], v[128:131]
  s_waitcnt vmcnt(12)
  v_xad_u32 v14, v0, 0, v8
  v_mfma_f32_4x4x4_16b_bf16 v[132:135], a[172:173], v[86:87], v[132:135]
  v_perm_b32 v136, v36, v32, s33
  v_mfma_f32_4x4x4_16b_bf16 v[128:131], a[174:175], v[86:87], v[128:131]
  v_perm_b32 v137, v44, v40, s33
  v_mfma_f32_4x4x4_16b_bf16 v[132:135], a[174:175], v[88:89], v[132:135]
  v_perm_b32 v138, v36, v32, s41
  v_mfma_f32_4x4x4_16b_bf16 v[120:123], a[144:145], v[100:101], 0
  v_perm_b32 v139, v44, v40, s41
  v_mfma_f32_4x4x4_16b_bf16 v[124:127], a[144:145], v[102:103], 0
  ds_write_b128 v14, v[136:139] offset:17408
  v_mfma_f32_4x4x4_16b_bf16 v[120:123], a[146:147], v[102:103], v[120:123]
  v_mfma_f32_4x4x4_16b_bf16 v[124:127], a[146:147], v[104:105], v[124:127]
  s_nop 0
  v_mfma_f32_4x4x4_16b_bf16 v[120:123], a[148:149], v[104:105], v[120:123]
  v_cvt_pk_bf16_f32 v140, v128, v129
  v_mfma_f32_4x4x4_16b_bf16 v[124:127], a[148:149], v[106:107], v[124:127]
  v_cvt_pk_bf16_f32 v141, v132, v133
  v_mfma_f32_4x4x4_16b_bf16 v[120:123], a[150:151], v[106:107], v[120:123]
  ds_write_b64 v11, v[140:141] offset:4096
  v_mfma_f32_4x4x4_16b_bf16 v[124:127], a[150:151], v[108:109], v[124:127]
  v_mfma_f32_4x4x4_16b_bf16 v[120:123], a[152:153], v[110:111], v[120:123]
  v_cvt_pk_bf16_f32 v142, v130, v131
  v_mfma_f32_4x4x4_16b_bf16 v[124:127], a[152:153], v[112:113], v[124:127]
  v_cvt_pk_bf16_f32 v143, v134, v135
  v_mfma_f32_4x4x4_16b_bf16 v[120:123], a[154:155], v[112:113], v[120:123]
  v_xad_u32 v14, v0, 16, v8
  v_mfma_f32_4x4x4_16b_bf16 v[124:127], a[154:155], v[114:115], v[124:127]
  v_perm_b32 v136, v37, v33, s33
  v_mfma_f32_4x4x4_16b_bf16 v[120:123], a[156:157], v[114:115], v[120:123]
  v_perm_b32 v137, v45, v41, s33
  v_mfma_f32_4x4x4_16b_bf16 v[124:127], a[156:157], v[116:117], v[124:127]
  v_perm_b32 v138, v37, v33, s41
  v_mfma_f32_4x4x4_16b_bf16 v[120:123], a[158:159], v[116:117], v[120:123]
  v_perm_b32 v139, v45, v41, s41
  v_mfma_f32_4x4x4_16b_bf16 v[124:127], a[158:159], v[118:119], v[124:127]
  ds_write_b128 v14, v[136:139] offset:17536
  v_mfma_f32_4x4x4_16b_bf16 v[120:123], a[160:161], v[80:81], v[120:123]
  ds_write_b64 v11, v[142:143] offset:6144
  v_mfma_f32_4x4x4_16b_bf16 v[124:127], a[160:161], v[82:83], v[124:127]
  ds_read_b64 v[100:101], v10 offset:35904
  v_mfma_f32_4x4x4_16b_bf16 v[120:123], a[162:163], v[82:83], v[120:123]
  ds_read_b64 v[102:103], v10 offset:36448
  v_mfma_f32_4x4x4_16b_bf16 v[124:127], a[162:163], v[84:85], v[124:127]
  ds_read_b64 v[104:105], v10 offset:36992
  v_mfma_f32_4x4x4_16b_bf16 v[120:123], a[164:165], v[84:85], v[120:123]
  v_xad_u32 v14, v0, 32, v8
  v_mfma_f32_4x4x4_16b_bf16 v[124:127], a[164:165], v[86:87], v[124:127]
  v_perm_b32 v136, v38, v34, s33
  v_mfma_f32_4x4x4_16b_bf16 v[120:123], a[166:167], v[86:87], v[120:123]
  v_perm_b32 v137, v46, v42, s33
  v_mfma_f32_4x4x4_16b_bf16 v[124:127], a[166:167], v[88:89], v[124:127]
  v_perm_b32 v138, v38, v34, s41
  s_waitcnt lgkmcnt(7)
  v_mfma_f32_4x4x4_16b_bf16 v[120:123], a[168:169], v[90:91], v[120:123]
  v_perm_b32 v139, v46, v42, s41
  v_mfma_f32_4x4x4_16b_bf16 v[124:127], a[168:169], v[92:93], v[124:127]
  ds_write_b128 v14, v[136:139] offset:17664
  v_mfma_f32_4x4x4_16b_bf16 v[120:123], a[170:171], v[92:93], v[120:123]
  ds_read_b64 v[106:107], v10 offset:37536
  v_mfma_f32_4x4x4_16b_bf16 v[124:127], a[170:171], v[94:95], v[124:127]
  ds_read_b64 v[108:109], v10 offset:38080
  v_mfma_f32_4x4x4_16b_bf16 v[120:123], a[172:173], v[94:95], v[120:123]
  v_xad_u32 v14, v0, 48, v8
  v_mfma_f32_4x4x4_16b_bf16 v[124:127], a[172:173], v[96:97], v[124:127]
  v_perm_b32 v136, v39, v35, s33
  v_mfma_f32_4x4x4_16b_bf16 v[120:123], a[174:175], v[96:97], v[120:123]
  v_perm_b32 v137, v47, v43, s33
  v_mfma_f32_4x4x4_16b_bf16 v[124:127], a[174:175], v[98:99], v[124:127]
  v_perm_b32 v138, v39, v35, s41
  v_mfma_f32_4x4x4_16b_bf16 v[128:131], a[144:145], v[110:111], 0
  v_perm_b32 v139, v47, v43, s41
  v_mfma_f32_4x4x4_16b_bf16 v[132:135], a[144:145], v[112:113], 0
  ds_write_b128 v14, v[136:139] offset:17792
  v_mfma_f32_4x4x4_16b_bf16 v[128:131], a[146:147], v[112:113], v[128:131]
  v_mfma_f32_4x4x4_16b_bf16 v[132:135], a[146:147], v[114:115], v[132:135]
  s_nop 0
  v_mfma_f32_4x4x4_16b_bf16 v[128:131], a[148:149], v[114:115], v[128:131]
  v_cvt_pk_bf16_f32 v140, v120, v121
  v_mfma_f32_4x4x4_16b_bf16 v[132:135], a[148:149], v[116:117], v[132:135]
  v_cvt_pk_bf16_f32 v141, v124, v125
  v_mfma_f32_4x4x4_16b_bf16 v[128:131], a[150:151], v[116:117], v[128:131]
  buffer_load_dwordx4 v[32:35], v220, s[16:19], 0 offen offset:256
  v_mfma_f32_4x4x4_16b_bf16 v[132:135], a[150:151], v[118:119], v[132:135]
  ds_write_b64 v11, v[140:141] offset:8192
  v_mfma_f32_4x4x4_16b_bf16 v[128:131], a[152:153], v[80:81], v[128:131]
  v_cvt_pk_bf16_f32 v142, v122, v123
  v_mfma_f32_4x4x4_16b_bf16 v[132:135], a[152:153], v[82:83], v[132:135]
  v_cvt_pk_bf16_f32 v143, v126, v127
  v_mfma_f32_4x4x4_16b_bf16 v[128:131], a[154:155], v[82:83], v[128:131]
  buffer_load_dwordx4 v[36:39], v221, s[16:19], 0 offen offset:256
  v_mfma_f32_4x4x4_16b_bf16 v[132:135], a[154:155], v[84:85], v[132:135]
  ds_write_b64 v11, v[142:143] offset:10240
  v_mfma_f32_4x4x4_16b_bf16 v[128:131], a[156:157], v[84:85], v[128:131]
  buffer_load_dwordx4 v[40:43], v222, s[16:19], 0 offen offset:256
  v_mfma_f32_4x4x4_16b_bf16 v[132:135], a[156:157], v[86:87], v[132:135]
  v_mfma_f32_4x4x4_16b_bf16 v[128:131], a[158:159], v[86:87], v[128:131]
  ds_read_b64 v[110:111], v10 offset:41888
  v_mfma_f32_4x4x4_16b_bf16 v[132:135], a[158:159], v[88:89], v[132:135]
  v_mfma_f32_4x4x4_16b_bf16 v[128:131], a[160:161], v[90:91], v[128:131]
  ds_read_b64 v[112:113], v10 offset:42432
  v_mfma_f32_4x4x4_16b_bf16 v[132:135], a[160:161], v[92:93], v[132:135]
  buffer_load_dwordx4 v[44:47], v223, s[16:19], 0 offen offset:256
  v_mfma_f32_4x4x4_16b_bf16 v[128:131], a[162:163], v[92:93], v[128:131]
  ds_read_b64 v[114:115], v10 offset:42976
  v_mfma_f32_4x4x4_16b_bf16 v[132:135], a[162:163], v[94:95], v[132:135]
  v_mfma_f32_4x4x4_16b_bf16 v[128:131], a[164:165], v[94:95], v[128:131]
  ds_read_b64 v[116:117], v10 offset:43520
  v_mfma_f32_4x4x4_16b_bf16 v[132:135], a[164:165], v[96:97], v[132:135]
  s_waitcnt vmcnt(12)
  v_xad_u32 v14, v0, 0, v8
  v_mfma_f32_4x4x4_16b_bf16 v[128:131], a[166:167], v[96:97], v[128:131]
  v_perm_b32 v136, v52, v48, s33
  v_mfma_f32_4x4x4_16b_bf16 v[132:135], a[166:167], v[98:99], v[132:135]
  v_perm_b32 v137, v60, v56, s33
  s_waitcnt lgkmcnt(7)
  v_mfma_f32_4x4x4_16b_bf16 v[128:131], a[168:169], v[100:101], v[128:131]
  v_perm_b32 v138, v52, v48, s41
  v_mfma_f32_4x4x4_16b_bf16 v[132:135], a[168:169], v[102:103], v[132:135]
  v_perm_b32 v139, v60, v56, s41
  v_mfma_f32_4x4x4_16b_bf16 v[128:131], a[170:171], v[102:103], v[128:131]
  ds_write_b128 v14, v[136:139] offset:34816
  v_mfma_f32_4x4x4_16b_bf16 v[132:135], a[170:171], v[104:105], v[132:135]
  ds_read_b64 v[118:119], v10 offset:44064
  v_mfma_f32_4x4x4_16b_bf16 v[128:131], a[172:173], v[104:105], v[128:131]
  v_xad_u32 v14, v0, 16, v8
  v_mfma_f32_4x4x4_16b_bf16 v[132:135], a[172:173], v[106:107], v[132:135]
  v_perm_b32 v136, v53, v49, s33
  v_mfma_f32_4x4x4_16b_bf16 v[128:131], a[174:175], v[106:107], v[128:131]
  v_perm_b32 v137, v61, v57, s33
  v_mfma_f32_4x4x4_16b_bf16 v[132:135], a[174:175], v[108:109], v[132:135]
  v_perm_b32 v138, v53, v49, s41
  v_mfma_f32_4x4x4_16b_bf16 v[120:123], a[144:145], v[80:81], 0
  v_perm_b32 v139, v61, v57, s41
  v_mfma_f32_4x4x4_16b_bf16 v[124:127], a[144:145], v[82:83], 0
  ds_write_b128 v14, v[136:139] offset:34944
  v_mfma_f32_4x4x4_16b_bf16 v[120:123], a[146:147], v[82:83], v[120:123]
  v_mfma_f32_4x4x4_16b_bf16 v[124:127], a[146:147], v[84:85], v[124:127]
  s_nop 0
  v_mfma_f32_4x4x4_16b_bf16 v[120:123], a[148:149], v[84:85], v[120:123]
  v_cvt_pk_bf16_f32 v140, v128, v129
  v_mfma_f32_4x4x4_16b_bf16 v[124:127], a[148:149], v[86:87], v[124:127]
  v_cvt_pk_bf16_f32 v141, v132, v133
  v_mfma_f32_4x4x4_16b_bf16 v[120:123], a[150:151], v[86:87], v[120:123]
  ds_write_b64 v11, v[140:141] offset:12288
  v_mfma_f32_4x4x4_16b_bf16 v[124:127], a[150:151], v[88:89], v[124:127]
  v_xad_u32 v14, v0, 32, v8
  v_mfma_f32_4x4x4_16b_bf16 v[120:123], a[152:153], v[90:91], v[120:123]
  v_perm_b32 v136, v54, v50, s33
  v_mfma_f32_4x4x4_16b_bf16 v[124:127], a[152:153], v[92:93], v[124:127]
  v_perm_b32 v137, v62, v58, s33
  v_mfma_f32_4x4x4_16b_bf16 v[120:123], a[154:155], v[92:93], v[120:123]
  v_perm_b32 v138, v54, v50, s41
  v_mfma_f32_4x4x4_16b_bf16 v[124:127], a[154:155], v[94:95], v[124:127]
  v_perm_b32 v139, v62, v58, s41
  v_mfma_f32_4x4x4_16b_bf16 v[120:123], a[156:157], v[94:95], v[120:123]
  ds_write_b128 v14, v[136:139] offset:35072
  v_mfma_f32_4x4x4_16b_bf16 v[124:127], a[156:157], v[96:97], v[124:127]
  v_cvt_pk_bf16_f32 v142, v130, v131
  v_mfma_f32_4x4x4_16b_bf16 v[120:123], a[158:159], v[96:97], v[120:123]
  v_cvt_pk_bf16_f32 v143, v134, v135
  v_mfma_f32_4x4x4_16b_bf16 v[124:127], a[158:159], v[98:99], v[124:127]
  ds_write_b64 v11, v[142:143] offset:14336
  v_mfma_f32_4x4x4_16b_bf16 v[120:123], a[160:161], v[100:101], v[120:123]
  ds_read_b64 v[80:81], v10 offset:47872
  v_mfma_f32_4x4x4_16b_bf16 v[124:127], a[160:161], v[102:103], v[124:127]
  ds_read_b64 v[82:83], v10 offset:48416
  v_mfma_f32_4x4x4_16b_bf16 v[120:123], a[162:163], v[102:103], v[120:123]
  v_xad_u32 v14, v0, 48, v8
  v_mfma_f32_4x4x4_16b_bf16 v[124:127], a[162:163], v[104:105], v[124:127]
  v_perm_b32 v136, v55, v51, s33
  v_mfma_f32_4x4x4_16b_bf16 v[120:123], a[164:165], v[104:105], v[120:123]
  v_perm_b32 v137, v63, v59, s33
  v_mfma_f32_4x4x4_16b_bf16 v[124:127], a[164:165], v[106:107], v[124:127]
  v_perm_b32 v138, v55, v51, s41
  v_mfma_f32_4x4x4_16b_bf16 v[120:123], a[166:167], v[106:107], v[120:123]
  v_perm_b32 v139, v63, v59, s41
  v_mfma_f32_4x4x4_16b_bf16 v[124:127], a[166:167], v[108:109], v[124:127]
  ds_write_b128 v14, v[136:139] offset:35200
  s_waitcnt lgkmcnt(7)
  v_mfma_f32_4x4x4_16b_bf16 v[120:123], a[168:169], v[110:111], v[120:123]
  ds_read_b64 v[84:85], v10 offset:48960
  v_mfma_f32_4x4x4_16b_bf16 v[124:127], a[168:169], v[112:113], v[124:127]
  ds_read_b64 v[86:87], v10 offset:49504
  v_mfma_f32_4x4x4_16b_bf16 v[120:123], a[170:171], v[112:113], v[120:123]
  ds_read_b64 v[88:89], v10 offset:50048
  v_mfma_f32_4x4x4_16b_bf16 v[124:127], a[170:171], v[114:115], v[124:127]
  buffer_load_dwordx4 v[48:51], v224, s[16:19], 0 offen offset:256
  v_mfma_f32_4x4x4_16b_bf16 v[120:123], a[172:173], v[114:115], v[120:123]
  buffer_load_dwordx4 v[52:55], v225, s[16:19], 0 offen offset:256
  v_mfma_f32_4x4x4_16b_bf16 v[124:127], a[172:173], v[116:117], v[124:127]
  v_mfma_f32_4x4x4_16b_bf16 v[120:123], a[174:175], v[116:117], v[120:123]
  buffer_load_dwordx4 v[56:59], v226, s[16:19], 0 offen offset:256
  v_mfma_f32_4x4x4_16b_bf16 v[124:127], a[174:175], v[118:119], v[124:127]
  v_mfma_f32_4x4x4_16b_bf16 v[128:131], a[144:145], v[90:91], 0
  v_mfma_f32_4x4x4_16b_bf16 v[132:135], a[144:145], v[92:93], 0
  s_nop 0
  v_mfma_f32_4x4x4_16b_bf16 v[128:131], a[146:147], v[92:93], v[128:131]
  buffer_load_dwordx4 v[60:63], v227, s[16:19], 0 offen offset:256
  v_mfma_f32_4x4x4_16b_bf16 v[132:135], a[146:147], v[94:95], v[132:135]
  v_mfma_f32_4x4x4_16b_bf16 v[128:131], a[148:149], v[94:95], v[128:131]
  v_cvt_pk_bf16_f32 v140, v120, v121
  v_mfma_f32_4x4x4_16b_bf16 v[132:135], a[148:149], v[96:97], v[132:135]
  v_cvt_pk_bf16_f32 v141, v124, v125
  v_mfma_f32_4x4x4_16b_bf16 v[128:131], a[150:151], v[96:97], v[128:131]
  ds_write_b64 v11, v[140:141] offset:16384
  v_mfma_f32_4x4x4_16b_bf16 v[132:135], a[150:151], v[98:99], v[132:135]
  s_waitcnt vmcnt(12)
  v_perm_b32 v136, v65, v64, s33
  v_mfma_f32_4x4x4_16b_bf16 v[128:131], a[152:153], v[100:101], v[128:131]
  v_perm_b32 v137, v67, v66, s33
  v_mfma_f32_4x4x4_16b_bf16 v[132:135], a[152:153], v[102:103], v[132:135]
  v_perm_b32 v138, v65, v64, s41
  v_mfma_f32_4x4x4_16b_bf16 v[128:131], a[154:155], v[102:103], v[128:131]
  v_perm_b32 v139, v67, v66, s41
  v_mfma_f32_4x4x4_16b_bf16 v[132:135], a[154:155], v[104:105], v[132:135]
  s_mov_b64 exec, s[100:101]
  ds_write_b128 v9, v[136:139]
  s_mov_b64 exec, -1
  v_mfma_f32_4x4x4_16b_bf16 v[128:131], a[156:157], v[104:105], v[128:131]
  v_cvt_pk_bf16_f32 v142, v122, v123
  v_mfma_f32_4x4x4_16b_bf16 v[132:135], a[156:157], v[106:107], v[132:135]
  v_cvt_pk_bf16_f32 v143, v126, v127
  v_mfma_f32_4x4x4_16b_bf16 v[128:131], a[158:159], v[106:107], v[128:131]
  ds_write_b64 v11, v[142:143] offset:18432
  v_mfma_f32_4x4x4_16b_bf16 v[132:135], a[158:159], v[108:109], v[132:135]
  buffer_load_dword v64, v228, s[16:19], 0 offen offset:256
  v_mfma_f32_4x4x4_16b_bf16 v[128:131], a[160:161], v[110:111], v[128:131]
  buffer_load_dword v65, v229, s[16:19], 0 offen offset:256
  v_mfma_f32_4x4x4_16b_bf16 v[132:135], a[160:161], v[112:113], v[132:135]
  buffer_load_dword v66, v230, s[16:19], 0 offen offset:256
  v_mfma_f32_4x4x4_16b_bf16 v[128:131], a[162:163], v[112:113], v[128:131]
  buffer_load_dword v67, v231, s[16:19], 0 offen offset:256
  v_mfma_f32_4x4x4_16b_bf16 v[132:135], a[162:163], v[114:115], v[132:135]
  v_mfma_f32_4x4x4_16b_bf16 v[128:131], a[164:165], v[114:115], v[128:131]
  s_nop 0
  v_mfma_f32_4x4x4_16b_bf16 v[132:135], a[164:165], v[116:117], v[132:135]
  v_mfma_f32_4x4x4_16b_bf16 v[128:131], a[166:167], v[116:117], v[128:131]
  s_nop 0
  v_mfma_f32_4x4x4_16b_bf16 v[132:135], a[166:167], v[118:119], v[132:135]
  s_waitcnt lgkmcnt(3)
  v_mfma_f32_4x4x4_16b_bf16 v[128:131], a[168:169], v[80:81], v[128:131]
  v_mfma_f32_4x4x4_16b_bf16 v[132:135], a[168:169], v[82:83], v[132:135]
  s_nop 0
  v_mfma_f32_4x4x4_16b_bf16 v[128:131], a[170:171], v[82:83], v[128:131]
  v_mfma_f32_4x4x4_16b_bf16 v[132:135], a[170:171], v[84:85], v[132:135]
  s_nop 0
  v_mfma_f32_4x4x4_16b_bf16 v[128:131], a[172:173], v[84:85], v[128:131]
  v_mfma_f32_4x4x4_16b_bf16 v[132:135], a[172:173], v[86:87], v[132:135]
  s_nop 0
  v_mfma_f32_4x4x4_16b_bf16 v[128:131], a[174:175], v[86:87], v[128:131]
  v_mfma_f32_4x4x4_16b_bf16 v[132:135], a[174:175], v[88:89], v[132:135]
  s_nop 4
  v_cvt_pk_bf16_f32 v140, v128, v129
  v_cvt_pk_bf16_f32 v141, v132, v133
  ds_write_b64 v11, v[140:141] offset:20480
  v_cvt_pk_bf16_f32 v142, v130, v131
  v_cvt_pk_bf16_f32 v143, v134, v135
  ds_write_b64 v11, v[142:143] offset:22528
  s_waitcnt lgkmcnt(0)
  s_barrier
  ds_read_b64_tr_b16 v[144:145], v12 offset:0
  ds_read_b64_tr_b16 v[146:147], v13 offset:0
  ds_read_b64_tr_b16 v[148:149], v12 offset:1024
  ds_read_b64_tr_b16 v[150:151], v13 offset:1024
  ds_read_b64_tr_b16 v[168:169], v12 offset:2048
  ds_read_b64_tr_b16 v[170:171], v13 offset:2048
  ds_read_b64_tr_b16 v[172:173], v12 offset:3072
  ds_read_b64_tr_b16 v[174:175], v13 offset:3072
  ds_read_b64_tr_b16 v[192:193], v12 offset:4096
  ds_read_b64_tr_b16 v[194:195], v13 offset:4096
  ds_read_b64_tr_b16 v[196:197], v12 offset:5120
  ds_read_b64_tr_b16 v[198:199], v13 offset:5120
  v_add_u32 v12, s97, v12
  v_add_u32 v13, s97, v13
  s_sub_u32 s97, 0, s97
  v_add_u32 v10, s34, v10
  v_subrev_u32 v8, s34, v8
  v_subrev_u32 v9, s34, v9
  v_add_u32 v11, s35, v11
  s_sub_u32 s34, 0, s34
  s_sub_u32 s35, 0, s35
  s_add_u32 s3, s37, 1
  s_mov_b32 s24, s3
  s_lshr_b32 s25, s2, 3
  s_lshl_b32 s24, s24, 5
  s_add_u32 s25, s25, s24
  s_and_b32 s26, s2, 7
  s_lshl_b32 s26, s26, 2
  s_and_b32 s27, s25, 3
  s_add_u32 s26, s26, s27
  s_lshr_b32 s27, s25, 2
  s_mul_i32 s24, s26, 4608
  s_lshl_b32 s25, s27, 4
  s_add_u32 s24, s24, s25
  s_sub_u32 s24, s24, 1155
  s_mul_i32 s28, s24, 384
  s_cmp_eq_u32 s3, 3
  s_cselect_b32 s28, 0x60000000, s28
  s_sub_u32 s25, s27, 1
  s_cmp_lt_u32 s25, 22
  s_cselect_b32 s25, 1, 0
  s_cmp_eq_u32 s26, 0
  s_cselect_b32 s25, 0, s25
  s_cmp_eq_u32 s28, 0x60000000
  s_cselect_b32 s25, 1, s25
  s_cmp_eq_u32 s25, 0
  s_cbranch_scc1 fused_kernel_to2_slow
  s_add_u32 s24, s28, 0
  v_add_u32 v216, s24, v4
  v_add_u32 v220, s24, v5
  v_add_u32 v224, s24, v6
  v_add_u32 v228, s24, v7
  s_add_u32 s24, s28, 384
  v_add_u32 v217, s24, v4
  v_add_u32 v221, s24, v5
  v_add_u32 v225, s24, v6
  v_add_u32 v229, s24, v7
  s_add_u32 s24, s28, 147456
  v_add_u32 v218, s24, v4
  v_add_u32 v222, s24, v5
  v_add_u32 v226, s24, v6
  v_add_u32 v230, s24, v7
  s_add_u32 s24, s28, 147840
  v_add_u32 v219, s24, v4
  v_add_u32 v223, s24, v5
  v_add_u32 v227, s24, v6
  v_add_u32 v231, s24, v7
  s_branch fused_kernel_to2_done
fused_kernel_to2_slow:
  s_mov_b64 s[24:25], -1
  s_cmp_eq_u32 s27, 0
  s_cselect_b64 s[24:25], s[44:45], s[24:25]
  s_cmp_eq_u32 s27, 23
  s_cselect_b64 s[24:25], s[60:61], s[24:25]
  s_add_u32 s26, s28, 0
  v_add_u32 v216, s26, v4
  v_cmp_gt_u32 vcc, s30, v216
  s_and_b64 vcc, vcc, s[24:25]
  v_cndmask_b32 v216, 2.0, v216, vcc
  s_add_u32 s26, s28, 147456
  v_add_u32 v218, s26, v4
  v_cmp_gt_u32 vcc, s30, v218
  s_and_b64 vcc, vcc, s[24:25]
  v_cndmask_b32 v218, 2.0, v218, vcc
  s_mov_b64 s[24:25], -1
  s_cmp_eq_u32 s27, 0
  s_cselect_b64 s[24:25], s[48:49], s[24:25]
  s_cmp_eq_u32 s27, 23
  s_cselect_b64 s[24:25], s[64:65], s[24:25]
  s_add_u32 s26, s28, 0
  v_add_u32 v220, s26, v5
  v_cmp_gt_u32 vcc, s30, v220
  s_and_b64 vcc, vcc, s[24:25]
  v_cndmask_b32 v220, 2.0, v220, vcc
  s_add_u32 s26, s28, 147456
  v_add_u32 v222, s26, v5
  v_cmp_gt_u32 vcc, s30, v222
  s_and_b64 vcc, vcc, s[24:25]
  v_cndmask_b32 v222, 2.0, v222, vcc
  s_mov_b64 s[24:25], -1
  s_cmp_eq_u32 s27, 0
  s_cselect_b64 s[24:25], s[52:53], s[24:25]
  s_cmp_eq_u32 s27, 23
  s_cselect_b64 s[24:25], s[68:69], s[24:25]
  s_add_u32 s26, s28, 0
  v_add_u32 v224, s26, v6
  v_cmp_gt_u32 vcc, s30, v224
  s_and_b64 vcc, vcc, s[24:25]
  v_cndmask_b32 v224, 2.0, v224, vcc
  s_add_u32 s26, s28, 147456
  v_add_u32 v226, s26, v6
  v_cmp_gt_u32 vcc, s30, v226
  s_and_b64 vcc, vcc, s[24:25]
  v_cndmask_b32 v226, 2.0, v226, vcc
  s_or_b64 s[24:25], s[56:57], s[72:73]
  s_cmp_eq_u32 s27, 0
  s_cselect_b64 s[24:25], s[56:57], s[24:25]
  s_cmp_eq_u32 s27, 23
  s_cselect_b64 s[24:25], s[72:73], s[24:25]
  s_add_u32 s26, s28, 0
  v_add_u32 v228, s26, v7
  v_cmp_gt_u32 vcc, s30, v228
  s_and_b64 vcc, vcc, s[24:25]
  v_cndmask_b32 v228, 2.0, v228, vcc
  s_add_u32 s26, s28, 147456
  v_add_u32 v230, s26, v7
  v_cmp_gt_u32 vcc, s30, v230
  s_and_b64 vcc, vcc, s[24:25]
  v_cndmask_b32 v230, 2.0, v230, vcc
  s_mov_b64 s[24:25], -1
  s_cmp_eq_u32 s27, 0
  s_cselect_b64 s[24:25], s[46:47], s[24:25]
  s_cmp_eq_u32 s27, 23
  s_cselect_b64 s[24:25], s[62:63], s[24:25]
  s_add_u32 s26, s28, 384
  v_add_u32 v217, s26, v4
  v_cmp_gt_u32 vcc, s30, v217
  s_and_b64 vcc, vcc, s[24:25]
  v_cndmask_b32 v217, 2.0, v217, vcc
  s_add_u32 s26, s28, 147840
  v_add_u32 v219, s26, v4
  v_cmp_gt_u32 vcc, s30, v219
  s_and_b64 vcc, vcc, s[24:25]
  v_cndmask_b32 v219, 2.0, v219, vcc
  s_mov_b64 s[24:25], -1
  s_cmp_eq_u32 s27, 0
  s_cselect_b64 s[24:25], s[50:51], s[24:25]
  s_cmp_eq_u32 s27, 23
  s_cselect_b64 s[24:25], s[66:67], s[24:25]
  s_add_u32 s26, s28, 384
  v_add_u32 v221, s26, v5
  v_cmp_gt_u32 vcc, s30, v221
  s_and_b64 vcc, vcc, s[24:25]
  v_cndmask_b32 v221, 2.0, v221, vcc
  s_add_u32 s26, s28, 147840
  v_add_u32 v223, s26, v5
  v_cmp_gt_u32 vcc, s30, v223
  s_and_b64 vcc, vcc, s[24:25]
  v_cndmask_b32 v223, 2.0, v223, vcc
  s_mov_b64 s[24:25], -1
  s_cmp_eq_u32 s27, 0
  s_cselect_b64 s[24:25], s[54:55], s[24:25]
  s_cmp_eq_u32 s27, 23
  s_cselect_b64 s[24:25], s[70:71], s[24:25]
  s_add_u32 s26, s28, 384
  v_add_u32 v225, s26, v6
  v_cmp_gt_u32 vcc, s30, v225
  s_and_b64 vcc, vcc, s[24:25]
  v_cndmask_b32 v225, 2.0, v225, vcc
  s_add_u32 s26, s28, 147840
  v_add_u32 v227, s26, v6
  v_cmp_gt_u32 vcc, s30, v227
  s_and_b64 vcc, vcc, s[24:25]
  v_cndmask_b32 v227, 2.0, v227, vcc
  s_or_b64 s[24:25], s[58:59], s[74:75]
  s_cmp_eq_u32 s27, 0
  s_cselect_b64 s[24:25], s[58:59], s[24:25]
  s_cmp_eq_u32 s27, 23
  s_cselect_b64 s[24:25], s[74:75], s[24:25]
  s_add_u32 s26, s28, 384
  v_add_u32 v229, s26, v7
  v_cmp_gt_u32 vcc, s30, v229
  s_and_b64 vcc, vcc, s[24:25]
  v_cndmask_b32 v229, 2.0, v229, vcc
  s_add_u32 s26, s28, 147840
  v_add_u32 v231, s26, v7
  v_cmp_gt_u32 vcc, s30, v231
  s_and_b64 vcc, vcc, s[24:25]
  v_cndmask_b32 v231, 2.0, v231, vcc
fused_kernel_to2_done:
  ds_read_b64 v[80:81], v10 offset:0
  ds_read_b64 v[82:83], v10 offset:544
  ds_read_b64 v[84:85], v10 offset:1088
  ds_read_b64 v[86:87], v10 offset:1632
  ds_read_b64 v[88:89], v10 offset:2176
  ds_read_b64 v[90:91], v10 offset:5984
  ds_read_b64 v[92:93], v10 offset:6528
  ds_read_b64 v[94:95], v10 offset:7072
  ds_read_b64 v[96:97], v10 offset:7616
  ds_read_b64 v[98:99], v10 offset:8160
  ds_read_b64 v[100:101], v10 offset:11968
  ds_read_b64 v[102:103], v10 offset:12512
  ds_read_b64 v[104:105], v10 offset:13056
  ds_read_b64 v[106:107], v10 offset:13600
  ds_read_b64 v[108:109], v10 offset:14144
  ds_read_b64 v[110:111], v10 offset:17952
  ds_read_b64 v[112:113], v10 offset:18496
  ds_read_b64 v[114:115], v10 offset:19040
  ds_read_b64 v[116:117], v10 offset:19584
  ds_read_b64 v[118:119], v10 offset:20128
  s_waitcnt vmcnt(12)
  v_xad_u32 v14, v0, 0, v8
  v_perm_b32 v136, v20, v16, s33
  v_perm_b32 v137, v28, v24, s33
  v_perm_b32 v138, v20, v16, s41
  v_perm_b32 v139, v28, v24, s41
  ds_write_b128 v14, v[136:139] offset:0
  s_waitcnt lgkmcnt(15)
  v_mfma_f32_4x4x4_16b_bf16 v[120:123], a[176:177], v[80:81], 0
  v_mfma_f32_4x4x4_16b_bf16 v[124:127], a[176:177], v[82:83], 0
  s_nop 0
  v_mfma_f32_4x4x4_16b_bf16 v[120:123], a[178:179], v[82:83], v[120:123]
  v_mfma_f32_4x4x4_16b_bf16 v[124:127], a[178:179], v[84:85], v[124:127]
  s_nop 0
  v_mfma_f32_4x4x4_16b_bf16 v[120:123], a[180:181], v[84:85], v[120:123]
  v_mfma_f32_4x4x4_16b_bf16 v[124:127], a[180:181], v[86:87], v[124:127]
  s_nop 0
  v_mfma_f32_4x4x4_16b_bf16 v[120:123], a[182:183], v[86:87], v[120:123]
  v_mfma_f32_4x4x4_16b_bf16 v[124:127], a[182:183], v[88:89], v[124:127]
  s_waitcnt lgkmcnt(11)
  v_mfma_f32_4x4x4_16b_bf16 v[120:123], a[184:185], v[90:91], v[120:123]
  v_xad_u32 v14, v0, 16, v8
  v_mfma_f32_4x4x4_16b_bf16 v[124:127], a[184:185], v[92:93], v[124:127]
  v_perm_b32 v136, v21, v17, s33
  v_mfma_f32_4x4x4_16b_bf16 v[120:123], a[186:187], v[92:93], v[120:123]
  v_perm_b32 v137, v29, v25, s33
  v_mfma_f32_4x4x4_16b_bf16 v[124:127], a[186:187], v[94:95], v[124:127]
  v_perm_b32 v138, v21, v17, s41
  v_mfma_f32_4x4x4_16b_bf16 v[120:123], a[188:189], v[94:95], v[120:123]
  v_perm_b32 v139, v29, v25, s41
  v_mfma_f32_4x4x4_16b_bf16 v[124:127], a[188:189], v[96:97], v[124:127]
  ds_write_b128 v14, v[136:139] offset:128
  v_mfma_f32_4x4x4_16b_bf16 v[120:123], a[190:191], v[96:97], v[120:123]
  ds_read_b64 v[80:81], v10 offset:23936
  v_mfma_f32_4x4x4_16b_bf16 v[124:127], a[190:191], v[98:99], v[124:127]
  s_waitcnt lgkmcnt(8)
  v_mfma_f32_4x4x4_16b_bf16 v[120:123], a[192:193], v[100:101], v[120:123]
  ds_read_b64 v[82:83], v10 offset:24480
  v_mfma_f32_4x4x4_16b_bf16 v[124:127], a[192:193], v[102:103], v[124:127]
  v_mfma_f32_4x4x4_16b_bf16 v[120:123], a[194:195], v[102:103], v[120:123]
  ds_read_b64 v[84:85], v10 offset:25024
  v_mfma_f32_4x4x4_16b_bf16 v[124:127], a[194:195], v[104:105], v[124:127]
  v_mfma_f32_4x4x4_16b_bf16 v[120:123], a[196:197], v[104:105], v[120:123]
  ds_read_b64 v[86:87], v10 offset:25568
  v_mfma_f32_4x4x4_16b_bf16 v[124:127], a[196:197], v[106:107], v[124:127]
  v_mfma_f32_4x4x4_16b_bf16 v[120:123], a[198:199], v[106:107], v[120:123]
  ds_read_b64 v[88:89], v10 offset:26112
  v_mfma_f32_4x4x4_16b_bf16 v[124:127], a[198:199], v[108:109], v[124:127]
  s_waitcnt lgkmcnt(7)
  v_mfma_f32_4x4x4_16b_bf16 v[120:123], a[200:201], v[110:111], v[120:123]
  v_xad_u32 v14, v0, 32, v8
  v_mfma_f32_4x4x4_16b_bf16 v[124:127], a[200:201], v[112:113], v[124:127]
  v_perm_b32 v136, v22, v18, s33
  v_mfma_f32_4x4x4_16b_bf16 v[120:123], a[202:203], v[112:113], v[120:123]
  v_perm_b32 v137, v30, v26, s33
  v_mfma_f32_4x4x4_16b_bf16 v[124:127], a[202:203], v[114:115], v[124:127]
  v_perm_b32 v138, v22, v18, s41
  v_mfma_f32_4x4x4_16b_bf16 v[120:123], a[204:205], v[114:115], v[120:123]
  v_perm_b32 v139, v30, v26, s41
  v_mfma_f32_4x4x4_16b_bf16 v[124:127], a[204:205], v[116:117], v[124:127]
  ds_write_b128 v14, v[136:139] offset:256
  v_mfma_f32_4x4x4_16b_bf16 v[120:123], a[206:207], v[116:117], v[120:123]
  v_mfma_f32_4x4x4_16b_bf16 v[124:127], a[206:207], v[118:119], v[124:127]
  v_mfma_f32_4x4x4_16b_bf16 v[128:131], a[176:177], v[90:91], 0
  v_mfma_f32_4x4x4_16b_bf16 v[132:135], a[176:177], v[92:93], 0
  s_nop 0
  v_mfma_f32_4x4x4_16b_bf16 v[128:131], a[178:179], v[92:93], v[128:131]
  v_mfma_f32_4x4x4_16b_bf16 v[132:135], a[178:179], v[94:95], v[132:135]
  s_nop 0
  v_mfma_f32_4x4x4_16b_bf16 v[128:131], a[180:181], v[94:95], v[128:131]
  v_cvt_pk_bf16_f32 v140, v120, v121
  v_mfma_f32_4x4x4_16b_bf16 v[132:135], a[180:181], v[96:97], v[132:135]
  v_cvt_pk_bf16_f32 v141, v124, v125
  v_mfma_f32_4x4x4_16b_bf16 v[128:131], a[182:183], v[96:97], v[128:131]
  v_xad_u32 v14, v0, 48, v8
  v_mfma_f32_4x4x4_16b_bf16 v[132:135], a[182:183], v[98:99], v[132:135]
  v_perm_b32 v136, v23, v19, s33
  v_mfma_f32_4x4x4_16b_bf16 v[128:131], a[184:185], v[100:101], v[128:131]
  v_perm_b32 v137, v31, v27, s33
  v_mfma_f32_4x4x4_16b_bf16 v[132:135], a[184:185], v[102:103], v[132:135]
  v_perm_b32 v138, v23, v19, s41
  v_mfma_f32_4x4x4_16b_bf16 v[128:131], a[186:187], v[102:103], v[128:131]
  v_perm_b32 v139, v31, v27, s41
  v_mfma_f32_4x4x4_16b_bf16 v[132:135], a[186:187], v[104:105], v[132:135]
  ds_write_b128 v14, v[136:139] offset:384
  v_mfma_f32_4x4x4_16b_bf16 v[128:131], a[188:189], v[104:105], v[128:131]
  ds_write_b64 v11, v[140:141] offset:0
  v_mfma_f32_4x4x4_16b_bf16 v[132:135], a[188:189], v[106:107], v[132:135]
  v_cvt_pk_bf16_f32 v142, v122, v123
  v_mfma_f32_4x4x4_16b_bf16 v[128:131], a[190:191], v[106:107], v[128:131]
  v_cvt_pk_bf16_f32 v143, v126, v127
  v_mfma_f32_4x4x4_16b_bf16 v[132:135], a[190:191], v[108:109], v[132:135]
  ds_write_b64 v11, v[142:143] offset:2048
  v_mfma_f32_4x4x4_16b_bf16 v[128:131], a[192:193], v[110:111], v[128:131]
  buffer_load_dwordx4 v[16:19], v216, s[16:19], 0 offen offset:0
  v_mfma_f32_4x4x4_16b_bf16 v[132:135], a[192:193], v[112:113], v[132:135]
  ds_read_b64 v[90:91], v10 offset:29920
  v_mfma_f32_4x4x4_16b_bf16 v[128:131], a[194:195], v[112:113], v[128:131]
  ds_read_b64 v[92:93], v10 offset:30464
  v_mfma_f32_4x4x4_16b_bf16 v[132:135], a[194:195], v[114:115], v[132:135]
  buffer_load_dwordx4 v[20:23], v217, s[16:19], 0 offen offset:0
  v_mfma_f32_4x4x4_16b_bf16 v[128:131], a[196:197], v[114:115], v[128:131]
  ds_read_b64 v[94:95], v10 offset:31008
  v_mfma_f32_4x4x4_16b_bf16 v[132:135], a[196:197], v[116:117], v[132:135]
  ds_read_b64 v[96:97], v10 offset:31552
  v_mfma_f32_4x4x4_16b_bf16 v[128:131], a[198:199], v[116:117], v[128:131]
  buffer_load_dwordx4 v[24:27], v218, s[16:19], 0 offen offset:0
  v_mfma_f32_4x4x4_16b_bf16 v[132:135], a[198:199], v[118:119], v[132:135]
  ds_read_b64 v[98:99], v10 offset:32096
  s_waitcnt lgkmcnt(9)
  v_mfma_f32_4x4x4_16b_bf16 v[128:131], a[200:201], v[80:81], v[128:131]
  buffer_load_dwordx4 v[28:31], v219, s[16:19], 0 offen offset:0
  v_mfma_f32_4x4x4_16b_bf16 v[132:135], a[200:201], v[82:83], v[132:135]
  v_mfma_f32_4x4x4_16b_bf16 v[128:131], a[202:203], v[82:83], v[128:131]
  s_nop 0
  v_mfma_f32_4x4x4_16b_bf16 v[132:135], a[202:203], v[84:85], v[132:135]
  v_mfma_f32_4x4x4_16b_bf16 v[128:131], a[204:205], v[84:85], v[128:131]
  s_waitcnt vmcnt(12)
  v_xad_u32 v14, v0, 0, v8
  v_mfma_f32_4x4x4_16b_bf16 v[132:135], a[204:205], v[86:87], v[132:135]
  v_perm_b32 v136, v36, v32, s33
  v_mfma_f32_4x4x4_16b_bf16 v[128:131], a[206:207], v[86:87], v[128:131]
  v_perm_b32 v137, v44, v40, s33
  v_mfma_f32_4x4x4_16b_bf16 v[132:135], a[206:207], v[88:89], v[132:135]
  v_perm_b32 v138, v36, v32, s41
  v_mfma_f32_4x4x4_16b_bf16 v[120:123], a[176:177], v[100:101], 0
  v_perm_b32 v139, v44, v40, s41
  v_mfma_f32_4x4x4_16b_bf16 v[124:127], a[176:177], v[102:103], 0
  ds_write_b128 v14, v[136:139] offset:17408
  v_mfma_f32_4x4x4_16b_bf16 v[120:123], a[178:179], v[102:103], v[120:123]
  v_mfma_f32_4x4x4_16b_bf16 v[124:127], a[178:179], v[104:105], v[124:127]
  s_nop 0
  v_mfma_f32_4x4x4_16b_bf16 v[120:123], a[180:181], v[104:105], v[120:123]
  v_cvt_pk_bf16_f32 v140, v128, v129
  v_mfma_f32_4x4x4_16b_bf16 v[124:127], a[180:181], v[106:107], v[124:127]
  v_cvt_pk_bf16_f32 v141, v132, v133
  v_mfma_f32_4x4x4_16b_bf16 v[120:123], a[182:183], v[106:107], v[120:123]
  ds_write_b64 v11, v[140:141] offset:4096
  v_mfma_f32_4x4x4_16b_bf16 v[124:127], a[182:183], v[108:109], v[124:127]
  v_mfma_f32_4x4x4_16b_bf16 v[120:123], a[184:185], v[110:111], v[120:123]
  v_cvt_pk_bf16_f32 v142, v130, v131
  v_mfma_f32_4x4x4_16b_bf16 v[124:127], a[184:185], v[112:113], v[124:127]
  v_cvt_pk_bf16_f32 v143, v134, v135
  v_mfma_f32_4x4x4_16b_bf16 v[120:123], a[186:187], v[112:113], v[120:123]
  v_xad_u32 v14, v0, 16, v8
  v_mfma_f32_4x4x4_16b_bf16 v[124:127], a[186:187], v[114:115], v[124:127]
  v_perm_b32 v136, v37, v33, s33
  v_mfma_f32_4x4x4_16b_bf16 v[120:123], a[188:189], v[114:115], v[120:123]
  v_perm_b32 v137, v45, v41, s33
  v_mfma_f32_4x4x4_16b_bf16 v[124:127], a[188:189], v[116:117], v[124:127]
  v_perm_b32 v138, v37, v33, s41
  v_mfma_f32_4x4x4_16b_bf16 v[120:123], a[190:191], v[116:117], v[120:123]
  v_perm_b32 v139, v45, v41, s41
  v_mfma_f32_4x4x4_16b_bf16 v[124:127], a[190:191], v[118:119], v[124:127]
  ds_write_b128 v14, v[136:139] offset:17536
  v_mfma_f32_4x4x4_16b_bf16 v[120:123], a[192:193], v[80:81], v[120:123]
  ds_write_b64 v11, v[142:143] offset:6144
  v_mfma_f32_4x4x4_16b_bf16 v[124:127], a[192:193], v[82:83], v[124:127]
  ds_read_b64 v[100:101], v10 offset:35904
  v_mfma_f32_4x4x4_16b_bf16 v[120:123], a[194:195], v[82:83], v[120:123]
  ds_read_b64 v[102:103], v10 offset:36448
  v_mfma_f32_4x4x4_16b_bf16 v[124:127], a[194:195], v[84:85], v[124:127]
  ds_read_b64 v[104:105], v10 offset:36992
  v_mfma_f32_4x4x4_16b_bf16 v[120:123], a[196:197], v[84:85], v[120:123]
  v_xad_u32 v14, v0, 32, v8
  v_mfma_f32_4x4x4_16b_bf16 v[124:127], a[196:197], v[86:87], v[124:127]
  v_perm_b32 v136, v38, v34, s33
  v_mfma_f32_4x4x4_16b_bf16 v[120:123], a[198:199], v[86:87], v[120:123]
  v_perm_b32 v137, v46, v42, s33
  v_mfma_f32_4x4x4_16b_bf16 v[124:127], a[198:199], v[88:89], v[124:127]
  v_perm_b32 v138, v38, v34, s41
  s_waitcnt lgkmcnt(7)
  v_mfma_f32_4x4x4_16b_bf16 v[120:123], a[200:201], v[90:91], v[120:123]
  v_perm_b32 v139, v46, v42, s41
  v_mfma_f32_4x4x4_16b_bf16 v[124:127], a[200:201], v[92:93], v[124:127]
  ds_write_b128 v14, v[136:139] offset:17664
  v_mfma_f32_4x4x4_16b_bf16 v[120:123], a[202:203], v[92:93], v[120:123]
  ds_read_b64 v[106:107], v10 offset:37536
  v_mfma_f32_4x4x4_16b_bf16 v[124:127], a[202:203], v[94:95], v[124:127]
  ds_read_b64 v[108:109], v10 offset:38080
  v_mfma_f32_4x4x4_16b_bf16 v[120:123], a[204:205], v[94:95], v[120:123]
  v_xad_u32 v14, v0, 48, v8
  v_mfma_f32_4x4x4_16b_bf16 v[124:127], a[204:205], v[96:97], v[124:127]
  v_perm_b32 v136, v39, v35, s33
  v_mfma_f32_4x4x4_16b_bf16 v[120:123], a[206:207], v[96:97], v[120:123]
  v_perm_b32 v137, v47, v43, s33
  v_mfma_f32_4x4x4_16b_bf16 v[124:127], a[206:207], v[98:99], v[124:127]
  v_perm_b32 v138, v39, v35, s41
  v_mfma_f32_4x4x4_16b_bf16 v[128:131], a[176:177], v[110:111], 0
  v_perm_b32 v139, v47, v43, s41
  v_mfma_f32_4x4x4_16b_bf16 v[132:135], a[176:177], v[112:113], 0
  ds_write_b128 v14, v[136:139] offset:17792
  v_mfma_f32_4x4x4_16b_bf16 v[128:131], a[178:179], v[112:113], v[128:131]
  v_mfma_f32_4x4x4_16b_bf16 v[132:135], a[178:179], v[114:115], v[132:135]
  s_nop 0
  v_mfma_f32_4x4x4_16b_bf16 v[128:131], a[180:181], v[114:115], v[128:131]
  v_cvt_pk_bf16_f32 v140, v120, v121
  v_mfma_f32_4x4x4_16b_bf16 v[132:135], a[180:181], v[116:117], v[132:135]
  v_cvt_pk_bf16_f32 v141, v124, v125
  v_mfma_f32_4x4x4_16b_bf16 v[128:131], a[182:183], v[116:117], v[128:131]
  buffer_load_dwordx4 v[32:35], v220, s[16:19], 0 offen offset:0
  v_mfma_f32_4x4x4_16b_bf16 v[132:135], a[182:183], v[118:119], v[132:135]
  ds_write_b64 v11, v[140:141] offset:8192
  v_mfma_f32_4x4x4_16b_bf16 v[128:131], a[184:185], v[80:81], v[128:131]
  v_cvt_pk_bf16_f32 v142, v122, v123
  v_mfma_f32_4x4x4_16b_bf16 v[132:135], a[184:185], v[82:83], v[132:135]
  v_cvt_pk_bf16_f32 v143, v126, v127
  v_mfma_f32_4x4x4_16b_bf16 v[128:131], a[186:187], v[82:83], v[128:131]
  buffer_load_dwordx4 v[36:39], v221, s[16:19], 0 offen offset:0
  v_mfma_f32_4x4x4_16b_bf16 v[132:135], a[186:187], v[84:85], v[132:135]
  ds_write_b64 v11, v[142:143] offset:10240
  v_mfma_f32_4x4x4_16b_bf16 v[128:131], a[188:189], v[84:85], v[128:131]
  buffer_load_dwordx4 v[40:43], v222, s[16:19], 0 offen offset:0
  v_mfma_f32_4x4x4_16b_bf16 v[132:135], a[188:189], v[86:87], v[132:135]
  v_mfma_f32_4x4x4_16b_bf16 v[128:131], a[190:191], v[86:87], v[128:131]
  ds_read_b64 v[110:111], v10 offset:41888
  v_mfma_f32_4x4x4_16b_bf16 v[132:135], a[190:191], v[88:89], v[132:135]
  v_mfma_f32_4x4x4_16b_bf16 v[128:131], a[192:193], v[90:91], v[128:131]
  ds_read_b64 v[112:113], v10 offset:42432
  v_mfma_f32_4x4x4_16b_bf16 v[132:135], a[192:193], v[92:93], v[132:135]
  buffer_load_dwordx4 v[44:47], v223, s[16:19], 0 offen offset:0
  v_mfma_f32_4x4x4_16b_bf16 v[128:131], a[194:195], v[92:93], v[128:131]
  ds_read_b64 v[114:115], v10 offset:42976
  v_mfma_f32_4x4x4_16b_bf16 v[132:135], a[194:195], v[94:95], v[132:135]
  v_mfma_f32_4x4x4_16b_bf16 v[128:131], a[196:197], v[94:95], v[128:131]
  ds_read_b64 v[116:117], v10 offset:43520
  v_mfma_f32_4x4x4_16b_bf16 v[132:135], a[196:197], v[96:97], v[132:135]
  s_waitcnt vmcnt(12)
  v_xad_u32 v14, v0, 0, v8
  v_mfma_f32_4x4x4_16b_bf16 v[128:131], a[198:199], v[96:97], v[128:131]
  v_perm_b32 v136, v52, v48, s33
  v_mfma_f32_4x4x4_16b_bf16 v[132:135], a[198:199], v[98:99], v[132:135]
  v_perm_b32 v137, v60, v56, s33
  s_waitcnt lgkmcnt(7)
  v_mfma_f32_4x4x4_16b_bf16 v[128:131], a[200:201], v[100:101], v[128:131]
  v_perm_b32 v138, v52, v48, s41
  v_mfma_f32_4x4x4_16b_bf16 v[132:135], a[200:201], v[102:103], v[132:135]
  v_perm_b32 v139, v60, v56, s41
  v_mfma_f32_4x4x4_16b_bf16 v[128:131], a[202:203], v[102:103], v[128:131]
  ds_write_b128 v14, v[136:139] offset:34816
  v_mfma_f32_4x4x4_16b_bf16 v[132:135], a[202:203], v[104:105], v[132:135]
  ds_read_b64 v[118:119], v10 offset:44064
  v_mfma_f32_4x4x4_16b_bf16 v[128:131], a[204:205], v[104:105], v[128:131]
  v_xad_u32 v14, v0, 16, v8
  v_mfma_f32_4x4x4_16b_bf16 v[132:135], a[204:205], v[106:107], v[132:135]
  v_perm_b32 v136, v53, v49, s33
  v_mfma_f32_4x4x4_16b_bf16 v[128:131], a[206:207], v[106:107], v[128:131]
  v_perm_b32 v137, v61, v57, s33
  v_mfma_f32_4x4x4_16b_bf16 v[132:135], a[206:207], v[108:109], v[132:135]
  v_perm_b32 v138, v53, v49, s41
  v_mfma_f32_4x4x4_16b_bf16 v[120:123], a[176:177], v[80:81], 0
  v_perm_b32 v139, v61, v57, s41
  v_mfma_f32_4x4x4_16b_bf16 v[124:127], a[176:177], v[82:83], 0
  ds_write_b128 v14, v[136:139] offset:34944
  v_mfma_f32_4x4x4_16b_bf16 v[120:123], a[178:179], v[82:83], v[120:123]
  v_mfma_f32_4x4x4_16b_bf16 v[124:127], a[178:179], v[84:85], v[124:127]
  s_nop 0
  v_mfma_f32_4x4x4_16b_bf16 v[120:123], a[180:181], v[84:85], v[120:123]
  v_cvt_pk_bf16_f32 v140, v128, v129
  v_mfma_f32_4x4x4_16b_bf16 v[124:127], a[180:181], v[86:87], v[124:127]
  v_cvt_pk_bf16_f32 v141, v132, v133
  v_mfma_f32_4x4x4_16b_bf16 v[120:123], a[182:183], v[86:87], v[120:123]
  ds_write_b64 v11, v[140:141] offset:12288
  v_mfma_f32_4x4x4_16b_bf16 v[124:127], a[182:183], v[88:89], v[124:127]
  v_xad_u32 v14, v0, 32, v8
  v_mfma_f32_4x4x4_16b_bf16 v[120:123], a[184:185], v[90:91], v[120:123]
  v_perm_b32 v136, v54, v50, s33
  v_mfma_f32_4x4x4_16b_bf16 v[124:127], a[184:185], v[92:93], v[124:127]
  v_perm_b32 v137, v62, v58, s33
  v_mfma_f32_4x4x4_16b_bf16 v[120:123], a[186:187], v[92:93], v[120:123]
  v_perm_b32 v138, v54, v50, s41
  v_mfma_f32_4x4x4_16b_bf16 v[124:127], a[186:187], v[94:95], v[124:127]
  v_perm_b32 v139, v62, v58, s41
  v_mfma_f32_4x4x4_16b_bf16 v[120:123], a[188:189], v[94:95], v[120:123]
  ds_write_b128 v14, v[136:139] offset:35072
  v_mfma_f32_4x4x4_16b_bf16 v[124:127], a[188:189], v[96:97], v[124:127]
  v_cvt_pk_bf16_f32 v142, v130, v131
  v_mfma_f32_4x4x4_16b_bf16 v[120:123], a[190:191], v[96:97], v[120:123]
  v_cvt_pk_bf16_f32 v143, v134, v135
  v_mfma_f32_4x4x4_16b_bf16 v[124:127], a[190:191], v[98:99], v[124:127]
  ds_write_b64 v11, v[142:143] offset:14336
  v_mfma_f32_4x4x4_16b_bf16 v[120:123], a[192:193], v[100:101], v[120:123]
  ds_read_b64 v[80:81], v10 offset:47872
  v_mfma_f32_4x4x4_16b_bf16 v[124:127], a[192:193], v[102:103], v[124:127]
  ds_read_b64 v[82:83], v10 offset:48416
  v_mfma_f32_4x4x4_16b_bf16 v[120:123], a[194:195], v[102:103], v[120:123]
  v_xad_u32 v14, v0, 48, v8
  v_mfma_f32_4x4x4_16b_bf16 v[124:127], a[194:195], v[104:105], v[124:127]
  v_perm_b32 v136, v55, v51, s33
  v_mfma_f32_4x4x4_16b_bf16 v[120:123], a[196:197], v[104:105], v[120:123]
  v_perm_b32 v137, v63, v59, s33
  v_mfma_f32_4x4x4_16b_bf16 v[124:127], a[196:197], v[106:107], v[124:127]
  v_perm_b32 v138, v55, v51, s41
  v_mfma_f32_4x4x4_16b_bf16 v[120:123], a[198:199], v[106:107], v[120:123]
  v_perm_b32 v139, v63, v59, s41
  v_mfma_f32_4x4x4_16b_bf16 v[124:127], a[198:199], v[108:109], v[124:127]
  ds_write_b128 v14, v[136:139] offset:35200
  s_waitcnt lgkmcnt(7)
  v_mfma_f32_4x4x4_16b_bf16 v[120:123], a[200:201], v[110:111], v[120:123]
  ds_read_b64 v[84:85], v10 offset:48960
  v_mfma_f32_4x4x4_16b_bf16 v[124:127], a[200:201], v[112:113], v[124:127]
  ds_read_b64 v[86:87], v10 offset:49504
  v_mfma_f32_4x4x4_16b_bf16 v[120:123], a[202:203], v[112:113], v[120:123]
  ds_read_b64 v[88:89], v10 offset:50048
  v_mfma_f32_4x4x4_16b_bf16 v[124:127], a[202:203], v[114:115], v[124:127]
  buffer_load_dwordx4 v[48:51], v224, s[16:19], 0 offen offset:0
  v_mfma_f32_4x4x4_16b_bf16 v[120:123], a[204:205], v[114:115], v[120:123]
  buffer_load_dwordx4 v[52:55], v225, s[16:19], 0 offen offset:0
  v_mfma_f32_4x4x4_16b_bf16 v[124:127], a[204:205], v[116:117], v[124:127]
  v_mfma_f32_4x4x4_16b_bf16 v[120:123], a[206:207], v[116:117], v[120:123]
  buffer_load_dwordx4 v[56:59], v226, s[16:19], 0 offen offset:0
  v_mfma_f32_4x4x4_16b_bf16 v[124:127], a[206:207], v[118:119], v[124:127]
  v_mfma_f32_4x4x4_16b_bf16 v[128:131], a[176:177], v[90:91], 0
  v_mfma_f32_4x4x4_16b_bf16 v[132:135], a[176:177], v[92:93], 0
  s_nop 0
  v_mfma_f32_4x4x4_16b_bf16 v[128:131], a[178:179], v[92:93], v[128:131]
  buffer_load_dwordx4 v[60:63], v227, s[16:19], 0 offen offset:0
  v_mfma_f32_4x4x4_16b_bf16 v[132:135], a[178:179], v[94:95], v[132:135]
  v_mfma_f32_4x4x4_16b_bf16 v[128:131], a[180:181], v[94:95], v[128:131]
  v_cvt_pk_bf16_f32 v140, v120, v121
  v_mfma_f32_4x4x4_16b_bf16 v[132:135], a[180:181], v[96:97], v[132:135]
  v_cvt_pk_bf16_f32 v141, v124, v125
  v_mfma_f32_4x4x4_16b_bf16 v[128:131], a[182:183], v[96:97], v[128:131]
  ds_write_b64 v11, v[140:141] offset:16384
  v_mfma_f32_4x4x4_16b_bf16 v[132:135], a[182:183], v[98:99], v[132:135]
  s_waitcnt vmcnt(12)
  v_perm_b32 v136, v65, v64, s33
  v_mfma_f32_4x4x4_16b_bf16 v[128:131], a[184:185], v[100:101], v[128:131]
  v_perm_b32 v137, v67, v66, s33
  v_mfma_f32_4x4x4_16b_bf16 v[132:135], a[184:185], v[102:103], v[132:135]
  v_perm_b32 v138, v65, v64, s41
  v_mfma_f32_4x4x4_16b_bf16 v[128:131], a[186:187], v[102:103], v[128:131]
  v_perm_b32 v139, v67, v66, s41
  v_mfma_f32_4x4x4_16b_bf16 v[132:135], a[186:187], v[104:105], v[132:135]
  s_mov_b64 exec, s[100:101]
  ds_write_b128 v9, v[136:139]
  s_mov_b64 exec, -1
  v_mfma_f32_4x4x4_16b_bf16 v[128:131], a[188:189], v[104:105], v[128:131]
  v_cvt_pk_bf16_f32 v142, v122, v123
  v_mfma_f32_4x4x4_16b_bf16 v[132:135], a[188:189], v[106:107], v[132:135]
  v_cvt_pk_bf16_f32 v143, v126, v127
  v_mfma_f32_4x4x4_16b_bf16 v[128:131], a[190:191], v[106:107], v[128:131]
  ds_write_b64 v11, v[142:143] offset:18432
  v_mfma_f32_4x4x4_16b_bf16 v[132:135], a[190:191], v[108:109], v[132:135]
  buffer_load_dword v64, v228, s[16:19], 0 offen offset:0
  v_mfma_f32_4x4x4_16b_bf16 v[128:131], a[192:193], v[110:111], v[128:131]
  buffer_load_dword v65, v229, s[16:19], 0 offen offset:0
  v_mfma_f32_4x4x4_16b_bf16 v[132:135], a[192:193], v[112:113], v[132:135]
  buffer_load_dword v66, v230, s[16:19], 0 offen offset:0
  v_mfma_f32_4x4x4_16b_bf16 v[128:131], a[194:195], v[112:113], v[128:131]
  buffer_load_dword v67, v231, s[16:19], 0 offen offset:0
  v_mfma_f32_4x4x4_16b_bf16 v[132:135], a[194:195], v[114:115], v[132:135]
  v_mfma_f32_4x4x4_16b_bf16 v[128:131], a[196:197], v[114:115], v[128:131]
  s_nop 0
  v_mfma_f32_4x4x4_16b_bf16 v[132:135], a[196:197], v[116:117], v[132:135]
  v_mfma_f32_4x4x4_16b_bf16 v[128:131], a[198:199], v[116:117], v[128:131]
  s_nop 0
  v_mfma_f32_4x4x4_16b_bf16 v[132:135], a[198:199], v[118:119], v[132:135]
  s_waitcnt lgkmcnt(3)
  v_mfma_f32_4x4x4_16b_bf16 v[128:131], a[200:201], v[80:81], v[128:131]
  v_mfma_f32_4x4x4_16b_bf16 v[132:135], a[200:201], v[82:83], v[132:135]
  s_nop 0
  v_mfma_f32_4x4x4_16b_bf16 v[128:131], a[202:203], v[82:83], v[128:131]
  v_mfma_f32_4x4x4_16b_bf16 v[132:135], a[202:203], v[84:85], v[132:135]
  s_nop 0
  v_mfma_f32_4x4x4_16b_bf16 v[128:131], a[204:205], v[84:85], v[128:131]
  v_mfma_f32_4x4x4_16b_bf16 v[132:135], a[204:205], v[86:87], v[132:135]
  s_nop 0
  v_mfma_f32_4x4x4_16b_bf16 v[128:131], a[206:207], v[86:87], v[128:131]
  v_mfma_f32_4x4x4_16b_bf16 v[132:135], a[206:207], v[88:89], v[132:135]
  s_nop 4
  v_cvt_pk_bf16_f32 v140, v128, v129
  v_cvt_pk_bf16_f32 v141, v132, v133
  ds_write_b64 v11, v[140:141] offset:20480
  v_cvt_pk_bf16_f32 v142, v130, v131
  v_cvt_pk_bf16_f32 v143, v134, v135
  ds_write_b64 v11, v[142:143] offset:22528
  s_waitcnt vmcnt(16)
  s_waitcnt lgkmcnt(0)
  s_barrier
  ds_read_b64_tr_b16 v[152:153], v12 offset:0
  ds_read_b64_tr_b16 v[154:155], v13 offset:0
  ds_read_b64_tr_b16 v[156:157], v12 offset:1024
  ds_read_b64_tr_b16 v[158:159], v13 offset:1024
  ds_read_b64_tr_b16 v[176:177], v12 offset:2048
  ds_read_b64_tr_b16 v[178:179], v13 offset:2048
  ds_read_b64_tr_b16 v[180:181], v12 offset:3072
  ds_read_b64_tr_b16 v[182:183], v13 offset:3072
  ds_read_b64_tr_b16 v[200:201], v12 offset:4096
  ds_read_b64_tr_b16 v[202:203], v13 offset:4096
  ds_read_b64_tr_b16 v[204:205], v12 offset:5120
  ds_read_b64_tr_b16 v[206:207], v13 offset:5120
  v_add_u32 v12, s97, v12
  v_add_u32 v13, s97, v13
  s_sub_u32 s97, 0, s97
  v_add_u32 v10, s34, v10
  v_subrev_u32 v8, s34, v8
  v_subrev_u32 v9, s34, v9
  v_add_u32 v11, s35, v11
  s_sub_u32 s34, 0, s34
  s_sub_u32 s35, 0, s35
  s_cmp_eq_u32 s37, 2
  s_cbranch_scc0 fused_kernel_nl
  s_lshr_b32 s24, s2, 3
  s_and_b32 s25, s2, 7
  s_lshl_b32 s25, s25, 2
  s_and_b32 s26, s24, 3
  s_add_u32 s25, s25, s26
  s_lshr_b32 s24, s24, 2
  s_mul_i32 s25, s25, 12
  s_mul_i32 s26, s40, 3
  s_add_u32 s25, s25, s26
  s_mul_i32 s25, s25, 24
  s_add_u32 s25, s25, s24
  s_mul_i32 s51, s25, 6144
  s_mov_b32 s48, s51
  s_add_u32 s49, s48, 147456
  s_add_u32 s50, s49, 147456
  v_and_b32 v14, 0xf0, v2
  v_mul_u32_u24 v3, 24, v14
  v_lshrrev_b32 v14, 4, v2
  v_and_b32 v14, 0x30, v14
  v_add_u32 v3, v3, v14
  s_add_u32 s8, s38, 0
  s_addc_u32 s9, s39, 0
  s_mov_b32 s10, 589824
  s_mov_b32 s11, 0x20000
  s_mul_i32 s29, s40, 12288
  s_cmp_eq_u32 s40, 1
  s_cselect_b32 s24, 565248, s29
  ds_read_b64 v[80:81], v10 offset:0
  ds_read_b64 v[82:83], v10 offset:544
  ds_read_b64 v[84:85], v10 offset:1088
  ds_read_b64 v[86:87], v10 offset:1632
  ds_read_b64 v[88:89], v10 offset:2176
  ds_read_b64 v[90:91], v10 offset:5984
  ds_read_b64 v[92:93], v10 offset:6528
  ds_read_b64 v[94:95], v10 offset:7072
  ds_read_b64 v[96:97], v10 offset:7616
  ds_read_b64 v[98:99], v10 offset:8160
  ds_read_b64 v[100:101], v10 offset:11968
  ds_read_b64 v[102:103], v10 offset:12512
  ds_read_b64 v[104:105], v10 offset:13056
  ds_read_b64 v[106:107], v10 offset:13600
  ds_read_b64 v[108:109], v10 offset:14144
  ds_read_b64 v[110:111], v10 offset:17952
  ds_read_b64 v[112:113], v10 offset:18496
  ds_read_b64 v[114:115], v10 offset:19040
  ds_read_b64 v[116:117], v10 offset:19584
  ds_read_b64 v[118:119], v10 offset:20128
  s_waitcnt lgkmcnt(15)
  v_mfma_f32_4x4x4_16b_bf16 v[120:123], a[208:209], v[80:81], 0
  v_mfma_f32_4x4x4_16b_bf16 v[124:127], a[208:209], v[82:83], 0
  s_nop 0
  v_mfma_f32_4x4x4_16b_bf16 v[120:123], a[210:211], v[82:83], v[120:123]
  v_mfma_f32_4x4x4_16b_bf16 v[124:127], a[210:211], v[84:85], v[124:127]
  s_nop 0
  v_mfma_f32_4x4x4_16b_bf16 v[120:123], a[212:213], v[84:85], v[120:123]
  v_mfma_f32_4x4x4_16b_bf16 v[124:127], a[212:213], v[86:87], v[124:127]
  s_nop 0
  v_mfma_f32_4x4x4_16b_bf16 v[120:123], a[214:215], v[86:87], v[120:123]
  v_mfma_f32_4x4x4_16b_bf16 v[124:127], a[214:215], v[88:89], v[124:127]
  s_waitcnt lgkmcnt(10)
  v_mfma_f32_4x4x4_16b_bf16 v[120:123], a[216:217], v[90:91], v[120:123]
  v_mfma_f32_4x4x4_16b_bf16 v[124:127], a[216:217], v[92:93], v[124:127]
  s_nop 0
  v_mfma_f32_4x4x4_16b_bf16 v[120:123], a[218:219], v[92:93], v[120:123]
  v_mfma_f32_4x4x4_16b_bf16 v[124:127], a[218:219], v[94:95], v[124:127]
  s_nop 0
  v_mfma_f32_4x4x4_16b_bf16 v[120:123], a[220:221], v[94:95], v[120:123]
  v_mfma_f32_4x4x4_16b_bf16 v[124:127], a[220:221], v[96:97], v[124:127]
  s_nop 0
  v_mfma_f32_4x4x4_16b_bf16 v[120:123], a[222:223], v[96:97], v[120:123]
  ds_read_b64 v[80:81], v10 offset:23936
  v_mfma_f32_4x4x4_16b_bf16 v[124:127], a[222:223], v[98:99], v[124:127]
  s_waitcnt lgkmcnt(6)
  v_mfma_f32_4x4x4_16b_bf16 v[120:123], a[224:225], v[100:101], v[120:123]
  ds_read_b64 v[82:83], v10 offset:24480
  v_mfma_f32_4x4x4_16b_bf16 v[124:127], a[224:225], v[102:103], v[124:127]
  v_mfma_f32_4x4x4_16b_bf16 v[120:123], a[226:227], v[102:103], v[120:123]
  ds_read_b64 v[84:85], v10 offset:25024
  v_mfma_f32_4x4x4_16b_bf16 v[124:127], a[226:227], v[104:105], v[124:127]
  v_mfma_f32_4x4x4_16b_bf16 v[120:123], a[228:229], v[104:105], v[120:123]
  ds_read_b64 v[86:87], v10 offset:25568
  v_mfma_f32_4x4x4_16b_bf16 v[124:127], a[228:229], v[106:107], v[124:127]
  v_mfma_f32_4x4x4_16b_bf16 v[120:123], a[230:231], v[106:107], v[120:123]
  ds_read_b64 v[88:89], v10 offset:26112
  v_mfma_f32_4x4x4_16b_bf16 v[124:127], a[230:231], v[108:109], v[124:127]
  s_waitcnt lgkmcnt(5)
  v_mfma_f32_4x4x4_16b_bf16 v[120:123], a[232:233], v[110:111], v[120:123]
  v_mfma_f32_4x4x4_16b_bf16 v[124:127], a[232:233], v[112:113], v[124:127]
  s_nop 0
  v_mfma_f32_4x4x4_16b_bf16 v[120:123], a[234:235], v[112:113], v[120:123]
  v_mfma_f32_4x4x4_16b_bf16 v[124:127], a[234:235], v[114:115], v[124:127]
  s_nop 0
  v_mfma_f32_4x4x4_16b_bf16 v[120:123], a[236:237], v[114:115], v[120:123]
  v_mfma_f32_4x4x4_16b_bf16 v[124:127], a[236:237], v[116:117], v[124:127]
  s_nop 0
  v_mfma_f32_4x4x4_16b_bf16 v[120:123], a[238:239], v[116:117], v[120:123]
  v_mfma_f32_4x4x4_16b_bf16 v[124:127], a[238:239], v[118:119], v[124:127]
  v_mfma_f32_4x4x4_16b_bf16 v[128:131], a[208:209], v[90:91], 0
  v_mfma_f32_4x4x4_16b_bf16 v[132:135], a[208:209], v[92:93], 0
  s_nop 0
  v_mfma_f32_4x4x4_16b_bf16 v[128:131], a[210:211], v[92:93], v[128:131]
  v_mfma_f32_4x4x4_16b_bf16 v[132:135], a[210:211], v[94:95], v[132:135]
  s_nop 0
  v_mfma_f32_4x4x4_16b_bf16 v[128:131], a[212:213], v[94:95], v[128:131]
  v_cvt_pk_bf16_f32 v140, v120, v121
  v_mfma_f32_4x4x4_16b_bf16 v[132:135], a[212:213], v[96:97], v[132:135]
  v_cvt_pk_bf16_f32 v141, v124, v125
  v_mfma_f32_4x4x4_16b_bf16 v[128:131], a[214:215], v[96:97], v[128:131]
  ds_write_b64 v11, v[140:141] offset:0
  v_mfma_f32_4x4x4_16b_bf16 v[132:135], a[214:215], v[98:99], v[132:135]
  v_mfma_f32_4x4x4_16b_bf16 v[128:131], a[216:217], v[100:101], v[128:131]
  v_cvt_pk_bf16_f32 v142, v122, v123
  v_mfma_f32_4x4x4_16b_bf16 v[132:135], a[216:217], v[102:103], v[132:135]
  v_cvt_pk_bf16_f32 v143, v126, v127
  v_mfma_f32_4x4x4_16b_bf16 v[128:131], a[218:219], v[102:103], v[128:131]
  ds_write_b64 v11, v[142:143] offset:2048
  v_mfma_f32_4x4x4_16b_bf16 v[132:135], a[218:219], v[104:105], v[132:135]
  v_mfma_f32_4x4x4_16b_bf16 v[128:131], a[220:221], v[104:105], v[128:131]
  s_add_u32 m0, s29, 0
  s_add_u32 s31, s24, 0
  s_nop 0
  buffer_load_dwordx4 v2, s[8:11], s31 offen offset:0 lds
  v_mfma_f32_4x4x4_16b_bf16 v[132:135], a[220:221], v[106:107], v[132:135]
  v_mfma_f32_4x4x4_16b_bf16 v[128:131], a[222:223], v[106:107], v[128:131]
  ds_read_b64 v[90:91], v10 offset:29920
  v_mfma_f32_4x4x4_16b_bf16 v[132:135], a[222:223], v[108:109], v[132:135]
  v_mfma_f32_4x4x4_16b_bf16 v[128:131], a[224:225], v[110:111], v[128:131]
  ds_read_b64 v[92:93], v10 offset:30464
  v_mfma_f32_4x4x4_16b_bf16 v[132:135], a[224:225], v[112:113], v[132:135]
  buffer_load_dwordx4 v2, s[8:11], s31 offen offset:1024 lds
  v_mfma_f32_4x4x4_16b_bf16 v[128:131], a[226:227], v[112:113], v[128:131]
  ds_read_b64 v[94:95], v10 offset:31008
  v_mfma_f32_4x4x4_16b_bf16 v[132:135], a[226:227], v[114:115], v[132:135]
  v_mfma_f32_4x4x4_16b_bf16 v[128:131], a[228:229], v[114:115], v[128:131]
  ds_read_b64 v[96:97], v10 offset:31552
  v_mfma_f32_4x4x4_16b_bf16 v[132:135], a[228:229], v[116:117], v[132:135]
  buffer_load_dwordx4 v2, s[8:11], s31 offen offset:2048 lds
  v_mfma_f32_4x4x4_16b_bf16 v[128:131], a[230:231], v[116:117], v[128:131]
  ds_read_b64 v[98:99], v10 offset:32096
  v_mfma_f32_4x4x4_16b_bf16 v[132:135], a[230:231], v[118:119], v[132:135]
  s_waitcnt lgkmcnt(7)
  v_mfma_f32_4x4x4_16b_bf16 v[128:131], a[232:233], v[80:81], v[128:131]
  buffer_load_dwordx4 v2, s[8:11], s31 offen offset:3072 lds
  v_mfma_f32_4x4x4_16b_bf16 v[132:135], a[232:233], v[82:83], v[132:135]
  v_mfma_f32_4x4x4_16b_bf16 v[128:131], a[234:235], v[82:83], v[128:131]
  s_nop 0
  v_mfma_f32_4x4x4_16b_bf16 v[132:135], a[234:235], v[84:85], v[132:135]
  v_mfma_f32_4x4x4_16b_bf16 v[128:131], a[236:237], v[84:85], v[128:131]
  s_nop 0
  v_mfma_f32_4x4x4_16b_bf16 v[132:135], a[236:237], v[86:87], v[132:135]
  v_mfma_f32_4x4x4_16b_bf16 v[128:131], a[238:239], v[86:87], v[128:131]
  s_nop 0
  v_mfma_f32_4x4x4_16b_bf16 v[132:135], a[238:239], v[88:89], v[132:135]
  v_mfma_f32_4x4x4_16b_bf16 v[120:123], a[208:209], v[100:101], 0
  v_mfma_f32_4x4x4_16b_bf16 v[124:127], a[208:209], v[102:103], 0
  s_nop 0
  v_mfma_f32_4x4x4_16b_bf16 v[120:123], a[210:211], v[102:103], v[120:123]
  v_mfma_f32_4x4x4_16b_bf16 v[124:127], a[210:211], v[104:105], v[124:127]
  s_nop 0
  v_mfma_f32_4x4x4_16b_bf16 v[120:123], a[212:213], v[104:105], v[120:123]
  v_cvt_pk_bf16_f32 v140, v128, v129
  v_mfma_f32_4x4x4_16b_bf16 v[124:127], a[212:213], v[106:107], v[124:127]
  v_cvt_pk_bf16_f32 v141, v132, v133
  v_mfma_f32_4x4x4_16b_bf16 v[120:123], a[214:215], v[106:107], v[120:123]
  ds_write_b64 v11, v[140:141] offset:4096
  v_mfma_f32_4x4x4_16b_bf16 v[124:127], a[214:215], v[108:109], v[124:127]
  v_mfma_f32_4x4x4_16b_bf16 v[120:123], a[216:217], v[110:111], v[120:123]
  v_cvt_pk_bf16_f32 v142, v130, v131
  v_mfma_f32_4x4x4_16b_bf16 v[124:127], a[216:217], v[112:113], v[124:127]
  v_cvt_pk_bf16_f32 v143, v134, v135
  v_mfma_f32_4x4x4_16b_bf16 v[120:123], a[218:219], v[112:113], v[120:123]
  ds_write_b64 v11, v[142:143] offset:6144
  v_mfma_f32_4x4x4_16b_bf16 v[124:127], a[218:219], v[114:115], v[124:127]
  v_mfma_f32_4x4x4_16b_bf16 v[120:123], a[220:221], v[114:115], v[120:123]
  s_nop 0
  v_mfma_f32_4x4x4_16b_bf16 v[124:127], a[220:221], v[116:117], v[124:127]
  v_mfma_f32_4x4x4_16b_bf16 v[120:123], a[222:223], v[116:117], v[120:123]
  ds_read_b64 v[100:101], v10 offset:35904
  v_mfma_f32_4x4x4_16b_bf16 v[124:127], a[222:223], v[118:119], v[124:127]
  v_mfma_f32_4x4x4_16b_bf16 v[120:123], a[224:225], v[80:81], v[120:123]
  ds_read_b64 v[102:103], v10 offset:36448
  v_mfma_f32_4x4x4_16b_bf16 v[124:127], a[224:225], v[82:83], v[124:127]
  v_mfma_f32_4x4x4_16b_bf16 v[120:123], a[226:227], v[82:83], v[120:123]
  ds_read_b64 v[104:105], v10 offset:36992
  v_mfma_f32_4x4x4_16b_bf16 v[124:127], a[226:227], v[84:85], v[124:127]
  v_mfma_f32_4x4x4_16b_bf16 v[120:123], a[228:229], v[84:85], v[120:123]
  ds_read_b64 v[106:107], v10 offset:37536
  v_mfma_f32_4x4x4_16b_bf16 v[124:127], a[228:229], v[86:87], v[124:127]
  v_mfma_f32_4x4x4_16b_bf16 v[120:123], a[230:231], v[86:87], v[120:123]
  ds_read_b64 v[108:109], v10 offset:38080
  v_mfma_f32_4x4x4_16b_bf16 v[124:127], a[230:231], v[88:89], v[124:127]
  s_waitcnt lgkmcnt(7)
  v_mfma_f32_4x4x4_16b_bf16 v[120:123], a[232:233], v[90:91], v[120:123]
  v_mfma_f32_4x4x4_16b_bf16 v[124:127], a[232:233], v[92:93], v[124:127]
  s_nop 0
  v_mfma_f32_4x4x4_16b_bf16 v[120:123], a[234:235], v[92:93], v[120:123]
  v_mfma_f32_4x4x4_16b_bf16 v[124:127], a[234:235], v[94:95], v[124:127]
  s_nop 0
  v_mfma_f32_4x4x4_16b_bf16 v[120:123], a[236:237], v[94:95], v[120:123]
  v_mfma_f32_4x4x4_16b_bf16 v[124:127], a[236:237], v[96:97], v[124:127]
  s_nop 0
  v_mfma_f32_4x4x4_16b_bf16 v[120:123], a[238:239], v[96:97], v[120:123]
  v_mfma_f32_4x4x4_16b_bf16 v[124:127], a[238:239], v[98:99], v[124:127]
  v_mfma_f32_4x4x4_16b_bf16 v[128:131], a[208:209], v[110:111], 0
  v_mfma_f32_4x4x4_16b_bf16 v[132:135], a[208:209], v[112:113], 0
  s_nop 0
  v_mfma_f32_4x4x4_16b_bf16 v[128:131], a[210:211], v[112:113], v[128:131]
  v_mfma_f32_4x4x4_16b_bf16 v[132:135], a[210:211], v[114:115], v[132:135]
  s_nop 0
  v_mfma_f32_4x4x4_16b_bf16 v[128:131], a[212:213], v[114:115], v[128:131]
  v_cvt_pk_bf16_f32 v140, v120, v121
  v_mfma_f32_4x4x4_16b_bf16 v[132:135], a[212:213], v[116:117], v[132:135]
  v_cvt_pk_bf16_f32 v141, v124, v125
  v_mfma_f32_4x4x4_16b_bf16 v[128:131], a[214:215], v[116:117], v[128:131]
  s_add_u32 m0, s29, 4096
  s_add_u32 s31, s24, 4096
  s_nop 0
  buffer_load_dwordx4 v2, s[8:11], s31 offen offset:0 lds
  v_mfma_f32_4x4x4_16b_bf16 v[132:135], a[214:215], v[118:119], v[132:135]
  ds_write_b64 v11, v[140:141] offset:8192
  v_mfma_f32_4x4x4_16b_bf16 v[128:131], a[216:217], v[80:81], v[128:131]
  v_cvt_pk_bf16_f32 v142, v122, v123
  v_mfma_f32_4x4x4_16b_bf16 v[132:135], a[216:217], v[82:83], v[132:135]
  v_cvt_pk_bf16_f32 v143, v126, v127
  v_mfma_f32_4x4x4_16b_bf16 v[128:131], a[218:219], v[82:83], v[128:131]
  buffer_load_dwordx4 v2, s[8:11], s31 offen offset:1024 lds
  v_mfma_f32_4x4x4_16b_bf16 v[132:135], a[218:219], v[84:85], v[132:135]
  ds_write_b64 v11, v[142:143] offset:10240
  v_mfma_f32_4x4x4_16b_bf16 v[128:131], a[220:221], v[84:85], v[128:131]
  buffer_load_dwordx4 v2, s[8:11], s31 offen offset:2048 lds
  v_mfma_f32_4x4x4_16b_bf16 v[132:135], a[220:221], v[86:87], v[132:135]
  v_mfma_f32_4x4x4_16b_bf16 v[128:131], a[222:223], v[86:87], v[128:131]
  ds_read_b64 v[110:111], v10 offset:41888
  v_mfma_f32_4x4x4_16b_bf16 v[132:135], a[222:223], v[88:89], v[132:135]
  v_mfma_f32_4x4x4_16b_bf16 v[128:131], a[224:225], v[90:91], v[128:131]
  ds_read_b64 v[112:113], v10 offset:42432
  v_mfma_f32_4x4x4_16b_bf16 v[132:135], a[224:225], v[92:93], v[132:135]
  buffer_load_dwordx4 v2, s[8:11], s31 offen offset:3072 lds
  v_mfma_f32_4x4x4_16b_bf16 v[128:131], a[226:227], v[92:93], v[128:131]
  ds_read_b64 v[114:115], v10 offset:42976
  v_mfma_f32_4x4x4_16b_bf16 v[132:135], a[226:227], v[94:95], v[132:135]
  v_mfma_f32_4x4x4_16b_bf16 v[128:131], a[228:229], v[94:95], v[128:131]
  ds_read_b64 v[116:117], v10 offset:43520
  v_mfma_f32_4x4x4_16b_bf16 v[132:135], a[228:229], v[96:97], v[132:135]
  v_mfma_f32_4x4x4_16b_bf16 v[128:131], a[230:231], v[96:97], v[128:131]
  ds_read_b64 v[118:119], v10 offset:44064
  v_mfma_f32_4x4x4_16b_bf16 v[132:135], a[230:231], v[98:99], v[132:135]
  s_waitcnt lgkmcnt(7)
  v_mfma_f32_4x4x4_16b_bf16 v[128:131], a[232:233], v[100:101], v[128:131]
  v_mfma_f32_4x4x4_16b_bf16 v[132:135], a[232:233], v[102:103], v[132:135]
  s_nop 0
  v_mfma_f32_4x4x4_16b_bf16 v[128:131], a[234:235], v[102:103], v[128:131]
  v_mfma_f32_4x4x4_16b_bf16 v[132:135], a[234:235], v[104:105], v[132:135]
  s_nop 0
  v_mfma_f32_4x4x4_16b_bf16 v[128:131], a[236:237], v[104:105], v[128:131]
  v_mfma_f32_4x4x4_16b_bf16 v[132:135], a[236:237], v[106:107], v[132:135]
  s_nop 0
  v_mfma_f32_4x4x4_16b_bf16 v[128:131], a[238:239], v[106:107], v[128:131]
  v_mfma_f32_4x4x4_16b_bf16 v[132:135], a[238:239], v[108:109], v[132:135]
  v_mfma_f32_4x4x4_16b_bf16 v[120:123], a[208:209], v[80:81], 0
  v_mfma_f32_4x4x4_16b_bf16 v[124:127], a[208:209], v[82:83], 0
  s_nop 0
  v_mfma_f32_4x4x4_16b_bf16 v[120:123], a[210:211], v[82:83], v[120:123]
  v_mfma_f32_4x4x4_16b_bf16 v[124:127], a[210:211], v[84:85], v[124:127]
  s_nop 0
  v_mfma_f32_4x4x4_16b_bf16 v[120:123], a[212:213], v[84:85], v[120:123]
  v_cvt_pk_bf16_f32 v140, v128, v129
  v_mfma_f32_4x4x4_16b_bf16 v[124:127], a[212:213], v[86:87], v[124:127]
  v_cvt_pk_bf16_f32 v141, v132, v133
  v_mfma_f32_4x4x4_16b_bf16 v[120:123], a[214:215], v[86:87], v[120:123]
  ds_write_b64 v11, v[140:141] offset:12288
  v_mfma_f32_4x4x4_16b_bf16 v[124:127], a[214:215], v[88:89], v[124:127]
  v_mfma_f32_4x4x4_16b_bf16 v[120:123], a[216:217], v[90:91], v[120:123]
  v_cvt_pk_bf16_f32 v142, v130, v131
  v_mfma_f32_4x4x4_16b_bf16 v[124:127], a[216:217], v[92:93], v[124:127]
  v_cvt_pk_bf16_f32 v143, v134, v135
  v_mfma_f32_4x4x4_16b_bf16 v[120:123], a[218:219], v[92:93], v[120:123]
  ds_write_b64 v11, v[142:143] offset:14336
  v_mfma_f32_4x4x4_16b_bf16 v[124:127], a[218:219], v[94:95], v[124:127]
  v_mfma_f32_4x4x4_16b_bf16 v[120:123], a[220:221], v[94:95], v[120:123]
  s_nop 0
  v_mfma_f32_4x4x4_16b_bf16 v[124:127], a[220:221], v[96:97], v[124:127]
  v_mfma_f32_4x4x4_16b_bf16 v[120:123], a[222:223], v[96:97], v[120:123]
  ds_read_b64 v[80:81], v10 offset:47872
  v_mfma_f32_4x4x4_16b_bf16 v[124:127], a[222:223], v[98:99], v[124:127]
  v_mfma_f32_4x4x4_16b_bf16 v[120:123], a[224:225], v[100:101], v[120:123]
  ds_read_b64 v[82:83], v10 offset:48416
  v_mfma_f32_4x4x4_16b_bf16 v[124:127], a[224:225], v[102:103], v[124:127]
  v_mfma_f32_4x4x4_16b_bf16 v[120:123], a[226:227], v[102:103], v[120:123]
  ds_read_b64 v[84:85], v10 offset:48960
  v_mfma_f32_4x4x4_16b_bf16 v[124:127], a[226:227], v[104:105], v[124:127]
  v_mfma_f32_4x4x4_16b_bf16 v[120:123], a[228:229], v[104:105], v[120:123]
  ds_read_b64 v[86:87], v10 offset:49504
  v_mfma_f32_4x4x4_16b_bf16 v[124:127], a[228:229], v[106:107], v[124:127]
  v_mfma_f32_4x4x4_16b_bf16 v[120:123], a[230:231], v[106:107], v[120:123]
  ds_read_b64 v[88:89], v10 offset:50048
  v_mfma_f32_4x4x4_16b_bf16 v[124:127], a[230:231], v[108:109], v[124:127]
  s_add_u32 m0, s29, 8192
  s_add_u32 s31, s24, 8192
  s_nop 0
  buffer_load_dwordx4 v2, s[8:11], s31 offen offset:0 lds
  s_waitcnt lgkmcnt(7)
  v_mfma_f32_4x4x4_16b_bf16 v[120:123], a[232:233], v[110:111], v[120:123]
  v_mfma_f32_4x4x4_16b_bf16 v[124:127], a[232:233], v[112:113], v[124:127]
  s_nop 0
  v_mfma_f32_4x4x4_16b_bf16 v[120:123], a[234:235], v[112:113], v[120:123]
  buffer_load_dwordx4 v2, s[8:11], s31 offen offset:1024 lds
  v_mfma_f32_4x4x4_16b_bf16 v[124:127], a[234:235], v[114:115], v[124:127]
  v_mfma_f32_4x4x4_16b_bf16 v[120:123], a[236:237], v[114:115], v[120:123]
  s_nop 0
  v_mfma_f32_4x4x4_16b_bf16 v[124:127], a[236:237], v[116:117], v[124:127]
  v_mfma_f32_4x4x4_16b_bf16 v[120:123], a[238:239], v[116:117], v[120:123]
  buffer_load_dwordx4 v2, s[8:11], s31 offen offset:2048 lds
  v_mfma_f32_4x4x4_16b_bf16 v[124:127], a[238:239], v[118:119], v[124:127]
  v_mfma_f32_4x4x4_16b_bf16 v[128:131], a[208:209], v[90:91], 0
  v_mfma_f32_4x4x4_16b_bf16 v[132:135], a[208:209], v[92:93], 0
  s_nop 0
  v_mfma_f32_4x4x4_16b_bf16 v[128:131], a[210:211], v[92:93], v[128:131]
  buffer_load_dwordx4 v2, s[8:11], s31 offen offset:3072 lds
  v_mfma_f32_4x4x4_16b_bf16 v[132:135], a[210:211], v[94:95], v[132:135]
  v_mfma_f32_4x4x4_16b_bf16 v[128:131], a[212:213], v[94:95], v[128:131]
  v_cvt_pk_bf16_f32 v140, v120, v121
  v_mfma_f32_4x4x4_16b_bf16 v[132:135], a[212:213], v[96:97], v[132:135]
  v_cvt_pk_bf16_f32 v141, v124, v125
  v_mfma_f32_4x4x4_16b_bf16 v[128:131], a[214:215], v[96:97], v[128:131]
  ds_write_b64 v11, v[140:141] offset:16384
  v_mfma_f32_4x4x4_16b_bf16 v[132:135], a[214:215], v[98:99], v[132:135]
  v_mfma_f32_4x4x4_16b_bf16 v[128:131], a[216:217], v[100:101], v[128:131]
  v_cvt_pk_bf16_f32 v142, v122, v123
  v_mfma_f32_4x4x4_16b_bf16 v[132:135], a[216:217], v[102:103], v[132:135]
  v_cvt_pk_bf16_f32 v143, v126, v127
  v_mfma_f32_4x4x4_16b_bf16 v[128:131], a[218:219], v[102:103], v[128:131]
  ds_write_b64 v11, v[142:143] offset:18432
  v_mfma_f32_4x4x4_16b_bf16 v[132:135], a[218:219], v[104:105], v[132:135]
  v_mfma_f32_4x4x4_16b_bf16 v[128:131], a[220:221], v[104:105], v[128:131]
  s_nop 0
  v_mfma_f32_4x4x4_16b_bf16 v[132:135], a[220:221], v[106:107], v[132:135]
  v_mfma_f32_4x4x4_16b_bf16 v[128:131], a[222:223], v[106:107], v[128:131]
  s_nop 0
  v_mfma_f32_4x4x4_16b_bf16 v[132:135], a[222:223], v[108:109], v[132:135]
  v_mfma_f32_4x4x4_16b_bf16 v[128:131], a[224:225], v[110:111], v[128:131]
  s_nop 0
  v_mfma_f32_4x4x4_16b_bf16 v[132:135], a[224:225], v[112:113], v[132:135]
  v_mfma_f32_4x4x4_16b_bf16 v[128:131], a[226:227], v[112:113], v[128:131]
  s_nop 0
  v_mfma_f32_4x4x4_16b_bf16 v[132:135], a[226:227], v[114:115], v[132:135]
  v_mfma_f32_4x4x4_16b_bf16 v[128:131], a[228:229], v[114:115], v[128:131]
  s_nop 0
  v_mfma_f32_4x4x4_16b_bf16 v[132:135], a[228:229], v[116:117], v[132:135]
  v_mfma_f32_4x4x4_16b_bf16 v[128:131], a[230:231], v[116:117], v[128:131]
  s_nop 0
  v_mfma_f32_4x4x4_16b_bf16 v[132:135], a[230:231], v[118:119], v[132:135]
  s_waitcnt lgkmcnt(2)
  v_mfma_f32_4x4x4_16b_bf16 v[128:131], a[232:233], v[80:81], v[128:131]
  v_mfma_f32_4x4x4_16b_bf16 v[132:135], a[232:233], v[82:83], v[132:135]
  s_nop 0
  v_mfma_f32_4x4x4_16b_bf16 v[128:131], a[234:235], v[82:83], v[128:131]
  v_mfma_f32_4x4x4_16b_bf16 v[132:135], a[234:235], v[84:85], v[132:135]
  s_nop 0
  v_mfma_f32_4x4x4_16b_bf16 v[128:131], a[236:237], v[84:85], v[128:131]
  v_mfma_f32_4x4x4_16b_bf16 v[132:135], a[236:237], v[86:87], v[132:135]
  s_nop 0
  v_mfma_f32_4x4x4_16b_bf16 v[128:131], a[238:239], v[86:87], v[128:131]
  v_mfma_f32_4x4x4_16b_bf16 v[132:135], a[238:239], v[88:89], v[132:135]
  s_nop 4
  v_cvt_pk_bf16_f32 v140, v128, v129
  v_cvt_pk_bf16_f32 v141, v132, v133
  ds_write_b64 v11, v[140:141] offset:20480
  v_cvt_pk_bf16_f32 v142, v130, v131
  v_cvt_pk_bf16_f32 v143, v134, v135
  ds_write_b64 v11, v[142:143] offset:22528
  s_waitcnt lgkmcnt(0)
  s_barrier
  ds_read_b64_tr_b16 v[160:161], v12 offset:0
  ds_read_b64_tr_b16 v[162:163], v13 offset:0
  ds_read_b64_tr_b16 v[164:165], v12 offset:1024
  ds_read_b64_tr_b16 v[166:167], v13 offset:1024
  ds_read_b64_tr_b16 v[184:185], v12 offset:2048
  ds_read_b64_tr_b16 v[186:187], v13 offset:2048
  ds_read_b64_tr_b16 v[188:189], v12 offset:3072
  ds_read_b64_tr_b16 v[190:191], v13 offset:3072
  ds_read_b64_tr_b16 v[208:209], v12 offset:4096
  ds_read_b64_tr_b16 v[210:211], v13 offset:4096
  ds_read_b64_tr_b16 v[212:213], v12 offset:5120
  ds_read_b64_tr_b16 v[214:215], v13 offset:5120
  v_add_u32 v12, s97, v12
  v_add_u32 v13, s97, v13
  s_sub_u32 s97, 0, s97
  v_add_u32 v10, s34, v10
  v_subrev_u32 v8, s34, v8
  v_subrev_u32 v9, s34, v9
  v_add_u32 v11, s35, v11
  s_sub_u32 s34, 0, s34
  s_sub_u32 s35, 0, s35
  s_branch fused_kernel_last
fused_kernel_nl:
  s_cmp_eq_u32 s37, 1
  s_cbranch_scc0 fused_kernel_nopoll
  s_cmp_eq_u32 s40, 0
  s_cbranch_scc0 fused_kernel_nopoll
  global_load_dword v1, v3, s[4:5] sc1
fused_kernel_nopoll:
  ds_read_b64 v[80:81], v10 offset:0
  ds_read_b64 v[82:83], v10 offset:544
  ds_read_b64 v[84:85], v10 offset:1088
  ds_read_b64 v[86:87], v10 offset:1632
  ds_read_b64 v[88:89], v10 offset:2176
  ds_read_b64 v[90:91], v10 offset:5984
  ds_read_b64 v[92:93], v10 offset:6528
  ds_read_b64 v[94:95], v10 offset:7072
  ds_read_b64 v[96:97], v10 offset:7616
  ds_read_b64 v[98:99], v10 offset:8160
  ds_read_b64 v[100:101], v10 offset:11968
  ds_read_b64 v[102:103], v10 offset:12512
  ds_read_b64 v[104:105], v10 offset:13056
  ds_read_b64 v[106:107], v10 offset:13600
  ds_read_b64 v[108:109], v10 offset:14144
  ds_read_b64 v[110:111], v10 offset:17952
  ds_read_b64 v[112:113], v10 offset:18496
  ds_read_b64 v[114:115], v10 offset:19040
  ds_read_b64 v[116:117], v10 offset:19584
  ds_read_b64 v[118:119], v10 offset:20128
  s_waitcnt vmcnt(12)
  v_xad_u32 v14, v0, 0, v8
  v_perm_b32 v136, v20, v16, s33
  v_perm_b32 v137, v28, v24, s33
  v_perm_b32 v138, v20, v16, s41
  v_perm_b32 v139, v28, v24, s41
  ds_write_b128 v14, v[136:139] offset:0
  s_waitcnt lgkmcnt(15)
  v_mfma_f32_4x4x4_16b_bf16 v[120:123], a[208:209], v[80:81], 0
  v_mfma_f32_4x4x4_16b_bf16 v[124:127], a[208:209], v[82:83], 0
  s_nop 0
  v_mfma_f32_4x4x4_16b_bf16 v[120:123], a[210:211], v[82:83], v[120:123]
  v_mfma_f32_4x4x4_16b_bf16 v[124:127], a[210:211], v[84:85], v[124:127]
  s_nop 0
  v_mfma_f32_4x4x4_16b_bf16 v[120:123], a[212:213], v[84:85], v[120:123]
  v_mfma_f32_4x4x4_16b_bf16 v[124:127], a[212:213], v[86:87], v[124:127]
  s_nop 0
  v_mfma_f32_4x4x4_16b_bf16 v[120:123], a[214:215], v[86:87], v[120:123]
  v_mfma_f32_4x4x4_16b_bf16 v[124:127], a[214:215], v[88:89], v[124:127]
  s_waitcnt lgkmcnt(11)
  v_mfma_f32_4x4x4_16b_bf16 v[120:123], a[216:217], v[90:91], v[120:123]
  v_xad_u32 v14, v0, 16, v8
  v_mfma_f32_4x4x4_16b_bf16 v[124:127], a[216:217], v[92:93], v[124:127]
  v_perm_b32 v136, v21, v17, s33
  v_mfma_f32_4x4x4_16b_bf16 v[120:123], a[218:219], v[92:93], v[120:123]
  v_perm_b32 v137, v29, v25, s33
  v_mfma_f32_4x4x4_16b_bf16 v[124:127], a[218:219], v[94:95], v[124:127]
  v_perm_b32 v138, v21, v17, s41
  v_mfma_f32_4x4x4_16b_bf16 v[120:123], a[220:221], v[94:95], v[120:123]
  v_perm_b32 v139, v29, v25, s41
  v_mfma_f32_4x4x4_16b_bf16 v[124:127], a[220:221], v[96:97], v[124:127]
  ds_write_b128 v14, v[136:139] offset:128
  v_mfma_f32_4x4x4_16b_bf16 v[120:123], a[222:223], v[96:97], v[120:123]
  ds_read_b64 v[80:81], v10 offset:23936
  v_mfma_f32_4x4x4_16b_bf16 v[124:127], a[222:223], v[98:99], v[124:127]
  s_waitcnt lgkmcnt(8)
  v_mfma_f32_4x4x4_16b_bf16 v[120:123], a[224:225], v[100:101], v[120:123]
  ds_read_b64 v[82:83], v10 offset:24480
  v_mfma_f32_4x4x4_16b_bf16 v[124:127], a[224:225], v[102:103], v[124:127]
  v_mfma_f32_4x4x4_16b_bf16 v[120:123], a[226:227], v[102:103], v[120:123]
  ds_read_b64 v[84:85], v10 offset:25024
  v_mfma_f32_4x4x4_16b_bf16 v[124:127], a[226:227], v[104:105], v[124:127]
  v_mfma_f32_4x4x4_16b_bf16 v[120:123], a[228:229], v[104:105], v[120:123]
  ds_read_b64 v[86:87], v10 offset:25568
  v_mfma_f32_4x4x4_16b_bf16 v[124:127], a[228:229], v[106:107], v[124:127]
  v_mfma_f32_4x4x4_16b_bf16 v[120:123], a[230:231], v[106:107], v[120:123]
  ds_read_b64 v[88:89], v10 offset:26112
  v_mfma_f32_4x4x4_16b_bf16 v[124:127], a[230:231], v[108:109], v[124:127]
  s_waitcnt lgkmcnt(7)
  v_mfma_f32_4x4x4_16b_bf16 v[120:123], a[232:233], v[110:111], v[120:123]
  v_xad_u32 v14, v0, 32, v8
  v_mfma_f32_4x4x4_16b_bf16 v[124:127], a[232:233], v[112:113], v[124:127]
  v_perm_b32 v136, v22, v18, s33
  v_mfma_f32_4x4x4_16b_bf16 v[120:123], a[234:235], v[112:113], v[120:123]
  v_perm_b32 v137, v30, v26, s33
  v_mfma_f32_4x4x4_16b_bf16 v[124:127], a[234:235], v[114:115], v[124:127]
  v_perm_b32 v138, v22, v18, s41
  v_mfma_f32_4x4x4_16b_bf16 v[120:123], a[236:237], v[114:115], v[120:123]
  v_perm_b32 v139, v30, v26, s41
  v_mfma_f32_4x4x4_16b_bf16 v[124:127], a[236:237], v[116:117], v[124:127]
  ds_write_b128 v14, v[136:139] offset:256
  v_mfma_f32_4x4x4_16b_bf16 v[120:123], a[238:239], v[116:117], v[120:123]
  v_mfma_f32_4x4x4_16b_bf16 v[124:127], a[238:239], v[118:119], v[124:127]
  v_mfma_f32_4x4x4_16b_bf16 v[128:131], a[208:209], v[90:91], 0
  v_mfma_f32_4x4x4_16b_bf16 v[132:135], a[208:209], v[92:93], 0
  s_nop 0
  v_mfma_f32_4x4x4_16b_bf16 v[128:131], a[210:211], v[92:93], v[128:131]
  v_mfma_f32_4x4x4_16b_bf16 v[132:135], a[210:211], v[94:95], v[132:135]
  s_nop 0
  v_mfma_f32_4x4x4_16b_bf16 v[128:131], a[212:213], v[94:95], v[128:131]
  v_cvt_pk_bf16_f32 v140, v120, v121
  v_mfma_f32_4x4x4_16b_bf16 v[132:135], a[212:213], v[96:97], v[132:135]
  v_cvt_pk_bf16_f32 v141, v124, v125
  v_mfma_f32_4x4x4_16b_bf16 v[128:131], a[214:215], v[96:97], v[128:131]
  v_xad_u32 v14, v0, 48, v8
  v_mfma_f32_4x4x4_16b_bf16 v[132:135], a[214:215], v[98:99], v[132:135]
  v_perm_b32 v136, v23, v19, s33
  v_mfma_f32_4x4x4_16b_bf16 v[128:131], a[216:217], v[100:101], v[128:131]
  v_perm_b32 v137, v31, v27, s33
  v_mfma_f32_4x4x4_16b_bf16 v[132:135], a[216:217], v[102:103], v[132:135]
  v_perm_b32 v138, v23, v19, s41
  v_mfma_f32_4x4x4_16b_bf16 v[128:131], a[218:219], v[102:103], v[128:131]
  v_perm_b32 v139, v31, v27, s41
  v_mfma_f32_4x4x4_16b_bf16 v[132:135], a[218:219], v[104:105], v[132:135]
  ds_write_b128 v14, v[136:139] offset:384
  v_mfma_f32_4x4x4_16b_bf16 v[128:131], a[220:221], v[104:105], v[128:131]
  ds_write_b64 v11, v[140:141] offset:0
  v_mfma_f32_4x4x4_16b_bf16 v[132:135], a[220:221], v[106:107], v[132:135]
  v_cvt_pk_bf16_f32 v142, v122, v123
  v_mfma_f32_4x4x4_16b_bf16 v[128:131], a[222:223], v[106:107], v[128:131]
  v_cvt_pk_bf16_f32 v143, v126, v127
  v_mfma_f32_4x4x4_16b_bf16 v[132:135], a[222:223], v[108:109], v[132:135]
  ds_write_b64 v11, v[142:143] offset:2048
  v_mfma_f32_4x4x4_16b_bf16 v[128:131], a[224:225], v[110:111], v[128:131]
  buffer_load_dwordx4 v[16:19], v216, s[16:19], 0 offen offset:128
  v_mfma_f32_4x4x4_16b_bf16 v[132:135], a[224:225], v[112:113], v[132:135]
  ds_read_b64 v[90:91], v10 offset:29920
  v_mfma_f32_4x4x4_16b_bf16 v[128:131], a[226:227], v[112:113], v[128:131]
  ds_read_b64 v[92:93], v10 offset:30464
  v_mfma_f32_4x4x4_16b_bf16 v[132:135], a[226:227], v[114:115], v[132:135]
  buffer_load_dwordx4 v[20:23], v217, s[16:19], 0 offen offset:128
  v_mfma_f32_4x4x4_16b_bf16 v[128:131], a[228:229], v[114:115], v[128:131]
  ds_read_b64 v[94:95], v10 offset:31008
  v_mfma_f32_4x4x4_16b_bf16 v[132:135], a[228:229], v[116:117], v[132:135]
  ds_read_b64 v[96:97], v10 offset:31552
  v_mfma_f32_4x4x4_16b_bf16 v[128:131], a[230:231], v[116:117], v[128:131]
  buffer_load_dwordx4 v[24:27], v218, s[16:19], 0 offen offset:128
  v_mfma_f32_4x4x4_16b_bf16 v[132:135], a[230:231], v[118:119], v[132:135]
  ds_read_b64 v[98:99], v10 offset:32096
  s_waitcnt lgkmcnt(9)
  v_mfma_f32_4x4x4_16b_bf16 v[128:131], a[232:233], v[80:81], v[128:131]
  buffer_load_dwordx4 v[28:31], v219, s[16:19], 0 offen offset:128
  v_mfma_f32_4x4x4_16b_bf16 v[132:135], a[232:233], v[82:83], v[132:135]
  v_mfma_f32_4x4x4_16b_bf16 v[128:131], a[234:235], v[82:83], v[128:131]
  s_nop 0
  v_mfma_f32_4x4x4_16b_bf16 v[132:135], a[234:235], v[84:85], v[132:135]
  v_mfma_f32_4x4x4_16b_bf16 v[128:131], a[236:237], v[84:85], v[128:131]
  s_waitcnt vmcnt(12)
  v_xad_u32 v14, v0, 0, v8
  v_mfma_f32_4x4x4_16b_bf16 v[132:135], a[236:237], v[86:87], v[132:135]
  v_perm_b32 v136, v36, v32, s33
  v_mfma_f32_4x4x4_16b_bf16 v[128:131], a[238:239], v[86:87], v[128:131]
  v_perm_b32 v137, v44, v40, s33
  v_mfma_f32_4x4x4_16b_bf16 v[132:135], a[238:239], v[88:89], v[132:135]
  v_perm_b32 v138, v36, v32, s41
  v_mfma_f32_4x4x4_16b_bf16 v[120:123], a[208:209], v[100:101], 0
  v_perm_b32 v139, v44, v40, s41
  v_mfma_f32_4x4x4_16b_bf16 v[124:127], a[208:209], v[102:103], 0
  ds_write_b128 v14, v[136:139] offset:17408
  v_mfma_f32_4x4x4_16b_bf16 v[120:123], a[210:211], v[102:103], v[120:123]
  v_mfma_f32_4x4x4_16b_bf16 v[124:127], a[210:211], v[104:105], v[124:127]
  s_nop 0
  v_mfma_f32_4x4x4_16b_bf16 v[120:123], a[212:213], v[104:105], v[120:123]
  v_cvt_pk_bf16_f32 v140, v128, v129
  v_mfma_f32_4x4x4_16b_bf16 v[124:127], a[212:213], v[106:107], v[124:127]
  v_cvt_pk_bf16_f32 v141, v132, v133
  v_mfma_f32_4x4x4_16b_bf16 v[120:123], a[214:215], v[106:107], v[120:123]
  ds_write_b64 v11, v[140:141] offset:4096
  v_mfma_f32_4x4x4_16b_bf16 v[124:127], a[214:215], v[108:109], v[124:127]
  v_mfma_f32_4x4x4_16b_bf16 v[120:123], a[216:217], v[110:111], v[120:123]
  v_cvt_pk_bf16_f32 v142, v130, v131
  v_mfma_f32_4x4x4_16b_bf16 v[124:127], a[216:217], v[112:113], v[124:127]
  v_cvt_pk_bf16_f32 v143, v134, v135
  v_mfma_f32_4x4x4_16b_bf16 v[120:123], a[218:219], v[112:113], v[120:123]
  v_xad_u32 v14, v0, 16, v8
  v_mfma_f32_4x4x4_16b_bf16 v[124:127], a[218:219], v[114:115], v[124:127]
  v_perm_b32 v136, v37, v33, s33
  v_mfma_f32_4x4x4_16b_bf16 v[120:123], a[220:221], v[114:115], v[120:123]
  v_perm_b32 v137, v45, v41, s33
  v_mfma_f32_4x4x4_16b_bf16 v[124:127], a[220:221], v[116:117], v[124:127]
  v_perm_b32 v138, v37, v33, s41
  v_mfma_f32_4x4x4_16b_bf16 v[120:123], a[222:223], v[116:117], v[120:123]
  v_perm_b32 v139, v45, v41, s41
  v_mfma_f32_4x4x4_16b_bf16 v[124:127], a[222:223], v[118:119], v[124:127]
  ds_write_b128 v14, v[136:139] offset:17536
  v_mfma_f32_4x4x4_16b_bf16 v[120:123], a[224:225], v[80:81], v[120:123]
  ds_write_b64 v11, v[142:143] offset:6144
  v_mfma_f32_4x4x4_16b_bf16 v[124:127], a[224:225], v[82:83], v[124:127]
  ds_read_b64 v[100:101], v10 offset:35904
  v_mfma_f32_4x4x4_16b_bf16 v[120:123], a[226:227], v[82:83], v[120:123]
  ds_read_b64 v[102:103], v10 offset:36448
  v_mfma_f32_4x4x4_16b_bf16 v[124:127], a[226:227], v[84:85], v[124:127]
  ds_read_b64 v[104:105], v10 offset:36992
  v_mfma_f32_4x4x4_16b_bf16 v[120:123], a[228:229], v[84:85], v[120:123]
  v_xad_u32 v14, v0, 32, v8
  v_mfma_f32_4x4x4_16b_bf16 v[124:127], a[228:229], v[86:87], v[124:127]
  v_perm_b32 v136, v38, v34, s33
  v_mfma_f32_4x4x4_16b_bf16 v[120:123], a[230:231], v[86:87], v[120:123]
  v_perm_b32 v137, v46, v42, s33
  v_mfma_f32_4x4x4_16b_bf16 v[124:127], a[230:231], v[88:89], v[124:127]
  v_perm_b32 v138, v38, v34, s41
  s_waitcnt lgkmcnt(7)
  v_mfma_f32_4x4x4_16b_bf16 v[120:123], a[232:233], v[90:91], v[120:123]
  v_perm_b32 v139, v46, v42, s41
  v_mfma_f32_4x4x4_16b_bf16 v[124:127], a[232:233], v[92:93], v[124:127]
  ds_write_b128 v14, v[136:139] offset:17664
  v_mfma_f32_4x4x4_16b_bf16 v[120:123], a[234:235], v[92:93], v[120:123]
  ds_read_b64 v[106:107], v10 offset:37536
  v_mfma_f32_4x4x4_16b_bf16 v[124:127], a[234:235], v[94:95], v[124:127]
  ds_read_b64 v[108:109], v10 offset:38080
  v_mfma_f32_4x4x4_16b_bf16 v[120:123], a[236:237], v[94:95], v[120:123]
  v_xad_u32 v14, v0, 48, v8
  v_mfma_f32_4x4x4_16b_bf16 v[124:127], a[236:237], v[96:97], v[124:127]
  v_perm_b32 v136, v39, v35, s33
  v_mfma_f32_4x4x4_16b_bf16 v[120:123], a[238:239], v[96:97], v[120:123]
  v_perm_b32 v137, v47, v43, s33
  v_mfma_f32_4x4x4_16b_bf16 v[124:127], a[238:239], v[98:99], v[124:127]
  v_perm_b32 v138, v39, v35, s41
  v_mfma_f32_4x4x4_16b_bf16 v[128:131], a[208:209], v[110:111], 0
  v_perm_b32 v139, v47, v43, s41
  v_mfma_f32_4x4x4_16b_bf16 v[132:135], a[208:209], v[112:113], 0
  ds_write_b128 v14, v[136:139] offset:17792
  v_mfma_f32_4x4x4_16b_bf16 v[128:131], a[210:211], v[112:113], v[128:131]
  v_mfma_f32_4x4x4_16b_bf16 v[132:135], a[210:211], v[114:115], v[132:135]
  s_nop 0
  v_mfma_f32_4x4x4_16b_bf16 v[128:131], a[212:213], v[114:115], v[128:131]
  v_cvt_pk_bf16_f32 v140, v120, v121
  v_mfma_f32_4x4x4_16b_bf16 v[132:135], a[212:213], v[116:117], v[132:135]
  v_cvt_pk_bf16_f32 v141, v124, v125
  v_mfma_f32_4x4x4_16b_bf16 v[128:131], a[214:215], v[116:117], v[128:131]
  buffer_load_dwordx4 v[32:35], v220, s[16:19], 0 offen offset:128
  v_mfma_f32_4x4x4_16b_bf16 v[132:135], a[214:215], v[118:119], v[132:135]
  ds_write_b64 v11, v[140:141] offset:8192
  v_mfma_f32_4x4x4_16b_bf16 v[128:131], a[216:217], v[80:81], v[128:131]
  v_cvt_pk_bf16_f32 v142, v122, v123
  v_mfma_f32_4x4x4_16b_bf16 v[132:135], a[216:217], v[82:83], v[132:135]
  v_cvt_pk_bf16_f32 v143, v126, v127
  v_mfma_f32_4x4x4_16b_bf16 v[128:131], a[218:219], v[82:83], v[128:131]
  buffer_load_dwordx4 v[36:39], v221, s[16:19], 0 offen offset:128
  v_mfma_f32_4x4x4_16b_bf16 v[132:135], a[218:219], v[84:85], v[132:135]
  ds_write_b64 v11, v[142:143] offset:10240
  v_mfma_f32_4x4x4_16b_bf16 v[128:131], a[220:221], v[84:85], v[128:131]
  buffer_load_dwordx4 v[40:43], v222, s[16:19], 0 offen offset:128
  v_mfma_f32_4x4x4_16b_bf16 v[132:135], a[220:221], v[86:87], v[132:135]
  v_mfma_f32_4x4x4_16b_bf16 v[128:131], a[222:223], v[86:87], v[128:131]
  ds_read_b64 v[110:111], v10 offset:41888
  v_mfma_f32_4x4x4_16b_bf16 v[132:135], a[222:223], v[88:89], v[132:135]
  v_mfma_f32_4x4x4_16b_bf16 v[128:131], a[224:225], v[90:91], v[128:131]
  ds_read_b64 v[112:113], v10 offset:42432
  v_mfma_f32_4x4x4_16b_bf16 v[132:135], a[224:225], v[92:93], v[132:135]
  buffer_load_dwordx4 v[44:47], v223, s[16:19], 0 offen offset:128
  v_mfma_f32_4x4x4_16b_bf16 v[128:131], a[226:227], v[92:93], v[128:131]
  ds_read_b64 v[114:115], v10 offset:42976
  v_mfma_f32_4x4x4_16b_bf16 v[132:135], a[226:227], v[94:95], v[132:135]
  v_mfma_f32_4x4x4_16b_bf16 v[128:131], a[228:229], v[94:95], v[128:131]
  ds_read_b64 v[116:117], v10 offset:43520
  v_mfma_f32_4x4x4_16b_bf16 v[132:135], a[228:229], v[96:97], v[132:135]
  s_waitcnt vmcnt(12)
  v_xad_u32 v14, v0, 0, v8
  v_mfma_f32_4x4x4_16b_bf16 v[128:131], a[230:231], v[96:97], v[128:131]
  v_perm_b32 v136, v52, v48, s33
  v_mfma_f32_4x4x4_16b_bf16 v[132:135], a[230:231], v[98:99], v[132:135]
  v_perm_b32 v137, v60, v56, s33
  s_waitcnt lgkmcnt(7)
  v_mfma_f32_4x4x4_16b_bf16 v[128:131], a[232:233], v[100:101], v[128:131]
  v_perm_b32 v138, v52, v48, s41
  v_mfma_f32_4x4x4_16b_bf16 v[132:135], a[232:233], v[102:103], v[132:135]
  v_perm_b32 v139, v60, v56, s41
  v_mfma_f32_4x4x4_16b_bf16 v[128:131], a[234:235], v[102:103], v[128:131]
  ds_write_b128 v14, v[136:139] offset:34816
  v_mfma_f32_4x4x4_16b_bf16 v[132:135], a[234:235], v[104:105], v[132:135]
  ds_read_b64 v[118:119], v10 offset:44064
  v_mfma_f32_4x4x4_16b_bf16 v[128:131], a[236:237], v[104:105], v[128:131]
  v_xad_u32 v14, v0, 16, v8
  v_mfma_f32_4x4x4_16b_bf16 v[132:135], a[236:237], v[106:107], v[132:135]
  v_perm_b32 v136, v53, v49, s33
  v_mfma_f32_4x4x4_16b_bf16 v[128:131], a[238:239], v[106:107], v[128:131]
  v_perm_b32 v137, v61, v57, s33
  v_mfma_f32_4x4x4_16b_bf16 v[132:135], a[238:239], v[108:109], v[132:135]
  v_perm_b32 v138, v53, v49, s41
  v_mfma_f32_4x4x4_16b_bf16 v[120:123], a[208:209], v[80:81], 0
  v_perm_b32 v139, v61, v57, s41
  v_mfma_f32_4x4x4_16b_bf16 v[124:127], a[208:209], v[82:83], 0
  ds_write_b128 v14, v[136:139] offset:34944
  v_mfma_f32_4x4x4_16b_bf16 v[120:123], a[210:211], v[82:83], v[120:123]
  v_mfma_f32_4x4x4_16b_bf16 v[124:127], a[210:211], v[84:85], v[124:127]
  s_nop 0
  v_mfma_f32_4x4x4_16b_bf16 v[120:123], a[212:213], v[84:85], v[120:123]
  v_cvt_pk_bf16_f32 v140, v128, v129
  v_mfma_f32_4x4x4_16b_bf16 v[124:127], a[212:213], v[86:87], v[124:127]
  v_cvt_pk_bf16_f32 v141, v132, v133
  v_mfma_f32_4x4x4_16b_bf16 v[120:123], a[214:215], v[86:87], v[120:123]
  ds_write_b64 v11, v[140:141] offset:12288
  v_mfma_f32_4x4x4_16b_bf16 v[124:127], a[214:215], v[88:89], v[124:127]
  v_xad_u32 v14, v0, 32, v8
  v_mfma_f32_4x4x4_16b_bf16 v[120:123], a[216:217], v[90:91], v[120:123]
  v_perm_b32 v136, v54, v50, s33
  v_mfma_f32_4x4x4_16b_bf16 v[124:127], a[216:217], v[92:93], v[124:127]
  v_perm_b32 v137, v62, v58, s33
  v_mfma_f32_4x4x4_16b_bf16 v[120:123], a[218:219], v[92:93], v[120:123]
  v_perm_b32 v138, v54, v50, s41
  v_mfma_f32_4x4x4_16b_bf16 v[124:127], a[218:219], v[94:95], v[124:127]
  v_perm_b32 v139, v62, v58, s41
  v_mfma_f32_4x4x4_16b_bf16 v[120:123], a[220:221], v[94:95], v[120:123]
  ds_write_b128 v14, v[136:139] offset:35072
  v_mfma_f32_4x4x4_16b_bf16 v[124:127], a[220:221], v[96:97], v[124:127]
  v_cvt_pk_bf16_f32 v142, v130, v131
  v_mfma_f32_4x4x4_16b_bf16 v[120:123], a[222:223], v[96:97], v[120:123]
  v_cvt_pk_bf16_f32 v143, v134, v135
  v_mfma_f32_4x4x4_16b_bf16 v[124:127], a[222:223], v[98:99], v[124:127]
  ds_write_b64 v11, v[142:143] offset:14336
  v_mfma_f32_4x4x4_16b_bf16 v[120:123], a[224:225], v[100:101], v[120:123]
  ds_read_b64 v[80:81], v10 offset:47872
  v_mfma_f32_4x4x4_16b_bf16 v[124:127], a[224:225], v[102:103], v[124:127]
  ds_read_b64 v[82:83], v10 offset:48416
  v_mfma_f32_4x4x4_16b_bf16 v[120:123], a[226:227], v[102:103], v[120:123]
  v_xad_u32 v14, v0, 48, v8
  v_mfma_f32_4x4x4_16b_bf16 v[124:127], a[226:227], v[104:105], v[124:127]
  v_perm_b32 v136, v55, v51, s33
  v_mfma_f32_4x4x4_16b_bf16 v[120:123], a[228:229], v[104:105], v[120:123]
  v_perm_b32 v137, v63, v59, s33
  v_mfma_f32_4x4x4_16b_bf16 v[124:127], a[228:229], v[106:107], v[124:127]
  v_perm_b32 v138, v55, v51, s41
  v_mfma_f32_4x4x4_16b_bf16 v[120:123], a[230:231], v[106:107], v[120:123]
  v_perm_b32 v139, v63, v59, s41
  v_mfma_f32_4x4x4_16b_bf16 v[124:127], a[230:231], v[108:109], v[124:127]
  ds_write_b128 v14, v[136:139] offset:35200
  s_waitcnt lgkmcnt(7)
  v_mfma_f32_4x4x4_16b_bf16 v[120:123], a[232:233], v[110:111], v[120:123]
  ds_read_b64 v[84:85], v10 offset:48960
  v_mfma_f32_4x4x4_16b_bf16 v[124:127], a[232:233], v[112:113], v[124:127]
  ds_read_b64 v[86:87], v10 offset:49504
  v_mfma_f32_4x4x4_16b_bf16 v[120:123], a[234:235], v[112:113], v[120:123]
  ds_read_b64 v[88:89], v10 offset:50048
  v_mfma_f32_4x4x4_16b_bf16 v[124:127], a[234:235], v[114:115], v[124:127]
  buffer_load_dwordx4 v[48:51], v224, s[16:19], 0 offen offset:128
  v_mfma_f32_4x4x4_16b_bf16 v[120:123], a[236:237], v[114:115], v[120:123]
  buffer_load_dwordx4 v[52:55], v225, s[16:19], 0 offen offset:128
  v_mfma_f32_4x4x4_16b_bf16 v[124:127], a[236:237], v[116:117], v[124:127]
  v_mfma_f32_4x4x4_16b_bf16 v[120:123], a[238:239], v[116:117], v[120:123]
  buffer_load_dwordx4 v[56:59], v226, s[16:19], 0 offen offset:128
  v_mfma_f32_4x4x4_16b_bf16 v[124:127], a[238:239], v[118:119], v[124:127]
  v_mfma_f32_4x4x4_16b_bf16 v[128:131], a[208:209], v[90:91], 0
  v_mfma_f32_4x4x4_16b_bf16 v[132:135], a[208:209], v[92:93], 0
  s_nop 0
  v_mfma_f32_4x4x4_16b_bf16 v[128:131], a[210:211], v[92:93], v[128:131]
  buffer_load_dwordx4 v[60:63], v227, s[16:19], 0 offen offset:128
  v_mfma_f32_4x4x4_16b_bf16 v[132:135], a[210:211], v[94:95], v[132:135]
  v_mfma_f32_4x4x4_16b_bf16 v[128:131], a[212:213], v[94:95], v[128:131]
  v_cvt_pk_bf16_f32 v140, v120, v121
  v_mfma_f32_4x4x4_16b_bf16 v[132:135], a[212:213], v[96:97], v[132:135]
  v_cvt_pk_bf16_f32 v141, v124, v125
  v_mfma_f32_4x4x4_16b_bf16 v[128:131], a[214:215], v[96:97], v[128:131]
  ds_write_b64 v11, v[140:141] offset:16384
  v_mfma_f32_4x4x4_16b_bf16 v[132:135], a[214:215], v[98:99], v[132:135]
  s_waitcnt vmcnt(12)
  v_perm_b32 v136, v65, v64, s33
  v_mfma_f32_4x4x4_16b_bf16 v[128:131], a[216:217], v[100:101], v[128:131]
  v_perm_b32 v137, v67, v66, s33
  v_mfma_f32_4x4x4_16b_bf16 v[132:135], a[216:217], v[102:103], v[132:135]
  v_perm_b32 v138, v65, v64, s41
  v_mfma_f32_4x4x4_16b_bf16 v[128:131], a[218:219], v[102:103], v[128:131]
  v_perm_b32 v139, v67, v66, s41
  v_mfma_f32_4x4x4_16b_bf16 v[132:135], a[218:219], v[104:105], v[132:135]
  s_mov_b64 exec, s[100:101]
  ds_write_b128 v9, v[136:139]
  s_mov_b64 exec, -1
  v_mfma_f32_4x4x4_16b_bf16 v[128:131], a[220:221], v[104:105], v[128:131]
  v_cvt_pk_bf16_f32 v142, v122, v123
  v_mfma_f32_4x4x4_16b_bf16 v[132:135], a[220:221], v[106:107], v[132:135]
  v_cvt_pk_bf16_f32 v143, v126, v127
  v_mfma_f32_4x4x4_16b_bf16 v[128:131], a[222:223], v[106:107], v[128:131]
  ds_write_b64 v11, v[142:143] offset:18432
  v_mfma_f32_4x4x4_16b_bf16 v[132:135], a[222:223], v[108:109], v[132:135]
  buffer_load_dword v64, v228, s[16:19], 0 offen offset:128
  v_mfma_f32_4x4x4_16b_bf16 v[128:131], a[224:225], v[110:111], v[128:131]
  buffer_load_dword v65, v229, s[16:19], 0 offen offset:128
  v_mfma_f32_4x4x4_16b_bf16 v[132:135], a[224:225], v[112:113], v[132:135]
  buffer_load_dword v66, v230, s[16:19], 0 offen offset:128
  v_mfma_f32_4x4x4_16b_bf16 v[128:131], a[226:227], v[112:113], v[128:131]
  buffer_load_dword v67, v231, s[16:19], 0 offen offset:128
  v_mfma_f32_4x4x4_16b_bf16 v[132:135], a[226:227], v[114:115], v[132:135]
  v_mfma_f32_4x4x4_16b_bf16 v[128:131], a[228:229], v[114:115], v[128:131]
  s_nop 0
  v_mfma_f32_4x4x4_16b_bf16 v[132:135], a[228:229], v[116:117], v[132:135]
  v_mfma_f32_4x4x4_16b_bf16 v[128:131], a[230:231], v[116:117], v[128:131]
  s_nop 0
  v_mfma_f32_4x4x4_16b_bf16 v[132:135], a[230:231], v[118:119], v[132:135]
  s_waitcnt lgkmcnt(3)
  v_mfma_f32_4x4x4_16b_bf16 v[128:131], a[232:233], v[80:81], v[128:131]
  v_mfma_f32_4x4x4_16b_bf16 v[132:135], a[232:233], v[82:83], v[132:135]
  s_nop 0
  v_mfma_f32_4x4x4_16b_bf16 v[128:131], a[234:235], v[82:83], v[128:131]
  v_mfma_f32_4x4x4_16b_bf16 v[132:135], a[234:235], v[84:85], v[132:135]
  s_nop 0
  v_mfma_f32_4x4x4_16b_bf16 v[128:131], a[236:237], v[84:85], v[128:131]
  v_mfma_f32_4x4x4_16b_bf16 v[132:135], a[236:237], v[86:87], v[132:135]
  s_nop 0
  v_mfma_f32_4x4x4_16b_bf16 v[128:131], a[238:239], v[86:87], v[128:131]
  v_mfma_f32_4x4x4_16b_bf16 v[132:135], a[238:239], v[88:89], v[132:135]
  s_nop 4
  v_cvt_pk_bf16_f32 v140, v128, v129
  v_cvt_pk_bf16_f32 v141, v132, v133
  ds_write_b64 v11, v[140:141] offset:20480
  v_cvt_pk_bf16_f32 v142, v130, v131
  v_cvt_pk_bf16_f32 v143, v134, v135
  ds_write_b64 v11, v[142:143] offset:22528
  s_waitcnt lgkmcnt(0)
  s_barrier
  ds_read_b64_tr_b16 v[160:161], v12 offset:0
  ds_read_b64_tr_b16 v[162:163], v13 offset:0
  ds_read_b64_tr_b16 v[164:165], v12 offset:1024
  ds_read_b64_tr_b16 v[166:167], v13 offset:1024
  ds_read_b64_tr_b16 v[184:185], v12 offset:2048
  ds_read_b64_tr_b16 v[186:187], v13 offset:2048
  ds_read_b64_tr_b16 v[188:189], v12 offset:3072
  ds_read_b64_tr_b16 v[190:191], v13 offset:3072
  ds_read_b64_tr_b16 v[208:209], v12 offset:4096
  ds_read_b64_tr_b16 v[210:211], v13 offset:4096
  ds_read_b64_tr_b16 v[212:213], v12 offset:5120
  ds_read_b64_tr_b16 v[214:215], v13 offset:5120
  v_add_u32 v12, s97, v12
  v_add_u32 v13, s97, v13
  s_sub_u32 s97, 0, s97
  v_add_u32 v10, s34, v10
  v_subrev_u32 v8, s34, v8
  v_subrev_u32 v9, s34, v9
  v_add_u32 v11, s35, v11
  s_sub_u32 s34, 0, s34
  s_sub_u32 s35, 0, s35
  s_waitcnt lgkmcnt(0)
  s_cmp_eq_u32 s37, 1
  s_cbranch_scc0 fused_kernel_nochk
  s_cmp_eq_u32 s40, 0
  s_cbranch_scc0 fused_kernel_nochk
  s_waitcnt vmcnt(16)
  v_readfirstlane_b32 s44, v1
  s_nop 3
  s_cmp_ge_u32 s44, 72
  s_cbranch_scc1 fused_kernel_acq
  s_mov_b32 s45, 16384
fused_kernel_spin:
  global_load_dword v1, v3, s[4:5] sc1
  s_waitcnt vmcnt(0)
  v_readfirstlane_b32 s44, v1
  s_nop 3
  s_cmp_ge_u32 s44, 72
  s_cbranch_scc1 fused_kernel_acq
  s_sub_u32 s45, s45, 1
  s_cmp_lg_u32 s45, 0
  s_cbranch_scc1 fused_kernel_spin
  s_load_dwordx4 s[52:55], s[0:1], 16
  v_lshrrev_b32 v120, 4, v2
  s_mov_b32 s42, 0
  s_waitcnt vmcnt(0) lgkmcnt(0)
fused_kernel_self:
  s_mul_hi_u32 s46, s42, 178956971
  s_mul_i32 s47, s46, 24
  s_sub_u32 s43, s42, s47
  v_and_b32 v121, 15, v120
  v_lshrrev_b32 v122, 4, v120
  s_cmp_lt_u32 s43, 12
  s_cbranch_scc0 fused_kernel_c_pk2
  s_add_u32 s48, s46, 1
  s_cmp_eq_u32 s48, 24
  s_cselect_b32 s48, 0, s48
  s_lshr_b32 s49, s43, 1
  s_and_b32 s50, s43, 1
  s_lshl_b32 s48, s48, 6
  s_lshl_b32 s50, s50, 5
  s_add_u32 s48, s48, s50
  s_mul_i32 s49, s49, 49152
  s_add_u32 s48, s48, s49
  v_mul_u32_u24 v123, 12288, v122
  v_lshl_add_u32 v123, v121, 1, v123
  s_mov_b32 s8, s52
  s_mov_b32 s9, s53
  s_mov_b32 s10, 294912
  s_mov_b32 s11, 0x20000
  s_add_u32 s49, s48, 0
  buffer_load_ushort v128, v123, s[8:11], s49 offen
  s_add_u32 s49, s48, 1536
  buffer_load_ushort v129, v123, s[8:11], s49 offen
  s_add_u32 s49, s48, 3072
  buffer_load_ushort v130, v123, s[8:11], s49 offen
  s_add_u32 s49, s48, 4608
  buffer_load_ushort v131, v123, s[8:11], s49 offen
  s_add_u32 s49, s48, 6144
  buffer_load_ushort v132, v123, s[8:11], s49 offen
  s_add_u32 s49, s48, 7680
  buffer_load_ushort v133, v123, s[8:11], s49 offen
  s_add_u32 s49, s48, 9216
  buffer_load_ushort v134, v123, s[8:11], s49 offen
  s_add_u32 s49, s48, 10752
  buffer_load_ushort v135, v123, s[8:11], s49 offen
  s_branch fused_kernel_c_pk3
fused_kernel_c_pk2:
  s_add_u32 s48, s46, 23
  s_cmp_ge_u32 s48, 24
  s_cselect_b32 s49, 24, 0
  s_sub_u32 s48, s48, s49
  s_sub_u32 s49, s43, 12
  s_lshr_b32 s50, s49, 1
  s_and_b32 s49, s49, 1
  s_mul_i32 s48, s48, 12288
  s_lshl_b32 s50, s50, 6
  s_lshl_b32 s49, s49, 3
  s_add_u32 s48, s48, s50
  s_add_u32 s48, s48, s49
  v_lshrrev_b32 v124, 2, v121
  v_lshlrev_b32 v124, 4, v124
  v_and_b32 v125, 3, v121
  v_lshl_add_u32 v124, v125, 1, v124
  v_mul_u32_u24 v123, 1536, v122
  v_add_u32 v123, v123, v124
  s_mov_b32 s8, s54
  s_mov_b32 s9, s55
  s_mov_b32 s10, 294912
  s_mov_b32 s11, 0x20000
  s_add_u32 s49, s48, 0
  buffer_load_ushort v128, v123, s[8:11], s49 offen
  s_add_u32 s49, s48, 384
  buffer_load_ushort v129, v123, s[8:11], s49 offen
  s_add_u32 s49, s48, 768
  buffer_load_ushort v130, v123, s[8:11], s49 offen
  s_add_u32 s49, s48, 1152
  buffer_load_ushort v131, v123, s[8:11], s49 offen
  s_add_u32 s49, s48, 6144
  buffer_load_ushort v132, v123, s[8:11], s49 offen
  s_add_u32 s49, s48, 6528
  buffer_load_ushort v133, v123, s[8:11], s49 offen
  s_add_u32 s49, s48, 6912
  buffer_load_ushort v134, v123, s[8:11], s49 offen
  s_add_u32 s49, s48, 7296
  buffer_load_ushort v135, v123, s[8:11], s49 offen
fused_kernel_c_pk3:
  s_waitcnt vmcnt(0)
  v_lshl_or_b32 v136, v129, 16, v128
  v_lshl_or_b32 v137, v131, 16, v130
  v_lshl_or_b32 v138, v133, 16, v132
  v_lshl_or_b32 v139, v135, 16, v134
  s_cmp_lt_u32 s43, 12
  s_cbranch_scc1 fused_kernel_d_pk5
  v_lshlrev_b32 v128, 16, v128
  v_lshlrev_b32 v129, 16, v129
  v_lshlrev_b32 v130, 16, v130
  v_lshlrev_b32 v131, 16, v131
  v_lshlrev_b32 v132, 16, v132
  v_lshlrev_b32 v133, 16, v133
  v_lshlrev_b32 v134, 16, v134
  v_lshlrev_b32 v135, 16, v135
  v_cvt_pk_f16_f32 v136, v128, v129
  v_cvt_pk_f16_f32 v137, v130, v131
  v_cvt_pk_f16_f32 v138, v132, v133
  v_cvt_pk_f16_f32 v139, v134, v135
fused_kernel_d_pk5:
  s_add_u32 s8, s38, 0
  s_addc_u32 s9, s39, 0
  s_mov_b32 s10, 589824
  s_mov_b32 s11, 0x20000
  s_lshl_b32 s3, s42, 10
  buffer_store_dwordx4 v[136:139], v2, s[8:11], s3 offen sc1
  s_waitcnt vmcnt(0)
  s_add_u32 s42, s42, 1
  s_cmp_lt_u32 s42, 576
  s_cbranch_scc1 fused_kernel_self
fused_kernel_acq:
  buffer_inv sc1
fused_kernel_nochk:
  s_call_b64 s[42:43], fused_kernel_ln
  s_cmp_eq_u32 s37, 1
  s_cbranch_scc1 fused_kernel_ln1
  v_accvgpr_write_b32 a0, v144
  v_accvgpr_write_b32 a1, v145
  v_accvgpr_write_b32 a2, v146
  v_accvgpr_write_b32 a3, v147
  v_accvgpr_write_b32 a4, v148
  v_accvgpr_write_b32 a5, v149
  v_accvgpr_write_b32 a6, v150
  v_accvgpr_write_b32 a7, v151
  v_accvgpr_write_b32 a8, v152
  v_accvgpr_write_b32 a9, v153
  v_accvgpr_write_b32 a10, v154
  v_accvgpr_write_b32 a11, v155
  v_accvgpr_write_b32 a12, v156
  v_accvgpr_write_b32 a13, v157
  v_accvgpr_write_b32 a14, v158
  v_accvgpr_write_b32 a15, v159
  v_accvgpr_write_b32 a16, v160
  v_accvgpr_write_b32 a17, v161
  v_accvgpr_write_b32 a18, v162
  v_accvgpr_write_b32 a19, v163
  v_accvgpr_write_b32 a20, v164
  v_accvgpr_write_b32 a21, v165
  v_accvgpr_write_b32 a22, v166
  v_accvgpr_write_b32 a23, v167
  v_accvgpr_write_b32 a24, v168
  v_accvgpr_write_b32 a25, v169
  v_accvgpr_write_b32 a26, v170
  v_accvgpr_write_b32 a27, v171
  v_accvgpr_write_b32 a28, v172
  v_accvgpr_write_b32 a29, v173
  v_accvgpr_write_b32 a30, v174
  v_accvgpr_write_b32 a31, v175
  v_accvgpr_write_b32 a32, v176
  v_accvgpr_write_b32 a33, v177
  v_accvgpr_write_b32 a34, v178
  v_accvgpr_write_b32 a35, v179
  v_accvgpr_write_b32 a36, v180
  v_accvgpr_write_b32 a37, v181
  v_accvgpr_write_b32 a38, v182
  v_accvgpr_write_b32 a39, v183
  v_accvgpr_write_b32 a40, v184
  v_accvgpr_write_b32 a41, v185
  v_accvgpr_write_b32 a42, v186
  v_accvgpr_write_b32 a43, v187
  v_accvgpr_write_b32 a44, v188
  v_accvgpr_write_b32 a45, v189
  v_accvgpr_write_b32 a46, v190
  v_accvgpr_write_b32 a47, v191
  v_accvgpr_write_b32 a48, v192
  v_accvgpr_write_b32 a49, v193
  v_accvgpr_write_b32 a50, v194
  v_accvgpr_write_b32 a51, v195
  v_accvgpr_write_b32 a52, v196
  v_accvgpr_write_b32 a53, v197
  v_accvgpr_write_b32 a54, v198
  v_accvgpr_write_b32 a55, v199
  v_accvgpr_write_b32 a56, v200
  v_accvgpr_write_b32 a57, v201
  v_accvgpr_write_b32 a58, v202
  v_accvgpr_write_b32 a59, v203
  v_accvgpr_write_b32 a60, v204
  v_accvgpr_write_b32 a61, v205
  v_accvgpr_write_b32 a62, v206
  v_accvgpr_write_b32 a63, v207
  v_accvgpr_write_b32 a64, v208
  v_accvgpr_write_b32 a65, v209
  v_accvgpr_write_b32 a66, v210
  v_accvgpr_write_b32 a67, v211
  v_accvgpr_write_b32 a68, v212
  v_accvgpr_write_b32 a69, v213
  v_accvgpr_write_b32 a70, v214
  v_accvgpr_write_b32 a71, v215
  s_branch fused_kernel_lnd
fused_kernel_ln1:
  v_accvgpr_write_b32 a72, v144
  v_accvgpr_write_b32 a73, v145
  v_accvgpr_write_b32 a74, v146
  v_accvgpr_write_b32 a75, v147
  v_accvgpr_write_b32 a76, v148
  v_accvgpr_write_b32 a77, v149
  v_accvgpr_write_b32 a78, v150
  v_accvgpr_write_b32 a79, v151
  v_accvgpr_write_b32 a80, v152
  v_accvgpr_write_b32 a81, v153
  v_accvgpr_write_b32 a82, v154
  v_accvgpr_write_b32 a83, v155
  v_accvgpr_write_b32 a84, v156
  v_accvgpr_write_b32 a85, v157
  v_accvgpr_write_b32 a86, v158
  v_accvgpr_write_b32 a87, v159
  v_accvgpr_write_b32 a88, v160
  v_accvgpr_write_b32 a89, v161
  v_accvgpr_write_b32 a90, v162
  v_accvgpr_write_b32 a91, v163
  v_accvgpr_write_b32 a92, v164
  v_accvgpr_write_b32 a93, v165
  v_accvgpr_write_b32 a94, v166
  v_accvgpr_write_b32 a95, v167
  v_accvgpr_write_b32 a96, v168
  v_accvgpr_write_b32 a97, v169
  v_accvgpr_write_b32 a98, v170
  v_accvgpr_write_b32 a99, v171
  v_accvgpr_write_b32 a100, v172
  v_accvgpr_write_b32 a101, v173
  v_accvgpr_write_b32 a102, v174
  v_accvgpr_write_b32 a103, v175
  v_accvgpr_write_b32 a104, v176
  v_accvgpr_write_b32 a105, v177
  v_accvgpr_write_b32 a106, v178
  v_accvgpr_write_b32 a107, v179
  v_accvgpr_write_b32 a108, v180
  v_accvgpr_write_b32 a109, v181
  v_accvgpr_write_b32 a110, v182
  v_accvgpr_write_b32 a111, v183
  v_accvgpr_write_b32 a112, v184
  v_accvgpr_write_b32 a113, v185
  v_accvgpr_write_b32 a114, v186
  v_accvgpr_write_b32 a115, v187
  v_accvgpr_write_b32 a116, v188
  v_accvgpr_write_b32 a117, v189
  v_accvgpr_write_b32 a118, v190
  v_accvgpr_write_b32 a119, v191
  v_accvgpr_write_b32 a120, v192
  v_accvgpr_write_b32 a121, v193
  v_accvgpr_write_b32 a122, v194
  v_accvgpr_write_b32 a123, v195
  v_accvgpr_write_b32 a124, v196
  v_accvgpr_write_b32 a125, v197
  v_accvgpr_write_b32 a126, v198
  v_accvgpr_write_b32 a127, v199
  v_accvgpr_write_b32 a128, v200
  v_accvgpr_write_b32 a129, v201
  v_accvgpr_write_b32 a130, v202
  v_accvgpr_write_b32 a131, v203
  v_accvgpr_write_b32 a132, v204
  v_accvgpr_write_b32 a133, v205
  v_accvgpr_write_b32 a134, v206
  v_accvgpr_write_b32 a135, v207
  v_accvgpr_write_b32 a136, v208
  v_accvgpr_write_b32 a137, v209
  v_accvgpr_write_b32 a138, v210
  v_accvgpr_write_b32 a139, v211
  v_accvgpr_write_b32 a140, v212
  v_accvgpr_write_b32 a141, v213
  v_accvgpr_write_b32 a142, v214
  v_accvgpr_write_b32 a143, v215
fused_kernel_lnd:
  s_add_u32 s37, s37, 1
  s_branch fused_kernel_tile
fused_kernel_last:
  s_waitcnt vmcnt(0) lgkmcnt(0)
  s_barrier
  s_load_dwordx2 s[6:7], s[0:1], 32
  v_mbcnt_lo_u32_b32 v0, -1, 0
  v_mbcnt_hi_u32_b32 v0, -1, v0
  s_mov_b32 s34, 0xc4eac4ea
  s_mov_b32 s35, 0x37803780
  v_lshlrev_b32 v2, 4, v0
  v_mov_b32 v1, v2
  v_and_b32 v4, 15, v0
  v_lshrrev_b32 v5, 4, v0
  v_mul_u32_u24 v3, 384, v4
  v_lshl_add_u32 v3, v5, 4, v3
  v_lshrrev_b32 v6, 2, v4
  v_cmp_eq_u32 vcc, v6, v5
  v_and_b32 v6, 1, v4
  v_lshlrev_b32 v6, 4, v6
  v_mov_b32 v7, 0x3f80
  v_lshlrev_b32 v7, v6, v7
  v_cndmask_b32 v7, 0, v7, vcc
  v_and_b32 v6, 2, v4
  v_cmp_eq_u32 vcc, 0, v6
  s_nop 1
  v_cndmask_b32 v8, 0, v7, vcc
  v_sub_u32 v9, v7, v8
  v_mov_b32 v10, 0
  v_accvgpr_write_b32 a248, v8
  v_accvgpr_write_b32 a249, v9
  v_accvgpr_write_b32 a250, v10
  v_accvgpr_write_b32 a251, v10
  v_accvgpr_write_b32 a252, v10
  v_accvgpr_write_b32 a253, v10
  v_accvgpr_write_b32 a254, v8
  v_accvgpr_write_b32 a255, v9
  s_add_u32 s8, s38, 0
  s_addc_u32 s9, s39, 0
  s_mov_b32 s10, 589824
  s_mov_b32 s11, 0x20000
  s_mul_i32 s29, s40, 12288
  s_mul_i32 s30, s2, 221184
  s_mul_i32 s41, s40, 18432
  s_add_u32 s30, s30, s41
  s_waitcnt lgkmcnt(0)
  s_mov_b32 s20, s6
  s_mov_b32 s21, s7
  s_mov_b32 s22, 56623104
  s_mov_b32 s23, 0x20000
  s_mov_b32 s98, s6
  s_mov_b32 s99, s7
  s_lshr_b32 s24, s2, 3
  s_and_b32 s25, s2, 7
  s_lshl_b32 s25, s25, 2
  s_and_b32 s26, s24, 3
  s_add_u32 s25, s25, s26
  s_lshr_b32 s24, s24, 2
  s_mul_i32 s25, s25, 12
  s_mul_i32 s26, s40, 3
  s_add_u32 s25, s25, s26
  s_mul_i32 s25, s25, 24
  s_add_u32 s25, s25, s24
  s_mul_i32 s51, s25, 6144
  s_mov_b32 s48, s51
  s_add_u32 s49, s48, 147456
  s_add_u32 s50, s49, 147456
  s_lshr_b32 s41, s2, 3
  s_and_b32 s41, s41, 31
  s_mul_i32 s41, s41, 18432
  s_mul_i32 s3, s40, 5120
  s_add_u32 s41, s41, s3
  buffer_load_dwordx4 v[248:251], v2, s[8:11], s41 offen offset:0
  buffer_load_dwordx4 v[252:255], v2, s[8:11], s41 offen offset:1024
  buffer_load_dwordx4 v[248:251], v2, s[8:11], s41 offen offset:2048
  buffer_load_dwordx4 v[252:255], v2, s[8:11], s41 offen offset:3072
  s_add_u32 s41, s41, 4096
  buffer_load_dwordx4 v[248:251], v2, s[8:11], s41 offen offset:0
  s_add_u32 s26, s29, 98304
  s_add_u32 s27, s29, 147456
  s_add_u32 s28, s29, 98304
  s_mov_b32 s37, 0
  s_mov_b32 s24, 0
  s_call_b64 s[42:43], fused_kernel_ln
  s_lshl_b32 s31, s40, 14
  s_add_u32 s31, s31, 98304
  v_add_u32 v5, s31, v2
  ds_write_b128 v5, v[144:147] offset:0
  ds_write_b128 v5, v[148:151] offset:1024
  ds_write_b128 v5, v[152:155] offset:2048
  ds_write_b128 v5, v[156:159] offset:3072
  ds_write_b128 v5, v[160:163] offset:4096
  ds_write_b128 v5, v[164:167] offset:5120
  ds_write_b128 v5, v[168:171] offset:6144
  ds_write_b128 v5, v[172:175] offset:7168
  ds_write_b128 v5, v[176:179] offset:8192
  ds_write_b128 v5, v[180:183] offset:9216
  ds_write_b128 v5, v[184:187] offset:10240
  ds_write_b128 v5, v[188:191] offset:11264
  ds_write_b128 v5, v[192:195] offset:12288
  ds_write_b128 v5, v[196:199] offset:13312
  ds_write_b128 v5, v[200:203] offset:14336
  ds_write_b128 v5, v[204:207] offset:15360
  v_mov_b32 v240, v208
  v_mov_b32 v241, v209
  v_mov_b32 v242, v210
  v_mov_b32 v243, v211
  v_mov_b32 v244, v212
  v_mov_b32 v245, v213
  v_mov_b32 v246, v214
  v_mov_b32 v247, v215
  v_add_u32 v4, 0, v1
  ds_read_b128 a[216:219], v4 offset:12288
  ds_read_b128 a[220:223], v4 offset:13312
  ds_read_b128 a[224:227], v4 offset:14336
  ds_read_b128 a[228:231], v4 offset:15360
  ds_read_b128 a[232:235], v4 offset:16384
  ds_read_b128 a[236:239], v4 offset:17408
  s_waitcnt lgkmcnt(4)
  v_mfma_f32_16x16x32_bf16 v[48:51], a[216:219], a[0:3], 0
  v_mfma_f32_16x16x32_bf16 v[52:55], a[216:219], a[24:27], 0
  v_mfma_f32_16x16x32_bf16 v[56:59], a[216:219], a[48:51], 0
  ds_read_b128 a[240:243], v4 offset:18432
  v_mfma_f32_16x16x32_bf16 v[68:71], a[220:223], a[48:51], 0
  v_mfma_f32_16x16x32_bf16 v[64:67], a[220:223], a[24:27], 0
  v_mfma_f32_16x16x32_bf16 v[60:63], a[220:223], a[0:3], 0
  ds_read_b128 a[244:247], v4 offset:19456
  s_waitcnt lgkmcnt(4)
  v_mfma_f32_16x16x32_bf16 v[48:51], a[224:227], a[4:7], v[48:51]
  v_mfma_f32_16x16x32_bf16 v[52:55], a[224:227], a[28:31], v[52:55]
  v_mfma_f32_16x16x32_bf16 v[56:59], a[224:227], a[52:55], v[56:59]
  ds_read_b128 a[216:219], v4 offset:20480
  v_mfma_f32_16x16x32_bf16 v[68:71], a[228:231], a[52:55], v[68:71]
  v_mfma_f32_16x16x32_bf16 v[64:67], a[228:231], a[28:31], v[64:67]
  v_mfma_f32_16x16x32_bf16 v[60:63], a[228:231], a[4:7], v[60:63]
  ds_read_b128 a[220:223], v4 offset:21504
  s_waitcnt lgkmcnt(4)
  v_mfma_f32_16x16x32_bf16 v[48:51], a[232:235], a[8:11], v[48:51]
  v_mfma_f32_16x16x32_bf16 v[52:55], a[232:235], a[32:35], v[52:55]
  v_mfma_f32_16x16x32_bf16 v[56:59], a[232:235], a[56:59], v[56:59]
  ds_read_b128 a[224:227], v4 offset:22528
  v_mfma_f32_16x16x32_bf16 v[68:71], a[236:239], a[56:59], v[68:71]
  v_mfma_f32_16x16x32_bf16 v[64:67], a[236:239], a[32:35], v[64:67]
  v_mfma_f32_16x16x32_bf16 v[60:63], a[236:239], a[8:11], v[60:63]
  ds_read_b128 a[228:231], v4 offset:23552
  s_waitcnt lgkmcnt(4)
  v_mfma_f32_16x16x32_bf16 v[48:51], a[240:243], a[12:15], v[48:51]
  v_mfma_f32_16x16x32_bf16 v[52:55], a[240:243], a[36:39], v[52:55]
  v_mfma_f32_16x16x32_bf16 v[56:59], a[240:243], a[60:63], v[56:59]
  v_mfma_f32_16x16x32_bf16 v[68:71], a[244:247], a[60:63], v[68:71]
  v_mfma_f32_16x16x32_bf16 v[64:67], a[244:247], a[36:39], v[64:67]
  v_mfma_f32_16x16x32_bf16 v[60:63], a[244:247], a[12:15], v[60:63]
  s_waitcnt lgkmcnt(2)
  v_mfma_f32_16x16x32_bf16 v[48:51], a[216:219], a[16:19], v[48:51]
  v_mfma_f32_16x16x32_bf16 v[52:55], a[216:219], a[40:43], v[52:55]
  v_mfma_f32_16x16x32_bf16 v[56:59], a[216:219], a[64:67], v[56:59]
  v_mfma_f32_16x16x32_bf16 v[68:71], a[220:223], a[64:67], v[68:71]
  v_mfma_f32_16x16x32_bf16 v[64:67], a[220:223], a[40:43], v[64:67]
  v_mfma_f32_16x16x32_bf16 v[60:63], a[220:223], a[16:19], v[60:63]
  s_waitcnt lgkmcnt(0)
  v_mfma_f32_16x16x32_bf16 v[48:51], a[224:227], a[20:23], v[48:51]
  v_mfma_f32_16x16x32_bf16 v[52:55], a[224:227], a[44:47], v[52:55]
  v_mfma_f32_16x16x32_bf16 v[56:59], a[224:227], a[68:71], v[56:59]
  v_mfma_f32_16x16x32_bf16 v[68:71], a[228:231], a[68:71], v[68:71]
  v_mfma_f32_16x16x32_bf16 v[64:67], a[228:231], a[44:47], v[64:67]
  v_mfma_f32_16x16x32_bf16 v[60:63], a[228:231], a[20:23], v[60:63]
  s_waitcnt lgkmcnt(0)
  ds_read_b128 a[216:219], v1 offset:0
  ds_read_b128 a[220:223], v1 offset:1024
  ds_read_b128 a[224:227], v1 offset:2048
  ds_read_b128 a[228:231], v1 offset:3072
  ds_read_b128 a[232:235], v1 offset:4096
  ds_read_b128 a[236:239], v1 offset:5120
  s_waitcnt lgkmcnt(3)
  v_add_u32 v4, 49152, v2
.p2align 6
fused_kernel_pass:
  s_cmp_eq_u32 s24, 0
  s_cselect_b32 s44, 0x70000000, s36
  s_add_u32 s45, s44, 147456
  s_add_u32 s46, s44, 294912
  s_mov_b32 s95, s51
  s_add_u32 s96, s95, 147456
  s_add_u32 s97, s95, 294912
  v_mfma_f32_16x16x32_bf16 v[72:75], a[216:219], a[0:3], 0
  ds_read_b128 a[240:243], v1 offset:6144
  s_add_u32 m0, s29, 49152
  s_add_u32 s31, s29, 49152
  buffer_load_dwordx4 v2, s[8:11], s31 offen offset:0 lds
  v_cvt_pk_f16_f32 v8, v48, v49
  v_cvt_pk_f16_f32 v10, v50, v51
  v_mfma_f32_16x16x32_bf16 v[76:79], a[216:219], a[24:27], 0
  v_cvt_pk_f16_f32 v12, v52, v53
  v_cvt_pk_f16_f32 v14, v54, v55
  v_mfma_f32_16x16x32_bf16 v[80:83], a[216:219], a[48:51], 0
  v_pk_fma_f16 v9, v8, v8, s34 neg_lo:[1,0,0] neg_hi:[1,0,0]
  v_pk_fma_f16 v11, v10, v10, s34 neg_lo:[1,0,0] neg_hi:[1,0,0]
  v_pk_fma_f16 v13, v12, v12, s34 neg_lo:[1,0,0] neg_hi:[1,0,0]
  v_mfma_f32_16x16x32_bf16 v[92:95], a[220:223], a[48:51], 0
  ds_read_b128 a[244:247], v1 offset:7168
  buffer_load_dwordx4 v2, s[8:11], s31 offen offset:1024 lds
  v_pk_fma_f16 v15, v14, v14, s34 neg_lo:[1,0,0] neg_hi:[1,0,0]
  v_pk_mul_f16 v9, v9, v8
  v_mfma_f32_16x16x32_bf16 v[88:91], a[220:223], a[24:27], 0
  v_pk_mul_f16 v11, v11, v10
  v_pk_mul_f16 v13, v13, v12
  v_mfma_f32_16x16x32_bf16 v[84:87], a[220:223], a[0:3], 0
  v_pk_mul_f16 v15, v15, v14
  v_exp_f16_sdwa v9, v9 dst_sel:WORD_0 dst_unused:UNUSED_PRESERVE src0_sel:WORD_0
  v_mfma_f32_16x16x32_bf16 v[72:75], a[224:227], a[4:7], v[72:75]
  ds_read_b128 a[216:219], v1 offset:8192
  buffer_load_dwordx4 v2, s[8:11], s31 offen offset:2048 lds
  v_exp_f16_sdwa v11, v11 dst_sel:WORD_0 dst_unused:UNUSED_PRESERVE src0_sel:WORD_0
  v_mfma_f32_16x16x32_bf16 v[76:79], a[224:227], a[28:31], v[76:79]
  v_exp_f16_sdwa v13, v13 dst_sel:WORD_0 dst_unused:UNUSED_PRESERVE src0_sel:WORD_0
  v_mfma_f32_16x16x32_bf16 v[80:83], a[224:227], a[52:55], v[80:83]
  s_waitcnt lgkmcnt(3)
  v_exp_f16_sdwa v15, v15 dst_sel:WORD_0 dst_unused:UNUSED_PRESERVE src0_sel:WORD_0
  v_mfma_f32_16x16x32_bf16 v[92:95], a[228:231], a[52:55], v[92:95]
  ds_read_b128 a[220:223], v1 offset:9216
  buffer_load_dwordx4 v2, s[8:11], s31 offen offset:3072 lds
  v_exp_f16_sdwa v9, v9 dst_sel:WORD_1 dst_unused:UNUSED_PRESERVE src0_sel:WORD_1
  v_mfma_f32_16x16x32_bf16 v[88:91], a[228:231], a[28:31], v[88:91]
  s_add_u32 m0, s29, 53248
  v_exp_f16_sdwa v11, v11 dst_sel:WORD_1 dst_unused:UNUSED_PRESERVE src0_sel:WORD_1
  v_mfma_f32_16x16x32_bf16 v[84:87], a[228:231], a[4:7], v[84:87]
  s_add_u32 s31, s29, 53248
  v_exp_f16_sdwa v13, v13 dst_sel:WORD_1 dst_unused:UNUSED_PRESERVE src0_sel:WORD_1
  v_mfma_f32_16x16x32_bf16 v[72:75], a[232:235], a[8:11], v[72:75]
  ds_read_b128 a[224:227], v1 offset:10240
  buffer_load_dwordx4 v2, s[8:11], s31 offen offset:0 lds
  v_exp_f16_sdwa v15, v15 dst_sel:WORD_1 dst_unused:UNUSED_PRESERVE src0_sel:WORD_1
  v_mfma_f32_16x16x32_bf16 v[76:79], a[232:235], a[32:35], v[76:79]
  v_pk_fma_f16 v9, v9, s35, s35
  v_pk_fma_f16 v11, v11, s35, s35
  v_mfma_f32_16x16x32_bf16 v[80:83], a[232:235], a[56:59], v[80:83]
  v_pk_fma_f16 v13, v13, s35, s35
  v_pk_fma_f16 v15, v15, s35, s35
  v_mfma_f32_16x16x32_bf16 v[92:95], a[236:239], a[56:59], v[92:95]
  ds_read_b128 a[228:231], v1 offset:11264
  buffer_load_dwordx4 v2, s[8:11], s31 offen offset:1024 lds
  v_rcp_f16_sdwa v9, v9 dst_sel:WORD_0 dst_unused:UNUSED_PRESERVE src0_sel:WORD_0
  v_mfma_f32_16x16x32_bf16 v[88:91], a[236:239], a[32:35], v[88:91]
  v_rcp_f16_sdwa v11, v11 dst_sel:WORD_0 dst_unused:UNUSED_PRESERVE src0_sel:WORD_0
  v_mfma_f32_16x16x32_bf16 v[84:87], a[236:239], a[8:11], v[84:87]
  s_waitcnt lgkmcnt(3)
  v_rcp_f16_sdwa v13, v13 dst_sel:WORD_0 dst_unused:UNUSED_PRESERVE src0_sel:WORD_0
  v_rcp_f16_sdwa v15, v15 dst_sel:WORD_0 dst_unused:UNUSED_PRESERVE src0_sel:WORD_0
  v_mfma_f32_16x16x32_bf16 v[72:75], a[240:243], a[12:15], v[72:75]
  ds_read_b128 a[232:235], v1 offset:12288
  buffer_load_dwordx4 v2, s[8:11], s31 offen offset:2048 lds
  v_rcp_f16_sdwa v9, v9 dst_sel:WORD_1 dst_unused:UNUSED_PRESERVE src0_sel:WORD_1
  v_mfma_f32_16x16x32_bf16 v[76:79], a[240:243], a[36:39], v[76:79]
  v_rcp_f16_sdwa v11, v11 dst_sel:WORD_1 dst_unused:UNUSED_PRESERVE src0_sel:WORD_1
  v_mfma_f32_16x16x32_bf16 v[80:83], a[240:243], a[60:63], v[80:83]
  v_rcp_f16_sdwa v13, v13 dst_sel:WORD_1 dst_unused:UNUSED_PRESERVE src0_sel:WORD_1
  v_mfma_f32_16x16x32_bf16 v[92:95], a[244:247], a[60:63], v[92:95]
  ds_read_b128 a[236:239], v1 offset:13312
  buffer_load_dwordx4 v2, s[8:11], s31 offen offset:3072 lds
  v_rcp_f16_sdwa v15, v15 dst_sel:WORD_1 dst_unused:UNUSED_PRESERVE src0_sel:WORD_1
  v_mfma_f32_16x16x32_bf16 v[88:91], a[244:247], a[36:39], v[88:91]
  s_add_u32 m0, s29, 57344
  v_pk_mul_f16 v24, v8, v9
  v_pk_mul_f16 v25, v10, v11
  v_mfma_f32_16x16x32_bf16 v[84:87], a[244:247], a[12:15], v[84:87]
  s_add_u32 s31, s29, 57344
  v_pk_mul_f16 v28, v12, v13
  v_pk_mul_f16 v29, v14, v15
  v_mfma_f32_16x16x32_bf16 v[72:75], a[216:219], a[16:19], v[72:75]
  ds_read_b128 a[240:243], v1 offset:14336
  buffer_load_dwordx4 v2, s[8:11], s31 offen offset:0 lds
  v_cvt_pk_f16_f32 v16, v56, v57
  v_cvt_pk_f16_f32 v18, v58, v59
  v_mfma_f32_16x16x32_bf16 v[76:79], a[216:219], a[40:43], v[76:79]
  v_cvt_pk_f16_f32 v20, v60, v61
  v_cvt_pk_f16_f32 v22, v62, v63
  v_mfma_f32_16x16x32_bf16 v[80:83], a[216:219], a[64:67], v[80:83]
  s_waitcnt lgkmcnt(3)
  v_pk_fma_f16 v17, v16, v16, s34 neg_lo:[1,0,0] neg_hi:[1,0,0]
  v_pk_fma_f16 v19, v18, v18, s34 neg_lo:[1,0,0] neg_hi:[1,0,0]
  v_pk_fma_f16 v21, v20, v20, s34 neg_lo:[1,0,0] neg_hi:[1,0,0]
  v_mfma_f32_16x16x32_bf16 v[92:95], a[220:223], a[64:67], v[92:95]
  ds_read_b128 a[244:247], v1 offset:15360
  buffer_load_dwordx4 v2, s[8:11], s31 offen offset:1024 lds
  v_pk_fma_f16 v23, v22, v22, s34 neg_lo:[1,0,0] neg_hi:[1,0,0]
  v_pk_mul_f16 v17, v17, v16
  v_mfma_f32_16x16x32_bf16 v[88:91], a[220:223], a[40:43], v[88:91]
  v_pk_mul_f16 v19, v19, v18
  v_pk_mul_f16 v21, v21, v20
  v_mfma_f32_16x16x32_bf16 v[84:87], a[220:223], a[16:19], v[84:87]
  v_pk_mul_f16 v23, v23, v22
  v_exp_f16_sdwa v17, v17 dst_sel:WORD_0 dst_unused:UNUSED_PRESERVE src0_sel:WORD_0
  v_mfma_f32_16x16x32_bf16 v[72:75], a[224:227], a[20:23], v[72:75]
  ds_read_b128 a[216:219], v1 offset:16384
  buffer_load_dwordx4 v2, s[8:11], s31 offen offset:2048 lds
  v_exp_f16_sdwa v19, v19 dst_sel:WORD_0 dst_unused:UNUSED_PRESERVE src0_sel:WORD_0
  v_mfma_f32_16x16x32_bf16 v[76:79], a[224:227], a[44:47], v[76:79]
  v_exp_f16_sdwa v21, v21 dst_sel:WORD_0 dst_unused:UNUSED_PRESERVE src0_sel:WORD_0
  v_mfma_f32_16x16x32_bf16 v[80:83], a[224:227], a[68:71], v[80:83]
  v_exp_f16_sdwa v23, v23 dst_sel:WORD_0 dst_unused:UNUSED_PRESERVE src0_sel:WORD_0
  v_mfma_f32_16x16x32_bf16 v[92:95], a[228:231], a[68:71], v[92:95]
  ds_read_b128 a[220:223], v1 offset:17408
  buffer_load_dwordx4 v2, s[8:11], s31 offen offset:3072 lds
  v_exp_f16_sdwa v17, v17 dst_sel:WORD_1 dst_unused:UNUSED_PRESERVE src0_sel:WORD_1
  v_mfma_f32_16x16x32_bf16 v[88:91], a[228:231], a[44:47], v[88:91]
  v_exp_f16_sdwa v19, v19 dst_sel:WORD_1 dst_unused:UNUSED_PRESERVE src0_sel:WORD_1
  v_mfma_f32_16x16x32_bf16 v[84:87], a[228:231], a[20:23], v[84:87]
  s_waitcnt lgkmcnt(3)
  v_exp_f16_sdwa v21, v21 dst_sel:WORD_1 dst_unused:UNUSED_PRESERVE src0_sel:WORD_1
  v_mfma_f32_16x16x32_f16 v[96:99], a[232:235], v[36:39], v[96:99]
  ds_read_b128 a[224:227], v1 offset:18432
  v_exp_f16_sdwa v23, v23 dst_sel:WORD_1 dst_unused:UNUSED_PRESERVE src0_sel:WORD_1
  v_mfma_f32_16x16x32_f16 v[100:103], a[232:235], v[40:43], v[100:103]
  v_pk_fma_f16 v17, v17, s35, s35
  v_pk_fma_f16 v19, v19, s35, s35
  v_mfma_f32_16x16x32_f16 v[104:107], a[232:235], v[44:47], v[104:107]
  v_pk_fma_f16 v21, v21, s35, s35
  v_pk_fma_f16 v23, v23, s35, s35
  v_mfma_f32_16x16x32_f16 v[116:119], a[236:239], v[44:47], v[116:119]
  ds_read_b128 a[228:231], v1 offset:19456
  v_rcp_f16_sdwa v17, v17 dst_sel:WORD_0 dst_unused:UNUSED_PRESERVE src0_sel:WORD_0
  v_mfma_f32_16x16x32_f16 v[112:115], a[236:239], v[40:43], v[112:115]
  v_rcp_f16_sdwa v19, v19 dst_sel:WORD_0 dst_unused:UNUSED_PRESERVE src0_sel:WORD_0
  v_mfma_f32_16x16x32_f16 v[108:111], a[236:239], v[36:39], v[108:111]
  v_rcp_f16_sdwa v21, v21 dst_sel:WORD_0 dst_unused:UNUSED_PRESERVE src0_sel:WORD_0
  v_rcp_f16_sdwa v23, v23 dst_sel:WORD_0 dst_unused:UNUSED_PRESERVE src0_sel:WORD_0
  v_mfma_f32_16x16x32_f16 v[120:123], a[240:243], v[36:39], v[120:123]
  ds_read_b128 a[232:235], v1 offset:20480
  v_rcp_f16_sdwa v17, v17 dst_sel:WORD_1 dst_unused:UNUSED_PRESERVE src0_sel:WORD_1
  v_mfma_f32_16x16x32_f16 v[124:127], a[240:243], v[40:43], v[124:127]
  v_rcp_f16_sdwa v19, v19 dst_sel:WORD_1 dst_unused:UNUSED_PRESERVE src0_sel:WORD_1
  v_mfma_f32_16x16x32_f16 v[128:131], a[240:243], v[44:47], v[128:131]
  s_waitcnt lgkmcnt(3)
  v_rcp_f16_sdwa v21, v21 dst_sel:WORD_1 dst_unused:UNUSED_PRESERVE src0_sel:WORD_1
  v_mfma_f32_16x16x32_f16 v[140:143], a[244:247], v[44:47], v[140:143]
  ds_read_b128 a[236:239], v1 offset:21504
  v_rcp_f16_sdwa v23, v23 dst_sel:WORD_1 dst_unused:UNUSED_PRESERVE src0_sel:WORD_1
  v_mfma_f32_16x16x32_f16 v[136:139], a[244:247], v[40:43], v[136:139]
  v_pk_mul_f16 v32, v16, v17
  v_pk_mul_f16 v33, v18, v19
  v_mfma_f32_16x16x32_f16 v[132:135], a[244:247], v[36:39], v[132:135]
  v_pk_mul_f16 v26, v20, v21
  v_pk_mul_f16 v27, v22, v23
  v_mfma_f32_16x16x32_f16 v[144:147], a[216:219], v[36:39], v[144:147]
  ds_read_b128 a[240:243], v1 offset:22528
  v_cvt_pk_f16_f32 v8, v64, v65
  v_cvt_pk_f16_f32 v10, v66, v67
  v_mfma_f32_16x16x32_f16 v[148:151], a[216:219], v[40:43], v[148:151]
  v_cvt_pk_f16_f32 v12, v68, v69
  v_cvt_pk_f16_f32 v14, v70, v71
  v_mfma_f32_16x16x32_f16 v[152:155], a[216:219], v[44:47], v[152:155]
  v_pk_fma_f16 v9, v8, v8, s34 neg_lo:[1,0,0] neg_hi:[1,0,0]
  v_pk_fma_f16 v11, v10, v10, s34 neg_lo:[1,0,0] neg_hi:[1,0,0]
  v_pk_fma_f16 v13, v12, v12, s34 neg_lo:[1,0,0] neg_hi:[1,0,0]
  v_mfma_f32_16x16x32_f16 v[164:167], a[220:223], v[44:47], v[164:167]
  ds_read_b128 a[244:247], v1 offset:23552
  v_pk_fma_f16 v15, v14, v14, s34 neg_lo:[1,0,0] neg_hi:[1,0,0]
  v_pk_mul_f16 v9, v9, v8
  v_mfma_f32_16x16x32_f16 v[160:163], a[220:223], v[40:43], v[160:163]
  v_pk_mul_f16 v11, v11, v10
  v_pk_mul_f16 v13, v13, v12
  v_mfma_f32_16x16x32_f16 v[156:159], a[220:223], v[36:39], v[156:159]
  s_waitcnt lgkmcnt(3)
  v_pk_mul_f16 v15, v15, v14
  v_exp_f16_sdwa v9, v9 dst_sel:WORD_0 dst_unused:UNUSED_PRESERVE src0_sel:WORD_0
  v_mfma_f32_16x16x32_f16 v[168:171], a[224:227], v[36:39], v[168:171]
  ds_read_b128 a[216:219], v1 offset:24576
  v_exp_f16_sdwa v11, v11 dst_sel:WORD_0 dst_unused:UNUSED_PRESERVE src0_sel:WORD_0
  v_mfma_f32_16x16x32_f16 v[172:175], a[224:227], v[40:43], v[172:175]
  v_exp_f16_sdwa v13, v13 dst_sel:WORD_0 dst_unused:UNUSED_PRESERVE src0_sel:WORD_0
  v_mfma_f32_16x16x32_f16 v[176:179], a[224:227], v[44:47], v[176:179]
  v_exp_f16_sdwa v15, v15 dst_sel:WORD_0 dst_unused:UNUSED_PRESERVE src0_sel:WORD_0
  v_mfma_f32_16x16x32_f16 v[188:191], a[228:231], v[44:47], v[188:191]
  ds_read_b128 a[220:223], v1 offset:25600
  v_exp_f16_sdwa v9, v9 dst_sel:WORD_1 dst_unused:UNUSED_PRESERVE src0_sel:WORD_1
  v_mfma_f32_16x16x32_f16 v[184:187], a[228:231], v[40:43], v[184:187]
  v_exp_f16_sdwa v11, v11 dst_sel:WORD_1 dst_unused:UNUSED_PRESERVE src0_sel:WORD_1
  v_mfma_f32_16x16x32_f16 v[180:183], a[228:231], v[36:39], v[180:183]
  v_exp_f16_sdwa v13, v13 dst_sel:WORD_1 dst_unused:UNUSED_PRESERVE src0_sel:WORD_1
  v_mfma_f32_16x16x32_f16 v[192:195], a[232:235], v[36:39], v[192:195]
  ds_read_b128 a[224:227], v1 offset:26624
  v_exp_f16_sdwa v15, v15 dst_sel:WORD_1 dst_unused:UNUSED_PRESERVE src0_sel:WORD_1
  v_mfma_f32_16x16x32_f16 v[196:199], a[232:235], v[40:43], v[196:199]
  v_pk_fma_f16 v9, v9, s35, s35
  v_pk_fma_f16 v11, v11, s35, s35
  v_mfma_f32_16x16x32_f16 v[200:203], a[232:235], v[44:47], v[200:203]
  s_waitcnt lgkmcnt(3)
  v_pk_fma_f16 v13, v13, s35, s35
  v_pk_fma_f16 v15, v15, s35, s35
  v_mfma_f32_16x16x32_f16 v[212:215], a[236:239], v[44:47], v[212:215]
  ds_read_b128 a[228:231], v1 offset:27648
  v_rcp_f16_sdwa v9, v9 dst_sel:WORD_0 dst_unused:UNUSED_PRESERVE src0_sel:WORD_0
  v_mfma_f32_16x16x32_f16 v[208:211], a[236:239], v[40:43], v[208:211]
  v_rcp_f16_sdwa v11, v11 dst_sel:WORD_0 dst_unused:UNUSED_PRESERVE src0_sel:WORD_0
  v_mfma_f32_16x16x32_f16 v[204:207], a[236:239], v[36:39], v[204:207]
  v_rcp_f16_sdwa v13, v13 dst_sel:WORD_0 dst_unused:UNUSED_PRESERVE src0_sel:WORD_0
  v_rcp_f16_sdwa v15, v15 dst_sel:WORD_0 dst_unused:UNUSED_PRESERVE src0_sel:WORD_0
  v_mfma_f32_16x16x32_f16 v[216:219], a[240:243], v[36:39], v[216:219]
  ds_read_b128 a[232:235], v1 offset:28672
  v_rcp_f16_sdwa v9, v9 dst_sel:WORD_1 dst_unused:UNUSED_PRESERVE src0_sel:WORD_1
  v_mfma_f32_16x16x32_f16 v[220:223], a[240:243], v[40:43], v[220:223]
  v_rcp_f16_sdwa v11, v11 dst_sel:WORD_1 dst_unused:UNUSED_PRESERVE src0_sel:WORD_1
  v_mfma_f32_16x16x32_f16 v[224:227], a[240:243], v[44:47], v[224:227]
  v_rcp_f16_sdwa v13, v13 dst_sel:WORD_1 dst_unused:UNUSED_PRESERVE src0_sel:WORD_1
  v_mfma_f32_16x16x32_f16 v[236:239], a[244:247], v[44:47], v[236:239]
  ds_read_b128 a[236:239], v1 offset:29696
  v_rcp_f16_sdwa v15, v15 dst_sel:WORD_1 dst_unused:UNUSED_PRESERVE src0_sel:WORD_1
  v_mfma_f32_16x16x32_f16 v[232:235], a[244:247], v[40:43], v[232:235]
  v_pk_mul_f16 v30, v8, v9
  v_pk_mul_f16 v31, v10, v11
  v_mfma_f32_16x16x32_f16 v[228:231], a[244:247], v[36:39], v[228:231]
  s_waitcnt lgkmcnt(3)
  v_pk_mul_f16 v34, v12, v13
  v_pk_mul_f16 v35, v14, v15
  s_cmp_eq_u32 s24, 0
  s_cbranch_scc1 fused_kernel_nomid
  v_mfma_f32_16x16x32_bf16 v[96:99], a[248:251], a[144:147], v[96:99]
  v_mfma_f32_16x16x32_bf16 v[108:111], a[252:255], a[144:147], v[108:111]
  s_nop 3
  v_mfma_f32_16x16x32_bf16 v[120:123], a[248:251], a[148:151], v[120:123]
  v_mfma_f32_16x16x32_bf16 v[132:135], a[252:255], a[148:151], v[132:135]
  s_nop 3
  v_mfma_f32_16x16x32_bf16 v[144:147], a[248:251], a[152:155], v[144:147]
  v_cvt_pk_bf16_f32 v16, v96, v97
  v_cvt_pk_bf16_f32 v17, v98, v99
  v_mfma_f32_16x16x32_bf16 v[156:159], a[252:255], a[152:155], v[156:159]
  v_cvt_pk_bf16_f32 v18, v108, v109
  v_cvt_pk_bf16_f32 v19, v110, v111
  v_accvgpr_write_b32 a144, v16
  v_accvgpr_write_b32 a145, v17
  v_accvgpr_write_b32 a146, v18
  v_accvgpr_write_b32 a147, v19
  v_mfma_f32_16x16x32_bf16 v[168:171], a[248:251], a[156:159], v[168:171]
  v_cvt_pk_bf16_f32 v20, v120, v121
  v_cvt_pk_bf16_f32 v21, v122, v123
  v_mfma_f32_16x16x32_bf16 v[180:183], a[252:255], a[156:159], v[180:183]
  v_cvt_pk_bf16_f32 v22, v132, v133
  v_cvt_pk_bf16_f32 v23, v134, v135
  v_accvgpr_write_b32 a148, v20
  v_accvgpr_write_b32 a149, v21
  v_accvgpr_write_b32 a150, v22
  v_accvgpr_write_b32 a151, v23
  v_mfma_f32_16x16x32_bf16 v[192:195], a[248:251], a[160:163], v[192:195]
  v_cvt_pk_bf16_f32 v16, v144, v145
  v_cvt_pk_bf16_f32 v17, v146, v147
  v_mfma_f32_16x16x32_bf16 v[204:207], a[252:255], a[160:163], v[204:207]
  v_cvt_pk_bf16_f32 v18, v156, v157
  v_cvt_pk_bf16_f32 v19, v158, v159
  v_accvgpr_write_b32 a152, v16
  v_accvgpr_write_b32 a153, v17
  v_accvgpr_write_b32 a154, v18
  v_accvgpr_write_b32 a155, v19
  v_mfma_f32_16x16x32_bf16 v[216:219], a[248:251], a[164:167], v[216:219]
  v_cvt_pk_bf16_f32 v20, v168, v169
  v_cvt_pk_bf16_f32 v21, v170, v171
  v_mfma_f32_16x16x32_bf16 v[228:231], a[252:255], a[164:167], v[228:231]
  v_cvt_pk_bf16_f32 v22, v180, v181
  v_cvt_pk_bf16_f32 v23, v182, v183
  v_accvgpr_write_b32 a156, v20
  v_accvgpr_write_b32 a157, v21
  v_accvgpr_write_b32 a158, v22
  v_accvgpr_write_b32 a159, v23
  v_mfma_f32_16x16x32_bf16 v[100:103], a[248:251], a[168:171], v[100:103]
  v_cvt_pk_bf16_f32 v16, v192, v193
  v_cvt_pk_bf16_f32 v17, v194, v195
  v_mfma_f32_16x16x32_bf16 v[112:115], a[252:255], a[168:171], v[112:115]
  v_cvt_pk_bf16_f32 v18, v204, v205
  v_cvt_pk_bf16_f32 v19, v206, v207
  v_accvgpr_write_b32 a160, v16
  v_accvgpr_write_b32 a161, v17
  v_accvgpr_write_b32 a162, v18
  v_accvgpr_write_b32 a163, v19
  v_mfma_f32_16x16x32_bf16 v[124:127], a[248:251], a[172:175], v[124:127]
  v_cvt_pk_bf16_f32 v20, v216, v217
  v_cvt_pk_bf16_f32 v21, v218, v219
  v_mfma_f32_16x16x32_bf16 v[136:139], a[252:255], a[172:175], v[136:139]
  v_cvt_pk_bf16_f32 v22, v228, v229
  v_cvt_pk_bf16_f32 v23, v230, v231
  v_accvgpr_write_b32 a164, v20
  v_accvgpr_write_b32 a165, v21
  v_accvgpr_write_b32 a166, v22
  v_accvgpr_write_b32 a167, v23
  v_mfma_f32_16x16x32_bf16 v[148:151], a[248:251], a[176:179], v[148:151]
  v_cvt_pk_bf16_f32 v16, v100, v101
  v_cvt_pk_bf16_f32 v17, v102, v103
  v_mfma_f32_16x16x32_bf16 v[160:163], a[252:255], a[176:179], v[160:163]
  v_cvt_pk_bf16_f32 v18, v112, v113
  v_cvt_pk_bf16_f32 v19, v114, v115
  v_accvgpr_write_b32 a168, v16
  v_accvgpr_write_b32 a169, v17
  v_accvgpr_write_b32 a170, v18
  v_accvgpr_write_b32 a171, v19
  v_mfma_f32_16x16x32_bf16 v[172:175], a[248:251], a[180:183], v[172:175]
  v_cvt_pk_bf16_f32 v20, v124, v125
  v_cvt_pk_bf16_f32 v21, v126, v127
  v_mfma_f32_16x16x32_bf16 v[184:187], a[252:255], a[180:183], v[184:187]
  v_cvt_pk_bf16_f32 v22, v136, v137
  v_cvt_pk_bf16_f32 v23, v138, v139
  v_accvgpr_write_b32 a172, v20
  v_accvgpr_write_b32 a173, v21
  v_accvgpr_write_b32 a174, v22
  v_accvgpr_write_b32 a175, v23
  v_mfma_f32_16x16x32_bf16 v[196:199], a[248:251], a[184:187], v[196:199]
  v_cvt_pk_bf16_f32 v16, v148, v149
  v_cvt_pk_bf16_f32 v17, v150, v151
  v_mfma_f32_16x16x32_bf16 v[208:211], a[252:255], a[184:187], v[208:211]
  v_cvt_pk_bf16_f32 v18, v160, v161
  v_cvt_pk_bf16_f32 v19, v162, v163
  v_accvgpr_write_b32 a176, v16
  v_accvgpr_write_b32 a177, v17
  v_accvgpr_write_b32 a178, v18
  v_accvgpr_write_b32 a179, v19
  v_mfma_f32_16x16x32_bf16 v[220:223], a[248:251], a[188:191], v[220:223]
  v_cvt_pk_bf16_f32 v20, v172, v173
  v_cvt_pk_bf16_f32 v21, v174, v175
  v_mfma_f32_16x16x32_bf16 v[232:235], a[252:255], a[188:191], v[232:235]
  v_cvt_pk_bf16_f32 v22, v184, v185
  v_cvt_pk_bf16_f32 v23, v186, v187
  v_accvgpr_write_b32 a180, v20
  v_accvgpr_write_b32 a181, v21
  v_accvgpr_write_b32 a182, v22
  v_accvgpr_write_b32 a183, v23
  v_mfma_f32_16x16x32_bf16 v[104:107], a[248:251], a[192:195], v[104:107]
  v_cvt_pk_bf16_f32 v16, v196, v197
  v_cvt_pk_bf16_f32 v17, v198, v199
  v_mfma_f32_16x16x32_bf16 v[116:119], a[252:255], a[192:195], v[116:119]
  v_cvt_pk_bf16_f32 v18, v208, v209
  v_cvt_pk_bf16_f32 v19, v210, v211
  v_accvgpr_write_b32 a184, v16
  v_accvgpr_write_b32 a185, v17
  v_accvgpr_write_b32 a186, v18
  v_accvgpr_write_b32 a187, v19
  v_mfma_f32_16x16x32_bf16 v[128:131], a[248:251], a[196:199], v[128:131]
  v_cvt_pk_bf16_f32 v20, v220, v221
  v_cvt_pk_bf16_f32 v21, v222, v223
  v_mfma_f32_16x16x32_bf16 v[140:143], a[252:255], a[196:199], v[140:143]
  v_cvt_pk_bf16_f32 v22, v232, v233
  v_cvt_pk_bf16_f32 v23, v234, v235
  v_accvgpr_write_b32 a188, v20
  v_accvgpr_write_b32 a189, v21
  v_accvgpr_write_b32 a190, v22
  v_accvgpr_write_b32 a191, v23
  v_mfma_f32_16x16x32_bf16 v[152:155], a[248:251], a[200:203], v[152:155]
  v_cvt_pk_bf16_f32 v16, v104, v105
  v_cvt_pk_bf16_f32 v17, v106, v107
  v_mfma_f32_16x16x32_bf16 v[164:167], a[252:255], a[200:203], v[164:167]
  v_cvt_pk_bf16_f32 v18, v116, v117
  v_cvt_pk_bf16_f32 v19, v118, v119
  v_accvgpr_write_b32 a192, v16
  v_accvgpr_write_b32 a193, v17
  v_accvgpr_write_b32 a194, v18
  v_accvgpr_write_b32 a195, v19
  v_mfma_f32_16x16x32_bf16 v[176:179], a[248:251], a[204:207], v[176:179]
  v_cvt_pk_bf16_f32 v20, v128, v129
  v_cvt_pk_bf16_f32 v21, v130, v131
  v_mfma_f32_16x16x32_bf16 v[188:191], a[252:255], a[204:207], v[188:191]
  v_cvt_pk_bf16_f32 v22, v140, v141
  v_cvt_pk_bf16_f32 v23, v142, v143
  v_accvgpr_write_b32 a196, v20
  v_accvgpr_write_b32 a197, v21
  v_accvgpr_write_b32 a198, v22
  v_accvgpr_write_b32 a199, v23
  v_mfma_f32_16x16x32_bf16 v[200:203], a[248:251], a[208:211], v[200:203]
  v_cvt_pk_bf16_f32 v16, v152, v153
  v_cvt_pk_bf16_f32 v17, v154, v155
  v_mfma_f32_16x16x32_bf16 v[212:215], a[252:255], a[208:211], v[212:215]
  v_cvt_pk_bf16_f32 v18, v164, v165
  v_cvt_pk_bf16_f32 v19, v166, v167
  v_accvgpr_write_b32 a200, v16
  v_accvgpr_write_b32 a201, v17
  v_accvgpr_write_b32 a202, v18
  v_accvgpr_write_b32 a203, v19
  v_mfma_f32_16x16x32_bf16 v[224:227], a[248:251], a[212:215], v[224:227]
  v_cvt_pk_bf16_f32 v20, v176, v177
  v_cvt_pk_bf16_f32 v21, v178, v179
  v_mfma_f32_16x16x32_bf16 v[236:239], a[252:255], a[212:215], v[236:239]
  v_cvt_pk_bf16_f32 v22, v188, v189
  v_cvt_pk_bf16_f32 v23, v190, v191
  v_accvgpr_write_b32 a204, v20
  v_accvgpr_write_b32 a205, v21
  v_accvgpr_write_b32 a206, v22
  v_accvgpr_write_b32 a207, v23
  v_cvt_pk_bf16_f32 v16, v200, v201
  v_cvt_pk_bf16_f32 v17, v202, v203
  v_cvt_pk_bf16_f32 v18, v212, v213
  v_cvt_pk_bf16_f32 v19, v214, v215
  v_accvgpr_write_b32 a208, v16
  v_accvgpr_write_b32 a209, v17
  v_accvgpr_write_b32 a210, v18
  v_accvgpr_write_b32 a211, v19
  v_cvt_pk_bf16_f32 v20, v224, v225
  v_cvt_pk_bf16_f32 v21, v226, v227
  v_cvt_pk_bf16_f32 v22, v236, v237
  v_cvt_pk_bf16_f32 v23, v238, v239
  v_accvgpr_write_b32 a212, v20
  v_accvgpr_write_b32 a213, v21
  v_accvgpr_write_b32 a214, v22
  v_accvgpr_write_b32 a215, v23
fused_kernel_nomid:
  v_mfma_f32_16x16x32_bf16 v[48:51], a[216:219], a[0:3], 0
  ds_read_b128 a[240:243], v1 offset:30720
  v_cvt_pk_f16_f32 v8, v72, v73
  v_cvt_pk_f16_f32 v10, v74, v75
  v_mfma_f32_16x16x32_bf16 v[52:55], a[216:219], a[24:27], 0
  v_cvt_pk_f16_f32 v12, v76, v77
  v_cvt_pk_f16_f32 v14, v78, v79
  v_mfma_f32_16x16x32_bf16 v[56:59], a[216:219], a[48:51], 0
  v_pk_fma_f16 v9, v8, v8, s34 neg_lo:[1,0,0] neg_hi:[1,0,0]
  v_pk_fma_f16 v11, v10, v10, s34 neg_lo:[1,0,0] neg_hi:[1,0,0]
  v_pk_fma_f16 v13, v12, v12, s34 neg_lo:[1,0,0] neg_hi:[1,0,0]
  v_mfma_f32_16x16x32_bf16 v[68:71], a[220:223], a[48:51], 0
  ds_read_b128 a[244:247], v1 offset:31744
  v_pk_fma_f16 v15, v14, v14, s34 neg_lo:[1,0,0] neg_hi:[1,0,0]
  v_pk_mul_f16 v9, v9, v8
  v_mfma_f32_16x16x32_bf16 v[64:67], a[220:223], a[24:27], 0
  buffer_store_dwordx4 a[144:147], v3, s[20:23], s44 offen offset:0 sc1
  v_pk_mul_f16 v11, v11, v10
  v_pk_mul_f16 v13, v13, v12
  v_mfma_f32_16x16x32_bf16 v[60:63], a[220:223], a[0:3], 0
  v_pk_mul_f16 v15, v15, v14
  v_exp_f16_sdwa v9, v9 dst_sel:WORD_0 dst_unused:UNUSED_PRESERVE src0_sel:WORD_0
  v_mfma_f32_16x16x32_bf16 v[48:51], a[224:227], a[4:7], v[48:51]
  ds_read_b128 a[216:219], v1 offset:32768
  v_exp_f16_sdwa v11, v11 dst_sel:WORD_0 dst_unused:UNUSED_PRESERVE src0_sel:WORD_0
  v_mfma_f32_16x16x32_bf16 v[52:55], a[224:227], a[28:31], v[52:55]
  v_exp_f16_sdwa v13, v13 dst_sel:WORD_0 dst_unused:UNUSED_PRESERVE src0_sel:WORD_0
  v_mfma_f32_16x16x32_bf16 v[56:59], a[224:227], a[52:55], v[56:59]
  s_waitcnt lgkmcnt(3)
  v_exp_f16_sdwa v15, v15 dst_sel:WORD_0 dst_unused:UNUSED_PRESERVE src0_sel:WORD_0
  v_mfma_f32_16x16x32_bf16 v[68:71], a[228:231], a[52:55], v[68:71]
  ds_read_b128 a[220:223], v1 offset:33792
  v_exp_f16_sdwa v9, v9 dst_sel:WORD_1 dst_unused:UNUSED_PRESERVE src0_sel:WORD_1
  v_mfma_f32_16x16x32_bf16 v[64:67], a[228:231], a[28:31], v[64:67]
  v_exp_f16_sdwa v11, v11 dst_sel:WORD_1 dst_unused:UNUSED_PRESERVE src0_sel:WORD_1
  v_mfma_f32_16x16x32_bf16 v[60:63], a[228:231], a[4:7], v[60:63]
  v_exp_f16_sdwa v13, v13 dst_sel:WORD_1 dst_unused:UNUSED_PRESERVE src0_sel:WORD_1
  v_mfma_f32_16x16x32_bf16 v[48:51], a[232:235], a[8:11], v[48:51]
  ds_read_b128 a[224:227], v1 offset:34816
  v_exp_f16_sdwa v15, v15 dst_sel:WORD_1 dst_unused:UNUSED_PRESERVE src0_sel:WORD_1
  v_mfma_f32_16x16x32_bf16 v[52:55], a[232:235], a[32:35], v[52:55]
  buffer_store_dwordx4 a[148:151], v3, s[20:23], s44 offen offset:64 sc1
  v_pk_fma_f16 v9, v9, s35, s35
  v_pk_fma_f16 v11, v11, s35, s35
  v_mfma_f32_16x16x32_bf16 v[56:59], a[232:235], a[56:59], v[56:59]
  v_pk_fma_f16 v13, v13, s35, s35
  v_pk_fma_f16 v15, v15, s35, s35
  v_mfma_f32_16x16x32_bf16 v[68:71], a[236:239], a[56:59], v[68:71]
  ds_read_b128 a[228:231], v1 offset:35840
  v_rcp_f16_sdwa v9, v9 dst_sel:WORD_0 dst_unused:UNUSED_PRESERVE src0_sel:WORD_0
  v_mfma_f32_16x16x32_bf16 v[64:67], a[236:239], a[32:35], v[64:67]
  v_rcp_f16_sdwa v11, v11 dst_sel:WORD_0 dst_unused:UNUSED_PRESERVE src0_sel:WORD_0
  v_mfma_f32_16x16x32_bf16 v[60:63], a[236:239], a[8:11], v[60:63]
  s_waitcnt lgkmcnt(3)
  v_rcp_f16_sdwa v13, v13 dst_sel:WORD_0 dst_unused:UNUSED_PRESERVE src0_sel:WORD_0
  v_rcp_f16_sdwa v15, v15 dst_sel:WORD_0 dst_unused:UNUSED_PRESERVE src0_sel:WORD_0
  v_mfma_f32_16x16x32_bf16 v[48:51], a[240:243], a[12:15], v[48:51]
  ds_read_b128 a[232:235], v1 offset:36864
  v_rcp_f16_sdwa v9, v9 dst_sel:WORD_1 dst_unused:UNUSED_PRESERVE src0_sel:WORD_1
  v_mfma_f32_16x16x32_bf16 v[52:55], a[240:243], a[36:39], v[52:55]
  v_rcp_f16_sdwa v11, v11 dst_sel:WORD_1 dst_unused:UNUSED_PRESERVE src0_sel:WORD_1
  v_mfma_f32_16x16x32_bf16 v[56:59], a[240:243], a[60:63], v[56:59]
  v_rcp_f16_sdwa v13, v13 dst_sel:WORD_1 dst_unused:UNUSED_PRESERVE src0_sel:WORD_1
  v_mfma_f32_16x16x32_bf16 v[68:71], a[244:247], a[60:63], v[68:71]
  ds_read_b128 a[236:239], v1 offset:37888
  v_rcp_f16_sdwa v15, v15 dst_sel:WORD_1 dst_unused:UNUSED_PRESERVE src0_sel:WORD_1
  v_mfma_f32_16x16x32_bf16 v[64:67], a[244:247], a[36:39], v[64:67]
  buffer_store_dwordx4 a[152:155], v3, s[20:23], s44 offen offset:128 sc1
  v_pk_mul_f16 v36, v8, v9
  v_pk_mul_f16 v37, v10, v11
  v_mfma_f32_16x16x32_bf16 v[60:63], a[244:247], a[12:15], v[60:63]
  v_pk_mul_f16 v40, v12, v13
  v_pk_mul_f16 v41, v14, v15
  v_mfma_f32_16x16x32_bf16 v[48:51], a[216:219], a[16:19], v[48:51]
  ds_read_b128 a[240:243], v1 offset:38912
  v_cvt_pk_f16_f32 v16, v80, v81
  v_cvt_pk_f16_f32 v18, v82, v83
  v_mfma_f32_16x16x32_bf16 v[52:55], a[216:219], a[40:43], v[52:55]
  v_cvt_pk_f16_f32 v20, v84, v85
  v_cvt_pk_f16_f32 v22, v86, v87
  v_mfma_f32_16x16x32_bf16 v[56:59], a[216:219], a[64:67], v[56:59]
  s_waitcnt lgkmcnt(3)
  v_pk_fma_f16 v17, v16, v16, s34 neg_lo:[1,0,0] neg_hi:[1,0,0]
  v_pk_fma_f16 v19, v18, v18, s34 neg_lo:[1,0,0] neg_hi:[1,0,0]
  v_pk_fma_f16 v21, v20, v20, s34 neg_lo:[1,0,0] neg_hi:[1,0,0]
  v_mfma_f32_16x16x32_bf16 v[68:71], a[220:223], a[64:67], v[68:71]
  ds_read_b128 a[244:247], v1 offset:39936
  v_pk_fma_f16 v23, v22, v22, s34 neg_lo:[1,0,0] neg_hi:[1,0,0]
  v_pk_mul_f16 v17, v17, v16
  v_mfma_f32_16x16x32_bf16 v[64:67], a[220:223], a[40:43], v[64:67]
  v_pk_mul_f16 v19, v19, v18
  v_pk_mul_f16 v21, v21, v20
  v_mfma_f32_16x16x32_bf16 v[60:63], a[220:223], a[16:19], v[60:63]
  v_pk_mul_f16 v23, v23, v22
  v_exp_f16_sdwa v17, v17 dst_sel:WORD_0 dst_unused:UNUSED_PRESERVE src0_sel:WORD_0
  v_mfma_f32_16x16x32_bf16 v[48:51], a[224:227], a[20:23], v[48:51]
  ds_read_b128 a[216:219], v1 offset:40960
  v_exp_f16_sdwa v19, v19 dst_sel:WORD_0 dst_unused:UNUSED_PRESERVE src0_sel:WORD_0
  v_mfma_f32_16x16x32_bf16 v[52:55], a[224:227], a[44:47], v[52:55]
  v_exp_f16_sdwa v21, v21 dst_sel:WORD_0 dst_unused:UNUSED_PRESERVE src0_sel:WORD_0
  v_mfma_f32_16x16x32_bf16 v[56:59], a[224:227], a[68:71], v[56:59]
  v_exp_f16_sdwa v23, v23 dst_sel:WORD_0 dst_unused:UNUSED_PRESERVE src0_sel:WORD_0
  v_mfma_f32_16x16x32_bf16 v[68:71], a[228:231], a[68:71], v[68:71]
  ds_read_b128 a[220:223], v1 offset:41984
  v_exp_f16_sdwa v17, v17 dst_sel:WORD_1 dst_unused:UNUSED_PRESERVE src0_sel:WORD_1
  v_mfma_f32_16x16x32_bf16 v[64:67], a[228:231], a[44:47], v[64:67]
  v_exp_f16_sdwa v19, v19 dst_sel:WORD_1 dst_unused:UNUSED_PRESERVE src0_sel:WORD_1
  v_mfma_f32_16x16x32_bf16 v[60:63], a[228:231], a[20:23], v[60:63]
  s_waitcnt lgkmcnt(3)
  v_exp_f16_sdwa v21, v21 dst_sel:WORD_1 dst_unused:UNUSED_PRESERVE src0_sel:WORD_1
  v_mfma_f32_16x16x32_f16 v[96:99], a[232:235], v[24:27], 0
  ds_read_b128 a[224:227], v1 offset:43008
  v_exp_f16_sdwa v23, v23 dst_sel:WORD_1 dst_unused:UNUSED_PRESERVE src0_sel:WORD_1
  v_mfma_f32_16x16x32_f16 v[100:103], a[232:235], v[28:31], 0
  v_pk_fma_f16 v17, v17, s35, s35
  v_pk_fma_f16 v19, v19, s35, s35
  v_mfma_f32_16x16x32_f16 v[104:107], a[232:235], v[32:35], 0
  v_pk_fma_f16 v21, v21, s35, s35
  v_pk_fma_f16 v23, v23, s35, s35
  v_mfma_f32_16x16x32_f16 v[116:119], a[236:239], v[32:35], 0
  ds_read_b128 a[228:231], v1 offset:44032
  v_rcp_f16_sdwa v17, v17 dst_sel:WORD_0 dst_unused:UNUSED_PRESERVE src0_sel:WORD_0
  v_mfma_f32_16x16x32_f16 v[112:115], a[236:239], v[28:31], 0
  v_rcp_f16_sdwa v19, v19 dst_sel:WORD_0 dst_unused:UNUSED_PRESERVE src0_sel:WORD_0
  v_mfma_f32_16x16x32_f16 v[108:111], a[236:239], v[24:27], 0
  v_rcp_f16_sdwa v21, v21 dst_sel:WORD_0 dst_unused:UNUSED_PRESERVE src0_sel:WORD_0
  v_rcp_f16_sdwa v23, v23 dst_sel:WORD_0 dst_unused:UNUSED_PRESERVE src0_sel:WORD_0
  v_mfma_f32_16x16x32_f16 v[120:123], a[240:243], v[24:27], 0
  ds_read_b128 a[232:235], v1 offset:45056
  v_rcp_f16_sdwa v17, v17 dst_sel:WORD_1 dst_unused:UNUSED_PRESERVE src0_sel:WORD_1
  v_mfma_f32_16x16x32_f16 v[124:127], a[240:243], v[28:31], 0
  v_rcp_f16_sdwa v19, v19 dst_sel:WORD_1 dst_unused:UNUSED_PRESERVE src0_sel:WORD_1
  v_mfma_f32_16x16x32_f16 v[128:131], a[240:243], v[32:35], 0
  s_waitcnt lgkmcnt(3)
  v_rcp_f16_sdwa v21, v21 dst_sel:WORD_1 dst_unused:UNUSED_PRESERVE src0_sel:WORD_1
  v_mfma_f32_16x16x32_f16 v[140:143], a[244:247], v[32:35], 0
  ds_read_b128 a[236:239], v1 offset:46080
  v_rcp_f16_sdwa v23, v23 dst_sel:WORD_1 dst_unused:UNUSED_PRESERVE src0_sel:WORD_1
  v_mfma_f32_16x16x32_f16 v[136:139], a[244:247], v[28:31], 0
  v_pk_mul_f16 v44, v16, v17
  v_pk_mul_f16 v45, v18, v19
  v_mfma_f32_16x16x32_f16 v[132:135], a[244:247], v[24:27], 0
  v_pk_mul_f16 v38, v20, v21
  v_pk_mul_f16 v39, v22, v23
  v_mfma_f32_16x16x32_f16 v[144:147], a[216:219], v[24:27], 0
  ds_read_b128 a[240:243], v1 offset:47104
  ds_read_b128 a[244:247], v1 offset:48128
  v_cvt_pk_f16_f32 v8, v88, v89
  v_cvt_pk_f16_f32 v10, v90, v91
  v_mfma_f32_16x16x32_f16 v[148:151], a[216:219], v[28:31], 0
  v_cvt_pk_f16_f32 v12, v92, v93
  v_cvt_pk_f16_f32 v14, v94, v95
  v_mfma_f32_16x16x32_f16 v[152:155], a[216:219], v[32:35], 0
  v_pk_fma_f16 v9, v8, v8, s34 neg_lo:[1,0,0] neg_hi:[1,0,0]
  v_pk_fma_f16 v11, v10, v10, s34 neg_lo:[1,0,0] neg_hi:[1,0,0]
  v_pk_fma_f16 v13, v12, v12, s34 neg_lo:[1,0,0] neg_hi:[1,0,0]
  v_mfma_f32_16x16x32_f16 v[164:167], a[220:223], v[32:35], 0
  v_pk_fma_f16 v15, v14, v14, s34 neg_lo:[1,0,0] neg_hi:[1,0,0]
  v_pk_mul_f16 v9, v9, v8
  v_mfma_f32_16x16x32_f16 v[160:163], a[220:223], v[28:31], 0
  v_pk_mul_f16 v11, v11, v10
  v_pk_mul_f16 v13, v13, v12
  v_mfma_f32_16x16x32_f16 v[156:159], a[220:223], v[24:27], 0
  s_waitcnt lgkmcnt(3)
  v_pk_mul_f16 v15, v15, v14
  v_exp_f16_sdwa v9, v9 dst_sel:WORD_0 dst_unused:UNUSED_PRESERVE src0_sel:WORD_0
  v_mfma_f32_16x16x32_f16 v[168:171], a[224:227], v[24:27], 0
  s_waitcnt lgkmcnt(0)
  s_waitcnt vmcnt(3)
  s_barrier
  ds_read_b128 a[216:219], v4 offset:0
  v_exp_f16_sdwa v11, v11 dst_sel:WORD_0 dst_unused:UNUSED_PRESERVE src0_sel:WORD_0
  v_mfma_f32_16x16x32_f16 v[172:175], a[224:227], v[28:31], 0
  v_exp_f16_sdwa v13, v13 dst_sel:WORD_0 dst_unused:UNUSED_PRESERVE src0_sel:WORD_0
  v_mfma_f32_16x16x32_f16 v[176:179], a[224:227], v[32:35], 0
  v_exp_f16_sdwa v15, v15 dst_sel:WORD_0 dst_unused:UNUSED_PRESERVE src0_sel:WORD_0
  v_mfma_f32_16x16x32_f16 v[188:191], a[228:231], v[32:35], 0
  ds_read_b128 a[220:223], v4 offset:1024
  v_exp_f16_sdwa v9, v9 dst_sel:WORD_1 dst_unused:UNUSED_PRESERVE src0_sel:WORD_1
  v_mfma_f32_16x16x32_f16 v[184:187], a[228:231], v[28:31], 0
  v_exp_f16_sdwa v11, v11 dst_sel:WORD_1 dst_unused:UNUSED_PRESERVE src0_sel:WORD_1
  v_mfma_f32_16x16x32_f16 v[180:183], a[228:231], v[24:27], 0
  v_exp_f16_sdwa v13, v13 dst_sel:WORD_1 dst_unused:UNUSED_PRESERVE src0_sel:WORD_1
  v_mfma_f32_16x16x32_f16 v[192:195], a[232:235], v[24:27], 0
  ds_read_b128 a[224:227], v4 offset:2048
  v_exp_f16_sdwa v15, v15 dst_sel:WORD_1 dst_unused:UNUSED_PRESERVE src0_sel:WORD_1
  v_mfma_f32_16x16x32_f16 v[196:199], a[232:235], v[28:31], 0
  v_pk_fma_f16 v9, v9, s35, s35
  v_pk_fma_f16 v11, v11, s35, s35
  v_mfma_f32_16x16x32_f16 v[200:203], a[232:235], v[32:35], 0
  v_pk_fma_f16 v13, v13, s35, s35
  v_pk_fma_f16 v15, v15, s35, s35
  v_mfma_f32_16x16x32_f16 v[212:215], a[236:239], v[32:35], 0
  ds_read_b128 a[228:231], v4 offset:3072
  v_rcp_f16_sdwa v9, v9 dst_sel:WORD_0 dst_unused:UNUSED_PRESERVE src0_sel:WORD_0
  v_mfma_f32_16x16x32_f16 v[208:211], a[236:239], v[28:31], 0
  v_rcp_f16_sdwa v11, v11 dst_sel:WORD_0 dst_unused:UNUSED_PRESERVE src0_sel:WORD_0
  v_mfma_f32_16x16x32_f16 v[204:207], a[236:239], v[24:27], 0
  v_rcp_f16_sdwa v13, v13 dst_sel:WORD_0 dst_unused:UNUSED_PRESERVE src0_sel:WORD_0
  v_rcp_f16_sdwa v15, v15 dst_sel:WORD_0 dst_unused:UNUSED_PRESERVE src0_sel:WORD_0
  v_mfma_f32_16x16x32_f16 v[216:219], a[240:243], v[24:27], 0
  ds_read_b128 a[232:235], v4 offset:4096
  v_rcp_f16_sdwa v9, v9 dst_sel:WORD_1 dst_unused:UNUSED_PRESERVE src0_sel:WORD_1
  v_mfma_f32_16x16x32_f16 v[220:223], a[240:243], v[28:31], 0
  v_rcp_f16_sdwa v11, v11 dst_sel:WORD_1 dst_unused:UNUSED_PRESERVE src0_sel:WORD_1
  v_mfma_f32_16x16x32_f16 v[224:227], a[240:243], v[32:35], 0
  v_rcp_f16_sdwa v13, v13 dst_sel:WORD_1 dst_unused:UNUSED_PRESERVE src0_sel:WORD_1
  v_mfma_f32_16x16x32_f16 v[236:239], a[244:247], v[32:35], 0
  ds_read_b128 a[236:239], v4 offset:5120
  v_rcp_f16_sdwa v15, v15 dst_sel:WORD_1 dst_unused:UNUSED_PRESERVE src0_sel:WORD_1
  v_mfma_f32_16x16x32_f16 v[232:235], a[244:247], v[28:31], 0
  v_pk_mul_f16 v42, v8, v9
  v_pk_mul_f16 v43, v10, v11
  v_mfma_f32_16x16x32_f16 v[228:231], a[244:247], v[24:27], 0
  s_waitcnt lgkmcnt(3)
  v_pk_mul_f16 v46, v12, v13
  v_pk_mul_f16 v47, v14, v15
  v_mfma_f32_16x16x32_bf16 v[72:75], a[216:219], a[0:3], 0
  ds_read_b128 a[240:243], v4 offset:6144
  s_add_u32 m0, s29, 0
  s_add_u32 s31, s29, 98304
  buffer_load_dwordx4 v2, s[8:11], s31 offen offset:0 lds
  v_cvt_pk_f16_f32 v8, v48, v49
  v_cvt_pk_f16_f32 v10, v50, v51
  v_mfma_f32_16x16x32_bf16 v[76:79], a[216:219], a[24:27], 0
  v_cvt_pk_f16_f32 v12, v52, v53
  v_cvt_pk_f16_f32 v14, v54, v55
  v_mfma_f32_16x16x32_bf16 v[80:83], a[216:219], a[48:51], 0
  v_pk_fma_f16 v9, v8, v8, s34 neg_lo:[1,0,0] neg_hi:[1,0,0]
  v_pk_fma_f16 v11, v10, v10, s34 neg_lo:[1,0,0] neg_hi:[1,0,0]
  v_pk_fma_f16 v13, v12, v12, s34 neg_lo:[1,0,0] neg_hi:[1,0,0]
  v_mfma_f32_16x16x32_bf16 v[92:95], a[220:223], a[48:51], 0
  ds_read_b128 a[244:247], v4 offset:7168
  buffer_load_dwordx4 v2, s[8:11], s31 offen offset:1024 lds
  v_pk_fma_f16 v15, v14, v14, s34 neg_lo:[1,0,0] neg_hi:[1,0,0]
  v_pk_mul_f16 v9, v9, v8
  v_mfma_f32_16x16x32_bf16 v[88:91], a[220:223], a[24:27], 0
  v_pk_mul_f16 v11, v11, v10
  v_pk_mul_f16 v13, v13, v12
  v_mfma_f32_16x16x32_bf16 v[84:87], a[220:223], a[0:3], 0
  v_pk_mul_f16 v15, v15, v14
  v_exp_f16_sdwa v9, v9 dst_sel:WORD_0 dst_unused:UNUSED_PRESERVE src0_sel:WORD_0
  v_mfma_f32_16x16x32_bf16 v[72:75], a[224:227], a[4:7], v[72:75]
  ds_read_b128 a[216:219], v4 offset:8192
  buffer_load_dwordx4 v2, s[8:11], s31 offen offset:2048 lds
  v_exp_f16_sdwa v11, v11 dst_sel:WORD_0 dst_unused:UNUSED_PRESERVE src0_sel:WORD_0
  v_mfma_f32_16x16x32_bf16 v[76:79], a[224:227], a[28:31], v[76:79]
  v_exp_f16_sdwa v13, v13 dst_sel:WORD_0 dst_unused:UNUSED_PRESERVE src0_sel:WORD_0
  v_mfma_f32_16x16x32_bf16 v[80:83], a[224:227], a[52:55], v[80:83]
  s_waitcnt lgkmcnt(3)
  v_exp_f16_sdwa v15, v15 dst_sel:WORD_0 dst_unused:UNUSED_PRESERVE src0_sel:WORD_0
  v_mfma_f32_16x16x32_bf16 v[92:95], a[228:231], a[52:55], v[92:95]
  ds_read_b128 a[220:223], v4 offset:9216
  buffer_load_dwordx4 v2, s[8:11], s31 offen offset:3072 lds
  v_exp_f16_sdwa v9, v9 dst_sel:WORD_1 dst_unused:UNUSED_PRESERVE src0_sel:WORD_1
  v_mfma_f32_16x16x32_bf16 v[88:91], a[228:231], a[28:31], v[88:91]
  s_add_u32 m0, s29, 4096
  v_exp_f16_sdwa v11, v11 dst_sel:WORD_1 dst_unused:UNUSED_PRESERVE src0_sel:WORD_1
  v_mfma_f32_16x16x32_bf16 v[84:87], a[228:231], a[4:7], v[84:87]
  s_add_u32 s31, s29, 102400
  v_exp_f16_sdwa v13, v13 dst_sel:WORD_1 dst_unused:UNUSED_PRESERVE src0_sel:WORD_1
  v_mfma_f32_16x16x32_bf16 v[72:75], a[232:235], a[8:11], v[72:75]
  ds_read_b128 a[224:227], v4 offset:10240
  buffer_load_dwordx4 v2, s[8:11], s31 offen offset:0 lds
  v_exp_f16_sdwa v15, v15 dst_sel:WORD_1 dst_unused:UNUSED_PRESERVE src0_sel:WORD_1
  v_mfma_f32_16x16x32_bf16 v[76:79], a[232:235], a[32:35], v[76:79]
  v_pk_fma_f16 v9, v9, s35, s35
  v_pk_fma_f16 v11, v11, s35, s35
  v_mfma_f32_16x16x32_bf16 v[80:83], a[232:235], a[56:59], v[80:83]
  v_pk_fma_f16 v13, v13, s35, s35
  v_pk_fma_f16 v15, v15, s35, s35
  v_mfma_f32_16x16x32_bf16 v[92:95], a[236:239], a[56:59], v[92:95]
  ds_read_b128 a[228:231], v4 offset:11264
  buffer_load_dwordx4 v2, s[8:11], s31 offen offset:1024 lds
  v_rcp_f16_sdwa v9, v9 dst_sel:WORD_0 dst_unused:UNUSED_PRESERVE src0_sel:WORD_0
  v_mfma_f32_16x16x32_bf16 v[88:91], a[236:239], a[32:35], v[88:91]
  v_rcp_f16_sdwa v11, v11 dst_sel:WORD_0 dst_unused:UNUSED_PRESERVE src0_sel:WORD_0
  v_mfma_f32_16x16x32_bf16 v[84:87], a[236:239], a[8:11], v[84:87]
  s_waitcnt lgkmcnt(3)
  v_rcp_f16_sdwa v13, v13 dst_sel:WORD_0 dst_unused:UNUSED_PRESERVE src0_sel:WORD_0
  v_rcp_f16_sdwa v15, v15 dst_sel:WORD_0 dst_unused:UNUSED_PRESERVE src0_sel:WORD_0
  v_mfma_f32_16x16x32_bf16 v[72:75], a[240:243], a[12:15], v[72:75]
  ds_read_b128 a[232:235], v4 offset:12288
  buffer_load_dwordx4 v2, s[8:11], s31 offen offset:2048 lds
  v_rcp_f16_sdwa v9, v9 dst_sel:WORD_1 dst_unused:UNUSED_PRESERVE src0_sel:WORD_1
  v_mfma_f32_16x16x32_bf16 v[76:79], a[240:243], a[36:39], v[76:79]
  v_rcp_f16_sdwa v11, v11 dst_sel:WORD_1 dst_unused:UNUSED_PRESERVE src0_sel:WORD_1
  v_mfma_f32_16x16x32_bf16 v[80:83], a[240:243], a[60:63], v[80:83]
  v_rcp_f16_sdwa v13, v13 dst_sel:WORD_1 dst_unused:UNUSED_PRESERVE src0_sel:WORD_1
  v_mfma_f32_16x16x32_bf16 v[92:95], a[244:247], a[60:63], v[92:95]
  ds_read_b128 a[236:239], v4 offset:13312
  buffer_load_dwordx4 v2, s[8:11], s31 offen offset:3072 lds
  v_rcp_f16_sdwa v15, v15 dst_sel:WORD_1 dst_unused:UNUSED_PRESERVE src0_sel:WORD_1
  v_mfma_f32_16x16x32_bf16 v[88:91], a[244:247], a[36:39], v[88:91]
  s_add_u32 m0, s29, 8192
  v_pk_mul_f16 v24, v8, v9
  v_pk_mul_f16 v25, v10, v11
  v_mfma_f32_16x16x32_bf16 v[84:87], a[244:247], a[12:15], v[84:87]
  s_add_u32 s31, s29, 106496
  v_pk_mul_f16 v28, v12, v13
  v_pk_mul_f16 v29, v14, v15
  v_mfma_f32_16x16x32_bf16 v[72:75], a[216:219], a[16:19], v[72:75]
  ds_read_b128 a[240:243], v4 offset:14336
  buffer_load_dwordx4 v2, s[8:11], s31 offen offset:0 lds
  v_cvt_pk_f16_f32 v16, v56, v57
  v_cvt_pk_f16_f32 v18, v58, v59
  v_mfma_f32_16x16x32_bf16 v[76:79], a[216:219], a[40:43], v[76:79]
  v_cvt_pk_f16_f32 v20, v60, v61
  v_cvt_pk_f16_f32 v22, v62, v63
  v_mfma_f32_16x16x32_bf16 v[80:83], a[216:219], a[64:67], v[80:83]
  s_waitcnt lgkmcnt(3)
  v_pk_fma_f16 v17, v16, v16, s34 neg_lo:[1,0,0] neg_hi:[1,0,0]
  v_pk_fma_f16 v19, v18, v18, s34 neg_lo:[1,0,0] neg_hi:[1,0,0]
  v_pk_fma_f16 v21, v20, v20, s34 neg_lo:[1,0,0] neg_hi:[1,0,0]
  v_mfma_f32_16x16x32_bf16 v[92:95], a[220:223], a[64:67], v[92:95]
  ds_read_b128 a[244:247], v4 offset:15360
  buffer_load_dwordx4 v2, s[8:11], s31 offen offset:1024 lds
  v_pk_fma_f16 v23, v22, v22, s34 neg_lo:[1,0,0] neg_hi:[1,0,0]
  v_pk_mul_f16 v17, v17, v16
  v_mfma_f32_16x16x32_bf16 v[88:91], a[220:223], a[40:43], v[88:91]
  v_pk_mul_f16 v19, v19, v18
  v_pk_mul_f16 v21, v21, v20
  v_mfma_f32_16x16x32_bf16 v[84:87], a[220:223], a[16:19], v[84:87]
  v_pk_mul_f16 v23, v23, v22
  v_exp_f16_sdwa v17, v17 dst_sel:WORD_0 dst_unused:UNUSED_PRESERVE src0_sel:WORD_0
  v_mfma_f32_16x16x32_bf16 v[72:75], a[224:227], a[20:23], v[72:75]
  ds_read_b128 a[216:219], v4 offset:16384
  buffer_load_dwordx4 v2, s[8:11], s31 offen offset:2048 lds
  v_exp_f16_sdwa v19, v19 dst_sel:WORD_0 dst_unused:UNUSED_PRESERVE src0_sel:WORD_0
  v_mfma_f32_16x16x32_bf16 v[76:79], a[224:227], a[44:47], v[76:79]
  v_exp_f16_sdwa v21, v21 dst_sel:WORD_0 dst_unused:UNUSED_PRESERVE src0_sel:WORD_0
  v_mfma_f32_16x16x32_bf16 v[80:83], a[224:227], a[68:71], v[80:83]
  v_exp_f16_sdwa v23, v23 dst_sel:WORD_0 dst_unused:UNUSED_PRESERVE src0_sel:WORD_0
  v_mfma_f32_16x16x32_bf16 v[92:95], a[228:231], a[68:71], v[92:95]
  ds_read_b128 a[220:223], v4 offset:17408
  buffer_load_dwordx4 v2, s[8:11], s31 offen offset:3072 lds
  v_exp_f16_sdwa v17, v17 dst_sel:WORD_1 dst_unused:UNUSED_PRESERVE src0_sel:WORD_1
  v_mfma_f32_16x16x32_bf16 v[88:91], a[228:231], a[44:47], v[88:91]
  v_exp_f16_sdwa v19, v19 dst_sel:WORD_1 dst_unused:UNUSED_PRESERVE src0_sel:WORD_1
  v_mfma_f32_16x16x32_bf16 v[84:87], a[228:231], a[20:23], v[84:87]
  s_waitcnt lgkmcnt(3)
  v_exp_f16_sdwa v21, v21 dst_sel:WORD_1 dst_unused:UNUSED_PRESERVE src0_sel:WORD_1
  v_mfma_f32_16x16x32_f16 v[96:99], a[232:235], v[36:39], v[96:99]
  ds_read_b128 a[224:227], v4 offset:18432
  v_exp_f16_sdwa v23, v23 dst_sel:WORD_1 dst_unused:UNUSED_PRESERVE src0_sel:WORD_1
  v_mfma_f32_16x16x32_f16 v[100:103], a[232:235], v[40:43], v[100:103]
  v_pk_fma_f16 v17, v17, s35, s35
  v_pk_fma_f16 v19, v19, s35, s35
  v_mfma_f32_16x16x32_f16 v[104:107], a[232:235], v[44:47], v[104:107]
  v_pk_fma_f16 v21, v21, s35, s35
  v_pk_fma_f16 v23, v23, s35, s35
  v_mfma_f32_16x16x32_f16 v[116:119], a[236:239], v[44:47], v[116:119]
  ds_read_b128 a[228:231], v4 offset:19456
  v_rcp_f16_sdwa v17, v17 dst_sel:WORD_0 dst_unused:UNUSED_PRESERVE src0_sel:WORD_0
  v_mfma_f32_16x16x32_f16 v[112:115], a[236:239], v[40:43], v[112:115]
  v_rcp_f16_sdwa v19, v19 dst_sel:WORD_0 dst_unused:UNUSED_PRESERVE src0_sel:WORD_0
  v_mfma_f32_16x16x32_f16 v[108:111], a[236:239], v[36:39], v[108:111]
  v_rcp_f16_sdwa v21, v21 dst_sel:WORD_0 dst_unused:UNUSED_PRESERVE src0_sel:WORD_0
  v_rcp_f16_sdwa v23, v23 dst_sel:WORD_0 dst_unused:UNUSED_PRESERVE src0_sel:WORD_0
  v_mfma_f32_16x16x32_f16 v[120:123], a[240:243], v[36:39], v[120:123]
  ds_read_b128 a[232:235], v4 offset:20480
  v_rcp_f16_sdwa v17, v17 dst_sel:WORD_1 dst_unused:UNUSED_PRESERVE src0_sel:WORD_1
  v_mfma_f32_16x16x32_f16 v[124:127], a[240:243], v[40:43], v[124:127]
  v_rcp_f16_sdwa v19, v19 dst_sel:WORD_1 dst_unused:UNUSED_PRESERVE src0_sel:WORD_1
  v_mfma_f32_16x16x32_f16 v[128:131], a[240:243], v[44:47], v[128:131]
  s_waitcnt lgkmcnt(3)
  v_rcp_f16_sdwa v21, v21 dst_sel:WORD_1 dst_unused:UNUSED_PRESERVE src0_sel:WORD_1
  v_mfma_f32_16x16x32_f16 v[140:143], a[244:247], v[44:47], v[140:143]
  ds_read_b128 a[236:239], v4 offset:21504
  v_rcp_f16_sdwa v23, v23 dst_sel:WORD_1 dst_unused:UNUSED_PRESERVE src0_sel:WORD_1
  v_mfma_f32_16x16x32_f16 v[136:139], a[244:247], v[40:43], v[136:139]
  v_pk_mul_f16 v32, v16, v17
  v_pk_mul_f16 v33, v18, v19
  v_mfma_f32_16x16x32_f16 v[132:135], a[244:247], v[36:39], v[132:135]
  v_pk_mul_f16 v26, v20, v21
  v_pk_mul_f16 v27, v22, v23
  v_mfma_f32_16x16x32_f16 v[144:147], a[216:219], v[36:39], v[144:147]
  ds_read_b128 a[240:243], v4 offset:22528
  v_cvt_pk_f16_f32 v8, v64, v65
  v_cvt_pk_f16_f32 v10, v66, v67
  v_mfma_f32_16x16x32_f16 v[148:151], a[216:219], v[40:43], v[148:151]
  v_cvt_pk_f16_f32 v12, v68, v69
  v_cvt_pk_f16_f32 v14, v70, v71
  v_mfma_f32_16x16x32_f16 v[152:155], a[216:219], v[44:47], v[152:155]
  v_pk_fma_f16 v9, v8, v8, s34 neg_lo:[1,0,0] neg_hi:[1,0,0]
  v_pk_fma_f16 v11, v10, v10, s34 neg_lo:[1,0,0] neg_hi:[1,0,0]
  v_pk_fma_f16 v13, v12, v12, s34 neg_lo:[1,0,0] neg_hi:[1,0,0]
  v_mfma_f32_16x16x32_f16 v[164:167], a[220:223], v[44:47], v[164:167]
  ds_read_b128 a[244:247], v4 offset:23552
  v_pk_fma_f16 v15, v14, v14, s34 neg_lo:[1,0,0] neg_hi:[1,0,0]
  v_pk_mul_f16 v9, v9, v8
  v_mfma_f32_16x16x32_f16 v[160:163], a[220:223], v[40:43], v[160:163]
  v_pk_mul_f16 v11, v11, v10
  v_pk_mul_f16 v13, v13, v12
  v_mfma_f32_16x16x32_f16 v[156:159], a[220:223], v[36:39], v[156:159]
  s_waitcnt lgkmcnt(3)
  v_pk_mul_f16 v15, v15, v14
  v_exp_f16_sdwa v9, v9 dst_sel:WORD_0 dst_unused:UNUSED_PRESERVE src0_sel:WORD_0
  v_mfma_f32_16x16x32_f16 v[168:171], a[224:227], v[36:39], v[168:171]
  ds_read_b128 a[216:219], v4 offset:24576
  v_exp_f16_sdwa v11, v11 dst_sel:WORD_0 dst_unused:UNUSED_PRESERVE src0_sel:WORD_0
  v_mfma_f32_16x16x32_f16 v[172:175], a[224:227], v[40:43], v[172:175]
  v_exp_f16_sdwa v13, v13 dst_sel:WORD_0 dst_unused:UNUSED_PRESERVE src0_sel:WORD_0
  v_mfma_f32_16x16x32_f16 v[176:179], a[224:227], v[44:47], v[176:179]
  v_exp_f16_sdwa v15, v15 dst_sel:WORD_0 dst_unused:UNUSED_PRESERVE src0_sel:WORD_0
  v_mfma_f32_16x16x32_f16 v[188:191], a[228:231], v[44:47], v[188:191]
  ds_read_b128 a[220:223], v4 offset:25600
  v_exp_f16_sdwa v9, v9 dst_sel:WORD_1 dst_unused:UNUSED_PRESERVE src0_sel:WORD_1
  v_mfma_f32_16x16x32_f16 v[184:187], a[228:231], v[40:43], v[184:187]
  v_exp_f16_sdwa v11, v11 dst_sel:WORD_1 dst_unused:UNUSED_PRESERVE src0_sel:WORD_1
  v_mfma_f32_16x16x32_f16 v[180:183], a[228:231], v[36:39], v[180:183]
  v_exp_f16_sdwa v13, v13 dst_sel:WORD_1 dst_unused:UNUSED_PRESERVE src0_sel:WORD_1
  v_mfma_f32_16x16x32_f16 v[192:195], a[232:235], v[36:39], v[192:195]
  ds_read_b128 a[224:227], v4 offset:26624
  v_exp_f16_sdwa v15, v15 dst_sel:WORD_1 dst_unused:UNUSED_PRESERVE src0_sel:WORD_1
  v_mfma_f32_16x16x32_f16 v[196:199], a[232:235], v[40:43], v[196:199]
  v_pk_fma_f16 v9, v9, s35, s35
  v_pk_fma_f16 v11, v11, s35, s35
  v_mfma_f32_16x16x32_f16 v[200:203], a[232:235], v[44:47], v[200:203]
  s_waitcnt lgkmcnt(3)
  v_pk_fma_f16 v13, v13, s35, s35
  v_pk_fma_f16 v15, v15, s35, s35
  v_mfma_f32_16x16x32_f16 v[212:215], a[236:239], v[44:47], v[212:215]
  ds_read_b128 a[228:231], v4 offset:27648
  v_rcp_f16_sdwa v9, v9 dst_sel:WORD_0 dst_unused:UNUSED_PRESERVE src0_sel:WORD_0
  v_mfma_f32_16x16x32_f16 v[208:211], a[236:239], v[40:43], v[208:211]
  v_rcp_f16_sdwa v11, v11 dst_sel:WORD_0 dst_unused:UNUSED_PRESERVE src0_sel:WORD_0
  v_mfma_f32_16x16x32_f16 v[204:207], a[236:239], v[36:39], v[204:207]
  v_rcp_f16_sdwa v13, v13 dst_sel:WORD_0 dst_unused:UNUSED_PRESERVE src0_sel:WORD_0
  v_rcp_f16_sdwa v15, v15 dst_sel:WORD_0 dst_unused:UNUSED_PRESERVE src0_sel:WORD_0
  v_mfma_f32_16x16x32_f16 v[216:219], a[240:243], v[36:39], v[216:219]
  ds_read_b128 a[232:235], v4 offset:28672
  v_rcp_f16_sdwa v9, v9 dst_sel:WORD_1 dst_unused:UNUSED_PRESERVE src0_sel:WORD_1
  v_mfma_f32_16x16x32_f16 v[220:223], a[240:243], v[40:43], v[220:223]
  v_rcp_f16_sdwa v11, v11 dst_sel:WORD_1 dst_unused:UNUSED_PRESERVE src0_sel:WORD_1
  v_mfma_f32_16x16x32_f16 v[224:227], a[240:243], v[44:47], v[224:227]
  v_rcp_f16_sdwa v13, v13 dst_sel:WORD_1 dst_unused:UNUSED_PRESERVE src0_sel:WORD_1
  v_mfma_f32_16x16x32_f16 v[236:239], a[244:247], v[44:47], v[236:239]
  ds_read_b128 a[236:239], v4 offset:29696
  v_rcp_f16_sdwa v15, v15 dst_sel:WORD_1 dst_unused:UNUSED_PRESERVE src0_sel:WORD_1
  v_mfma_f32_16x16x32_f16 v[232:235], a[244:247], v[40:43], v[232:235]
  v_pk_mul_f16 v30, v8, v9
  v_pk_mul_f16 v31, v10, v11
  v_mfma_f32_16x16x32_f16 v[228:231], a[244:247], v[36:39], v[228:231]
  s_waitcnt lgkmcnt(3)
  v_pk_mul_f16 v34, v12, v13
  v_pk_mul_f16 v35, v14, v15
  v_mfma_f32_16x16x32_bf16 v[48:51], a[216:219], a[0:3], 0
  ds_read_b128 a[240:243], v4 offset:30720
  v_cvt_pk_f16_f32 v8, v72, v73
  v_cvt_pk_f16_f32 v10, v74, v75
  v_mfma_f32_16x16x32_bf16 v[52:55], a[216:219], a[24:27], 0
  v_cvt_pk_f16_f32 v12, v76, v77
  v_cvt_pk_f16_f32 v14, v78, v79
  v_mfma_f32_16x16x32_bf16 v[56:59], a[216:219], a[48:51], 0
  v_pk_fma_f16 v9, v8, v8, s34 neg_lo:[1,0,0] neg_hi:[1,0,0]
  v_pk_fma_f16 v11, v10, v10, s34 neg_lo:[1,0,0] neg_hi:[1,0,0]
  v_pk_fma_f16 v13, v12, v12, s34 neg_lo:[1,0,0] neg_hi:[1,0,0]
  v_mfma_f32_16x16x32_bf16 v[68:71], a[220:223], a[48:51], 0
  ds_read_b128 a[244:247], v4 offset:31744
  v_pk_fma_f16 v15, v14, v14, s34 neg_lo:[1,0,0] neg_hi:[1,0,0]
  v_pk_mul_f16 v9, v9, v8
  v_mfma_f32_16x16x32_bf16 v[64:67], a[220:223], a[24:27], 0
  buffer_store_dwordx4 a[156:159], v3, s[20:23], s44 offen offset:192 sc1
  v_pk_mul_f16 v11, v11, v10
  v_pk_mul_f16 v13, v13, v12
  v_mfma_f32_16x16x32_bf16 v[60:63], a[220:223], a[0:3], 0
  v_pk_mul_f16 v15, v15, v14
  v_exp_f16_sdwa v9, v9 dst_sel:WORD_0 dst_unused:UNUSED_PRESERVE src0_sel:WORD_0
  v_mfma_f32_16x16x32_bf16 v[48:51], a[224:227], a[4:7], v[48:51]
  ds_read_b128 a[216:219], v4 offset:32768
  v_exp_f16_sdwa v11, v11 dst_sel:WORD_0 dst_unused:UNUSED_PRESERVE src0_sel:WORD_0
  v_mfma_f32_16x16x32_bf16 v[52:55], a[224:227], a[28:31], v[52:55]
  v_exp_f16_sdwa v13, v13 dst_sel:WORD_0 dst_unused:UNUSED_PRESERVE src0_sel:WORD_0
  v_mfma_f32_16x16x32_bf16 v[56:59], a[224:227], a[52:55], v[56:59]
  s_waitcnt lgkmcnt(3)
  v_exp_f16_sdwa v15, v15 dst_sel:WORD_0 dst_unused:UNUSED_PRESERVE src0_sel:WORD_0
  v_mfma_f32_16x16x32_bf16 v[68:71], a[228:231], a[52:55], v[68:71]
  ds_read_b128 a[220:223], v4 offset:33792
  v_exp_f16_sdwa v9, v9 dst_sel:WORD_1 dst_unused:UNUSED_PRESERVE src0_sel:WORD_1
  v_mfma_f32_16x16x32_bf16 v[64:67], a[228:231], a[28:31], v[64:67]
  v_exp_f16_sdwa v11, v11 dst_sel:WORD_1 dst_unused:UNUSED_PRESERVE src0_sel:WORD_1
  v_mfma_f32_16x16x32_bf16 v[60:63], a[228:231], a[4:7], v[60:63]
  v_exp_f16_sdwa v13, v13 dst_sel:WORD_1 dst_unused:UNUSED_PRESERVE src0_sel:WORD_1
  v_mfma_f32_16x16x32_bf16 v[48:51], a[232:235], a[8:11], v[48:51]
  ds_read_b128 a[224:227], v4 offset:34816
  v_exp_f16_sdwa v15, v15 dst_sel:WORD_1 dst_unused:UNUSED_PRESERVE src0_sel:WORD_1
  v_mfma_f32_16x16x32_bf16 v[52:55], a[232:235], a[32:35], v[52:55]
  buffer_store_dwordx4 a[160:163], v3, s[20:23], s44 offen offset:256 sc1
  v_pk_fma_f16 v9, v9, s35, s35
  v_pk_fma_f16 v11, v11, s35, s35
  v_mfma_f32_16x16x32_bf16 v[56:59], a[232:235], a[56:59], v[56:59]
  v_pk_fma_f16 v13, v13, s35, s35
  v_pk_fma_f16 v15, v15, s35, s35
  v_mfma_f32_16x16x32_bf16 v[68:71], a[236:239], a[56:59], v[68:71]
  ds_read_b128 a[228:231], v4 offset:35840
  v_rcp_f16_sdwa v9, v9 dst_sel:WORD_0 dst_unused:UNUSED_PRESERVE src0_sel:WORD_0
  v_mfma_f32_16x16x32_bf16 v[64:67], a[236:239], a[32:35], v[64:67]
  v_rcp_f16_sdwa v11, v11 dst_sel:WORD_0 dst_unused:UNUSED_PRESERVE src0_sel:WORD_0
  v_mfma_f32_16x16x32_bf16 v[60:63], a[236:239], a[8:11], v[60:63]
  s_waitcnt lgkmcnt(3)
  v_rcp_f16_sdwa v13, v13 dst_sel:WORD_0 dst_unused:UNUSED_PRESERVE src0_sel:WORD_0
  v_rcp_f16_sdwa v15, v15 dst_sel:WORD_0 dst_unused:UNUSED_PRESERVE src0_sel:WORD_0
  v_mfma_f32_16x16x32_bf16 v[48:51], a[240:243], a[12:15], v[48:51]
  ds_read_b128 a[232:235], v4 offset:36864
  v_rcp_f16_sdwa v9, v9 dst_sel:WORD_1 dst_unused:UNUSED_PRESERVE src0_sel:WORD_1
  v_mfma_f32_16x16x32_bf16 v[52:55], a[240:243], a[36:39], v[52:55]
  v_rcp_f16_sdwa v11, v11 dst_sel:WORD_1 dst_unused:UNUSED_PRESERVE src0_sel:WORD_1
  v_mfma_f32_16x16x32_bf16 v[56:59], a[240:243], a[60:63], v[56:59]
  v_rcp_f16_sdwa v13, v13 dst_sel:WORD_1 dst_unused:UNUSED_PRESERVE src0_sel:WORD_1
  v_mfma_f32_16x16x32_bf16 v[68:71], a[244:247], a[60:63], v[68:71]
  ds_read_b128 a[236:239], v4 offset:37888
  v_rcp_f16_sdwa v15, v15 dst_sel:WORD_1 dst_unused:UNUSED_PRESERVE src0_sel:WORD_1
  v_mfma_f32_16x16x32_bf16 v[64:67], a[244:247], a[36:39], v[64:67]
  buffer_store_dwordx4 a[164:167], v3, s[20:23], s44 offen offset:320 sc1
  v_pk_mul_f16 v36, v8, v9
  v_pk_mul_f16 v37, v10, v11
  v_mfma_f32_16x16x32_bf16 v[60:63], a[244:247], a[12:15], v[60:63]
  v_pk_mul_f16 v40, v12, v13
  v_pk_mul_f16 v41, v14, v15
  v_mfma_f32_16x16x32_bf16 v[48:51], a[216:219], a[16:19], v[48:51]
  ds_read_b128 a[240:243], v4 offset:38912
  v_cvt_pk_f16_f32 v16, v80, v81
  v_cvt_pk_f16_f32 v18, v82, v83
  v_mfma_f32_16x16x32_bf16 v[52:55], a[216:219], a[40:43], v[52:55]
  v_cvt_pk_f16_f32 v20, v84, v85
  v_cvt_pk_f16_f32 v22, v86, v87
  v_mfma_f32_16x16x32_bf16 v[56:59], a[216:219], a[64:67], v[56:59]
  s_waitcnt lgkmcnt(3)
  v_pk_fma_f16 v17, v16, v16, s34 neg_lo:[1,0,0] neg_hi:[1,0,0]
  v_pk_fma_f16 v19, v18, v18, s34 neg_lo:[1,0,0] neg_hi:[1,0,0]
  v_pk_fma_f16 v21, v20, v20, s34 neg_lo:[1,0,0] neg_hi:[1,0,0]
  v_mfma_f32_16x16x32_bf16 v[68:71], a[220:223], a[64:67], v[68:71]
  ds_read_b128 a[244:247], v4 offset:39936
  v_pk_fma_f16 v23, v22, v22, s34 neg_lo:[1,0,0] neg_hi:[1,0,0]
  v_pk_mul_f16 v17, v17, v16
  v_mfma_f32_16x16x32_bf16 v[64:67], a[220:223], a[40:43], v[64:67]
  v_pk_mul_f16 v19, v19, v18
  v_pk_mul_f16 v21, v21, v20
  v_mfma_f32_16x16x32_bf16 v[60:63], a[220:223], a[16:19], v[60:63]
  v_pk_mul_f16 v23, v23, v22
  v_exp_f16_sdwa v17, v17 dst_sel:WORD_0 dst_unused:UNUSED_PRESERVE src0_sel:WORD_0
  v_mfma_f32_16x16x32_bf16 v[48:51], a[224:227], a[20:23], v[48:51]
  ds_read_b128 a[216:219], v4 offset:40960
  v_exp_f16_sdwa v19, v19 dst_sel:WORD_0 dst_unused:UNUSED_PRESERVE src0_sel:WORD_0
  v_mfma_f32_16x16x32_bf16 v[52:55], a[224:227], a[44:47], v[52:55]
  v_exp_f16_sdwa v21, v21 dst_sel:WORD_0 dst_unused:UNUSED_PRESERVE src0_sel:WORD_0
  v_mfma_f32_16x16x32_bf16 v[56:59], a[224:227], a[68:71], v[56:59]
  v_exp_f16_sdwa v23, v23 dst_sel:WORD_0 dst_unused:UNUSED_PRESERVE src0_sel:WORD_0
  v_mfma_f32_16x16x32_bf16 v[68:71], a[228:231], a[68:71], v[68:71]
  ds_read_b128 a[220:223], v4 offset:41984
  v_exp_f16_sdwa v17, v17 dst_sel:WORD_1 dst_unused:UNUSED_PRESERVE src0_sel:WORD_1
  v_mfma_f32_16x16x32_bf16 v[64:67], a[228:231], a[44:47], v[64:67]
  v_exp_f16_sdwa v19, v19 dst_sel:WORD_1 dst_unused:UNUSED_PRESERVE src0_sel:WORD_1
  v_mfma_f32_16x16x32_bf16 v[60:63], a[228:231], a[20:23], v[60:63]
  s_waitcnt lgkmcnt(3)
  v_exp_f16_sdwa v21, v21 dst_sel:WORD_1 dst_unused:UNUSED_PRESERVE src0_sel:WORD_1
  v_mfma_f32_16x16x32_f16 v[96:99], a[232:235], v[24:27], v[96:99]
  ds_read_b128 a[224:227], v4 offset:43008
  v_exp_f16_sdwa v23, v23 dst_sel:WORD_1 dst_unused:UNUSED_PRESERVE src0_sel:WORD_1
  v_mfma_f32_16x16x32_f16 v[100:103], a[232:235], v[28:31], v[100:103]
  v_pk_fma_f16 v17, v17, s35, s35
  v_pk_fma_f16 v19, v19, s35, s35
  v_mfma_f32_16x16x32_f16 v[104:107], a[232:235], v[32:35], v[104:107]
  v_pk_fma_f16 v21, v21, s35, s35
  v_pk_fma_f16 v23, v23, s35, s35
  v_mfma_f32_16x16x32_f16 v[116:119], a[236:239], v[32:35], v[116:119]
  ds_read_b128 a[228:231], v4 offset:44032
  v_rcp_f16_sdwa v17, v17 dst_sel:WORD_0 dst_unused:UNUSED_PRESERVE src0_sel:WORD_0
  v_mfma_f32_16x16x32_f16 v[112:115], a[236:239], v[28:31], v[112:115]
  v_rcp_f16_sdwa v19, v19 dst_sel:WORD_0 dst_unused:UNUSED_PRESERVE src0_sel:WORD_0
  v_mfma_f32_16x16x32_f16 v[108:111], a[236:239], v[24:27], v[108:111]
  v_rcp_f16_sdwa v21, v21 dst_sel:WORD_0 dst_unused:UNUSED_PRESERVE src0_sel:WORD_0
  v_rcp_f16_sdwa v23, v23 dst_sel:WORD_0 dst_unused:UNUSED_PRESERVE src0_sel:WORD_0
  v_mfma_f32_16x16x32_f16 v[120:123], a[240:243], v[24:27], v[120:123]
  ds_read_b128 a[232:235], v4 offset:45056
  v_rcp_f16_sdwa v17, v17 dst_sel:WORD_1 dst_unused:UNUSED_PRESERVE src0_sel:WORD_1
  v_mfma_f32_16x16x32_f16 v[124:127], a[240:243], v[28:31], v[124:127]
  v_rcp_f16_sdwa v19, v19 dst_sel:WORD_1 dst_unused:UNUSED_PRESERVE src0_sel:WORD_1
  v_mfma_f32_16x16x32_f16 v[128:131], a[240:243], v[32:35], v[128:131]
  s_waitcnt lgkmcnt(3)
  v_rcp_f16_sdwa v21, v21 dst_sel:WORD_1 dst_unused:UNUSED_PRESERVE src0_sel:WORD_1
  v_mfma_f32_16x16x32_f16 v[140:143], a[244:247], v[32:35], v[140:143]
  ds_read_b128 a[236:239], v4 offset:46080
  v_rcp_f16_sdwa v23, v23 dst_sel:WORD_1 dst_unused:UNUSED_PRESERVE src0_sel:WORD_1
  v_mfma_f32_16x16x32_f16 v[136:139], a[244:247], v[28:31], v[136:139]
  v_pk_mul_f16 v44, v16, v17
  v_pk_mul_f16 v45, v18, v19
  v_mfma_f32_16x16x32_f16 v[132:135], a[244:247], v[24:27], v[132:135]
  v_pk_mul_f16 v38, v20, v21
  v_pk_mul_f16 v39, v22, v23
  v_mfma_f32_16x16x32_f16 v[144:147], a[216:219], v[24:27], v[144:147]
  ds_read_b128 a[240:243], v4 offset:47104
  ds_read_b128 a[244:247], v4 offset:48128
  v_cvt_pk_f16_f32 v8, v88, v89
  v_cvt_pk_f16_f32 v10, v90, v91
  v_mfma_f32_16x16x32_f16 v[148:151], a[216:219], v[28:31], v[148:151]
  v_cvt_pk_f16_f32 v12, v92, v93
  v_cvt_pk_f16_f32 v14, v94, v95
  v_mfma_f32_16x16x32_f16 v[152:155], a[216:219], v[32:35], v[152:155]
  v_pk_fma_f16 v9, v8, v8, s34 neg_lo:[1,0,0] neg_hi:[1,0,0]
  v_pk_fma_f16 v11, v10, v10, s34 neg_lo:[1,0,0] neg_hi:[1,0,0]
  v_pk_fma_f16 v13, v12, v12, s34 neg_lo:[1,0,0] neg_hi:[1,0,0]
  v_mfma_f32_16x16x32_f16 v[164:167], a[220:223], v[32:35], v[164:167]
  v_pk_fma_f16 v15, v14, v14, s34 neg_lo:[1,0,0] neg_hi:[1,0,0]
  v_pk_mul_f16 v9, v9, v8
  v_mfma_f32_16x16x32_f16 v[160:163], a[220:223], v[28:31], v[160:163]
  v_pk_mul_f16 v11, v11, v10
  v_pk_mul_f16 v13, v13, v12
  v_mfma_f32_16x16x32_f16 v[156:159], a[220:223], v[24:27], v[156:159]
  s_waitcnt lgkmcnt(3)
  v_pk_mul_f16 v15, v15, v14
  v_exp_f16_sdwa v9, v9 dst_sel:WORD_0 dst_unused:UNUSED_PRESERVE src0_sel:WORD_0
  v_mfma_f32_16x16x32_f16 v[168:171], a[224:227], v[24:27], v[168:171]
  s_waitcnt lgkmcnt(0)
  s_waitcnt vmcnt(3)
  s_barrier
  ds_read_b128 a[216:219], v1 offset:0
  v_exp_f16_sdwa v11, v11 dst_sel:WORD_0 dst_unused:UNUSED_PRESERVE src0_sel:WORD_0
  v_mfma_f32_16x16x32_f16 v[172:175], a[224:227], v[28:31], v[172:175]
  v_exp_f16_sdwa v13, v13 dst_sel:WORD_0 dst_unused:UNUSED_PRESERVE src0_sel:WORD_0
  v_mfma_f32_16x16x32_f16 v[176:179], a[224:227], v[32:35], v[176:179]
  v_exp_f16_sdwa v15, v15 dst_sel:WORD_0 dst_unused:UNUSED_PRESERVE src0_sel:WORD_0
  v_mfma_f32_16x16x32_f16 v[188:191], a[228:231], v[32:35], v[188:191]
  ds_read_b128 a[220:223], v1 offset:1024
  v_exp_f16_sdwa v9, v9 dst_sel:WORD_1 dst_unused:UNUSED_PRESERVE src0_sel:WORD_1
  v_mfma_f32_16x16x32_f16 v[184:187], a[228:231], v[28:31], v[184:187]
  v_exp_f16_sdwa v11, v11 dst_sel:WORD_1 dst_unused:UNUSED_PRESERVE src0_sel:WORD_1
  v_mfma_f32_16x16x32_f16 v[180:183], a[228:231], v[24:27], v[180:183]
  v_exp_f16_sdwa v13, v13 dst_sel:WORD_1 dst_unused:UNUSED_PRESERVE src0_sel:WORD_1
  v_mfma_f32_16x16x32_f16 v[192:195], a[232:235], v[24:27], v[192:195]
  ds_read_b128 a[224:227], v1 offset:2048
  v_exp_f16_sdwa v15, v15 dst_sel:WORD_1 dst_unused:UNUSED_PRESERVE src0_sel:WORD_1
  v_mfma_f32_16x16x32_f16 v[196:199], a[232:235], v[28:31], v[196:199]
  v_pk_fma_f16 v9, v9, s35, s35
  v_pk_fma_f16 v11, v11, s35, s35
  v_mfma_f32_16x16x32_f16 v[200:203], a[232:235], v[32:35], v[200:203]
  v_pk_fma_f16 v13, v13, s35, s35
  v_pk_fma_f16 v15, v15, s35, s35
  v_mfma_f32_16x16x32_f16 v[212:215], a[236:239], v[32:35], v[212:215]
  ds_read_b128 a[228:231], v1 offset:3072
  v_rcp_f16_sdwa v9, v9 dst_sel:WORD_0 dst_unused:UNUSED_PRESERVE src0_sel:WORD_0
  v_mfma_f32_16x16x32_f16 v[208:211], a[236:239], v[28:31], v[208:211]
  v_rcp_f16_sdwa v11, v11 dst_sel:WORD_0 dst_unused:UNUSED_PRESERVE src0_sel:WORD_0
  v_mfma_f32_16x16x32_f16 v[204:207], a[236:239], v[24:27], v[204:207]
  v_rcp_f16_sdwa v13, v13 dst_sel:WORD_0 dst_unused:UNUSED_PRESERVE src0_sel:WORD_0
  v_rcp_f16_sdwa v15, v15 dst_sel:WORD_0 dst_unused:UNUSED_PRESERVE src0_sel:WORD_0
  v_mfma_f32_16x16x32_f16 v[216:219], a[240:243], v[24:27], v[216:219]
  ds_read_b128 a[232:235], v1 offset:4096
  v_rcp_f16_sdwa v9, v9 dst_sel:WORD_1 dst_unused:UNUSED_PRESERVE src0_sel:WORD_1
  v_mfma_f32_16x16x32_f16 v[220:223], a[240:243], v[28:31], v[220:223]
  v_rcp_f16_sdwa v11, v11 dst_sel:WORD_1 dst_unused:UNUSED_PRESERVE src0_sel:WORD_1
  v_mfma_f32_16x16x32_f16 v[224:227], a[240:243], v[32:35], v[224:227]
  v_rcp_f16_sdwa v13, v13 dst_sel:WORD_1 dst_unused:UNUSED_PRESERVE src0_sel:WORD_1
  v_mfma_f32_16x16x32_f16 v[236:239], a[244:247], v[32:35], v[236:239]
  ds_read_b128 a[236:239], v1 offset:5120
  v_rcp_f16_sdwa v15, v15 dst_sel:WORD_1 dst_unused:UNUSED_PRESERVE src0_sel:WORD_1
  v_mfma_f32_16x16x32_f16 v[232:235], a[244:247], v[28:31], v[232:235]
  v_pk_mul_f16 v42, v8, v9
  v_pk_mul_f16 v43, v10, v11
  v_mfma_f32_16x16x32_f16 v[228:231], a[244:247], v[24:27], v[228:231]
  s_waitcnt lgkmcnt(3)
  v_pk_mul_f16 v46, v12, v13
  v_pk_mul_f16 v47, v14, v15
  v_mfma_f32_16x16x32_bf16 v[72:75], a[216:219], a[0:3], 0
  ds_read_b128 a[240:243], v1 offset:6144
  s_add_u32 m0, s29, 49152
  s_add_u32 s31, s29, 147456
  buffer_load_dwordx4 v2, s[8:11], s31 offen offset:0 lds
  v_cvt_pk_f16_f32 v8, v48, v49
  v_cvt_pk_f16_f32 v10, v50, v51
  v_mfma_f32_16x16x32_bf16 v[76:79], a[216:219], a[24:27], 0
  v_cvt_pk_f16_f32 v12, v52, v53
  v_cvt_pk_f16_f32 v14, v54, v55
  v_mfma_f32_16x16x32_bf16 v[80:83], a[216:219], a[48:51], 0
  v_pk_fma_f16 v9, v8, v8, s34 neg_lo:[1,0,0] neg_hi:[1,0,0]
  v_pk_fma_f16 v11, v10, v10, s34 neg_lo:[1,0,0] neg_hi:[1,0,0]
  v_pk_fma_f16 v13, v12, v12, s34 neg_lo:[1,0,0] neg_hi:[1,0,0]
  v_mfma_f32_16x16x32_bf16 v[92:95], a[220:223], a[48:51], 0
  ds_read_b128 a[244:247], v1 offset:7168
  buffer_load_dwordx4 v2, s[8:11], s31 offen offset:1024 lds
  v_pk_fma_f16 v15, v14, v14, s34 neg_lo:[1,0,0] neg_hi:[1,0,0]
  v_pk_mul_f16 v9, v9, v8
  v_mfma_f32_16x16x32_bf16 v[88:91], a[220:223], a[24:27], 0
  v_pk_mul_f16 v11, v11, v10
  v_pk_mul_f16 v13, v13, v12
  v_mfma_f32_16x16x32_bf16 v[84:87], a[220:223], a[0:3], 0
  v_pk_mul_f16 v15, v15, v14
  v_exp_f16_sdwa v9, v9 dst_sel:WORD_0 dst_unused:UNUSED_PRESERVE src0_sel:WORD_0
  v_mfma_f32_16x16x32_bf16 v[72:75], a[224:227], a[4:7], v[72:75]
  ds_read_b128 a[216:219], v1 offset:8192
  buffer_load_dwordx4 v2, s[8:11], s31 offen offset:2048 lds
  v_exp_f16_sdwa v11, v11 dst_sel:WORD_0 dst_unused:UNUSED_PRESERVE src0_sel:WORD_0
  v_mfma_f32_16x16x32_bf16 v[76:79], a[224:227], a[28:31], v[76:79]
  v_exp_f16_sdwa v13, v13 dst_sel:WORD_0 dst_unused:UNUSED_PRESERVE src0_sel:WORD_0
  v_mfma_f32_16x16x32_bf16 v[80:83], a[224:227], a[52:55], v[80:83]
  s_waitcnt lgkmcnt(3)
  v_exp_f16_sdwa v15, v15 dst_sel:WORD_0 dst_unused:UNUSED_PRESERVE src0_sel:WORD_0
  v_mfma_f32_16x16x32_bf16 v[92:95], a[228:231], a[52:55], v[92:95]
  ds_read_b128 a[220:223], v1 offset:9216
  buffer_load_dwordx4 v2, s[8:11], s31 offen offset:3072 lds
  v_exp_f16_sdwa v9, v9 dst_sel:WORD_1 dst_unused:UNUSED_PRESERVE src0_sel:WORD_1
  v_mfma_f32_16x16x32_bf16 v[88:91], a[228:231], a[28:31], v[88:91]
  s_add_u32 m0, s29, 53248
  v_exp_f16_sdwa v11, v11 dst_sel:WORD_1 dst_unused:UNUSED_PRESERVE src0_sel:WORD_1
  v_mfma_f32_16x16x32_bf16 v[84:87], a[228:231], a[4:7], v[84:87]
  s_add_u32 s31, s29, 151552
  v_exp_f16_sdwa v13, v13 dst_sel:WORD_1 dst_unused:UNUSED_PRESERVE src0_sel:WORD_1
  v_mfma_f32_16x16x32_bf16 v[72:75], a[232:235], a[8:11], v[72:75]
  ds_read_b128 a[224:227], v1 offset:10240
  buffer_load_dwordx4 v2, s[8:11], s31 offen offset:0 lds
  v_exp_f16_sdwa v15, v15 dst_sel:WORD_1 dst_unused:UNUSED_PRESERVE src0_sel:WORD_1
  v_mfma_f32_16x16x32_bf16 v[76:79], a[232:235], a[32:35], v[76:79]
  v_pk_fma_f16 v9, v9, s35, s35
  v_pk_fma_f16 v11, v11, s35, s35
  v_mfma_f32_16x16x32_bf16 v[80:83], a[232:235], a[56:59], v[80:83]
  v_pk_fma_f16 v13, v13, s35, s35
  v_pk_fma_f16 v15, v15, s35, s35
  v_mfma_f32_16x16x32_bf16 v[92:95], a[236:239], a[56:59], v[92:95]
  ds_read_b128 a[228:231], v1 offset:11264
  buffer_load_dwordx4 v2, s[8:11], s31 offen offset:1024 lds
  v_rcp_f16_sdwa v9, v9 dst_sel:WORD_0 dst_unused:UNUSED_PRESERVE src0_sel:WORD_0
  v_mfma_f32_16x16x32_bf16 v[88:91], a[236:239], a[32:35], v[88:91]
  v_rcp_f16_sdwa v11, v11 dst_sel:WORD_0 dst_unused:UNUSED_PRESERVE src0_sel:WORD_0
  v_mfma_f32_16x16x32_bf16 v[84:87], a[236:239], a[8:11], v[84:87]
  s_waitcnt lgkmcnt(3)
  v_rcp_f16_sdwa v13, v13 dst_sel:WORD_0 dst_unused:UNUSED_PRESERVE src0_sel:WORD_0
  v_rcp_f16_sdwa v15, v15 dst_sel:WORD_0 dst_unused:UNUSED_PRESERVE src0_sel:WORD_0
  v_mfma_f32_16x16x32_bf16 v[72:75], a[240:243], a[12:15], v[72:75]
  ds_read_b128 a[232:235], v1 offset:12288
  buffer_load_dwordx4 v2, s[8:11], s31 offen offset:2048 lds
  v_rcp_f16_sdwa v9, v9 dst_sel:WORD_1 dst_unused:UNUSED_PRESERVE src0_sel:WORD_1
  v_mfma_f32_16x16x32_bf16 v[76:79], a[240:243], a[36:39], v[76:79]
  v_rcp_f16_sdwa v11, v11 dst_sel:WORD_1 dst_unused:UNUSED_PRESERVE src0_sel:WORD_1
  v_mfma_f32_16x16x32_bf16 v[80:83], a[240:243], a[60:63], v[80:83]
  v_rcp_f16_sdwa v13, v13 dst_sel:WORD_1 dst_unused:UNUSED_PRESERVE src0_sel:WORD_1
  v_mfma_f32_16x16x32_bf16 v[92:95], a[244:247], a[60:63], v[92:95]
  ds_read_b128 a[236:239], v1 offset:13312
  buffer_load_dwordx4 v2, s[8:11], s31 offen offset:3072 lds
  v_rcp_f16_sdwa v15, v15 dst_sel:WORD_1 dst_unused:UNUSED_PRESERVE src0_sel:WORD_1
  v_mfma_f32_16x16x32_bf16 v[88:91], a[244:247], a[36:39], v[88:91]
  s_add_u32 m0, s29, 57344
  v_pk_mul_f16 v24, v8, v9
  v_pk_mul_f16 v25, v10, v11
  v_mfma_f32_16x16x32_bf16 v[84:87], a[244:247], a[12:15], v[84:87]
  s_add_u32 s31, s29, 155648
  v_pk_mul_f16 v28, v12, v13
  v_pk_mul_f16 v29, v14, v15
  v_mfma_f32_16x16x32_bf16 v[72:75], a[216:219], a[16:19], v[72:75]
  ds_read_b128 a[240:243], v1 offset:14336
  buffer_load_dwordx4 v2, s[8:11], s31 offen offset:0 lds
  v_cvt_pk_f16_f32 v16, v56, v57
  v_cvt_pk_f16_f32 v18, v58, v59
  v_mfma_f32_16x16x32_bf16 v[76:79], a[216:219], a[40:43], v[76:79]
  v_cvt_pk_f16_f32 v20, v60, v61
  v_cvt_pk_f16_f32 v22, v62, v63
  v_mfma_f32_16x16x32_bf16 v[80:83], a[216:219], a[64:67], v[80:83]
  s_waitcnt lgkmcnt(3)
  v_pk_fma_f16 v17, v16, v16, s34 neg_lo:[1,0,0] neg_hi:[1,0,0]
  v_pk_fma_f16 v19, v18, v18, s34 neg_lo:[1,0,0] neg_hi:[1,0,0]
  v_pk_fma_f16 v21, v20, v20, s34 neg_lo:[1,0,0] neg_hi:[1,0,0]
  v_mfma_f32_16x16x32_bf16 v[92:95], a[220:223], a[64:67], v[92:95]
  ds_read_b128 a[244:247], v1 offset:15360
  buffer_load_dwordx4 v2, s[8:11], s31 offen offset:1024 lds
  v_pk_fma_f16 v23, v22, v22, s34 neg_lo:[1,0,0] neg_hi:[1,0,0]
  v_pk_mul_f16 v17, v17, v16
  v_mfma_f32_16x16x32_bf16 v[88:91], a[220:223], a[40:43], v[88:91]
  v_pk_mul_f16 v19, v19, v18
  v_pk_mul_f16 v21, v21, v20
  v_mfma_f32_16x16x32_bf16 v[84:87], a[220:223], a[16:19], v[84:87]
  v_pk_mul_f16 v23, v23, v22
  v_exp_f16_sdwa v17, v17 dst_sel:WORD_0 dst_unused:UNUSED_PRESERVE src0_sel:WORD_0
  v_mfma_f32_16x16x32_bf16 v[72:75], a[224:227], a[20:23], v[72:75]
  ds_read_b128 a[216:219], v1 offset:16384
  buffer_load_dwordx4 v2, s[8:11], s31 offen offset:2048 lds
  v_exp_f16_sdwa v19, v19 dst_sel:WORD_0 dst_unused:UNUSED_PRESERVE src0_sel:WORD_0
  v_mfma_f32_16x16x32_bf16 v[76:79], a[224:227], a[44:47], v[76:79]
  v_exp_f16_sdwa v21, v21 dst_sel:WORD_0 dst_unused:UNUSED_PRESERVE src0_sel:WORD_0
  v_mfma_f32_16x16x32_bf16 v[80:83], a[224:227], a[68:71], v[80:83]
  v_exp_f16_sdwa v23, v23 dst_sel:WORD_0 dst_unused:UNUSED_PRESERVE src0_sel:WORD_0
  v_mfma_f32_16x16x32_bf16 v[92:95], a[228:231], a[68:71], v[92:95]
  ds_read_b128 a[220:223], v1 offset:17408
  buffer_load_dwordx4 v2, s[8:11], s31 offen offset:3072 lds
  v_exp_f16_sdwa v17, v17 dst_sel:WORD_1 dst_unused:UNUSED_PRESERVE src0_sel:WORD_1
  v_mfma_f32_16x16x32_bf16 v[88:91], a[228:231], a[44:47], v[88:91]
  v_exp_f16_sdwa v19, v19 dst_sel:WORD_1 dst_unused:UNUSED_PRESERVE src0_sel:WORD_1
  v_mfma_f32_16x16x32_bf16 v[84:87], a[228:231], a[20:23], v[84:87]
  s_waitcnt lgkmcnt(3)
  v_exp_f16_sdwa v21, v21 dst_sel:WORD_1 dst_unused:UNUSED_PRESERVE src0_sel:WORD_1
  v_mfma_f32_16x16x32_f16 v[96:99], a[232:235], v[36:39], v[96:99]
  ds_read_b128 a[224:227], v1 offset:18432
  v_exp_f16_sdwa v23, v23 dst_sel:WORD_1 dst_unused:UNUSED_PRESERVE src0_sel:WORD_1
  v_mfma_f32_16x16x32_f16 v[100:103], a[232:235], v[40:43], v[100:103]
  v_pk_fma_f16 v17, v17, s35, s35
  v_pk_fma_f16 v19, v19, s35, s35
  v_mfma_f32_16x16x32_f16 v[104:107], a[232:235], v[44:47], v[104:107]
  v_pk_fma_f16 v21, v21, s35, s35
  v_pk_fma_f16 v23, v23, s35, s35
  v_mfma_f32_16x16x32_f16 v[116:119], a[236:239], v[44:47], v[116:119]
  ds_read_b128 a[228:231], v1 offset:19456
  v_rcp_f16_sdwa v17, v17 dst_sel:WORD_0 dst_unused:UNUSED_PRESERVE src0_sel:WORD_0
  v_mfma_f32_16x16x32_f16 v[112:115], a[236:239], v[40:43], v[112:115]
  v_rcp_f16_sdwa v19, v19 dst_sel:WORD_0 dst_unused:UNUSED_PRESERVE src0_sel:WORD_0
  v_mfma_f32_16x16x32_f16 v[108:111], a[236:239], v[36:39], v[108:111]
  v_rcp_f16_sdwa v21, v21 dst_sel:WORD_0 dst_unused:UNUSED_PRESERVE src0_sel:WORD_0
  v_rcp_f16_sdwa v23, v23 dst_sel:WORD_0 dst_unused:UNUSED_PRESERVE src0_sel:WORD_0
  v_mfma_f32_16x16x32_f16 v[120:123], a[240:243], v[36:39], v[120:123]
  ds_read_b128 a[232:235], v1 offset:20480
  v_rcp_f16_sdwa v17, v17 dst_sel:WORD_1 dst_unused:UNUSED_PRESERVE src0_sel:WORD_1
  v_mfma_f32_16x16x32_f16 v[124:127], a[240:243], v[40:43], v[124:127]
  v_rcp_f16_sdwa v19, v19 dst_sel:WORD_1 dst_unused:UNUSED_PRESERVE src0_sel:WORD_1
  v_mfma_f32_16x16x32_f16 v[128:131], a[240:243], v[44:47], v[128:131]
  s_waitcnt lgkmcnt(3)
  v_rcp_f16_sdwa v21, v21 dst_sel:WORD_1 dst_unused:UNUSED_PRESERVE src0_sel:WORD_1
  v_mfma_f32_16x16x32_f16 v[140:143], a[244:247], v[44:47], v[140:143]
  ds_read_b128 a[236:239], v1 offset:21504
  v_rcp_f16_sdwa v23, v23 dst_sel:WORD_1 dst_unused:UNUSED_PRESERVE src0_sel:WORD_1
  v_mfma_f32_16x16x32_f16 v[136:139], a[244:247], v[40:43], v[136:139]
  v_pk_mul_f16 v32, v16, v17
  v_pk_mul_f16 v33, v18, v19
  v_mfma_f32_16x16x32_f16 v[132:135], a[244:247], v[36:39], v[132:135]
  v_pk_mul_f16 v26, v20, v21
  v_pk_mul_f16 v27, v22, v23
  v_mfma_f32_16x16x32_f16 v[144:147], a[216:219], v[36:39], v[144:147]
  ds_read_b128 a[240:243], v1 offset:22528
  v_cvt_pk_f16_f32 v8, v64, v65
  v_cvt_pk_f16_f32 v10, v66, v67
  v_mfma_f32_16x16x32_f16 v[148:151], a[216:219], v[40:43], v[148:151]
  v_cvt_pk_f16_f32 v12, v68, v69
  v_cvt_pk_f16_f32 v14, v70, v71
  v_mfma_f32_16x16x32_f16 v[152:155], a[216:219], v[44:47], v[152:155]
  v_pk_fma_f16 v9, v8, v8, s34 neg_lo:[1,0,0] neg_hi:[1,0,0]
  v_pk_fma_f16 v11, v10, v10, s34 neg_lo:[1,0,0] neg_hi:[1,0,0]
  v_pk_fma_f16 v13, v12, v12, s34 neg_lo:[1,0,0] neg_hi:[1,0,0]
  v_mfma_f32_16x16x32_f16 v[164:167], a[220:223], v[44:47], v[164:167]
  ds_read_b128 a[244:247], v1 offset:23552
  v_pk_fma_f16 v15, v14, v14, s34 neg_lo:[1,0,0] neg_hi:[1,0,0]
  v_pk_mul_f16 v9, v9, v8
  v_mfma_f32_16x16x32_f16 v[160:163], a[220:223], v[40:43], v[160:163]
  v_pk_mul_f16 v11, v11, v10
  v_pk_mul_f16 v13, v13, v12
  v_mfma_f32_16x16x32_f16 v[156:159], a[220:223], v[36:39], v[156:159]
  s_waitcnt lgkmcnt(3)
  v_pk_mul_f16 v15, v15, v14
  v_exp_f16_sdwa v9, v9 dst_sel:WORD_0 dst_unused:UNUSED_PRESERVE src0_sel:WORD_0
  v_mfma_f32_16x16x32_f16 v[168:171], a[224:227], v[36:39], v[168:171]
  ds_read_b128 a[216:219], v1 offset:24576
  v_exp_f16_sdwa v11, v11 dst_sel:WORD_0 dst_unused:UNUSED_PRESERVE src0_sel:WORD_0
  v_mfma_f32_16x16x32_f16 v[172:175], a[224:227], v[40:43], v[172:175]
  v_exp_f16_sdwa v13, v13 dst_sel:WORD_0 dst_unused:UNUSED_PRESERVE src0_sel:WORD_0
  v_mfma_f32_16x16x32_f16 v[176:179], a[224:227], v[44:47], v[176:179]
  v_exp_f16_sdwa v15, v15 dst_sel:WORD_0 dst_unused:UNUSED_PRESERVE src0_sel:WORD_0
  v_mfma_f32_16x16x32_f16 v[188:191], a[228:231], v[44:47], v[188:191]
  ds_read_b128 a[220:223], v1 offset:25600
  v_exp_f16_sdwa v9, v9 dst_sel:WORD_1 dst_unused:UNUSED_PRESERVE src0_sel:WORD_1
  v_mfma_f32_16x16x32_f16 v[184:187], a[228:231], v[40:43], v[184:187]
  v_exp_f16_sdwa v11, v11 dst_sel:WORD_1 dst_unused:UNUSED_PRESERVE src0_sel:WORD_1
  v_mfma_f32_16x16x32_f16 v[180:183], a[228:231], v[36:39], v[180:183]
  v_exp_f16_sdwa v13, v13 dst_sel:WORD_1 dst_unused:UNUSED_PRESERVE src0_sel:WORD_1
  v_mfma_f32_16x16x32_f16 v[192:195], a[232:235], v[36:39], v[192:195]
  ds_read_b128 a[224:227], v1 offset:26624
  v_exp_f16_sdwa v15, v15 dst_sel:WORD_1 dst_unused:UNUSED_PRESERVE src0_sel:WORD_1
  v_mfma_f32_16x16x32_f16 v[196:199], a[232:235], v[40:43], v[196:199]
  v_pk_fma_f16 v9, v9, s35, s35
  v_pk_fma_f16 v11, v11, s35, s35
  v_mfma_f32_16x16x32_f16 v[200:203], a[232:235], v[44:47], v[200:203]
  s_waitcnt lgkmcnt(3)
  v_pk_fma_f16 v13, v13, s35, s35
  v_pk_fma_f16 v15, v15, s35, s35
  v_mfma_f32_16x16x32_f16 v[212:215], a[236:239], v[44:47], v[212:215]
  ds_read_b128 a[228:231], v1 offset:27648
  v_rcp_f16_sdwa v9, v9 dst_sel:WORD_0 dst_unused:UNUSED_PRESERVE src0_sel:WORD_0
  v_mfma_f32_16x16x32_f16 v[208:211], a[236:239], v[40:43], v[208:211]
  v_rcp_f16_sdwa v11, v11 dst_sel:WORD_0 dst_unused:UNUSED_PRESERVE src0_sel:WORD_0
  v_mfma_f32_16x16x32_f16 v[204:207], a[236:239], v[36:39], v[204:207]
  v_rcp_f16_sdwa v13, v13 dst_sel:WORD_0 dst_unused:UNUSED_PRESERVE src0_sel:WORD_0
  v_rcp_f16_sdwa v15, v15 dst_sel:WORD_0 dst_unused:UNUSED_PRESERVE src0_sel:WORD_0
  v_mfma_f32_16x16x32_f16 v[216:219], a[240:243], v[36:39], v[216:219]
  ds_read_b128 a[232:235], v1 offset:28672
  v_rcp_f16_sdwa v9, v9 dst_sel:WORD_1 dst_unused:UNUSED_PRESERVE src0_sel:WORD_1
  v_mfma_f32_16x16x32_f16 v[220:223], a[240:243], v[40:43], v[220:223]
  v_rcp_f16_sdwa v11, v11 dst_sel:WORD_1 dst_unused:UNUSED_PRESERVE src0_sel:WORD_1
  v_mfma_f32_16x16x32_f16 v[224:227], a[240:243], v[44:47], v[224:227]
  v_rcp_f16_sdwa v13, v13 dst_sel:WORD_1 dst_unused:UNUSED_PRESERVE src0_sel:WORD_1
  v_mfma_f32_16x16x32_f16 v[236:239], a[244:247], v[44:47], v[236:239]
  ds_read_b128 a[236:239], v1 offset:29696
  v_rcp_f16_sdwa v15, v15 dst_sel:WORD_1 dst_unused:UNUSED_PRESERVE src0_sel:WORD_1
  v_mfma_f32_16x16x32_f16 v[232:235], a[244:247], v[40:43], v[232:235]
  v_pk_mul_f16 v30, v8, v9
  v_pk_mul_f16 v31, v10, v11
  v_mfma_f32_16x16x32_f16 v[228:231], a[244:247], v[36:39], v[228:231]
  s_waitcnt lgkmcnt(3)
  v_pk_mul_f16 v34, v12, v13
  v_pk_mul_f16 v35, v14, v15
  v_mfma_f32_16x16x32_bf16 v[48:51], a[216:219], a[0:3], 0
  ds_read_b128 a[240:243], v1 offset:30720
  v_cvt_pk_f16_f32 v8, v72, v73
  v_cvt_pk_f16_f32 v10, v74, v75
  v_mfma_f32_16x16x32_bf16 v[52:55], a[216:219], a[24:27], 0
  v_cvt_pk_f16_f32 v12, v76, v77
  v_cvt_pk_f16_f32 v14, v78, v79
  v_mfma_f32_16x16x32_bf16 v[56:59], a[216:219], a[48:51], 0
  v_pk_fma_f16 v9, v8, v8, s34 neg_lo:[1,0,0] neg_hi:[1,0,0]
  v_pk_fma_f16 v11, v10, v10, s34 neg_lo:[1,0,0] neg_hi:[1,0,0]
  v_pk_fma_f16 v13, v12, v12, s34 neg_lo:[1,0,0] neg_hi:[1,0,0]
  v_mfma_f32_16x16x32_bf16 v[68:71], a[220:223], a[48:51], 0
  ds_read_b128 a[244:247], v1 offset:31744
  v_pk_fma_f16 v15, v14, v14, s34 neg_lo:[1,0,0] neg_hi:[1,0,0]
  v_pk_mul_f16 v9, v9, v8
  v_mfma_f32_16x16x32_bf16 v[64:67], a[220:223], a[24:27], 0
  buffer_store_dwordx4 a[168:171], v3, s[20:23], s45 offen offset:0 sc1
  v_pk_mul_f16 v11, v11, v10
  v_pk_mul_f16 v13, v13, v12
  v_mfma_f32_16x16x32_bf16 v[60:63], a[220:223], a[0:3], 0
  v_pk_mul_f16 v15, v15, v14
  v_exp_f16_sdwa v9, v9 dst_sel:WORD_0 dst_unused:UNUSED_PRESERVE src0_sel:WORD_0
  v_mfma_f32_16x16x32_bf16 v[48:51], a[224:227], a[4:7], v[48:51]
  ds_read_b128 a[216:219], v1 offset:32768
  v_exp_f16_sdwa v11, v11 dst_sel:WORD_0 dst_unused:UNUSED_PRESERVE src0_sel:WORD_0
  v_mfma_f32_16x16x32_bf16 v[52:55], a[224:227], a[28:31], v[52:55]
  v_exp_f16_sdwa v13, v13 dst_sel:WORD_0 dst_unused:UNUSED_PRESERVE src0_sel:WORD_0
  v_mfma_f32_16x16x32_bf16 v[56:59], a[224:227], a[52:55], v[56:59]
  s_waitcnt lgkmcnt(3)
  v_exp_f16_sdwa v15, v15 dst_sel:WORD_0 dst_unused:UNUSED_PRESERVE src0_sel:WORD_0
  v_mfma_f32_16x16x32_bf16 v[68:71], a[228:231], a[52:55], v[68:71]
  ds_read_b128 a[220:223], v1 offset:33792
  v_exp_f16_sdwa v9, v9 dst_sel:WORD_1 dst_unused:UNUSED_PRESERVE src0_sel:WORD_1
  v_mfma_f32_16x16x32_bf16 v[64:67], a[228:231], a[28:31], v[64:67]
  v_exp_f16_sdwa v11, v11 dst_sel:WORD_1 dst_unused:UNUSED_PRESERVE src0_sel:WORD_1
  v_mfma_f32_16x16x32_bf16 v[60:63], a[228:231], a[4:7], v[60:63]
  v_exp_f16_sdwa v13, v13 dst_sel:WORD_1 dst_unused:UNUSED_PRESERVE src0_sel:WORD_1
  v_mfma_f32_16x16x32_bf16 v[48:51], a[232:235], a[8:11], v[48:51]
  ds_read_b128 a[224:227], v1 offset:34816
  v_exp_f16_sdwa v15, v15 dst_sel:WORD_1 dst_unused:UNUSED_PRESERVE src0_sel:WORD_1
  v_mfma_f32_16x16x32_bf16 v[52:55], a[232:235], a[32:35], v[52:55]
  buffer_store_dwordx4 a[172:175], v3, s[20:23], s45 offen offset:64 sc1
  v_pk_fma_f16 v9, v9, s35, s35
  v_pk_fma_f16 v11, v11, s35, s35
  v_mfma_f32_16x16x32_bf16 v[56:59], a[232:235], a[56:59], v[56:59]
  v_pk_fma_f16 v13, v13, s35, s35
  v_pk_fma_f16 v15, v15, s35, s35
  v_mfma_f32_16x16x32_bf16 v[68:71], a[236:239], a[56:59], v[68:71]
  ds_read_b128 a[228:231], v1 offset:35840
  v_rcp_f16_sdwa v9, v9 dst_sel:WORD_0 dst_unused:UNUSED_PRESERVE src0_sel:WORD_0
  v_mfma_f32_16x16x32_bf16 v[64:67], a[236:239], a[32:35], v[64:67]
  v_rcp_f16_sdwa v11, v11 dst_sel:WORD_0 dst_unused:UNUSED_PRESERVE src0_sel:WORD_0
  v_mfma_f32_16x16x32_bf16 v[60:63], a[236:239], a[8:11], v[60:63]
  s_waitcnt lgkmcnt(3)
  v_rcp_f16_sdwa v13, v13 dst_sel:WORD_0 dst_unused:UNUSED_PRESERVE src0_sel:WORD_0
  v_rcp_f16_sdwa v15, v15 dst_sel:WORD_0 dst_unused:UNUSED_PRESERVE src0_sel:WORD_0
  v_mfma_f32_16x16x32_bf16 v[48:51], a[240:243], a[12:15], v[48:51]
  ds_read_b128 a[232:235], v1 offset:36864
  v_rcp_f16_sdwa v9, v9 dst_sel:WORD_1 dst_unused:UNUSED_PRESERVE src0_sel:WORD_1
  v_mfma_f32_16x16x32_bf16 v[52:55], a[240:243], a[36:39], v[52:55]
  v_rcp_f16_sdwa v11, v11 dst_sel:WORD_1 dst_unused:UNUSED_PRESERVE src0_sel:WORD_1
  v_mfma_f32_16x16x32_bf16 v[56:59], a[240:243], a[60:63], v[56:59]
  v_rcp_f16_sdwa v13, v13 dst_sel:WORD_1 dst_unused:UNUSED_PRESERVE src0_sel:WORD_1
  v_mfma_f32_16x16x32_bf16 v[68:71], a[244:247], a[60:63], v[68:71]
  ds_read_b128 a[236:239], v1 offset:37888
  v_rcp_f16_sdwa v15, v15 dst_sel:WORD_1 dst_unused:UNUSED_PRESERVE src0_sel:WORD_1
  v_mfma_f32_16x16x32_bf16 v[64:67], a[244:247], a[36:39], v[64:67]
  buffer_store_dwordx4 a[176:179], v3, s[20:23], s45 offen offset:128 sc1
  v_pk_mul_f16 v36, v8, v9
  v_pk_mul_f16 v37, v10, v11
  v_mfma_f32_16x16x32_bf16 v[60:63], a[244:247], a[12:15], v[60:63]
  v_pk_mul_f16 v40, v12, v13
  v_pk_mul_f16 v41, v14, v15
  v_mfma_f32_16x16x32_bf16 v[48:51], a[216:219], a[16:19], v[48:51]
  ds_read_b128 a[240:243], v1 offset:38912
  v_cvt_pk_f16_f32 v16, v80, v81
  v_cvt_pk_f16_f32 v18, v82, v83
  v_mfma_f32_16x16x32_bf16 v[52:55], a[216:219], a[40:43], v[52:55]
  v_cvt_pk_f16_f32 v20, v84, v85
  v_cvt_pk_f16_f32 v22, v86, v87
  v_mfma_f32_16x16x32_bf16 v[56:59], a[216:219], a[64:67], v[56:59]
  s_waitcnt lgkmcnt(3)
  v_pk_fma_f16 v17, v16, v16, s34 neg_lo:[1,0,0] neg_hi:[1,0,0]
  v_pk_fma_f16 v19, v18, v18, s34 neg_lo:[1,0,0] neg_hi:[1,0,0]
  v_pk_fma_f16 v21, v20, v20, s34 neg_lo:[1,0,0] neg_hi:[1,0,0]
  v_mfma_f32_16x16x32_bf16 v[68:71], a[220:223], a[64:67], v[68:71]
  ds_read_b128 a[244:247], v1 offset:39936
  v_pk_fma_f16 v23, v22, v22, s34 neg_lo:[1,0,0] neg_hi:[1,0,0]
  v_pk_mul_f16 v17, v17, v16
  v_mfma_f32_16x16x32_bf16 v[64:67], a[220:223], a[40:43], v[64:67]
  v_pk_mul_f16 v19, v19, v18
  v_pk_mul_f16 v21, v21, v20
  v_mfma_f32_16x16x32_bf16 v[60:63], a[220:223], a[16:19], v[60:63]
  v_pk_mul_f16 v23, v23, v22
  v_exp_f16_sdwa v17, v17 dst_sel:WORD_0 dst_unused:UNUSED_PRESERVE src0_sel:WORD_0
  v_mfma_f32_16x16x32_bf16 v[48:51], a[224:227], a[20:23], v[48:51]
  ds_read_b128 a[216:219], v1 offset:40960
  v_exp_f16_sdwa v19, v19 dst_sel:WORD_0 dst_unused:UNUSED_PRESERVE src0_sel:WORD_0
  v_mfma_f32_16x16x32_bf16 v[52:55], a[224:227], a[44:47], v[52:55]
  v_exp_f16_sdwa v21, v21 dst_sel:WORD_0 dst_unused:UNUSED_PRESERVE src0_sel:WORD_0
  v_mfma_f32_16x16x32_bf16 v[56:59], a[224:227], a[68:71], v[56:59]
  v_exp_f16_sdwa v23, v23 dst_sel:WORD_0 dst_unused:UNUSED_PRESERVE src0_sel:WORD_0
  v_mfma_f32_16x16x32_bf16 v[68:71], a[228:231], a[68:71], v[68:71]
  ds_read_b128 a[220:223], v1 offset:41984
  v_exp_f16_sdwa v17, v17 dst_sel:WORD_1 dst_unused:UNUSED_PRESERVE src0_sel:WORD_1
  v_mfma_f32_16x16x32_bf16 v[64:67], a[228:231], a[44:47], v[64:67]
  v_exp_f16_sdwa v19, v19 dst_sel:WORD_1 dst_unused:UNUSED_PRESERVE src0_sel:WORD_1
  v_mfma_f32_16x16x32_bf16 v[60:63], a[228:231], a[20:23], v[60:63]
  s_waitcnt lgkmcnt(3)
  v_exp_f16_sdwa v21, v21 dst_sel:WORD_1 dst_unused:UNUSED_PRESERVE src0_sel:WORD_1
  v_mfma_f32_16x16x32_f16 v[96:99], a[232:235], v[24:27], v[96:99]
  ds_read_b128 a[224:227], v1 offset:43008
  v_exp_f16_sdwa v23, v23 dst_sel:WORD_1 dst_unused:UNUSED_PRESERVE src0_sel:WORD_1
  v_mfma_f32_16x16x32_f16 v[100:103], a[232:235], v[28:31], v[100:103]
  v_pk_fma_f16 v17, v17, s35, s35
  v_pk_fma_f16 v19, v19, s35, s35
  v_mfma_f32_16x16x32_f16 v[104:107], a[232:235], v[32:35], v[104:107]
  v_pk_fma_f16 v21, v21, s35, s35
  v_pk_fma_f16 v23, v23, s35, s35
  v_mfma_f32_16x16x32_f16 v[116:119], a[236:239], v[32:35], v[116:119]
  ds_read_b128 a[228:231], v1 offset:44032
  v_rcp_f16_sdwa v17, v17 dst_sel:WORD_0 dst_unused:UNUSED_PRESERVE src0_sel:WORD_0
  v_mfma_f32_16x16x32_f16 v[112:115], a[236:239], v[28:31], v[112:115]
  v_rcp_f16_sdwa v19, v19 dst_sel:WORD_0 dst_unused:UNUSED_PRESERVE src0_sel:WORD_0
  v_mfma_f32_16x16x32_f16 v[108:111], a[236:239], v[24:27], v[108:111]
  v_rcp_f16_sdwa v21, v21 dst_sel:WORD_0 dst_unused:UNUSED_PRESERVE src0_sel:WORD_0
  v_rcp_f16_sdwa v23, v23 dst_sel:WORD_0 dst_unused:UNUSED_PRESERVE src0_sel:WORD_0
  v_mfma_f32_16x16x32_f16 v[120:123], a[240:243], v[24:27], v[120:123]
  ds_read_b128 a[232:235], v1 offset:45056
  v_rcp_f16_sdwa v17, v17 dst_sel:WORD_1 dst_unused:UNUSED_PRESERVE src0_sel:WORD_1
  v_mfma_f32_16x16x32_f16 v[124:127], a[240:243], v[28:31], v[124:127]
  v_rcp_f16_sdwa v19, v19 dst_sel:WORD_1 dst_unused:UNUSED_PRESERVE src0_sel:WORD_1
  v_mfma_f32_16x16x32_f16 v[128:131], a[240:243], v[32:35], v[128:131]
  s_waitcnt lgkmcnt(3)
  v_rcp_f16_sdwa v21, v21 dst_sel:WORD_1 dst_unused:UNUSED_PRESERVE src0_sel:WORD_1
  v_mfma_f32_16x16x32_f16 v[140:143], a[244:247], v[32:35], v[140:143]
  ds_read_b128 a[236:239], v1 offset:46080
  v_rcp_f16_sdwa v23, v23 dst_sel:WORD_1 dst_unused:UNUSED_PRESERVE src0_sel:WORD_1
  v_mfma_f32_16x16x32_f16 v[136:139], a[244:247], v[28:31], v[136:139]
  v_pk_mul_f16 v44, v16, v17
  v_pk_mul_f16 v45, v18, v19
  v_mfma_f32_16x16x32_f16 v[132:135], a[244:247], v[24:27], v[132:135]
  v_pk_mul_f16 v38, v20, v21
  v_pk_mul_f16 v39, v22, v23
  v_mfma_f32_16x16x32_f16 v[144:147], a[216:219], v[24:27], v[144:147]
  ds_read_b128 a[240:243], v1 offset:47104
  ds_read_b128 a[244:247], v1 offset:48128
  v_cvt_pk_f16_f32 v8, v88, v89
  v_cvt_pk_f16_f32 v10, v90, v91
  v_mfma_f32_16x16x32_f16 v[148:151], a[216:219], v[28:31], v[148:151]
  v_cvt_pk_f16_f32 v12, v92, v93
  v_cvt_pk_f16_f32 v14, v94, v95
  v_mfma_f32_16x16x32_f16 v[152:155], a[216:219], v[32:35], v[152:155]
  v_pk_fma_f16 v9, v8, v8, s34 neg_lo:[1,0,0] neg_hi:[1,0,0]
  v_pk_fma_f16 v11, v10, v10, s34 neg_lo:[1,0,0] neg_hi:[1,0,0]
  v_pk_fma_f16 v13, v12, v12, s34 neg_lo:[1,0,0] neg_hi:[1,0,0]
  v_mfma_f32_16x16x32_f16 v[164:167], a[220:223], v[32:35], v[164:167]
  v_pk_fma_f16 v15, v14, v14, s34 neg_lo:[1,0,0] neg_hi:[1,0,0]
  v_pk_mul_f16 v9, v9, v8
  v_mfma_f32_16x16x32_f16 v[160:163], a[220:223], v[28:31], v[160:163]
  v_pk_mul_f16 v11, v11, v10
  v_pk_mul_f16 v13, v13, v12
  v_mfma_f32_16x16x32_f16 v[156:159], a[220:223], v[24:27], v[156:159]
  s_waitcnt lgkmcnt(3)
  v_pk_mul_f16 v15, v15, v14
  v_exp_f16_sdwa v9, v9 dst_sel:WORD_0 dst_unused:UNUSED_PRESERVE src0_sel:WORD_0
  v_mfma_f32_16x16x32_f16 v[168:171], a[224:227], v[24:27], v[168:171]
  s_waitcnt lgkmcnt(0)
  s_waitcnt vmcnt(3)
  s_barrier
  ds_read_b128 a[216:219], v4 offset:0
  v_exp_f16_sdwa v11, v11 dst_sel:WORD_0 dst_unused:UNUSED_PRESERVE src0_sel:WORD_0
  v_mfma_f32_16x16x32_f16 v[172:175], a[224:227], v[28:31], v[172:175]
  v_exp_f16_sdwa v13, v13 dst_sel:WORD_0 dst_unused:UNUSED_PRESERVE src0_sel:WORD_0
  v_mfma_f32_16x16x32_f16 v[176:179], a[224:227], v[32:35], v[176:179]
  v_exp_f16_sdwa v15, v15 dst_sel:WORD_0 dst_unused:UNUSED_PRESERVE src0_sel:WORD_0
  v_mfma_f32_16x16x32_f16 v[188:191], a[228:231], v[32:35], v[188:191]
  ds_read_b128 a[220:223], v4 offset:1024
  v_exp_f16_sdwa v9, v9 dst_sel:WORD_1 dst_unused:UNUSED_PRESERVE src0_sel:WORD_1
  v_mfma_f32_16x16x32_f16 v[184:187], a[228:231], v[28:31], v[184:187]
  v_exp_f16_sdwa v11, v11 dst_sel:WORD_1 dst_unused:UNUSED_PRESERVE src0_sel:WORD_1
  v_mfma_f32_16x16x32_f16 v[180:183], a[228:231], v[24:27], v[180:183]
  v_exp_f16_sdwa v13, v13 dst_sel:WORD_1 dst_unused:UNUSED_PRESERVE src0_sel:WORD_1
  v_mfma_f32_16x16x32_f16 v[192:195], a[232:235], v[24:27], v[192:195]
  ds_read_b128 a[224:227], v4 offset:2048
  v_exp_f16_sdwa v15, v15 dst_sel:WORD_1 dst_unused:UNUSED_PRESERVE src0_sel:WORD_1
  v_mfma_f32_16x16x32_f16 v[196:199], a[232:235], v[28:31], v[196:199]
  v_pk_fma_f16 v9, v9, s35, s35
  v_pk_fma_f16 v11, v11, s35, s35
  v_mfma_f32_16x16x32_f16 v[200:203], a[232:235], v[32:35], v[200:203]
  v_pk_fma_f16 v13, v13, s35, s35
  v_pk_fma_f16 v15, v15, s35, s35
  v_mfma_f32_16x16x32_f16 v[212:215], a[236:239], v[32:35], v[212:215]
  ds_read_b128 a[228:231], v4 offset:3072
  v_rcp_f16_sdwa v9, v9 dst_sel:WORD_0 dst_unused:UNUSED_PRESERVE src0_sel:WORD_0
  v_mfma_f32_16x16x32_f16 v[208:211], a[236:239], v[28:31], v[208:211]
  v_rcp_f16_sdwa v11, v11 dst_sel:WORD_0 dst_unused:UNUSED_PRESERVE src0_sel:WORD_0
  v_mfma_f32_16x16x32_f16 v[204:207], a[236:239], v[24:27], v[204:207]
  v_rcp_f16_sdwa v13, v13 dst_sel:WORD_0 dst_unused:UNUSED_PRESERVE src0_sel:WORD_0
  v_rcp_f16_sdwa v15, v15 dst_sel:WORD_0 dst_unused:UNUSED_PRESERVE src0_sel:WORD_0
  v_mfma_f32_16x16x32_f16 v[216:219], a[240:243], v[24:27], v[216:219]
  ds_read_b128 a[232:235], v4 offset:4096
  v_rcp_f16_sdwa v9, v9 dst_sel:WORD_1 dst_unused:UNUSED_PRESERVE src0_sel:WORD_1
  v_mfma_f32_16x16x32_f16 v[220:223], a[240:243], v[28:31], v[220:223]
  v_rcp_f16_sdwa v11, v11 dst_sel:WORD_1 dst_unused:UNUSED_PRESERVE src0_sel:WORD_1
  v_mfma_f32_16x16x32_f16 v[224:227], a[240:243], v[32:35], v[224:227]
  v_rcp_f16_sdwa v13, v13 dst_sel:WORD_1 dst_unused:UNUSED_PRESERVE src0_sel:WORD_1
  v_mfma_f32_16x16x32_f16 v[236:239], a[244:247], v[32:35], v[236:239]
  ds_read_b128 a[236:239], v4 offset:5120
  v_rcp_f16_sdwa v15, v15 dst_sel:WORD_1 dst_unused:UNUSED_PRESERVE src0_sel:WORD_1
  v_mfma_f32_16x16x32_f16 v[232:235], a[244:247], v[28:31], v[232:235]
  v_pk_mul_f16 v42, v8, v9
  v_pk_mul_f16 v43, v10, v11
  v_mfma_f32_16x16x32_f16 v[228:231], a[244:247], v[24:27], v[228:231]
  s_waitcnt lgkmcnt(3)
  v_pk_mul_f16 v46, v12, v13
  v_pk_mul_f16 v47, v14, v15
  v_mfma_f32_16x16x32_bf16 v[72:75], a[216:219], a[0:3], 0
  ds_read_b128 a[240:243], v4 offset:6144
  s_add_u32 m0, s29, 0
  s_add_u32 s31, s29, 196608
  buffer_load_dwordx4 v2, s[8:11], s31 offen offset:0 lds
  v_cvt_pk_f16_f32 v8, v48, v49
  v_cvt_pk_f16_f32 v10, v50, v51
  v_mfma_f32_16x16x32_bf16 v[76:79], a[216:219], a[24:27], 0
  v_cvt_pk_f16_f32 v12, v52, v53
  v_cvt_pk_f16_f32 v14, v54, v55
  v_mfma_f32_16x16x32_bf16 v[80:83], a[216:219], a[48:51], 0
  v_pk_fma_f16 v9, v8, v8, s34 neg_lo:[1,0,0] neg_hi:[1,0,0]
  v_pk_fma_f16 v11, v10, v10, s34 neg_lo:[1,0,0] neg_hi:[1,0,0]
  v_pk_fma_f16 v13, v12, v12, s34 neg_lo:[1,0,0] neg_hi:[1,0,0]
  v_mfma_f32_16x16x32_bf16 v[92:95], a[220:223], a[48:51], 0
  ds_read_b128 a[244:247], v4 offset:7168
  buffer_load_dwordx4 v2, s[8:11], s31 offen offset:1024 lds
  v_pk_fma_f16 v15, v14, v14, s34 neg_lo:[1,0,0] neg_hi:[1,0,0]
  v_pk_mul_f16 v9, v9, v8
  v_mfma_f32_16x16x32_bf16 v[88:91], a[220:223], a[24:27], 0
  v_pk_mul_f16 v11, v11, v10
  v_pk_mul_f16 v13, v13, v12
  v_mfma_f32_16x16x32_bf16 v[84:87], a[220:223], a[0:3], 0
  v_pk_mul_f16 v15, v15, v14
  v_exp_f16_sdwa v9, v9 dst_sel:WORD_0 dst_unused:UNUSED_PRESERVE src0_sel:WORD_0
  v_mfma_f32_16x16x32_bf16 v[72:75], a[224:227], a[4:7], v[72:75]
  ds_read_b128 a[216:219], v4 offset:8192
  buffer_load_dwordx4 v2, s[8:11], s31 offen offset:2048 lds
  v_exp_f16_sdwa v11, v11 dst_sel:WORD_0 dst_unused:UNUSED_PRESERVE src0_sel:WORD_0
  v_mfma_f32_16x16x32_bf16 v[76:79], a[224:227], a[28:31], v[76:79]
  v_exp_f16_sdwa v13, v13 dst_sel:WORD_0 dst_unused:UNUSED_PRESERVE src0_sel:WORD_0
  v_mfma_f32_16x16x32_bf16 v[80:83], a[224:227], a[52:55], v[80:83]
  s_waitcnt lgkmcnt(3)
  v_exp_f16_sdwa v15, v15 dst_sel:WORD_0 dst_unused:UNUSED_PRESERVE src0_sel:WORD_0
  v_mfma_f32_16x16x32_bf16 v[92:95], a[228:231], a[52:55], v[92:95]
  ds_read_b128 a[220:223], v4 offset:9216
  buffer_load_dwordx4 v2, s[8:11], s31 offen offset:3072 lds
  v_exp_f16_sdwa v9, v9 dst_sel:WORD_1 dst_unused:UNUSED_PRESERVE src0_sel:WORD_1
  v_mfma_f32_16x16x32_bf16 v[88:91], a[228:231], a[28:31], v[88:91]
  s_add_u32 m0, s29, 4096
  v_exp_f16_sdwa v11, v11 dst_sel:WORD_1 dst_unused:UNUSED_PRESERVE src0_sel:WORD_1
  v_mfma_f32_16x16x32_bf16 v[84:87], a[228:231], a[4:7], v[84:87]
  s_add_u32 s31, s29, 200704
  v_exp_f16_sdwa v13, v13 dst_sel:WORD_1 dst_unused:UNUSED_PRESERVE src0_sel:WORD_1
  v_mfma_f32_16x16x32_bf16 v[72:75], a[232:235], a[8:11], v[72:75]
  ds_read_b128 a[224:227], v4 offset:10240
  buffer_load_dwordx4 v2, s[8:11], s31 offen offset:0 lds
  v_exp_f16_sdwa v15, v15 dst_sel:WORD_1 dst_unused:UNUSED_PRESERVE src0_sel:WORD_1
  v_mfma_f32_16x16x32_bf16 v[76:79], a[232:235], a[32:35], v[76:79]
  v_pk_fma_f16 v9, v9, s35, s35
  v_pk_fma_f16 v11, v11, s35, s35
  v_mfma_f32_16x16x32_bf16 v[80:83], a[232:235], a[56:59], v[80:83]
  v_pk_fma_f16 v13, v13, s35, s35
  v_pk_fma_f16 v15, v15, s35, s35
  v_mfma_f32_16x16x32_bf16 v[92:95], a[236:239], a[56:59], v[92:95]
  ds_read_b128 a[228:231], v4 offset:11264
  buffer_load_dwordx4 v2, s[8:11], s31 offen offset:1024 lds
  v_rcp_f16_sdwa v9, v9 dst_sel:WORD_0 dst_unused:UNUSED_PRESERVE src0_sel:WORD_0
  v_mfma_f32_16x16x32_bf16 v[88:91], a[236:239], a[32:35], v[88:91]
  v_rcp_f16_sdwa v11, v11 dst_sel:WORD_0 dst_unused:UNUSED_PRESERVE src0_sel:WORD_0
  v_mfma_f32_16x16x32_bf16 v[84:87], a[236:239], a[8:11], v[84:87]
  s_waitcnt lgkmcnt(3)
  v_rcp_f16_sdwa v13, v13 dst_sel:WORD_0 dst_unused:UNUSED_PRESERVE src0_sel:WORD_0
  v_rcp_f16_sdwa v15, v15 dst_sel:WORD_0 dst_unused:UNUSED_PRESERVE src0_sel:WORD_0
  v_mfma_f32_16x16x32_bf16 v[72:75], a[240:243], a[12:15], v[72:75]
  ds_read_b128 a[232:235], v4 offset:12288
  buffer_load_dwordx4 v2, s[8:11], s31 offen offset:2048 lds
  v_rcp_f16_sdwa v9, v9 dst_sel:WORD_1 dst_unused:UNUSED_PRESERVE src0_sel:WORD_1
  v_mfma_f32_16x16x32_bf16 v[76:79], a[240:243], a[36:39], v[76:79]
  v_rcp_f16_sdwa v11, v11 dst_sel:WORD_1 dst_unused:UNUSED_PRESERVE src0_sel:WORD_1
  v_mfma_f32_16x16x32_bf16 v[80:83], a[240:243], a[60:63], v[80:83]
  v_rcp_f16_sdwa v13, v13 dst_sel:WORD_1 dst_unused:UNUSED_PRESERVE src0_sel:WORD_1
  v_mfma_f32_16x16x32_bf16 v[92:95], a[244:247], a[60:63], v[92:95]
  ds_read_b128 a[236:239], v4 offset:13312
  buffer_load_dwordx4 v2, s[8:11], s31 offen offset:3072 lds
  v_rcp_f16_sdwa v15, v15 dst_sel:WORD_1 dst_unused:UNUSED_PRESERVE src0_sel:WORD_1
  v_mfma_f32_16x16x32_bf16 v[88:91], a[244:247], a[36:39], v[88:91]
  s_add_u32 m0, s29, 8192
  v_pk_mul_f16 v24, v8, v9
  v_pk_mul_f16 v25, v10, v11
  v_mfma_f32_16x16x32_bf16 v[84:87], a[244:247], a[12:15], v[84:87]
  s_add_u32 s31, s29, 204800
  v_pk_mul_f16 v28, v12, v13
  v_pk_mul_f16 v29, v14, v15
  v_mfma_f32_16x16x32_bf16 v[72:75], a[216:219], a[16:19], v[72:75]
  ds_read_b128 a[240:243], v4 offset:14336
  buffer_load_dwordx4 v2, s[8:11], s31 offen offset:0 lds
  v_cvt_pk_f16_f32 v16, v56, v57
  v_cvt_pk_f16_f32 v18, v58, v59
  v_mfma_f32_16x16x32_bf16 v[76:79], a[216:219], a[40:43], v[76:79]
  v_cvt_pk_f16_f32 v20, v60, v61
  v_cvt_pk_f16_f32 v22, v62, v63
  v_mfma_f32_16x16x32_bf16 v[80:83], a[216:219], a[64:67], v[80:83]
  s_waitcnt lgkmcnt(3)
  v_pk_fma_f16 v17, v16, v16, s34 neg_lo:[1,0,0] neg_hi:[1,0,0]
  v_pk_fma_f16 v19, v18, v18, s34 neg_lo:[1,0,0] neg_hi:[1,0,0]
  v_pk_fma_f16 v21, v20, v20, s34 neg_lo:[1,0,0] neg_hi:[1,0,0]
  v_mfma_f32_16x16x32_bf16 v[92:95], a[220:223], a[64:67], v[92:95]
  ds_read_b128 a[244:247], v4 offset:15360
  buffer_load_dwordx4 v2, s[8:11], s31 offen offset:1024 lds
  v_pk_fma_f16 v23, v22, v22, s34 neg_lo:[1,0,0] neg_hi:[1,0,0]
  v_pk_mul_f16 v17, v17, v16
  v_mfma_f32_16x16x32_bf16 v[88:91], a[220:223], a[40:43], v[88:91]
  v_pk_mul_f16 v19, v19, v18
  v_pk_mul_f16 v21, v21, v20
  v_mfma_f32_16x16x32_bf16 v[84:87], a[220:223], a[16:19], v[84:87]
  v_pk_mul_f16 v23, v23, v22
  v_exp_f16_sdwa v17, v17 dst_sel:WORD_0 dst_unused:UNUSED_PRESERVE src0_sel:WORD_0
  v_mfma_f32_16x16x32_bf16 v[72:75], a[224:227], a[20:23], v[72:75]
  ds_read_b128 a[216:219], v4 offset:16384
  buffer_load_dwordx4 v2, s[8:11], s31 offen offset:2048 lds
  v_exp_f16_sdwa v19, v19 dst_sel:WORD_0 dst_unused:UNUSED_PRESERVE src0_sel:WORD_0
  v_mfma_f32_16x16x32_bf16 v[76:79], a[224:227], a[44:47], v[76:79]
  v_exp_f16_sdwa v21, v21 dst_sel:WORD_0 dst_unused:UNUSED_PRESERVE src0_sel:WORD_0
  v_mfma_f32_16x16x32_bf16 v[80:83], a[224:227], a[68:71], v[80:83]
  v_exp_f16_sdwa v23, v23 dst_sel:WORD_0 dst_unused:UNUSED_PRESERVE src0_sel:WORD_0
  v_mfma_f32_16x16x32_bf16 v[92:95], a[228:231], a[68:71], v[92:95]
  ds_read_b128 a[220:223], v4 offset:17408
  buffer_load_dwordx4 v2, s[8:11], s31 offen offset:3072 lds
  v_exp_f16_sdwa v17, v17 dst_sel:WORD_1 dst_unused:UNUSED_PRESERVE src0_sel:WORD_1
  v_mfma_f32_16x16x32_bf16 v[88:91], a[228:231], a[44:47], v[88:91]
  v_exp_f16_sdwa v19, v19 dst_sel:WORD_1 dst_unused:UNUSED_PRESERVE src0_sel:WORD_1
  v_mfma_f32_16x16x32_bf16 v[84:87], a[228:231], a[20:23], v[84:87]
  s_waitcnt lgkmcnt(3)
  v_exp_f16_sdwa v21, v21 dst_sel:WORD_1 dst_unused:UNUSED_PRESERVE src0_sel:WORD_1
  v_mfma_f32_16x16x32_f16 v[96:99], a[232:235], v[36:39], v[96:99]
  ds_read_b128 a[224:227], v4 offset:18432
  v_exp_f16_sdwa v23, v23 dst_sel:WORD_1 dst_unused:UNUSED_PRESERVE src0_sel:WORD_1
  v_mfma_f32_16x16x32_f16 v[100:103], a[232:235], v[40:43], v[100:103]
  v_pk_fma_f16 v17, v17, s35, s35
  v_pk_fma_f16 v19, v19, s35, s35
  v_mfma_f32_16x16x32_f16 v[104:107], a[232:235], v[44:47], v[104:107]
  v_pk_fma_f16 v21, v21, s35, s35
  v_pk_fma_f16 v23, v23, s35, s35
  v_mfma_f32_16x16x32_f16 v[116:119], a[236:239], v[44:47], v[116:119]
  ds_read_b128 a[228:231], v4 offset:19456
  v_rcp_f16_sdwa v17, v17 dst_sel:WORD_0 dst_unused:UNUSED_PRESERVE src0_sel:WORD_0
  v_mfma_f32_16x16x32_f16 v[112:115], a[236:239], v[40:43], v[112:115]
  v_rcp_f16_sdwa v19, v19 dst_sel:WORD_0 dst_unused:UNUSED_PRESERVE src0_sel:WORD_0
  v_mfma_f32_16x16x32_f16 v[108:111], a[236:239], v[36:39], v[108:111]
  v_rcp_f16_sdwa v21, v21 dst_sel:WORD_0 dst_unused:UNUSED_PRESERVE src0_sel:WORD_0
  v_rcp_f16_sdwa v23, v23 dst_sel:WORD_0 dst_unused:UNUSED_PRESERVE src0_sel:WORD_0
  v_mfma_f32_16x16x32_f16 v[120:123], a[240:243], v[36:39], v[120:123]
  ds_read_b128 a[232:235], v4 offset:20480
  v_rcp_f16_sdwa v17, v17 dst_sel:WORD_1 dst_unused:UNUSED_PRESERVE src0_sel:WORD_1
  v_mfma_f32_16x16x32_f16 v[124:127], a[240:243], v[40:43], v[124:127]
  v_rcp_f16_sdwa v19, v19 dst_sel:WORD_1 dst_unused:UNUSED_PRESERVE src0_sel:WORD_1
  v_mfma_f32_16x16x32_f16 v[128:131], a[240:243], v[44:47], v[128:131]
  s_waitcnt lgkmcnt(3)
  v_rcp_f16_sdwa v21, v21 dst_sel:WORD_1 dst_unused:UNUSED_PRESERVE src0_sel:WORD_1
  v_mfma_f32_16x16x32_f16 v[140:143], a[244:247], v[44:47], v[140:143]
  ds_read_b128 a[236:239], v4 offset:21504
  v_rcp_f16_sdwa v23, v23 dst_sel:WORD_1 dst_unused:UNUSED_PRESERVE src0_sel:WORD_1
  v_mfma_f32_16x16x32_f16 v[136:139], a[244:247], v[40:43], v[136:139]
  v_pk_mul_f16 v32, v16, v17
  v_pk_mul_f16 v33, v18, v19
  v_mfma_f32_16x16x32_f16 v[132:135], a[244:247], v[36:39], v[132:135]
  v_pk_mul_f16 v26, v20, v21
  v_pk_mul_f16 v27, v22, v23
  v_mfma_f32_16x16x32_f16 v[144:147], a[216:219], v[36:39], v[144:147]
  ds_read_b128 a[240:243], v4 offset:22528
  v_cvt_pk_f16_f32 v8, v64, v65
  v_cvt_pk_f16_f32 v10, v66, v67
  v_mfma_f32_16x16x32_f16 v[148:151], a[216:219], v[40:43], v[148:151]
  v_cvt_pk_f16_f32 v12, v68, v69
  v_cvt_pk_f16_f32 v14, v70, v71
  v_mfma_f32_16x16x32_f16 v[152:155], a[216:219], v[44:47], v[152:155]
  v_pk_fma_f16 v9, v8, v8, s34 neg_lo:[1,0,0] neg_hi:[1,0,0]
  v_pk_fma_f16 v11, v10, v10, s34 neg_lo:[1,0,0] neg_hi:[1,0,0]
  v_pk_fma_f16 v13, v12, v12, s34 neg_lo:[1,0,0] neg_hi:[1,0,0]
  v_mfma_f32_16x16x32_f16 v[164:167], a[220:223], v[44:47], v[164:167]
  ds_read_b128 a[244:247], v4 offset:23552
  v_pk_fma_f16 v15, v14, v14, s34 neg_lo:[1,0,0] neg_hi:[1,0,0]
  v_pk_mul_f16 v9, v9, v8
  v_mfma_f32_16x16x32_f16 v[160:163], a[220:223], v[40:43], v[160:163]
  v_pk_mul_f16 v11, v11, v10
  v_pk_mul_f16 v13, v13, v12
  v_mfma_f32_16x16x32_f16 v[156:159], a[220:223], v[36:39], v[156:159]
  s_waitcnt lgkmcnt(3)
  v_pk_mul_f16 v15, v15, v14
  v_exp_f16_sdwa v9, v9 dst_sel:WORD_0 dst_unused:UNUSED_PRESERVE src0_sel:WORD_0
  v_mfma_f32_16x16x32_f16 v[168:171], a[224:227], v[36:39], v[168:171]
  ds_read_b128 a[216:219], v4 offset:24576
  v_exp_f16_sdwa v11, v11 dst_sel:WORD_0 dst_unused:UNUSED_PRESERVE src0_sel:WORD_0
  v_mfma_f32_16x16x32_f16 v[172:175], a[224:227], v[40:43], v[172:175]
  v_exp_f16_sdwa v13, v13 dst_sel:WORD_0 dst_unused:UNUSED_PRESERVE src0_sel:WORD_0
  v_mfma_f32_16x16x32_f16 v[176:179], a[224:227], v[44:47], v[176:179]
  v_exp_f16_sdwa v15, v15 dst_sel:WORD_0 dst_unused:UNUSED_PRESERVE src0_sel:WORD_0
  v_mfma_f32_16x16x32_f16 v[188:191], a[228:231], v[44:47], v[188:191]
  ds_read_b128 a[220:223], v4 offset:25600
  v_exp_f16_sdwa v9, v9 dst_sel:WORD_1 dst_unused:UNUSED_PRESERVE src0_sel:WORD_1
  v_mfma_f32_16x16x32_f16 v[184:187], a[228:231], v[40:43], v[184:187]
  v_exp_f16_sdwa v11, v11 dst_sel:WORD_1 dst_unused:UNUSED_PRESERVE src0_sel:WORD_1
  v_mfma_f32_16x16x32_f16 v[180:183], a[228:231], v[36:39], v[180:183]
  v_exp_f16_sdwa v13, v13 dst_sel:WORD_1 dst_unused:UNUSED_PRESERVE src0_sel:WORD_1
  v_mfma_f32_16x16x32_f16 v[192:195], a[232:235], v[36:39], v[192:195]
  ds_read_b128 a[224:227], v4 offset:26624
  v_exp_f16_sdwa v15, v15 dst_sel:WORD_1 dst_unused:UNUSED_PRESERVE src0_sel:WORD_1
  v_mfma_f32_16x16x32_f16 v[196:199], a[232:235], v[40:43], v[196:199]
  v_pk_fma_f16 v9, v9, s35, s35
  v_pk_fma_f16 v11, v11, s35, s35
  v_mfma_f32_16x16x32_f16 v[200:203], a[232:235], v[44:47], v[200:203]
  s_waitcnt lgkmcnt(3)
  v_pk_fma_f16 v13, v13, s35, s35
  v_pk_fma_f16 v15, v15, s35, s35
  v_mfma_f32_16x16x32_f16 v[212:215], a[236:239], v[44:47], v[212:215]
  ds_read_b128 a[228:231], v4 offset:27648
  v_rcp_f16_sdwa v9, v9 dst_sel:WORD_0 dst_unused:UNUSED_PRESERVE src0_sel:WORD_0
  v_mfma_f32_16x16x32_f16 v[208:211], a[236:239], v[40:43], v[208:211]
  v_rcp_f16_sdwa v11, v11 dst_sel:WORD_0 dst_unused:UNUSED_PRESERVE src0_sel:WORD_0
  v_mfma_f32_16x16x32_f16 v[204:207], a[236:239], v[36:39], v[204:207]
  v_rcp_f16_sdwa v13, v13 dst_sel:WORD_0 dst_unused:UNUSED_PRESERVE src0_sel:WORD_0
  v_rcp_f16_sdwa v15, v15 dst_sel:WORD_0 dst_unused:UNUSED_PRESERVE src0_sel:WORD_0
  v_mfma_f32_16x16x32_f16 v[216:219], a[240:243], v[36:39], v[216:219]
  ds_read_b128 a[232:235], v4 offset:28672
  v_rcp_f16_sdwa v9, v9 dst_sel:WORD_1 dst_unused:UNUSED_PRESERVE src0_sel:WORD_1
  v_mfma_f32_16x16x32_f16 v[220:223], a[240:243], v[40:43], v[220:223]
  v_rcp_f16_sdwa v11, v11 dst_sel:WORD_1 dst_unused:UNUSED_PRESERVE src0_sel:WORD_1
  v_mfma_f32_16x16x32_f16 v[224:227], a[240:243], v[44:47], v[224:227]
  v_rcp_f16_sdwa v13, v13 dst_sel:WORD_1 dst_unused:UNUSED_PRESERVE src0_sel:WORD_1
  v_mfma_f32_16x16x32_f16 v[236:239], a[244:247], v[44:47], v[236:239]
  ds_read_b128 a[236:239], v4 offset:29696
  v_rcp_f16_sdwa v15, v15 dst_sel:WORD_1 dst_unused:UNUSED_PRESERVE src0_sel:WORD_1
  v_mfma_f32_16x16x32_f16 v[232:235], a[244:247], v[40:43], v[232:235]
  v_pk_mul_f16 v30, v8, v9
  v_pk_mul_f16 v31, v10, v11
  v_mfma_f32_16x16x32_f16 v[228:231], a[244:247], v[36:39], v[228:231]
  s_waitcnt lgkmcnt(3)
  v_pk_mul_f16 v34, v12, v13
  v_pk_mul_f16 v35, v14, v15
  v_mfma_f32_16x16x32_bf16 v[48:51], a[216:219], a[0:3], 0
  ds_read_b128 a[240:243], v4 offset:30720
  v_cvt_pk_f16_f32 v8, v72, v73
  v_cvt_pk_f16_f32 v10, v74, v75
  v_mfma_f32_16x16x32_bf16 v[52:55], a[216:219], a[24:27], 0
  v_cvt_pk_f16_f32 v12, v76, v77
  v_cvt_pk_f16_f32 v14, v78, v79
  v_mfma_f32_16x16x32_bf16 v[56:59], a[216:219], a[48:51], 0
  v_pk_fma_f16 v9, v8, v8, s34 neg_lo:[1,0,0] neg_hi:[1,0,0]
  v_pk_fma_f16 v11, v10, v10, s34 neg_lo:[1,0,0] neg_hi:[1,0,0]
  v_pk_fma_f16 v13, v12, v12, s34 neg_lo:[1,0,0] neg_hi:[1,0,0]
  v_mfma_f32_16x16x32_bf16 v[68:71], a[220:223], a[48:51], 0
  ds_read_b128 a[244:247], v4 offset:31744
  v_pk_fma_f16 v15, v14, v14, s34 neg_lo:[1,0,0] neg_hi:[1,0,0]
  v_pk_mul_f16 v9, v9, v8
  v_mfma_f32_16x16x32_bf16 v[64:67], a[220:223], a[24:27], 0
  buffer_store_dwordx4 a[180:183], v3, s[20:23], s45 offen offset:192 sc1
  v_pk_mul_f16 v11, v11, v10
  v_pk_mul_f16 v13, v13, v12
  v_mfma_f32_16x16x32_bf16 v[60:63], a[220:223], a[0:3], 0
  v_pk_mul_f16 v15, v15, v14
  v_exp_f16_sdwa v9, v9 dst_sel:WORD_0 dst_unused:UNUSED_PRESERVE src0_sel:WORD_0
  v_mfma_f32_16x16x32_bf16 v[48:51], a[224:227], a[4:7], v[48:51]
  ds_read_b128 a[216:219], v4 offset:32768
  v_exp_f16_sdwa v11, v11 dst_sel:WORD_0 dst_unused:UNUSED_PRESERVE src0_sel:WORD_0
  v_mfma_f32_16x16x32_bf16 v[52:55], a[224:227], a[28:31], v[52:55]
  v_exp_f16_sdwa v13, v13 dst_sel:WORD_0 dst_unused:UNUSED_PRESERVE src0_sel:WORD_0
  v_mfma_f32_16x16x32_bf16 v[56:59], a[224:227], a[52:55], v[56:59]
  s_waitcnt lgkmcnt(3)
  v_exp_f16_sdwa v15, v15 dst_sel:WORD_0 dst_unused:UNUSED_PRESERVE src0_sel:WORD_0
  v_mfma_f32_16x16x32_bf16 v[68:71], a[228:231], a[52:55], v[68:71]
  ds_read_b128 a[220:223], v4 offset:33792
  v_exp_f16_sdwa v9, v9 dst_sel:WORD_1 dst_unused:UNUSED_PRESERVE src0_sel:WORD_1
  v_mfma_f32_16x16x32_bf16 v[64:67], a[228:231], a[28:31], v[64:67]
  v_exp_f16_sdwa v11, v11 dst_sel:WORD_1 dst_unused:UNUSED_PRESERVE src0_sel:WORD_1
  v_mfma_f32_16x16x32_bf16 v[60:63], a[228:231], a[4:7], v[60:63]
  v_exp_f16_sdwa v13, v13 dst_sel:WORD_1 dst_unused:UNUSED_PRESERVE src0_sel:WORD_1
  v_mfma_f32_16x16x32_bf16 v[48:51], a[232:235], a[8:11], v[48:51]
  ds_read_b128 a[224:227], v4 offset:34816
  v_exp_f16_sdwa v15, v15 dst_sel:WORD_1 dst_unused:UNUSED_PRESERVE src0_sel:WORD_1
  v_mfma_f32_16x16x32_bf16 v[52:55], a[232:235], a[32:35], v[52:55]
  buffer_store_dwordx4 a[184:187], v3, s[20:23], s45 offen offset:256 sc1
  v_pk_fma_f16 v9, v9, s35, s35
  v_pk_fma_f16 v11, v11, s35, s35
  v_mfma_f32_16x16x32_bf16 v[56:59], a[232:235], a[56:59], v[56:59]
  v_pk_fma_f16 v13, v13, s35, s35
  v_pk_fma_f16 v15, v15, s35, s35
  v_mfma_f32_16x16x32_bf16 v[68:71], a[236:239], a[56:59], v[68:71]
  ds_read_b128 a[228:231], v4 offset:35840
  v_rcp_f16_sdwa v9, v9 dst_sel:WORD_0 dst_unused:UNUSED_PRESERVE src0_sel:WORD_0
  v_mfma_f32_16x16x32_bf16 v[64:67], a[236:239], a[32:35], v[64:67]
  v_rcp_f16_sdwa v11, v11 dst_sel:WORD_0 dst_unused:UNUSED_PRESERVE src0_sel:WORD_0
  v_mfma_f32_16x16x32_bf16 v[60:63], a[236:239], a[8:11], v[60:63]
  s_waitcnt lgkmcnt(3)
  v_rcp_f16_sdwa v13, v13 dst_sel:WORD_0 dst_unused:UNUSED_PRESERVE src0_sel:WORD_0
  v_rcp_f16_sdwa v15, v15 dst_sel:WORD_0 dst_unused:UNUSED_PRESERVE src0_sel:WORD_0
  v_mfma_f32_16x16x32_bf16 v[48:51], a[240:243], a[12:15], v[48:51]
  ds_read_b128 a[232:235], v4 offset:36864
  v_rcp_f16_sdwa v9, v9 dst_sel:WORD_1 dst_unused:UNUSED_PRESERVE src0_sel:WORD_1
  v_mfma_f32_16x16x32_bf16 v[52:55], a[240:243], a[36:39], v[52:55]
  v_rcp_f16_sdwa v11, v11 dst_sel:WORD_1 dst_unused:UNUSED_PRESERVE src0_sel:WORD_1
  v_mfma_f32_16x16x32_bf16 v[56:59], a[240:243], a[60:63], v[56:59]
  v_rcp_f16_sdwa v13, v13 dst_sel:WORD_1 dst_unused:UNUSED_PRESERVE src0_sel:WORD_1
  v_mfma_f32_16x16x32_bf16 v[68:71], a[244:247], a[60:63], v[68:71]
  ds_read_b128 a[236:239], v4 offset:37888
  v_rcp_f16_sdwa v15, v15 dst_sel:WORD_1 dst_unused:UNUSED_PRESERVE src0_sel:WORD_1
  v_mfma_f32_16x16x32_bf16 v[64:67], a[244:247], a[36:39], v[64:67]
  buffer_store_dwordx4 a[188:191], v3, s[20:23], s45 offen offset:320 sc1
  v_pk_mul_f16 v36, v8, v9
  v_pk_mul_f16 v37, v10, v11
  v_mfma_f32_16x16x32_bf16 v[60:63], a[244:247], a[12:15], v[60:63]
  v_pk_mul_f16 v40, v12, v13
  v_pk_mul_f16 v41, v14, v15
  v_mfma_f32_16x16x32_bf16 v[48:51], a[216:219], a[16:19], v[48:51]
  ds_read_b128 a[240:243], v4 offset:38912
  v_cvt_pk_f16_f32 v16, v80, v81
  v_cvt_pk_f16_f32 v18, v82, v83
  v_mfma_f32_16x16x32_bf16 v[52:55], a[216:219], a[40:43], v[52:55]
  v_cvt_pk_f16_f32 v20, v84, v85
  v_cvt_pk_f16_f32 v22, v86, v87
  v_mfma_f32_16x16x32_bf16 v[56:59], a[216:219], a[64:67], v[56:59]
  s_waitcnt lgkmcnt(3)
  v_pk_fma_f16 v17, v16, v16, s34 neg_lo:[1,0,0] neg_hi:[1,0,0]
  v_pk_fma_f16 v19, v18, v18, s34 neg_lo:[1,0,0] neg_hi:[1,0,0]
  v_pk_fma_f16 v21, v20, v20, s34 neg_lo:[1,0,0] neg_hi:[1,0,0]
  v_mfma_f32_16x16x32_bf16 v[68:71], a[220:223], a[64:67], v[68:71]
  ds_read_b128 a[244:247], v4 offset:39936
  v_pk_fma_f16 v23, v22, v22, s34 neg_lo:[1,0,0] neg_hi:[1,0,0]
  v_pk_mul_f16 v17, v17, v16
  v_mfma_f32_16x16x32_bf16 v[64:67], a[220:223], a[40:43], v[64:67]
  v_pk_mul_f16 v19, v19, v18
  v_pk_mul_f16 v21, v21, v20
  v_mfma_f32_16x16x32_bf16 v[60:63], a[220:223], a[16:19], v[60:63]
  v_pk_mul_f16 v23, v23, v22
  v_exp_f16_sdwa v17, v17 dst_sel:WORD_0 dst_unused:UNUSED_PRESERVE src0_sel:WORD_0
  v_mfma_f32_16x16x32_bf16 v[48:51], a[224:227], a[20:23], v[48:51]
  ds_read_b128 a[216:219], v4 offset:40960
  v_exp_f16_sdwa v19, v19 dst_sel:WORD_0 dst_unused:UNUSED_PRESERVE src0_sel:WORD_0
  v_mfma_f32_16x16x32_bf16 v[52:55], a[224:227], a[44:47], v[52:55]
  v_exp_f16_sdwa v21, v21 dst_sel:WORD_0 dst_unused:UNUSED_PRESERVE src0_sel:WORD_0
  v_mfma_f32_16x16x32_bf16 v[56:59], a[224:227], a[68:71], v[56:59]
  v_exp_f16_sdwa v23, v23 dst_sel:WORD_0 dst_unused:UNUSED_PRESERVE src0_sel:WORD_0
  v_mfma_f32_16x16x32_bf16 v[68:71], a[228:231], a[68:71], v[68:71]
  ds_read_b128 a[220:223], v4 offset:41984
  v_exp_f16_sdwa v17, v17 dst_sel:WORD_1 dst_unused:UNUSED_PRESERVE src0_sel:WORD_1
  v_mfma_f32_16x16x32_bf16 v[64:67], a[228:231], a[44:47], v[64:67]
  v_exp_f16_sdwa v19, v19 dst_sel:WORD_1 dst_unused:UNUSED_PRESERVE src0_sel:WORD_1
  v_mfma_f32_16x16x32_bf16 v[60:63], a[228:231], a[20:23], v[60:63]
  s_waitcnt lgkmcnt(3)
  v_exp_f16_sdwa v21, v21 dst_sel:WORD_1 dst_unused:UNUSED_PRESERVE src0_sel:WORD_1
  v_mfma_f32_16x16x32_f16 v[96:99], a[232:235], v[24:27], v[96:99]
  ds_read_b128 a[224:227], v4 offset:43008
  v_exp_f16_sdwa v23, v23 dst_sel:WORD_1 dst_unused:UNUSED_PRESERVE src0_sel:WORD_1
  v_mfma_f32_16x16x32_f16 v[100:103], a[232:235], v[28:31], v[100:103]
  v_pk_fma_f16 v17, v17, s35, s35
  v_pk_fma_f16 v19, v19, s35, s35
  v_mfma_f32_16x16x32_f16 v[104:107], a[232:235], v[32:35], v[104:107]
  v_pk_fma_f16 v21, v21, s35, s35
  v_pk_fma_f16 v23, v23, s35, s35
  v_mfma_f32_16x16x32_f16 v[116:119], a[236:239], v[32:35], v[116:119]
  ds_read_b128 a[228:231], v4 offset:44032
  v_rcp_f16_sdwa v17, v17 dst_sel:WORD_0 dst_unused:UNUSED_PRESERVE src0_sel:WORD_0
  v_mfma_f32_16x16x32_f16 v[112:115], a[236:239], v[28:31], v[112:115]
  v_rcp_f16_sdwa v19, v19 dst_sel:WORD_0 dst_unused:UNUSED_PRESERVE src0_sel:WORD_0
  v_mfma_f32_16x16x32_f16 v[108:111], a[236:239], v[24:27], v[108:111]
  v_rcp_f16_sdwa v21, v21 dst_sel:WORD_0 dst_unused:UNUSED_PRESERVE src0_sel:WORD_0
  v_rcp_f16_sdwa v23, v23 dst_sel:WORD_0 dst_unused:UNUSED_PRESERVE src0_sel:WORD_0
  v_mfma_f32_16x16x32_f16 v[120:123], a[240:243], v[24:27], v[120:123]
  ds_read_b128 a[232:235], v4 offset:45056
  v_rcp_f16_sdwa v17, v17 dst_sel:WORD_1 dst_unused:UNUSED_PRESERVE src0_sel:WORD_1
  v_mfma_f32_16x16x32_f16 v[124:127], a[240:243], v[28:31], v[124:127]
  v_rcp_f16_sdwa v19, v19 dst_sel:WORD_1 dst_unused:UNUSED_PRESERVE src0_sel:WORD_1
  v_mfma_f32_16x16x32_f16 v[128:131], a[240:243], v[32:35], v[128:131]
  s_waitcnt lgkmcnt(3)
  v_rcp_f16_sdwa v21, v21 dst_sel:WORD_1 dst_unused:UNUSED_PRESERVE src0_sel:WORD_1
  v_mfma_f32_16x16x32_f16 v[140:143], a[244:247], v[32:35], v[140:143]
  ds_read_b128 a[236:239], v4 offset:46080
  v_rcp_f16_sdwa v23, v23 dst_sel:WORD_1 dst_unused:UNUSED_PRESERVE src0_sel:WORD_1
  v_mfma_f32_16x16x32_f16 v[136:139], a[244:247], v[28:31], v[136:139]
  v_pk_mul_f16 v44, v16, v17
  v_pk_mul_f16 v45, v18, v19
  v_mfma_f32_16x16x32_f16 v[132:135], a[244:247], v[24:27], v[132:135]
  v_pk_mul_f16 v38, v20, v21
  v_pk_mul_f16 v39, v22, v23
  v_mfma_f32_16x16x32_f16 v[144:147], a[216:219], v[24:27], v[144:147]
  ds_read_b128 a[240:243], v4 offset:47104
  ds_read_b128 a[244:247], v4 offset:48128
  v_cvt_pk_f16_f32 v8, v88, v89
  v_cvt_pk_f16_f32 v10, v90, v91
  v_mfma_f32_16x16x32_f16 v[148:151], a[216:219], v[28:31], v[148:151]
  v_cvt_pk_f16_f32 v12, v92, v93
  v_cvt_pk_f16_f32 v14, v94, v95
  v_mfma_f32_16x16x32_f16 v[152:155], a[216:219], v[32:35], v[152:155]
  v_pk_fma_f16 v9, v8, v8, s34 neg_lo:[1,0,0] neg_hi:[1,0,0]
  v_pk_fma_f16 v11, v10, v10, s34 neg_lo:[1,0,0] neg_hi:[1,0,0]
  v_pk_fma_f16 v13, v12, v12, s34 neg_lo:[1,0,0] neg_hi:[1,0,0]
  v_mfma_f32_16x16x32_f16 v[164:167], a[220:223], v[32:35], v[164:167]
  v_pk_fma_f16 v15, v14, v14, s34 neg_lo:[1,0,0] neg_hi:[1,0,0]
  v_pk_mul_f16 v9, v9, v8
  v_mfma_f32_16x16x32_f16 v[160:163], a[220:223], v[28:31], v[160:163]
  v_pk_mul_f16 v11, v11, v10
  v_pk_mul_f16 v13, v13, v12
  v_mfma_f32_16x16x32_f16 v[156:159], a[220:223], v[24:27], v[156:159]
  s_waitcnt lgkmcnt(3)
  v_pk_mul_f16 v15, v15, v14
  v_exp_f16_sdwa v9, v9 dst_sel:WORD_0 dst_unused:UNUSED_PRESERVE src0_sel:WORD_0
  v_mfma_f32_16x16x32_f16 v[168:171], a[224:227], v[24:27], v[168:171]
  s_waitcnt lgkmcnt(0)
  s_waitcnt vmcnt(3)
  s_barrier
  ds_read_b128 a[216:219], v1 offset:0
  v_exp_f16_sdwa v11, v11 dst_sel:WORD_0 dst_unused:UNUSED_PRESERVE src0_sel:WORD_0
  v_mfma_f32_16x16x32_f16 v[172:175], a[224:227], v[28:31], v[172:175]
  v_exp_f16_sdwa v13, v13 dst_sel:WORD_0 dst_unused:UNUSED_PRESERVE src0_sel:WORD_0
  v_mfma_f32_16x16x32_f16 v[176:179], a[224:227], v[32:35], v[176:179]
  v_exp_f16_sdwa v15, v15 dst_sel:WORD_0 dst_unused:UNUSED_PRESERVE src0_sel:WORD_0
  v_mfma_f32_16x16x32_f16 v[188:191], a[228:231], v[32:35], v[188:191]
  ds_read_b128 a[220:223], v1 offset:1024
  v_exp_f16_sdwa v9, v9 dst_sel:WORD_1 dst_unused:UNUSED_PRESERVE src0_sel:WORD_1
  v_mfma_f32_16x16x32_f16 v[184:187], a[228:231], v[28:31], v[184:187]
  v_exp_f16_sdwa v11, v11 dst_sel:WORD_1 dst_unused:UNUSED_PRESERVE src0_sel:WORD_1
  v_mfma_f32_16x16x32_f16 v[180:183], a[228:231], v[24:27], v[180:183]
  v_exp_f16_sdwa v13, v13 dst_sel:WORD_1 dst_unused:UNUSED_PRESERVE src0_sel:WORD_1
  v_mfma_f32_16x16x32_f16 v[192:195], a[232:235], v[24:27], v[192:195]
  ds_read_b128 a[224:227], v1 offset:2048
  v_exp_f16_sdwa v15, v15 dst_sel:WORD_1 dst_unused:UNUSED_PRESERVE src0_sel:WORD_1
  v_mfma_f32_16x16x32_f16 v[196:199], a[232:235], v[28:31], v[196:199]
  v_pk_fma_f16 v9, v9, s35, s35
  v_pk_fma_f16 v11, v11, s35, s35
  v_mfma_f32_16x16x32_f16 v[200:203], a[232:235], v[32:35], v[200:203]
  v_pk_fma_f16 v13, v13, s35, s35
  v_pk_fma_f16 v15, v15, s35, s35
  v_mfma_f32_16x16x32_f16 v[212:215], a[236:239], v[32:35], v[212:215]
  ds_read_b128 a[228:231], v1 offset:3072
  v_rcp_f16_sdwa v9, v9 dst_sel:WORD_0 dst_unused:UNUSED_PRESERVE src0_sel:WORD_0
  v_mfma_f32_16x16x32_f16 v[208:211], a[236:239], v[28:31], v[208:211]
  v_rcp_f16_sdwa v11, v11 dst_sel:WORD_0 dst_unused:UNUSED_PRESERVE src0_sel:WORD_0
  v_mfma_f32_16x16x32_f16 v[204:207], a[236:239], v[24:27], v[204:207]
  v_rcp_f16_sdwa v13, v13 dst_sel:WORD_0 dst_unused:UNUSED_PRESERVE src0_sel:WORD_0
  v_rcp_f16_sdwa v15, v15 dst_sel:WORD_0 dst_unused:UNUSED_PRESERVE src0_sel:WORD_0
  v_mfma_f32_16x16x32_f16 v[216:219], a[240:243], v[24:27], v[216:219]
  ds_read_b128 a[232:235], v1 offset:4096
  v_rcp_f16_sdwa v9, v9 dst_sel:WORD_1 dst_unused:UNUSED_PRESERVE src0_sel:WORD_1
  v_mfma_f32_16x16x32_f16 v[220:223], a[240:243], v[28:31], v[220:223]
  v_rcp_f16_sdwa v11, v11 dst_sel:WORD_1 dst_unused:UNUSED_PRESERVE src0_sel:WORD_1
  v_mfma_f32_16x16x32_f16 v[224:227], a[240:243], v[32:35], v[224:227]
  v_rcp_f16_sdwa v13, v13 dst_sel:WORD_1 dst_unused:UNUSED_PRESERVE src0_sel:WORD_1
  v_mfma_f32_16x16x32_f16 v[236:239], a[244:247], v[32:35], v[236:239]
  ds_read_b128 a[236:239], v1 offset:5120
  v_rcp_f16_sdwa v15, v15 dst_sel:WORD_1 dst_unused:UNUSED_PRESERVE src0_sel:WORD_1
  v_mfma_f32_16x16x32_f16 v[232:235], a[244:247], v[28:31], v[232:235]
  v_pk_mul_f16 v42, v8, v9
  v_pk_mul_f16 v43, v10, v11
  v_mfma_f32_16x16x32_f16 v[228:231], a[244:247], v[24:27], v[228:231]
  s_waitcnt lgkmcnt(3)
  v_pk_mul_f16 v46, v12, v13
  v_pk_mul_f16 v47, v14, v15
  v_mfma_f32_16x16x32_bf16 v[72:75], a[216:219], a[0:3], 0
  ds_read_b128 a[240:243], v1 offset:6144
  s_add_u32 m0, s29, 49152
  s_add_u32 s31, s29, 245760
  buffer_load_dwordx4 v2, s[8:11], s31 offen offset:0 lds
  v_cvt_pk_f16_f32 v8, v48, v49
  v_cvt_pk_f16_f32 v10, v50, v51
  v_mfma_f32_16x16x32_bf16 v[76:79], a[216:219], a[24:27], 0
  v_cvt_pk_f16_f32 v12, v52, v53
  v_cvt_pk_f16_f32 v14, v54, v55
  v_mfma_f32_16x16x32_bf16 v[80:83], a[216:219], a[48:51], 0
  v_pk_fma_f16 v9, v8, v8, s34 neg_lo:[1,0,0] neg_hi:[1,0,0]
  v_pk_fma_f16 v11, v10, v10, s34 neg_lo:[1,0,0] neg_hi:[1,0,0]
  v_pk_fma_f16 v13, v12, v12, s34 neg_lo:[1,0,0] neg_hi:[1,0,0]
  v_mfma_f32_16x16x32_bf16 v[92:95], a[220:223], a[48:51], 0
  ds_read_b128 a[244:247], v1 offset:7168
  buffer_load_dwordx4 v2, s[8:11], s31 offen offset:1024 lds
  v_pk_fma_f16 v15, v14, v14, s34 neg_lo:[1,0,0] neg_hi:[1,0,0]
  v_pk_mul_f16 v9, v9, v8
  v_mfma_f32_16x16x32_bf16 v[88:91], a[220:223], a[24:27], 0
  v_pk_mul_f16 v11, v11, v10
  v_pk_mul_f16 v13, v13, v12
  v_mfma_f32_16x16x32_bf16 v[84:87], a[220:223], a[0:3], 0
  v_pk_mul_f16 v15, v15, v14
  v_exp_f16_sdwa v9, v9 dst_sel:WORD_0 dst_unused:UNUSED_PRESERVE src0_sel:WORD_0
  v_mfma_f32_16x16x32_bf16 v[72:75], a[224:227], a[4:7], v[72:75]
  ds_read_b128 a[216:219], v1 offset:8192
  buffer_load_dwordx4 v2, s[8:11], s31 offen offset:2048 lds
  v_exp_f16_sdwa v11, v11 dst_sel:WORD_0 dst_unused:UNUSED_PRESERVE src0_sel:WORD_0
  v_mfma_f32_16x16x32_bf16 v[76:79], a[224:227], a[28:31], v[76:79]
  v_exp_f16_sdwa v13, v13 dst_sel:WORD_0 dst_unused:UNUSED_PRESERVE src0_sel:WORD_0
  v_mfma_f32_16x16x32_bf16 v[80:83], a[224:227], a[52:55], v[80:83]
  s_waitcnt lgkmcnt(3)
  v_exp_f16_sdwa v15, v15 dst_sel:WORD_0 dst_unused:UNUSED_PRESERVE src0_sel:WORD_0
  v_mfma_f32_16x16x32_bf16 v[92:95], a[228:231], a[52:55], v[92:95]
  ds_read_b128 a[220:223], v1 offset:9216
  buffer_load_dwordx4 v2, s[8:11], s31 offen offset:3072 lds
  v_exp_f16_sdwa v9, v9 dst_sel:WORD_1 dst_unused:UNUSED_PRESERVE src0_sel:WORD_1
  v_mfma_f32_16x16x32_bf16 v[88:91], a[228:231], a[28:31], v[88:91]
  s_add_u32 m0, s29, 53248
  v_exp_f16_sdwa v11, v11 dst_sel:WORD_1 dst_unused:UNUSED_PRESERVE src0_sel:WORD_1
  v_mfma_f32_16x16x32_bf16 v[84:87], a[228:231], a[4:7], v[84:87]
  s_add_u32 s31, s29, 249856
  v_exp_f16_sdwa v13, v13 dst_sel:WORD_1 dst_unused:UNUSED_PRESERVE src0_sel:WORD_1
  v_mfma_f32_16x16x32_bf16 v[72:75], a[232:235], a[8:11], v[72:75]
  ds_read_b128 a[224:227], v1 offset:10240
  buffer_load_dwordx4 v2, s[8:11], s31 offen offset:0 lds
  v_exp_f16_sdwa v15, v15 dst_sel:WORD_1 dst_unused:UNUSED_PRESERVE src0_sel:WORD_1
  v_mfma_f32_16x16x32_bf16 v[76:79], a[232:235], a[32:35], v[76:79]
  v_pk_fma_f16 v9, v9, s35, s35
  v_pk_fma_f16 v11, v11, s35, s35
  v_mfma_f32_16x16x32_bf16 v[80:83], a[232:235], a[56:59], v[80:83]
  v_pk_fma_f16 v13, v13, s35, s35
  v_pk_fma_f16 v15, v15, s35, s35
  v_mfma_f32_16x16x32_bf16 v[92:95], a[236:239], a[56:59], v[92:95]
  ds_read_b128 a[228:231], v1 offset:11264
  buffer_load_dwordx4 v2, s[8:11], s31 offen offset:1024 lds
  v_rcp_f16_sdwa v9, v9 dst_sel:WORD_0 dst_unused:UNUSED_PRESERVE src0_sel:WORD_0
  v_mfma_f32_16x16x32_bf16 v[88:91], a[236:239], a[32:35], v[88:91]
  v_rcp_f16_sdwa v11, v11 dst_sel:WORD_0 dst_unused:UNUSED_PRESERVE src0_sel:WORD_0
  v_mfma_f32_16x16x32_bf16 v[84:87], a[236:239], a[8:11], v[84:87]
  s_waitcnt lgkmcnt(3)
  v_rcp_f16_sdwa v13, v13 dst_sel:WORD_0 dst_unused:UNUSED_PRESERVE src0_sel:WORD_0
  v_rcp_f16_sdwa v15, v15 dst_sel:WORD_0 dst_unused:UNUSED_PRESERVE src0_sel:WORD_0
  v_mfma_f32_16x16x32_bf16 v[72:75], a[240:243], a[12:15], v[72:75]
  ds_read_b128 a[232:235], v1 offset:12288
  buffer_load_dwordx4 v2, s[8:11], s31 offen offset:2048 lds
  v_rcp_f16_sdwa v9, v9 dst_sel:WORD_1 dst_unused:UNUSED_PRESERVE src0_sel:WORD_1
  v_mfma_f32_16x16x32_bf16 v[76:79], a[240:243], a[36:39], v[76:79]
  v_rcp_f16_sdwa v11, v11 dst_sel:WORD_1 dst_unused:UNUSED_PRESERVE src0_sel:WORD_1
  v_mfma_f32_16x16x32_bf16 v[80:83], a[240:243], a[60:63], v[80:83]
  v_rcp_f16_sdwa v13, v13 dst_sel:WORD_1 dst_unused:UNUSED_PRESERVE src0_sel:WORD_1
  v_mfma_f32_16x16x32_bf16 v[92:95], a[244:247], a[60:63], v[92:95]
  ds_read_b128 a[236:239], v1 offset:13312
  buffer_load_dwordx4 v2, s[8:11], s31 offen offset:3072 lds
  v_rcp_f16_sdwa v15, v15 dst_sel:WORD_1 dst_unused:UNUSED_PRESERVE src0_sel:WORD_1
  v_mfma_f32_16x16x32_bf16 v[88:91], a[244:247], a[36:39], v[88:91]
  s_add_u32 m0, s29, 57344
  v_pk_mul_f16 v24, v8, v9
  v_pk_mul_f16 v25, v10, v11
  v_mfma_f32_16x16x32_bf16 v[84:87], a[244:247], a[12:15], v[84:87]
  s_add_u32 s31, s29, 253952
  v_pk_mul_f16 v28, v12, v13
  v_pk_mul_f16 v29, v14, v15
  v_mfma_f32_16x16x32_bf16 v[72:75], a[216:219], a[16:19], v[72:75]
  ds_read_b128 a[240:243], v1 offset:14336
  buffer_load_dwordx4 v2, s[8:11], s31 offen offset:0 lds
  v_cvt_pk_f16_f32 v16, v56, v57
  v_cvt_pk_f16_f32 v18, v58, v59
  v_mfma_f32_16x16x32_bf16 v[76:79], a[216:219], a[40:43], v[76:79]
  v_cvt_pk_f16_f32 v20, v60, v61
  v_cvt_pk_f16_f32 v22, v62, v63
  v_mfma_f32_16x16x32_bf16 v[80:83], a[216:219], a[64:67], v[80:83]
  s_waitcnt lgkmcnt(3)
  v_pk_fma_f16 v17, v16, v16, s34 neg_lo:[1,0,0] neg_hi:[1,0,0]
  v_pk_fma_f16 v19, v18, v18, s34 neg_lo:[1,0,0] neg_hi:[1,0,0]
  v_pk_fma_f16 v21, v20, v20, s34 neg_lo:[1,0,0] neg_hi:[1,0,0]
  v_mfma_f32_16x16x32_bf16 v[92:95], a[220:223], a[64:67], v[92:95]
  ds_read_b128 a[244:247], v1 offset:15360
  buffer_load_dwordx4 v2, s[8:11], s31 offen offset:1024 lds
  v_pk_fma_f16 v23, v22, v22, s34 neg_lo:[1,0,0] neg_hi:[1,0,0]
  v_pk_mul_f16 v17, v17, v16
  v_mfma_f32_16x16x32_bf16 v[88:91], a[220:223], a[40:43], v[88:91]
  v_pk_mul_f16 v19, v19, v18
  v_pk_mul_f16 v21, v21, v20
  v_mfma_f32_16x16x32_bf16 v[84:87], a[220:223], a[16:19], v[84:87]
  v_pk_mul_f16 v23, v23, v22
  v_exp_f16_sdwa v17, v17 dst_sel:WORD_0 dst_unused:UNUSED_PRESERVE src0_sel:WORD_0
  v_mfma_f32_16x16x32_bf16 v[72:75], a[224:227], a[20:23], v[72:75]
  ds_read_b128 a[216:219], v1 offset:16384
  buffer_load_dwordx4 v2, s[8:11], s31 offen offset:2048 lds
  v_exp_f16_sdwa v19, v19 dst_sel:WORD_0 dst_unused:UNUSED_PRESERVE src0_sel:WORD_0
  v_mfma_f32_16x16x32_bf16 v[76:79], a[224:227], a[44:47], v[76:79]
  v_exp_f16_sdwa v21, v21 dst_sel:WORD_0 dst_unused:UNUSED_PRESERVE src0_sel:WORD_0
  v_mfma_f32_16x16x32_bf16 v[80:83], a[224:227], a[68:71], v[80:83]
  v_exp_f16_sdwa v23, v23 dst_sel:WORD_0 dst_unused:UNUSED_PRESERVE src0_sel:WORD_0
  v_mfma_f32_16x16x32_bf16 v[92:95], a[228:231], a[68:71], v[92:95]
  ds_read_b128 a[220:223], v1 offset:17408
  buffer_load_dwordx4 v2, s[8:11], s31 offen offset:3072 lds
  v_exp_f16_sdwa v17, v17 dst_sel:WORD_1 dst_unused:UNUSED_PRESERVE src0_sel:WORD_1
  v_mfma_f32_16x16x32_bf16 v[88:91], a[228:231], a[44:47], v[88:91]
  v_exp_f16_sdwa v19, v19 dst_sel:WORD_1 dst_unused:UNUSED_PRESERVE src0_sel:WORD_1
  v_mfma_f32_16x16x32_bf16 v[84:87], a[228:231], a[20:23], v[84:87]
  s_waitcnt lgkmcnt(3)
  v_exp_f16_sdwa v21, v21 dst_sel:WORD_1 dst_unused:UNUSED_PRESERVE src0_sel:WORD_1
  v_mfma_f32_16x16x32_f16 v[96:99], a[232:235], v[36:39], v[96:99]
  ds_read_b128 a[224:227], v1 offset:18432
  v_exp_f16_sdwa v23, v23 dst_sel:WORD_1 dst_unused:UNUSED_PRESERVE src0_sel:WORD_1
  v_mfma_f32_16x16x32_f16 v[100:103], a[232:235], v[40:43], v[100:103]
  v_pk_fma_f16 v17, v17, s35, s35
  v_pk_fma_f16 v19, v19, s35, s35
  v_mfma_f32_16x16x32_f16 v[104:107], a[232:235], v[44:47], v[104:107]
  v_pk_fma_f16 v21, v21, s35, s35
  v_pk_fma_f16 v23, v23, s35, s35
  v_mfma_f32_16x16x32_f16 v[116:119], a[236:239], v[44:47], v[116:119]
  ds_read_b128 a[228:231], v1 offset:19456
  v_rcp_f16_sdwa v17, v17 dst_sel:WORD_0 dst_unused:UNUSED_PRESERVE src0_sel:WORD_0
  v_mfma_f32_16x16x32_f16 v[112:115], a[236:239], v[40:43], v[112:115]
  v_rcp_f16_sdwa v19, v19 dst_sel:WORD_0 dst_unused:UNUSED_PRESERVE src0_sel:WORD_0
  v_mfma_f32_16x16x32_f16 v[108:111], a[236:239], v[36:39], v[108:111]
  v_rcp_f16_sdwa v21, v21 dst_sel:WORD_0 dst_unused:UNUSED_PRESERVE src0_sel:WORD_0
  v_rcp_f16_sdwa v23, v23 dst_sel:WORD_0 dst_unused:UNUSED_PRESERVE src0_sel:WORD_0
  v_mfma_f32_16x16x32_f16 v[120:123], a[240:243], v[36:39], v[120:123]
  ds_read_b128 a[232:235], v1 offset:20480
  v_rcp_f16_sdwa v17, v17 dst_sel:WORD_1 dst_unused:UNUSED_PRESERVE src0_sel:WORD_1
  v_mfma_f32_16x16x32_f16 v[124:127], a[240:243], v[40:43], v[124:127]
  v_rcp_f16_sdwa v19, v19 dst_sel:WORD_1 dst_unused:UNUSED_PRESERVE src0_sel:WORD_1
  v_mfma_f32_16x16x32_f16 v[128:131], a[240:243], v[44:47], v[128:131]
  s_waitcnt lgkmcnt(3)
  v_rcp_f16_sdwa v21, v21 dst_sel:WORD_1 dst_unused:UNUSED_PRESERVE src0_sel:WORD_1
  v_mfma_f32_16x16x32_f16 v[140:143], a[244:247], v[44:47], v[140:143]
  ds_read_b128 a[236:239], v1 offset:21504
  v_rcp_f16_sdwa v23, v23 dst_sel:WORD_1 dst_unused:UNUSED_PRESERVE src0_sel:WORD_1
  v_mfma_f32_16x16x32_f16 v[136:139], a[244:247], v[40:43], v[136:139]
  v_pk_mul_f16 v32, v16, v17
  v_pk_mul_f16 v33, v18, v19
  v_mfma_f32_16x16x32_f16 v[132:135], a[244:247], v[36:39], v[132:135]
  v_pk_mul_f16 v26, v20, v21
  v_pk_mul_f16 v27, v22, v23
  v_mfma_f32_16x16x32_f16 v[144:147], a[216:219], v[36:39], v[144:147]
  ds_read_b128 a[240:243], v1 offset:22528
  v_cvt_pk_f16_f32 v8, v64, v65
  v_cvt_pk_f16_f32 v10, v66, v67
  v_mfma_f32_16x16x32_f16 v[148:151], a[216:219], v[40:43], v[148:151]
  v_cvt_pk_f16_f32 v12, v68, v69
  v_cvt_pk_f16_f32 v14, v70, v71
  v_mfma_f32_16x16x32_f16 v[152:155], a[216:219], v[44:47], v[152:155]
  v_pk_fma_f16 v9, v8, v8, s34 neg_lo:[1,0,0] neg_hi:[1,0,0]
  v_pk_fma_f16 v11, v10, v10, s34 neg_lo:[1,0,0] neg_hi:[1,0,0]
  v_pk_fma_f16 v13, v12, v12, s34 neg_lo:[1,0,0] neg_hi:[1,0,0]
  v_mfma_f32_16x16x32_f16 v[164:167], a[220:223], v[44:47], v[164:167]
  ds_read_b128 a[244:247], v1 offset:23552
  v_pk_fma_f16 v15, v14, v14, s34 neg_lo:[1,0,0] neg_hi:[1,0,0]
  v_pk_mul_f16 v9, v9, v8
  v_mfma_f32_16x16x32_f16 v[160:163], a[220:223], v[40:43], v[160:163]
  v_pk_mul_f16 v11, v11, v10
  v_pk_mul_f16 v13, v13, v12
  v_mfma_f32_16x16x32_f16 v[156:159], a[220:223], v[36:39], v[156:159]
  s_waitcnt lgkmcnt(3)
  v_pk_mul_f16 v15, v15, v14
  v_exp_f16_sdwa v9, v9 dst_sel:WORD_0 dst_unused:UNUSED_PRESERVE src0_sel:WORD_0
  v_mfma_f32_16x16x32_f16 v[168:171], a[224:227], v[36:39], v[168:171]
  ds_read_b128 a[216:219], v1 offset:24576
  v_exp_f16_sdwa v11, v11 dst_sel:WORD_0 dst_unused:UNUSED_PRESERVE src0_sel:WORD_0
  v_mfma_f32_16x16x32_f16 v[172:175], a[224:227], v[40:43], v[172:175]
  v_exp_f16_sdwa v13, v13 dst_sel:WORD_0 dst_unused:UNUSED_PRESERVE src0_sel:WORD_0
  v_mfma_f32_16x16x32_f16 v[176:179], a[224:227], v[44:47], v[176:179]
  v_exp_f16_sdwa v15, v15 dst_sel:WORD_0 dst_unused:UNUSED_PRESERVE src0_sel:WORD_0
  v_mfma_f32_16x16x32_f16 v[188:191], a[228:231], v[44:47], v[188:191]
  ds_read_b128 a[220:223], v1 offset:25600
  v_exp_f16_sdwa v9, v9 dst_sel:WORD_1 dst_unused:UNUSED_PRESERVE src0_sel:WORD_1
  v_mfma_f32_16x16x32_f16 v[184:187], a[228:231], v[40:43], v[184:187]
  v_exp_f16_sdwa v11, v11 dst_sel:WORD_1 dst_unused:UNUSED_PRESERVE src0_sel:WORD_1
  v_mfma_f32_16x16x32_f16 v[180:183], a[228:231], v[36:39], v[180:183]
  v_exp_f16_sdwa v13, v13 dst_sel:WORD_1 dst_unused:UNUSED_PRESERVE src0_sel:WORD_1
  v_mfma_f32_16x16x32_f16 v[192:195], a[232:235], v[36:39], v[192:195]
  ds_read_b128 a[224:227], v1 offset:26624
  v_exp_f16_sdwa v15, v15 dst_sel:WORD_1 dst_unused:UNUSED_PRESERVE src0_sel:WORD_1
  v_mfma_f32_16x16x32_f16 v[196:199], a[232:235], v[40:43], v[196:199]
  v_pk_fma_f16 v9, v9, s35, s35
  v_pk_fma_f16 v11, v11, s35, s35
  v_mfma_f32_16x16x32_f16 v[200:203], a[232:235], v[44:47], v[200:203]
  s_waitcnt lgkmcnt(3)
  v_pk_fma_f16 v13, v13, s35, s35
  v_pk_fma_f16 v15, v15, s35, s35
  v_mfma_f32_16x16x32_f16 v[212:215], a[236:239], v[44:47], v[212:215]
  ds_read_b128 a[228:231], v1 offset:27648
  v_rcp_f16_sdwa v9, v9 dst_sel:WORD_0 dst_unused:UNUSED_PRESERVE src0_sel:WORD_0
  v_mfma_f32_16x16x32_f16 v[208:211], a[236:239], v[40:43], v[208:211]
  v_rcp_f16_sdwa v11, v11 dst_sel:WORD_0 dst_unused:UNUSED_PRESERVE src0_sel:WORD_0
  v_mfma_f32_16x16x32_f16 v[204:207], a[236:239], v[36:39], v[204:207]
  v_rcp_f16_sdwa v13, v13 dst_sel:WORD_0 dst_unused:UNUSED_PRESERVE src0_sel:WORD_0
  v_rcp_f16_sdwa v15, v15 dst_sel:WORD_0 dst_unused:UNUSED_PRESERVE src0_sel:WORD_0
  v_mfma_f32_16x16x32_f16 v[216:219], a[240:243], v[36:39], v[216:219]
  ds_read_b128 a[232:235], v1 offset:28672
  v_rcp_f16_sdwa v9, v9 dst_sel:WORD_1 dst_unused:UNUSED_PRESERVE src0_sel:WORD_1
  v_mfma_f32_16x16x32_f16 v[220:223], a[240:243], v[40:43], v[220:223]
  v_rcp_f16_sdwa v11, v11 dst_sel:WORD_1 dst_unused:UNUSED_PRESERVE src0_sel:WORD_1
  v_mfma_f32_16x16x32_f16 v[224:227], a[240:243], v[44:47], v[224:227]
  v_rcp_f16_sdwa v13, v13 dst_sel:WORD_1 dst_unused:UNUSED_PRESERVE src0_sel:WORD_1
  v_mfma_f32_16x16x32_f16 v[236:239], a[244:247], v[44:47], v[236:239]
  ds_read_b128 a[236:239], v1 offset:29696
  v_rcp_f16_sdwa v15, v15 dst_sel:WORD_1 dst_unused:UNUSED_PRESERVE src0_sel:WORD_1
  v_mfma_f32_16x16x32_f16 v[232:235], a[244:247], v[40:43], v[232:235]
  v_pk_mul_f16 v30, v8, v9
  v_pk_mul_f16 v31, v10, v11
  v_mfma_f32_16x16x32_f16 v[228:231], a[244:247], v[36:39], v[228:231]
  s_waitcnt lgkmcnt(3)
  v_pk_mul_f16 v34, v12, v13
  v_pk_mul_f16 v35, v14, v15
  v_mfma_f32_16x16x32_bf16 v[48:51], a[216:219], a[0:3], 0
  ds_read_b128 a[240:243], v1 offset:30720
  v_cvt_pk_f16_f32 v8, v72, v73
  v_cvt_pk_f16_f32 v10, v74, v75
  v_mfma_f32_16x16x32_bf16 v[52:55], a[216:219], a[24:27], 0
  v_cvt_pk_f16_f32 v12, v76, v77
  v_cvt_pk_f16_f32 v14, v78, v79
  v_mfma_f32_16x16x32_bf16 v[56:59], a[216:219], a[48:51], 0
  v_pk_fma_f16 v9, v8, v8, s34 neg_lo:[1,0,0] neg_hi:[1,0,0]
  v_pk_fma_f16 v11, v10, v10, s34 neg_lo:[1,0,0] neg_hi:[1,0,0]
  v_pk_fma_f16 v13, v12, v12, s34 neg_lo:[1,0,0] neg_hi:[1,0,0]
  v_mfma_f32_16x16x32_bf16 v[68:71], a[220:223], a[48:51], 0
  ds_read_b128 a[244:247], v1 offset:31744
  v_pk_fma_f16 v15, v14, v14, s34 neg_lo:[1,0,0] neg_hi:[1,0,0]
  v_pk_mul_f16 v9, v9, v8
  v_mfma_f32_16x16x32_bf16 v[64:67], a[220:223], a[24:27], 0
  buffer_store_dwordx4 a[192:195], v3, s[20:23], s46 offen offset:0 sc1
  v_pk_mul_f16 v11, v11, v10
  v_pk_mul_f16 v13, v13, v12
  v_mfma_f32_16x16x32_bf16 v[60:63], a[220:223], a[0:3], 0
  v_pk_mul_f16 v15, v15, v14
  v_exp_f16_sdwa v9, v9 dst_sel:WORD_0 dst_unused:UNUSED_PRESERVE src0_sel:WORD_0
  v_mfma_f32_16x16x32_bf16 v[48:51], a[224:227], a[4:7], v[48:51]
  ds_read_b128 a[216:219], v1 offset:32768
  v_exp_f16_sdwa v11, v11 dst_sel:WORD_0 dst_unused:UNUSED_PRESERVE src0_sel:WORD_0
  v_mfma_f32_16x16x32_bf16 v[52:55], a[224:227], a[28:31], v[52:55]
  v_exp_f16_sdwa v13, v13 dst_sel:WORD_0 dst_unused:UNUSED_PRESERVE src0_sel:WORD_0
  v_mfma_f32_16x16x32_bf16 v[56:59], a[224:227], a[52:55], v[56:59]
  s_waitcnt lgkmcnt(3)
  v_exp_f16_sdwa v15, v15 dst_sel:WORD_0 dst_unused:UNUSED_PRESERVE src0_sel:WORD_0
  v_mfma_f32_16x16x32_bf16 v[68:71], a[228:231], a[52:55], v[68:71]
  ds_read_b128 a[220:223], v1 offset:33792
  v_exp_f16_sdwa v9, v9 dst_sel:WORD_1 dst_unused:UNUSED_PRESERVE src0_sel:WORD_1
  v_mfma_f32_16x16x32_bf16 v[64:67], a[228:231], a[28:31], v[64:67]
  v_exp_f16_sdwa v11, v11 dst_sel:WORD_1 dst_unused:UNUSED_PRESERVE src0_sel:WORD_1
  v_mfma_f32_16x16x32_bf16 v[60:63], a[228:231], a[4:7], v[60:63]
  v_exp_f16_sdwa v13, v13 dst_sel:WORD_1 dst_unused:UNUSED_PRESERVE src0_sel:WORD_1
  v_mfma_f32_16x16x32_bf16 v[48:51], a[232:235], a[8:11], v[48:51]
  ds_read_b128 a[224:227], v1 offset:34816
  v_exp_f16_sdwa v15, v15 dst_sel:WORD_1 dst_unused:UNUSED_PRESERVE src0_sel:WORD_1
  v_mfma_f32_16x16x32_bf16 v[52:55], a[232:235], a[32:35], v[52:55]
  buffer_store_dwordx4 a[196:199], v3, s[20:23], s46 offen offset:64 sc1
  v_pk_fma_f16 v9, v9, s35, s35
  v_pk_fma_f16 v11, v11, s35, s35
  v_mfma_f32_16x16x32_bf16 v[56:59], a[232:235], a[56:59], v[56:59]
  v_pk_fma_f16 v13, v13, s35, s35
  v_pk_fma_f16 v15, v15, s35, s35
  v_mfma_f32_16x16x32_bf16 v[68:71], a[236:239], a[56:59], v[68:71]
  ds_read_b128 a[228:231], v1 offset:35840
  v_rcp_f16_sdwa v9, v9 dst_sel:WORD_0 dst_unused:UNUSED_PRESERVE src0_sel:WORD_0
  v_mfma_f32_16x16x32_bf16 v[64:67], a[236:239], a[32:35], v[64:67]
  v_rcp_f16_sdwa v11, v11 dst_sel:WORD_0 dst_unused:UNUSED_PRESERVE src0_sel:WORD_0
  v_mfma_f32_16x16x32_bf16 v[60:63], a[236:239], a[8:11], v[60:63]
  s_waitcnt lgkmcnt(3)
  v_rcp_f16_sdwa v13, v13 dst_sel:WORD_0 dst_unused:UNUSED_PRESERVE src0_sel:WORD_0
  v_rcp_f16_sdwa v15, v15 dst_sel:WORD_0 dst_unused:UNUSED_PRESERVE src0_sel:WORD_0
  v_mfma_f32_16x16x32_bf16 v[48:51], a[240:243], a[12:15], v[48:51]
  ds_read_b128 a[232:235], v1 offset:36864
  v_rcp_f16_sdwa v9, v9 dst_sel:WORD_1 dst_unused:UNUSED_PRESERVE src0_sel:WORD_1
  v_mfma_f32_16x16x32_bf16 v[52:55], a[240:243], a[36:39], v[52:55]
  v_rcp_f16_sdwa v11, v11 dst_sel:WORD_1 dst_unused:UNUSED_PRESERVE src0_sel:WORD_1
  v_mfma_f32_16x16x32_bf16 v[56:59], a[240:243], a[60:63], v[56:59]
  v_rcp_f16_sdwa v13, v13 dst_sel:WORD_1 dst_unused:UNUSED_PRESERVE src0_sel:WORD_1
  v_mfma_f32_16x16x32_bf16 v[68:71], a[244:247], a[60:63], v[68:71]
  ds_read_b128 a[236:239], v1 offset:37888
  v_rcp_f16_sdwa v15, v15 dst_sel:WORD_1 dst_unused:UNUSED_PRESERVE src0_sel:WORD_1
  v_mfma_f32_16x16x32_bf16 v[64:67], a[244:247], a[36:39], v[64:67]
  buffer_store_dwordx4 a[200:203], v3, s[20:23], s46 offen offset:128 sc1
  v_pk_mul_f16 v36, v8, v9
  v_pk_mul_f16 v37, v10, v11
  v_mfma_f32_16x16x32_bf16 v[60:63], a[244:247], a[12:15], v[60:63]
  v_pk_mul_f16 v40, v12, v13
  v_pk_mul_f16 v41, v14, v15
  v_mfma_f32_16x16x32_bf16 v[48:51], a[216:219], a[16:19], v[48:51]
  ds_read_b128 a[240:243], v1 offset:38912
  v_cvt_pk_f16_f32 v16, v80, v81
  v_cvt_pk_f16_f32 v18, v82, v83
  v_mfma_f32_16x16x32_bf16 v[52:55], a[216:219], a[40:43], v[52:55]
  v_cvt_pk_f16_f32 v20, v84, v85
  v_cvt_pk_f16_f32 v22, v86, v87
  v_mfma_f32_16x16x32_bf16 v[56:59], a[216:219], a[64:67], v[56:59]
  s_waitcnt lgkmcnt(3)
  v_pk_fma_f16 v17, v16, v16, s34 neg_lo:[1,0,0] neg_hi:[1,0,0]
  v_pk_fma_f16 v19, v18, v18, s34 neg_lo:[1,0,0] neg_hi:[1,0,0]
  v_pk_fma_f16 v21, v20, v20, s34 neg_lo:[1,0,0] neg_hi:[1,0,0]
  v_mfma_f32_16x16x32_bf16 v[68:71], a[220:223], a[64:67], v[68:71]
  ds_read_b128 a[244:247], v1 offset:39936
  v_pk_fma_f16 v23, v22, v22, s34 neg_lo:[1,0,0] neg_hi:[1,0,0]
  v_pk_mul_f16 v17, v17, v16
  v_mfma_f32_16x16x32_bf16 v[64:67], a[220:223], a[40:43], v[64:67]
  v_pk_mul_f16 v19, v19, v18
  v_pk_mul_f16 v21, v21, v20
  v_mfma_f32_16x16x32_bf16 v[60:63], a[220:223], a[16:19], v[60:63]
  v_pk_mul_f16 v23, v23, v22
  v_exp_f16_sdwa v17, v17 dst_sel:WORD_0 dst_unused:UNUSED_PRESERVE src0_sel:WORD_0
  v_mfma_f32_16x16x32_bf16 v[48:51], a[224:227], a[20:23], v[48:51]
  ds_read_b128 a[216:219], v1 offset:40960
  v_exp_f16_sdwa v19, v19 dst_sel:WORD_0 dst_unused:UNUSED_PRESERVE src0_sel:WORD_0
  v_mfma_f32_16x16x32_bf16 v[52:55], a[224:227], a[44:47], v[52:55]
  v_exp_f16_sdwa v21, v21 dst_sel:WORD_0 dst_unused:UNUSED_PRESERVE src0_sel:WORD_0
  v_mfma_f32_16x16x32_bf16 v[56:59], a[224:227], a[68:71], v[56:59]
  v_exp_f16_sdwa v23, v23 dst_sel:WORD_0 dst_unused:UNUSED_PRESERVE src0_sel:WORD_0
  v_mfma_f32_16x16x32_bf16 v[68:71], a[228:231], a[68:71], v[68:71]
  ds_read_b128 a[220:223], v1 offset:41984
  v_exp_f16_sdwa v17, v17 dst_sel:WORD_1 dst_unused:UNUSED_PRESERVE src0_sel:WORD_1
  v_mfma_f32_16x16x32_bf16 v[64:67], a[228:231], a[44:47], v[64:67]
  v_exp_f16_sdwa v19, v19 dst_sel:WORD_1 dst_unused:UNUSED_PRESERVE src0_sel:WORD_1
  v_mfma_f32_16x16x32_bf16 v[60:63], a[228:231], a[20:23], v[60:63]
  s_waitcnt lgkmcnt(3)
  v_exp_f16_sdwa v21, v21 dst_sel:WORD_1 dst_unused:UNUSED_PRESERVE src0_sel:WORD_1
  v_mfma_f32_16x16x32_f16 v[96:99], a[232:235], v[24:27], v[96:99]
  ds_read_b128 a[224:227], v1 offset:43008
  v_exp_f16_sdwa v23, v23 dst_sel:WORD_1 dst_unused:UNUSED_PRESERVE src0_sel:WORD_1
  v_mfma_f32_16x16x32_f16 v[100:103], a[232:235], v[28:31], v[100:103]
  v_pk_fma_f16 v17, v17, s35, s35
  v_pk_fma_f16 v19, v19, s35, s35
  v_mfma_f32_16x16x32_f16 v[104:107], a[232:235], v[32:35], v[104:107]
  v_pk_fma_f16 v21, v21, s35, s35
  v_pk_fma_f16 v23, v23, s35, s35
  v_mfma_f32_16x16x32_f16 v[116:119], a[236:239], v[32:35], v[116:119]
  ds_read_b128 a[228:231], v1 offset:44032
  v_rcp_f16_sdwa v17, v17 dst_sel:WORD_0 dst_unused:UNUSED_PRESERVE src0_sel:WORD_0
  v_mfma_f32_16x16x32_f16 v[112:115], a[236:239], v[28:31], v[112:115]
  v_rcp_f16_sdwa v19, v19 dst_sel:WORD_0 dst_unused:UNUSED_PRESERVE src0_sel:WORD_0
  v_mfma_f32_16x16x32_f16 v[108:111], a[236:239], v[24:27], v[108:111]
  v_rcp_f16_sdwa v21, v21 dst_sel:WORD_0 dst_unused:UNUSED_PRESERVE src0_sel:WORD_0
  v_rcp_f16_sdwa v23, v23 dst_sel:WORD_0 dst_unused:UNUSED_PRESERVE src0_sel:WORD_0
  v_mfma_f32_16x16x32_f16 v[120:123], a[240:243], v[24:27], v[120:123]
  ds_read_b128 a[232:235], v1 offset:45056
  v_rcp_f16_sdwa v17, v17 dst_sel:WORD_1 dst_unused:UNUSED_PRESERVE src0_sel:WORD_1
  v_mfma_f32_16x16x32_f16 v[124:127], a[240:243], v[28:31], v[124:127]
  v_rcp_f16_sdwa v19, v19 dst_sel:WORD_1 dst_unused:UNUSED_PRESERVE src0_sel:WORD_1
  v_mfma_f32_16x16x32_f16 v[128:131], a[240:243], v[32:35], v[128:131]
  s_waitcnt lgkmcnt(3)
  v_rcp_f16_sdwa v21, v21 dst_sel:WORD_1 dst_unused:UNUSED_PRESERVE src0_sel:WORD_1
  v_mfma_f32_16x16x32_f16 v[140:143], a[244:247], v[32:35], v[140:143]
  ds_read_b128 a[236:239], v1 offset:46080
  v_rcp_f16_sdwa v23, v23 dst_sel:WORD_1 dst_unused:UNUSED_PRESERVE src0_sel:WORD_1
  v_mfma_f32_16x16x32_f16 v[136:139], a[244:247], v[28:31], v[136:139]
  v_pk_mul_f16 v44, v16, v17
  v_pk_mul_f16 v45, v18, v19
  v_mfma_f32_16x16x32_f16 v[132:135], a[244:247], v[24:27], v[132:135]
  v_pk_mul_f16 v38, v20, v21
  v_pk_mul_f16 v39, v22, v23
  v_mfma_f32_16x16x32_f16 v[144:147], a[216:219], v[24:27], v[144:147]
  ds_read_b128 a[240:243], v1 offset:47104
  ds_read_b128 a[244:247], v1 offset:48128
  v_cvt_pk_f16_f32 v8, v88, v89
  v_cvt_pk_f16_f32 v10, v90, v91
  v_mfma_f32_16x16x32_f16 v[148:151], a[216:219], v[28:31], v[148:151]
  v_cvt_pk_f16_f32 v12, v92, v93
  v_cvt_pk_f16_f32 v14, v94, v95
  v_mfma_f32_16x16x32_f16 v[152:155], a[216:219], v[32:35], v[152:155]
  v_pk_fma_f16 v9, v8, v8, s34 neg_lo:[1,0,0] neg_hi:[1,0,0]
  v_pk_fma_f16 v11, v10, v10, s34 neg_lo:[1,0,0] neg_hi:[1,0,0]
  v_pk_fma_f16 v13, v12, v12, s34 neg_lo:[1,0,0] neg_hi:[1,0,0]
  v_mfma_f32_16x16x32_f16 v[164:167], a[220:223], v[32:35], v[164:167]
  v_pk_fma_f16 v15, v14, v14, s34 neg_lo:[1,0,0] neg_hi:[1,0,0]
  v_pk_mul_f16 v9, v9, v8
  v_mfma_f32_16x16x32_f16 v[160:163], a[220:223], v[28:31], v[160:163]
  v_pk_mul_f16 v11, v11, v10
  v_pk_mul_f16 v13, v13, v12
  v_mfma_f32_16x16x32_f16 v[156:159], a[220:223], v[24:27], v[156:159]
  s_waitcnt lgkmcnt(3)
  v_pk_mul_f16 v15, v15, v14
  v_exp_f16_sdwa v9, v9 dst_sel:WORD_0 dst_unused:UNUSED_PRESERVE src0_sel:WORD_0
  v_mfma_f32_16x16x32_f16 v[168:171], a[224:227], v[24:27], v[168:171]
  s_waitcnt lgkmcnt(0)
  s_waitcnt vmcnt(3)
  s_barrier
  ds_read_b128 a[216:219], v4 offset:0
  v_exp_f16_sdwa v11, v11 dst_sel:WORD_0 dst_unused:UNUSED_PRESERVE src0_sel:WORD_0
  v_mfma_f32_16x16x32_f16 v[172:175], a[224:227], v[28:31], v[172:175]
  v_exp_f16_sdwa v13, v13 dst_sel:WORD_0 dst_unused:UNUSED_PRESERVE src0_sel:WORD_0
  v_mfma_f32_16x16x32_f16 v[176:179], a[224:227], v[32:35], v[176:179]
  v_exp_f16_sdwa v15, v15 dst_sel:WORD_0 dst_unused:UNUSED_PRESERVE src0_sel:WORD_0
  v_mfma_f32_16x16x32_f16 v[188:191], a[228:231], v[32:35], v[188:191]
  ds_read_b128 a[220:223], v4 offset:1024
  v_exp_f16_sdwa v9, v9 dst_sel:WORD_1 dst_unused:UNUSED_PRESERVE src0_sel:WORD_1
  v_mfma_f32_16x16x32_f16 v[184:187], a[228:231], v[28:31], v[184:187]
  v_exp_f16_sdwa v11, v11 dst_sel:WORD_1 dst_unused:UNUSED_PRESERVE src0_sel:WORD_1
  v_mfma_f32_16x16x32_f16 v[180:183], a[228:231], v[24:27], v[180:183]
  v_exp_f16_sdwa v13, v13 dst_sel:WORD_1 dst_unused:UNUSED_PRESERVE src0_sel:WORD_1
  v_mfma_f32_16x16x32_f16 v[192:195], a[232:235], v[24:27], v[192:195]
  ds_read_b128 a[224:227], v4 offset:2048
  v_exp_f16_sdwa v15, v15 dst_sel:WORD_1 dst_unused:UNUSED_PRESERVE src0_sel:WORD_1
  v_mfma_f32_16x16x32_f16 v[196:199], a[232:235], v[28:31], v[196:199]
  v_pk_fma_f16 v9, v9, s35, s35
  v_pk_fma_f16 v11, v11, s35, s35
  v_mfma_f32_16x16x32_f16 v[200:203], a[232:235], v[32:35], v[200:203]
  v_pk_fma_f16 v13, v13, s35, s35
  v_pk_fma_f16 v15, v15, s35, s35
  v_mfma_f32_16x16x32_f16 v[212:215], a[236:239], v[32:35], v[212:215]
  ds_read_b128 a[228:231], v4 offset:3072
  v_rcp_f16_sdwa v9, v9 dst_sel:WORD_0 dst_unused:UNUSED_PRESERVE src0_sel:WORD_0
  v_mfma_f32_16x16x32_f16 v[208:211], a[236:239], v[28:31], v[208:211]
  v_rcp_f16_sdwa v11, v11 dst_sel:WORD_0 dst_unused:UNUSED_PRESERVE src0_sel:WORD_0
  v_mfma_f32_16x16x32_f16 v[204:207], a[236:239], v[24:27], v[204:207]
  v_rcp_f16_sdwa v13, v13 dst_sel:WORD_0 dst_unused:UNUSED_PRESERVE src0_sel:WORD_0
  v_rcp_f16_sdwa v15, v15 dst_sel:WORD_0 dst_unused:UNUSED_PRESERVE src0_sel:WORD_0
  v_mfma_f32_16x16x32_f16 v[216:219], a[240:243], v[24:27], v[216:219]
  ds_read_b128 a[232:235], v4 offset:4096
  v_rcp_f16_sdwa v9, v9 dst_sel:WORD_1 dst_unused:UNUSED_PRESERVE src0_sel:WORD_1
  v_mfma_f32_16x16x32_f16 v[220:223], a[240:243], v[28:31], v[220:223]
  v_rcp_f16_sdwa v11, v11 dst_sel:WORD_1 dst_unused:UNUSED_PRESERVE src0_sel:WORD_1
  v_mfma_f32_16x16x32_f16 v[224:227], a[240:243], v[32:35], v[224:227]
  v_rcp_f16_sdwa v13, v13 dst_sel:WORD_1 dst_unused:UNUSED_PRESERVE src0_sel:WORD_1
  v_mfma_f32_16x16x32_f16 v[236:239], a[244:247], v[32:35], v[236:239]
  ds_read_b128 a[236:239], v4 offset:5120
  v_rcp_f16_sdwa v15, v15 dst_sel:WORD_1 dst_unused:UNUSED_PRESERVE src0_sel:WORD_1
  v_mfma_f32_16x16x32_f16 v[232:235], a[244:247], v[28:31], v[232:235]
  v_pk_mul_f16 v42, v8, v9
  v_pk_mul_f16 v43, v10, v11
  v_mfma_f32_16x16x32_f16 v[228:231], a[244:247], v[24:27], v[228:231]
  s_waitcnt lgkmcnt(3)
  v_pk_mul_f16 v46, v12, v13
  v_pk_mul_f16 v47, v14, v15
  v_mfma_f32_16x16x32_bf16 v[72:75], a[216:219], a[0:3], 0
  ds_read_b128 a[240:243], v4 offset:6144
  s_add_u32 m0, s29, 0
  s_add_u32 s31, s29, 294912
  buffer_load_dwordx4 v2, s[8:11], s31 offen offset:0 lds
  v_cvt_pk_f16_f32 v8, v48, v49
  v_cvt_pk_f16_f32 v10, v50, v51
  v_mfma_f32_16x16x32_bf16 v[76:79], a[216:219], a[24:27], 0
  v_cvt_pk_f16_f32 v12, v52, v53
  v_cvt_pk_f16_f32 v14, v54, v55
  v_mfma_f32_16x16x32_bf16 v[80:83], a[216:219], a[48:51], 0
  v_pk_fma_f16 v9, v8, v8, s34 neg_lo:[1,0,0] neg_hi:[1,0,0]
  v_pk_fma_f16 v11, v10, v10, s34 neg_lo:[1,0,0] neg_hi:[1,0,0]
  v_pk_fma_f16 v13, v12, v12, s34 neg_lo:[1,0,0] neg_hi:[1,0,0]
  v_mfma_f32_16x16x32_bf16 v[92:95], a[220:223], a[48:51], 0
  ds_read_b128 a[244:247], v4 offset:7168
  buffer_load_dwordx4 v2, s[8:11], s31 offen offset:1024 lds
  v_pk_fma_f16 v15, v14, v14, s34 neg_lo:[1,0,0] neg_hi:[1,0,0]
  v_pk_mul_f16 v9, v9, v8
  v_mfma_f32_16x16x32_bf16 v[88:91], a[220:223], a[24:27], 0
  v_pk_mul_f16 v11, v11, v10
  v_pk_mul_f16 v13, v13, v12
  v_mfma_f32_16x16x32_bf16 v[84:87], a[220:223], a[0:3], 0
  v_pk_mul_f16 v15, v15, v14
  v_exp_f16_sdwa v9, v9 dst_sel:WORD_0 dst_unused:UNUSED_PRESERVE src0_sel:WORD_0
  v_mfma_f32_16x16x32_bf16 v[72:75], a[224:227], a[4:7], v[72:75]
  ds_read_b128 a[216:219], v4 offset:8192
  buffer_load_dwordx4 v2, s[8:11], s31 offen offset:2048 lds
  v_exp_f16_sdwa v11, v11 dst_sel:WORD_0 dst_unused:UNUSED_PRESERVE src0_sel:WORD_0
  v_mfma_f32_16x16x32_bf16 v[76:79], a[224:227], a[28:31], v[76:79]
  v_exp_f16_sdwa v13, v13 dst_sel:WORD_0 dst_unused:UNUSED_PRESERVE src0_sel:WORD_0
  v_mfma_f32_16x16x32_bf16 v[80:83], a[224:227], a[52:55], v[80:83]
  s_waitcnt lgkmcnt(3)
  v_exp_f16_sdwa v15, v15 dst_sel:WORD_0 dst_unused:UNUSED_PRESERVE src0_sel:WORD_0
  v_mfma_f32_16x16x32_bf16 v[92:95], a[228:231], a[52:55], v[92:95]
  ds_read_b128 a[220:223], v4 offset:9216
  buffer_load_dwordx4 v2, s[8:11], s31 offen offset:3072 lds
  v_exp_f16_sdwa v9, v9 dst_sel:WORD_1 dst_unused:UNUSED_PRESERVE src0_sel:WORD_1
  v_mfma_f32_16x16x32_bf16 v[88:91], a[228:231], a[28:31], v[88:91]
  s_add_u32 m0, s29, 4096
  v_exp_f16_sdwa v11, v11 dst_sel:WORD_1 dst_unused:UNUSED_PRESERVE src0_sel:WORD_1
  v_mfma_f32_16x16x32_bf16 v[84:87], a[228:231], a[4:7], v[84:87]
  s_add_u32 s31, s29, 299008
  v_exp_f16_sdwa v13, v13 dst_sel:WORD_1 dst_unused:UNUSED_PRESERVE src0_sel:WORD_1
  v_mfma_f32_16x16x32_bf16 v[72:75], a[232:235], a[8:11], v[72:75]
  ds_read_b128 a[224:227], v4 offset:10240
  buffer_load_dwordx4 v2, s[8:11], s31 offen offset:0 lds
  v_exp_f16_sdwa v15, v15 dst_sel:WORD_1 dst_unused:UNUSED_PRESERVE src0_sel:WORD_1
  v_mfma_f32_16x16x32_bf16 v[76:79], a[232:235], a[32:35], v[76:79]
  v_pk_fma_f16 v9, v9, s35, s35
  v_pk_fma_f16 v11, v11, s35, s35
  v_mfma_f32_16x16x32_bf16 v[80:83], a[232:235], a[56:59], v[80:83]
  v_pk_fma_f16 v13, v13, s35, s35
  v_pk_fma_f16 v15, v15, s35, s35
  v_mfma_f32_16x16x32_bf16 v[92:95], a[236:239], a[56:59], v[92:95]
  ds_read_b128 a[228:231], v4 offset:11264
  buffer_load_dwordx4 v2, s[8:11], s31 offen offset:1024 lds
  v_rcp_f16_sdwa v9, v9 dst_sel:WORD_0 dst_unused:UNUSED_PRESERVE src0_sel:WORD_0
  v_mfma_f32_16x16x32_bf16 v[88:91], a[236:239], a[32:35], v[88:91]
  v_rcp_f16_sdwa v11, v11 dst_sel:WORD_0 dst_unused:UNUSED_PRESERVE src0_sel:WORD_0
  v_mfma_f32_16x16x32_bf16 v[84:87], a[236:239], a[8:11], v[84:87]
  s_waitcnt lgkmcnt(3)
  v_rcp_f16_sdwa v13, v13 dst_sel:WORD_0 dst_unused:UNUSED_PRESERVE src0_sel:WORD_0
  v_rcp_f16_sdwa v15, v15 dst_sel:WORD_0 dst_unused:UNUSED_PRESERVE src0_sel:WORD_0
  v_mfma_f32_16x16x32_bf16 v[72:75], a[240:243], a[12:15], v[72:75]
  ds_read_b128 a[232:235], v4 offset:12288
  buffer_load_dwordx4 v2, s[8:11], s31 offen offset:2048 lds
  v_rcp_f16_sdwa v9, v9 dst_sel:WORD_1 dst_unused:UNUSED_PRESERVE src0_sel:WORD_1
  v_mfma_f32_16x16x32_bf16 v[76:79], a[240:243], a[36:39], v[76:79]
  v_rcp_f16_sdwa v11, v11 dst_sel:WORD_1 dst_unused:UNUSED_PRESERVE src0_sel:WORD_1
  v_mfma_f32_16x16x32_bf16 v[80:83], a[240:243], a[60:63], v[80:83]
  v_rcp_f16_sdwa v13, v13 dst_sel:WORD_1 dst_unused:UNUSED_PRESERVE src0_sel:WORD_1
  v_mfma_f32_16x16x32_bf16 v[92:95], a[244:247], a[60:63], v[92:95]
  ds_read_b128 a[236:239], v4 offset:13312
  buffer_load_dwordx4 v2, s[8:11], s31 offen offset:3072 lds
  v_rcp_f16_sdwa v15, v15 dst_sel:WORD_1 dst_unused:UNUSED_PRESERVE src0_sel:WORD_1
  v_mfma_f32_16x16x32_bf16 v[88:91], a[244:247], a[36:39], v[88:91]
  s_add_u32 m0, s29, 8192
  v_pk_mul_f16 v24, v8, v9
  v_pk_mul_f16 v25, v10, v11
  v_mfma_f32_16x16x32_bf16 v[84:87], a[244:247], a[12:15], v[84:87]
  s_add_u32 s31, s29, 303104
  v_pk_mul_f16 v28, v12, v13
  v_pk_mul_f16 v29, v14, v15
  v_mfma_f32_16x16x32_bf16 v[72:75], a[216:219], a[16:19], v[72:75]
  ds_read_b128 a[240:243], v4 offset:14336
  buffer_load_dwordx4 v2, s[8:11], s31 offen offset:0 lds
  v_cvt_pk_f16_f32 v16, v56, v57
  v_cvt_pk_f16_f32 v18, v58, v59
  v_mfma_f32_16x16x32_bf16 v[76:79], a[216:219], a[40:43], v[76:79]
  v_cvt_pk_f16_f32 v20, v60, v61
  v_cvt_pk_f16_f32 v22, v62, v63
  v_mfma_f32_16x16x32_bf16 v[80:83], a[216:219], a[64:67], v[80:83]
  s_waitcnt lgkmcnt(3)
  v_pk_fma_f16 v17, v16, v16, s34 neg_lo:[1,0,0] neg_hi:[1,0,0]
  v_pk_fma_f16 v19, v18, v18, s34 neg_lo:[1,0,0] neg_hi:[1,0,0]
  v_pk_fma_f16 v21, v20, v20, s34 neg_lo:[1,0,0] neg_hi:[1,0,0]
  v_mfma_f32_16x16x32_bf16 v[92:95], a[220:223], a[64:67], v[92:95]
  ds_read_b128 a[244:247], v4 offset:15360
  buffer_load_dwordx4 v2, s[8:11], s31 offen offset:1024 lds
  v_pk_fma_f16 v23, v22, v22, s34 neg_lo:[1,0,0] neg_hi:[1,0,0]
  v_pk_mul_f16 v17, v17, v16
  v_mfma_f32_16x16x32_bf16 v[88:91], a[220:223], a[40:43], v[88:91]
  v_pk_mul_f16 v19, v19, v18
  v_pk_mul_f16 v21, v21, v20
  v_mfma_f32_16x16x32_bf16 v[84:87], a[220:223], a[16:19], v[84:87]
  v_pk_mul_f16 v23, v23, v22
  v_exp_f16_sdwa v17, v17 dst_sel:WORD_0 dst_unused:UNUSED_PRESERVE src0_sel:WORD_0
  v_mfma_f32_16x16x32_bf16 v[72:75], a[224:227], a[20:23], v[72:75]
  ds_read_b128 a[216:219], v4 offset:16384
  buffer_load_dwordx4 v2, s[8:11], s31 offen offset:2048 lds
  v_exp_f16_sdwa v19, v19 dst_sel:WORD_0 dst_unused:UNUSED_PRESERVE src0_sel:WORD_0
  v_mfma_f32_16x16x32_bf16 v[76:79], a[224:227], a[44:47], v[76:79]
  v_exp_f16_sdwa v21, v21 dst_sel:WORD_0 dst_unused:UNUSED_PRESERVE src0_sel:WORD_0
  v_mfma_f32_16x16x32_bf16 v[80:83], a[224:227], a[68:71], v[80:83]
  v_exp_f16_sdwa v23, v23 dst_sel:WORD_0 dst_unused:UNUSED_PRESERVE src0_sel:WORD_0
  v_mfma_f32_16x16x32_bf16 v[92:95], a[228:231], a[68:71], v[92:95]
  ds_read_b128 a[220:223], v4 offset:17408
  buffer_load_dwordx4 v2, s[8:11], s31 offen offset:3072 lds
  v_exp_f16_sdwa v17, v17 dst_sel:WORD_1 dst_unused:UNUSED_PRESERVE src0_sel:WORD_1
  v_mfma_f32_16x16x32_bf16 v[88:91], a[228:231], a[44:47], v[88:91]
  v_exp_f16_sdwa v19, v19 dst_sel:WORD_1 dst_unused:UNUSED_PRESERVE src0_sel:WORD_1
  v_mfma_f32_16x16x32_bf16 v[84:87], a[228:231], a[20:23], v[84:87]
  s_waitcnt lgkmcnt(3)
  v_exp_f16_sdwa v21, v21 dst_sel:WORD_1 dst_unused:UNUSED_PRESERVE src0_sel:WORD_1
  v_mfma_f32_16x16x32_f16 v[96:99], a[232:235], v[36:39], v[96:99]
  ds_read_b128 a[224:227], v4 offset:18432
  v_exp_f16_sdwa v23, v23 dst_sel:WORD_1 dst_unused:UNUSED_PRESERVE src0_sel:WORD_1
  v_mfma_f32_16x16x32_f16 v[100:103], a[232:235], v[40:43], v[100:103]
  v_pk_fma_f16 v17, v17, s35, s35
  v_pk_fma_f16 v19, v19, s35, s35
  v_mfma_f32_16x16x32_f16 v[104:107], a[232:235], v[44:47], v[104:107]
  v_pk_fma_f16 v21, v21, s35, s35
  v_pk_fma_f16 v23, v23, s35, s35
  v_mfma_f32_16x16x32_f16 v[116:119], a[236:239], v[44:47], v[116:119]
  ds_read_b128 a[228:231], v4 offset:19456
  v_rcp_f16_sdwa v17, v17 dst_sel:WORD_0 dst_unused:UNUSED_PRESERVE src0_sel:WORD_0
  v_mfma_f32_16x16x32_f16 v[112:115], a[236:239], v[40:43], v[112:115]
  v_rcp_f16_sdwa v19, v19 dst_sel:WORD_0 dst_unused:UNUSED_PRESERVE src0_sel:WORD_0
  v_mfma_f32_16x16x32_f16 v[108:111], a[236:239], v[36:39], v[108:111]
  v_rcp_f16_sdwa v21, v21 dst_sel:WORD_0 dst_unused:UNUSED_PRESERVE src0_sel:WORD_0
  v_rcp_f16_sdwa v23, v23 dst_sel:WORD_0 dst_unused:UNUSED_PRESERVE src0_sel:WORD_0
  v_mfma_f32_16x16x32_f16 v[120:123], a[240:243], v[36:39], v[120:123]
  ds_read_b128 a[232:235], v4 offset:20480
  v_rcp_f16_sdwa v17, v17 dst_sel:WORD_1 dst_unused:UNUSED_PRESERVE src0_sel:WORD_1
  v_mfma_f32_16x16x32_f16 v[124:127], a[240:243], v[40:43], v[124:127]
  v_rcp_f16_sdwa v19, v19 dst_sel:WORD_1 dst_unused:UNUSED_PRESERVE src0_sel:WORD_1
  v_mfma_f32_16x16x32_f16 v[128:131], a[240:243], v[44:47], v[128:131]
  s_waitcnt lgkmcnt(3)
  v_rcp_f16_sdwa v21, v21 dst_sel:WORD_1 dst_unused:UNUSED_PRESERVE src0_sel:WORD_1
  v_mfma_f32_16x16x32_f16 v[140:143], a[244:247], v[44:47], v[140:143]
  ds_read_b128 a[236:239], v4 offset:21504
  v_rcp_f16_sdwa v23, v23 dst_sel:WORD_1 dst_unused:UNUSED_PRESERVE src0_sel:WORD_1
  v_mfma_f32_16x16x32_f16 v[136:139], a[244:247], v[40:43], v[136:139]
  v_pk_mul_f16 v32, v16, v17
  v_pk_mul_f16 v33, v18, v19
  v_mfma_f32_16x16x32_f16 v[132:135], a[244:247], v[36:39], v[132:135]
  v_pk_mul_f16 v26, v20, v21
  v_pk_mul_f16 v27, v22, v23
  v_mfma_f32_16x16x32_f16 v[144:147], a[216:219], v[36:39], v[144:147]
  ds_read_b128 a[240:243], v4 offset:22528
  v_cvt_pk_f16_f32 v8, v64, v65
  v_cvt_pk_f16_f32 v10, v66, v67
  v_mfma_f32_16x16x32_f16 v[148:151], a[216:219], v[40:43], v[148:151]
  v_cvt_pk_f16_f32 v12, v68, v69
  v_cvt_pk_f16_f32 v14, v70, v71
  v_mfma_f32_16x16x32_f16 v[152:155], a[216:219], v[44:47], v[152:155]
  v_pk_fma_f16 v9, v8, v8, s34 neg_lo:[1,0,0] neg_hi:[1,0,0]
  v_pk_fma_f16 v11, v10, v10, s34 neg_lo:[1,0,0] neg_hi:[1,0,0]
  v_pk_fma_f16 v13, v12, v12, s34 neg_lo:[1,0,0] neg_hi:[1,0,0]
  v_mfma_f32_16x16x32_f16 v[164:167], a[220:223], v[44:47], v[164:167]
  ds_read_b128 a[244:247], v4 offset:23552
  v_pk_fma_f16 v15, v14, v14, s34 neg_lo:[1,0,0] neg_hi:[1,0,0]
  v_pk_mul_f16 v9, v9, v8
  v_mfma_f32_16x16x32_f16 v[160:163], a[220:223], v[40:43], v[160:163]
  v_pk_mul_f16 v11, v11, v10
  v_pk_mul_f16 v13, v13, v12
  v_mfma_f32_16x16x32_f16 v[156:159], a[220:223], v[36:39], v[156:159]
  s_waitcnt lgkmcnt(3)
  v_pk_mul_f16 v15, v15, v14
  v_exp_f16_sdwa v9, v9 dst_sel:WORD_0 dst_unused:UNUSED_PRESERVE src0_sel:WORD_0
  v_mfma_f32_16x16x32_f16 v[168:171], a[224:227], v[36:39], v[168:171]
  ds_read_b128 a[216:219], v4 offset:24576
  v_exp_f16_sdwa v11, v11 dst_sel:WORD_0 dst_unused:UNUSED_PRESERVE src0_sel:WORD_0
  v_mfma_f32_16x16x32_f16 v[172:175], a[224:227], v[40:43], v[172:175]
  v_exp_f16_sdwa v13, v13 dst_sel:WORD_0 dst_unused:UNUSED_PRESERVE src0_sel:WORD_0
  v_mfma_f32_16x16x32_f16 v[176:179], a[224:227], v[44:47], v[176:179]
  v_exp_f16_sdwa v15, v15 dst_sel:WORD_0 dst_unused:UNUSED_PRESERVE src0_sel:WORD_0
  v_mfma_f32_16x16x32_f16 v[188:191], a[228:231], v[44:47], v[188:191]
  ds_read_b128 a[220:223], v4 offset:25600
  v_exp_f16_sdwa v9, v9 dst_sel:WORD_1 dst_unused:UNUSED_PRESERVE src0_sel:WORD_1
  v_mfma_f32_16x16x32_f16 v[184:187], a[228:231], v[40:43], v[184:187]
  v_exp_f16_sdwa v11, v11 dst_sel:WORD_1 dst_unused:UNUSED_PRESERVE src0_sel:WORD_1
  v_mfma_f32_16x16x32_f16 v[180:183], a[228:231], v[36:39], v[180:183]
  v_exp_f16_sdwa v13, v13 dst_sel:WORD_1 dst_unused:UNUSED_PRESERVE src0_sel:WORD_1
  v_mfma_f32_16x16x32_f16 v[192:195], a[232:235], v[36:39], v[192:195]
  ds_read_b128 a[224:227], v4 offset:26624
  v_exp_f16_sdwa v15, v15 dst_sel:WORD_1 dst_unused:UNUSED_PRESERVE src0_sel:WORD_1
  v_mfma_f32_16x16x32_f16 v[196:199], a[232:235], v[40:43], v[196:199]
  v_pk_fma_f16 v9, v9, s35, s35
  v_pk_fma_f16 v11, v11, s35, s35
  v_mfma_f32_16x16x32_f16 v[200:203], a[232:235], v[44:47], v[200:203]
  s_waitcnt lgkmcnt(3)
  v_pk_fma_f16 v13, v13, s35, s35
  v_pk_fma_f16 v15, v15, s35, s35
  v_mfma_f32_16x16x32_f16 v[212:215], a[236:239], v[44:47], v[212:215]
  ds_read_b128 a[228:231], v4 offset:27648
  v_rcp_f16_sdwa v9, v9 dst_sel:WORD_0 dst_unused:UNUSED_PRESERVE src0_sel:WORD_0
  v_mfma_f32_16x16x32_f16 v[208:211], a[236:239], v[40:43], v[208:211]
  v_rcp_f16_sdwa v11, v11 dst_sel:WORD_0 dst_unused:UNUSED_PRESERVE src0_sel:WORD_0
  v_mfma_f32_16x16x32_f16 v[204:207], a[236:239], v[36:39], v[204:207]
  v_rcp_f16_sdwa v13, v13 dst_sel:WORD_0 dst_unused:UNUSED_PRESERVE src0_sel:WORD_0
  v_rcp_f16_sdwa v15, v15 dst_sel:WORD_0 dst_unused:UNUSED_PRESERVE src0_sel:WORD_0
  v_mfma_f32_16x16x32_f16 v[216:219], a[240:243], v[36:39], v[216:219]
  ds_read_b128 a[232:235], v4 offset:28672
  v_rcp_f16_sdwa v9, v9 dst_sel:WORD_1 dst_unused:UNUSED_PRESERVE src0_sel:WORD_1
  v_mfma_f32_16x16x32_f16 v[220:223], a[240:243], v[40:43], v[220:223]
  v_rcp_f16_sdwa v11, v11 dst_sel:WORD_1 dst_unused:UNUSED_PRESERVE src0_sel:WORD_1
  v_mfma_f32_16x16x32_f16 v[224:227], a[240:243], v[44:47], v[224:227]
  v_rcp_f16_sdwa v13, v13 dst_sel:WORD_1 dst_unused:UNUSED_PRESERVE src0_sel:WORD_1
  v_mfma_f32_16x16x32_f16 v[236:239], a[244:247], v[44:47], v[236:239]
  ds_read_b128 a[236:239], v4 offset:29696
  v_rcp_f16_sdwa v15, v15 dst_sel:WORD_1 dst_unused:UNUSED_PRESERVE src0_sel:WORD_1
  v_mfma_f32_16x16x32_f16 v[232:235], a[244:247], v[40:43], v[232:235]
  v_pk_mul_f16 v30, v8, v9
  v_pk_mul_f16 v31, v10, v11
  v_mfma_f32_16x16x32_f16 v[228:231], a[244:247], v[36:39], v[228:231]
  s_waitcnt lgkmcnt(3)
  v_pk_mul_f16 v34, v12, v13
  v_pk_mul_f16 v35, v14, v15
  v_mfma_f32_16x16x32_bf16 v[48:51], a[216:219], a[0:3], 0
  ds_read_b128 a[240:243], v4 offset:30720
  v_cvt_pk_f16_f32 v8, v72, v73
  v_cvt_pk_f16_f32 v10, v74, v75
  v_mfma_f32_16x16x32_bf16 v[52:55], a[216:219], a[24:27], 0
  v_cvt_pk_f16_f32 v12, v76, v77
  v_cvt_pk_f16_f32 v14, v78, v79
  v_mfma_f32_16x16x32_bf16 v[56:59], a[216:219], a[48:51], 0
  v_pk_fma_f16 v9, v8, v8, s34 neg_lo:[1,0,0] neg_hi:[1,0,0]
  v_pk_fma_f16 v11, v10, v10, s34 neg_lo:[1,0,0] neg_hi:[1,0,0]
  v_pk_fma_f16 v13, v12, v12, s34 neg_lo:[1,0,0] neg_hi:[1,0,0]
  v_mfma_f32_16x16x32_bf16 v[68:71], a[220:223], a[48:51], 0
  ds_read_b128 a[244:247], v4 offset:31744
  v_pk_fma_f16 v15, v14, v14, s34 neg_lo:[1,0,0] neg_hi:[1,0,0]
  v_pk_mul_f16 v9, v9, v8
  v_mfma_f32_16x16x32_bf16 v[64:67], a[220:223], a[24:27], 0
  buffer_store_dwordx4 a[204:207], v3, s[20:23], s46 offen offset:192 sc1
  v_pk_mul_f16 v11, v11, v10
  v_pk_mul_f16 v13, v13, v12
  v_mfma_f32_16x16x32_bf16 v[60:63], a[220:223], a[0:3], 0
  v_pk_mul_f16 v15, v15, v14
  v_exp_f16_sdwa v9, v9 dst_sel:WORD_0 dst_unused:UNUSED_PRESERVE src0_sel:WORD_0
  v_mfma_f32_16x16x32_bf16 v[48:51], a[224:227], a[4:7], v[48:51]
  ds_read_b128 a[216:219], v4 offset:32768
  v_exp_f16_sdwa v11, v11 dst_sel:WORD_0 dst_unused:UNUSED_PRESERVE src0_sel:WORD_0
  v_mfma_f32_16x16x32_bf16 v[52:55], a[224:227], a[28:31], v[52:55]
  v_exp_f16_sdwa v13, v13 dst_sel:WORD_0 dst_unused:UNUSED_PRESERVE src0_sel:WORD_0
  v_mfma_f32_16x16x32_bf16 v[56:59], a[224:227], a[52:55], v[56:59]
  s_waitcnt lgkmcnt(3)
  v_exp_f16_sdwa v15, v15 dst_sel:WORD_0 dst_unused:UNUSED_PRESERVE src0_sel:WORD_0
  v_mfma_f32_16x16x32_bf16 v[68:71], a[228:231], a[52:55], v[68:71]
  ds_read_b128 a[220:223], v4 offset:33792
  v_exp_f16_sdwa v9, v9 dst_sel:WORD_1 dst_unused:UNUSED_PRESERVE src0_sel:WORD_1
  v_mfma_f32_16x16x32_bf16 v[64:67], a[228:231], a[28:31], v[64:67]
  v_exp_f16_sdwa v11, v11 dst_sel:WORD_1 dst_unused:UNUSED_PRESERVE src0_sel:WORD_1
  v_mfma_f32_16x16x32_bf16 v[60:63], a[228:231], a[4:7], v[60:63]
  v_exp_f16_sdwa v13, v13 dst_sel:WORD_1 dst_unused:UNUSED_PRESERVE src0_sel:WORD_1
  v_mfma_f32_16x16x32_bf16 v[48:51], a[232:235], a[8:11], v[48:51]
  ds_read_b128 a[224:227], v4 offset:34816
  v_exp_f16_sdwa v15, v15 dst_sel:WORD_1 dst_unused:UNUSED_PRESERVE src0_sel:WORD_1
  v_mfma_f32_16x16x32_bf16 v[52:55], a[232:235], a[32:35], v[52:55]
  buffer_store_dwordx4 a[208:211], v3, s[20:23], s46 offen offset:256 sc1
  v_pk_fma_f16 v9, v9, s35, s35
  v_pk_fma_f16 v11, v11, s35, s35
  v_mfma_f32_16x16x32_bf16 v[56:59], a[232:235], a[56:59], v[56:59]
  v_pk_fma_f16 v13, v13, s35, s35
  v_pk_fma_f16 v15, v15, s35, s35
  v_mfma_f32_16x16x32_bf16 v[68:71], a[236:239], a[56:59], v[68:71]
  ds_read_b128 a[228:231], v4 offset:35840
  v_rcp_f16_sdwa v9, v9 dst_sel:WORD_0 dst_unused:UNUSED_PRESERVE src0_sel:WORD_0
  v_mfma_f32_16x16x32_bf16 v[64:67], a[236:239], a[32:35], v[64:67]
  v_rcp_f16_sdwa v11, v11 dst_sel:WORD_0 dst_unused:UNUSED_PRESERVE src0_sel:WORD_0
  v_mfma_f32_16x16x32_bf16 v[60:63], a[236:239], a[8:11], v[60:63]
  s_waitcnt lgkmcnt(3)
  v_rcp_f16_sdwa v13, v13 dst_sel:WORD_0 dst_unused:UNUSED_PRESERVE src0_sel:WORD_0
  v_rcp_f16_sdwa v15, v15 dst_sel:WORD_0 dst_unused:UNUSED_PRESERVE src0_sel:WORD_0
  v_mfma_f32_16x16x32_bf16 v[48:51], a[240:243], a[12:15], v[48:51]
  ds_read_b128 a[232:235], v4 offset:36864
  v_rcp_f16_sdwa v9, v9 dst_sel:WORD_1 dst_unused:UNUSED_PRESERVE src0_sel:WORD_1
  v_mfma_f32_16x16x32_bf16 v[52:55], a[240:243], a[36:39], v[52:55]
  v_rcp_f16_sdwa v11, v11 dst_sel:WORD_1 dst_unused:UNUSED_PRESERVE src0_sel:WORD_1
  v_mfma_f32_16x16x32_bf16 v[56:59], a[240:243], a[60:63], v[56:59]
  v_rcp_f16_sdwa v13, v13 dst_sel:WORD_1 dst_unused:UNUSED_PRESERVE src0_sel:WORD_1
  v_mfma_f32_16x16x32_bf16 v[68:71], a[244:247], a[60:63], v[68:71]
  ds_read_b128 a[236:239], v4 offset:37888
  v_rcp_f16_sdwa v15, v15 dst_sel:WORD_1 dst_unused:UNUSED_PRESERVE src0_sel:WORD_1
  v_mfma_f32_16x16x32_bf16 v[64:67], a[244:247], a[36:39], v[64:67]
  buffer_store_dwordx4 a[212:215], v3, s[20:23], s46 offen offset:320 sc1
  v_pk_mul_f16 v36, v8, v9
  v_pk_mul_f16 v37, v10, v11
  v_mfma_f32_16x16x32_bf16 v[60:63], a[244:247], a[12:15], v[60:63]
  v_pk_mul_f16 v40, v12, v13
  v_pk_mul_f16 v41, v14, v15
  v_mfma_f32_16x16x32_bf16 v[48:51], a[216:219], a[16:19], v[48:51]
  ds_read_b128 a[240:243], v4 offset:38912
  v_cvt_pk_f16_f32 v16, v80, v81
  v_cvt_pk_f16_f32 v18, v82, v83
  v_mfma_f32_16x16x32_bf16 v[52:55], a[216:219], a[40:43], v[52:55]
  v_cvt_pk_f16_f32 v20, v84, v85
  v_cvt_pk_f16_f32 v22, v86, v87
  v_mfma_f32_16x16x32_bf16 v[56:59], a[216:219], a[64:67], v[56:59]
  s_waitcnt lgkmcnt(3)
  v_pk_fma_f16 v17, v16, v16, s34 neg_lo:[1,0,0] neg_hi:[1,0,0]
  v_pk_fma_f16 v19, v18, v18, s34 neg_lo:[1,0,0] neg_hi:[1,0,0]
  v_pk_fma_f16 v21, v20, v20, s34 neg_lo:[1,0,0] neg_hi:[1,0,0]
  v_mfma_f32_16x16x32_bf16 v[68:71], a[220:223], a[64:67], v[68:71]
  ds_read_b128 a[244:247], v4 offset:39936
  v_pk_fma_f16 v23, v22, v22, s34 neg_lo:[1,0,0] neg_hi:[1,0,0]
  v_pk_mul_f16 v17, v17, v16
  v_mfma_f32_16x16x32_bf16 v[64:67], a[220:223], a[40:43], v[64:67]
  v_pk_mul_f16 v19, v19, v18
  v_pk_mul_f16 v21, v21, v20
  v_mfma_f32_16x16x32_bf16 v[60:63], a[220:223], a[16:19], v[60:63]
  v_pk_mul_f16 v23, v23, v22
  v_exp_f16_sdwa v17, v17 dst_sel:WORD_0 dst_unused:UNUSED_PRESERVE src0_sel:WORD_0
  v_mfma_f32_16x16x32_bf16 v[48:51], a[224:227], a[20:23], v[48:51]
  ds_read_b128 a[216:219], v4 offset:40960
  v_exp_f16_sdwa v19, v19 dst_sel:WORD_0 dst_unused:UNUSED_PRESERVE src0_sel:WORD_0
  v_mfma_f32_16x16x32_bf16 v[52:55], a[224:227], a[44:47], v[52:55]
  v_exp_f16_sdwa v21, v21 dst_sel:WORD_0 dst_unused:UNUSED_PRESERVE src0_sel:WORD_0
  v_mfma_f32_16x16x32_bf16 v[56:59], a[224:227], a[68:71], v[56:59]
  v_exp_f16_sdwa v23, v23 dst_sel:WORD_0 dst_unused:UNUSED_PRESERVE src0_sel:WORD_0
  v_mfma_f32_16x16x32_bf16 v[68:71], a[228:231], a[68:71], v[68:71]
  ds_read_b128 a[220:223], v4 offset:41984
  v_exp_f16_sdwa v17, v17 dst_sel:WORD_1 dst_unused:UNUSED_PRESERVE src0_sel:WORD_1
  v_mfma_f32_16x16x32_bf16 v[64:67], a[228:231], a[44:47], v[64:67]
  v_exp_f16_sdwa v19, v19 dst_sel:WORD_1 dst_unused:UNUSED_PRESERVE src0_sel:WORD_1
  v_mfma_f32_16x16x32_bf16 v[60:63], a[228:231], a[20:23], v[60:63]
  s_waitcnt lgkmcnt(3)
  v_exp_f16_sdwa v21, v21 dst_sel:WORD_1 dst_unused:UNUSED_PRESERVE src0_sel:WORD_1
  v_mfma_f32_16x16x32_f16 v[96:99], a[232:235], v[24:27], v[96:99]
  ds_read_b128 a[224:227], v4 offset:43008
  v_exp_f16_sdwa v23, v23 dst_sel:WORD_1 dst_unused:UNUSED_PRESERVE src0_sel:WORD_1
  v_mfma_f32_16x16x32_f16 v[100:103], a[232:235], v[28:31], v[100:103]
  v_pk_fma_f16 v17, v17, s35, s35
  v_pk_fma_f16 v19, v19, s35, s35
  v_mfma_f32_16x16x32_f16 v[104:107], a[232:235], v[32:35], v[104:107]
  v_pk_fma_f16 v21, v21, s35, s35
  v_pk_fma_f16 v23, v23, s35, s35
  v_mfma_f32_16x16x32_f16 v[116:119], a[236:239], v[32:35], v[116:119]
  ds_read_b128 a[228:231], v4 offset:44032
  v_rcp_f16_sdwa v17, v17 dst_sel:WORD_0 dst_unused:UNUSED_PRESERVE src0_sel:WORD_0
  v_mfma_f32_16x16x32_f16 v[112:115], a[236:239], v[28:31], v[112:115]
  v_rcp_f16_sdwa v19, v19 dst_sel:WORD_0 dst_unused:UNUSED_PRESERVE src0_sel:WORD_0
  v_mfma_f32_16x16x32_f16 v[108:111], a[236:239], v[24:27], v[108:111]
  v_rcp_f16_sdwa v21, v21 dst_sel:WORD_0 dst_unused:UNUSED_PRESERVE src0_sel:WORD_0
  v_rcp_f16_sdwa v23, v23 dst_sel:WORD_0 dst_unused:UNUSED_PRESERVE src0_sel:WORD_0
  v_mfma_f32_16x16x32_f16 v[120:123], a[240:243], v[24:27], v[120:123]
  ds_read_b128 a[232:235], v4 offset:45056
  v_rcp_f16_sdwa v17, v17 dst_sel:WORD_1 dst_unused:UNUSED_PRESERVE src0_sel:WORD_1
  v_mfma_f32_16x16x32_f16 v[124:127], a[240:243], v[28:31], v[124:127]
  v_rcp_f16_sdwa v19, v19 dst_sel:WORD_1 dst_unused:UNUSED_PRESERVE src0_sel:WORD_1
  v_mfma_f32_16x16x32_f16 v[128:131], a[240:243], v[32:35], v[128:131]
  s_waitcnt lgkmcnt(3)
  v_rcp_f16_sdwa v21, v21 dst_sel:WORD_1 dst_unused:UNUSED_PRESERVE src0_sel:WORD_1
  v_mfma_f32_16x16x32_f16 v[140:143], a[244:247], v[32:35], v[140:143]
  ds_read_b128 a[236:239], v4 offset:46080
  v_rcp_f16_sdwa v23, v23 dst_sel:WORD_1 dst_unused:UNUSED_PRESERVE src0_sel:WORD_1
  v_mfma_f32_16x16x32_f16 v[136:139], a[244:247], v[28:31], v[136:139]
  v_pk_mul_f16 v44, v16, v17
  v_pk_mul_f16 v45, v18, v19
  v_mfma_f32_16x16x32_f16 v[132:135], a[244:247], v[24:27], v[132:135]
  v_pk_mul_f16 v38, v20, v21
  v_pk_mul_f16 v39, v22, v23
  v_mfma_f32_16x16x32_f16 v[144:147], a[216:219], v[24:27], v[144:147]
  ds_read_b128 a[240:243], v4 offset:47104
  ds_read_b128 a[244:247], v4 offset:48128
  v_cvt_pk_f16_f32 v8, v88, v89
  v_cvt_pk_f16_f32 v10, v90, v91
  v_mfma_f32_16x16x32_f16 v[148:151], a[216:219], v[28:31], v[148:151]
  v_cvt_pk_f16_f32 v12, v92, v93
  v_cvt_pk_f16_f32 v14, v94, v95
  v_mfma_f32_16x16x32_f16 v[152:155], a[216:219], v[32:35], v[152:155]
  v_pk_fma_f16 v9, v8, v8, s34 neg_lo:[1,0,0] neg_hi:[1,0,0]
  v_pk_fma_f16 v11, v10, v10, s34 neg_lo:[1,0,0] neg_hi:[1,0,0]
  v_pk_fma_f16 v13, v12, v12, s34 neg_lo:[1,0,0] neg_hi:[1,0,0]
  v_mfma_f32_16x16x32_f16 v[164:167], a[220:223], v[32:35], v[164:167]
  v_pk_fma_f16 v15, v14, v14, s34 neg_lo:[1,0,0] neg_hi:[1,0,0]
  v_pk_mul_f16 v9, v9, v8
  v_mfma_f32_16x16x32_f16 v[160:163], a[220:223], v[28:31], v[160:163]
  v_pk_mul_f16 v11, v11, v10
  v_pk_mul_f16 v13, v13, v12
  v_mfma_f32_16x16x32_f16 v[156:159], a[220:223], v[24:27], v[156:159]
  s_waitcnt lgkmcnt(3)
  v_pk_mul_f16 v15, v15, v14
  v_exp_f16_sdwa v9, v9 dst_sel:WORD_0 dst_unused:UNUSED_PRESERVE src0_sel:WORD_0
  v_mfma_f32_16x16x32_f16 v[168:171], a[224:227], v[24:27], v[168:171]
  s_waitcnt lgkmcnt(0)
  s_waitcnt vmcnt(3)
  s_barrier
  ds_read_b128 a[216:219], v1 offset:0
  v_exp_f16_sdwa v11, v11 dst_sel:WORD_0 dst_unused:UNUSED_PRESERVE src0_sel:WORD_0
  v_mfma_f32_16x16x32_f16 v[172:175], a[224:227], v[28:31], v[172:175]
  v_exp_f16_sdwa v13, v13 dst_sel:WORD_0 dst_unused:UNUSED_PRESERVE src0_sel:WORD_0
  v_mfma_f32_16x16x32_f16 v[176:179], a[224:227], v[32:35], v[176:179]
  v_exp_f16_sdwa v15, v15 dst_sel:WORD_0 dst_unused:UNUSED_PRESERVE src0_sel:WORD_0
  v_mfma_f32_16x16x32_f16 v[188:191], a[228:231], v[32:35], v[188:191]
  ds_read_b128 a[220:223], v1 offset:1024
  v_exp_f16_sdwa v9, v9 dst_sel:WORD_1 dst_unused:UNUSED_PRESERVE src0_sel:WORD_1
  v_mfma_f32_16x16x32_f16 v[184:187], a[228:231], v[28:31], v[184:187]
  v_exp_f16_sdwa v11, v11 dst_sel:WORD_1 dst_unused:UNUSED_PRESERVE src0_sel:WORD_1
  v_mfma_f32_16x16x32_f16 v[180:183], a[228:231], v[24:27], v[180:183]
  v_exp_f16_sdwa v13, v13 dst_sel:WORD_1 dst_unused:UNUSED_PRESERVE src0_sel:WORD_1
  v_mfma_f32_16x16x32_f16 v[192:195], a[232:235], v[24:27], v[192:195]
  ds_read_b128 a[224:227], v1 offset:2048
  v_exp_f16_sdwa v15, v15 dst_sel:WORD_1 dst_unused:UNUSED_PRESERVE src0_sel:WORD_1
  v_mfma_f32_16x16x32_f16 v[196:199], a[232:235], v[28:31], v[196:199]
  v_pk_fma_f16 v9, v9, s35, s35
  v_pk_fma_f16 v11, v11, s35, s35
  v_mfma_f32_16x16x32_f16 v[200:203], a[232:235], v[32:35], v[200:203]
  v_pk_fma_f16 v13, v13, s35, s35
  v_pk_fma_f16 v15, v15, s35, s35
  v_mfma_f32_16x16x32_f16 v[212:215], a[236:239], v[32:35], v[212:215]
  ds_read_b128 a[228:231], v1 offset:3072
  v_rcp_f16_sdwa v9, v9 dst_sel:WORD_0 dst_unused:UNUSED_PRESERVE src0_sel:WORD_0
  v_mfma_f32_16x16x32_f16 v[208:211], a[236:239], v[28:31], v[208:211]
  v_rcp_f16_sdwa v11, v11 dst_sel:WORD_0 dst_unused:UNUSED_PRESERVE src0_sel:WORD_0
  v_mfma_f32_16x16x32_f16 v[204:207], a[236:239], v[24:27], v[204:207]
  v_rcp_f16_sdwa v13, v13 dst_sel:WORD_0 dst_unused:UNUSED_PRESERVE src0_sel:WORD_0
  v_rcp_f16_sdwa v15, v15 dst_sel:WORD_0 dst_unused:UNUSED_PRESERVE src0_sel:WORD_0
  v_mfma_f32_16x16x32_f16 v[216:219], a[240:243], v[24:27], v[216:219]
  ds_read_b128 a[232:235], v1 offset:4096
  v_rcp_f16_sdwa v9, v9 dst_sel:WORD_1 dst_unused:UNUSED_PRESERVE src0_sel:WORD_1
  v_mfma_f32_16x16x32_f16 v[220:223], a[240:243], v[28:31], v[220:223]
  v_rcp_f16_sdwa v11, v11 dst_sel:WORD_1 dst_unused:UNUSED_PRESERVE src0_sel:WORD_1
  v_mfma_f32_16x16x32_f16 v[224:227], a[240:243], v[32:35], v[224:227]
  v_rcp_f16_sdwa v13, v13 dst_sel:WORD_1 dst_unused:UNUSED_PRESERVE src0_sel:WORD_1
  v_mfma_f32_16x16x32_f16 v[236:239], a[244:247], v[32:35], v[236:239]
  ds_read_b128 a[236:239], v1 offset:5120
  v_rcp_f16_sdwa v15, v15 dst_sel:WORD_1 dst_unused:UNUSED_PRESERVE src0_sel:WORD_1
  v_mfma_f32_16x16x32_f16 v[232:235], a[244:247], v[28:31], v[232:235]
  v_pk_mul_f16 v42, v8, v9
  v_pk_mul_f16 v43, v10, v11
  v_mfma_f32_16x16x32_f16 v[228:231], a[244:247], v[24:27], v[228:231]
  s_waitcnt lgkmcnt(3)
  v_pk_mul_f16 v46, v12, v13
  v_pk_mul_f16 v47, v14, v15
  v_mfma_f32_16x16x32_bf16 v[72:75], a[216:219], a[0:3], 0
  ds_read_b128 a[240:243], v1 offset:6144
  s_add_u32 m0, s29, 49152
  s_add_u32 s31, s29, 344064
  buffer_load_dwordx4 v2, s[8:11], s31 offen offset:0 lds
  v_cvt_pk_f16_f32 v8, v48, v49
  v_cvt_pk_f16_f32 v10, v50, v51
  v_mfma_f32_16x16x32_bf16 v[76:79], a[216:219], a[24:27], 0
  v_cvt_pk_f16_f32 v12, v52, v53
  v_cvt_pk_f16_f32 v14, v54, v55
  v_mfma_f32_16x16x32_bf16 v[80:83], a[216:219], a[48:51], 0
  v_pk_fma_f16 v9, v8, v8, s34 neg_lo:[1,0,0] neg_hi:[1,0,0]
  v_pk_fma_f16 v11, v10, v10, s34 neg_lo:[1,0,0] neg_hi:[1,0,0]
  v_pk_fma_f16 v13, v12, v12, s34 neg_lo:[1,0,0] neg_hi:[1,0,0]
  v_mfma_f32_16x16x32_bf16 v[92:95], a[220:223], a[48:51], 0
  ds_read_b128 a[244:247], v1 offset:7168
  buffer_load_dwordx4 v2, s[8:11], s31 offen offset:1024 lds
  v_pk_fma_f16 v15, v14, v14, s34 neg_lo:[1,0,0] neg_hi:[1,0,0]
  v_pk_mul_f16 v9, v9, v8
  v_mfma_f32_16x16x32_bf16 v[88:91], a[220:223], a[24:27], 0
  v_pk_mul_f16 v11, v11, v10
  v_pk_mul_f16 v13, v13, v12
  v_mfma_f32_16x16x32_bf16 v[84:87], a[220:223], a[0:3], 0
  v_pk_mul_f16 v15, v15, v14
  v_exp_f16_sdwa v9, v9 dst_sel:WORD_0 dst_unused:UNUSED_PRESERVE src0_sel:WORD_0
  v_mfma_f32_16x16x32_bf16 v[72:75], a[224:227], a[4:7], v[72:75]
  ds_read_b128 a[216:219], v1 offset:8192
  buffer_load_dwordx4 v2, s[8:11], s31 offen offset:2048 lds
  v_exp_f16_sdwa v11, v11 dst_sel:WORD_0 dst_unused:UNUSED_PRESERVE src0_sel:WORD_0
  v_mfma_f32_16x16x32_bf16 v[76:79], a[224:227], a[28:31], v[76:79]
  v_exp_f16_sdwa v13, v13 dst_sel:WORD_0 dst_unused:UNUSED_PRESERVE src0_sel:WORD_0
  v_mfma_f32_16x16x32_bf16 v[80:83], a[224:227], a[52:55], v[80:83]
  s_waitcnt lgkmcnt(3)
  v_exp_f16_sdwa v15, v15 dst_sel:WORD_0 dst_unused:UNUSED_PRESERVE src0_sel:WORD_0
  v_mfma_f32_16x16x32_bf16 v[92:95], a[228:231], a[52:55], v[92:95]
  ds_read_b128 a[220:223], v1 offset:9216
  buffer_load_dwordx4 v2, s[8:11], s31 offen offset:3072 lds
  v_exp_f16_sdwa v9, v9 dst_sel:WORD_1 dst_unused:UNUSED_PRESERVE src0_sel:WORD_1
  v_mfma_f32_16x16x32_bf16 v[88:91], a[228:231], a[28:31], v[88:91]
  s_add_u32 m0, s29, 53248
  v_exp_f16_sdwa v11, v11 dst_sel:WORD_1 dst_unused:UNUSED_PRESERVE src0_sel:WORD_1
  v_mfma_f32_16x16x32_bf16 v[84:87], a[228:231], a[4:7], v[84:87]
  s_add_u32 s31, s29, 348160
  v_exp_f16_sdwa v13, v13 dst_sel:WORD_1 dst_unused:UNUSED_PRESERVE src0_sel:WORD_1
  v_mfma_f32_16x16x32_bf16 v[72:75], a[232:235], a[8:11], v[72:75]
  ds_read_b128 a[224:227], v1 offset:10240
  buffer_load_dwordx4 v2, s[8:11], s31 offen offset:0 lds
  v_exp_f16_sdwa v15, v15 dst_sel:WORD_1 dst_unused:UNUSED_PRESERVE src0_sel:WORD_1
  v_mfma_f32_16x16x32_bf16 v[76:79], a[232:235], a[32:35], v[76:79]
  v_pk_fma_f16 v9, v9, s35, s35
  v_pk_fma_f16 v11, v11, s35, s35
  v_mfma_f32_16x16x32_bf16 v[80:83], a[232:235], a[56:59], v[80:83]
  v_pk_fma_f16 v13, v13, s35, s35
  v_pk_fma_f16 v15, v15, s35, s35
  v_mfma_f32_16x16x32_bf16 v[92:95], a[236:239], a[56:59], v[92:95]
  ds_read_b128 a[228:231], v1 offset:11264
  buffer_load_dwordx4 v2, s[8:11], s31 offen offset:1024 lds
  v_rcp_f16_sdwa v9, v9 dst_sel:WORD_0 dst_unused:UNUSED_PRESERVE src0_sel:WORD_0
  v_mfma_f32_16x16x32_bf16 v[88:91], a[236:239], a[32:35], v[88:91]
  v_rcp_f16_sdwa v11, v11 dst_sel:WORD_0 dst_unused:UNUSED_PRESERVE src0_sel:WORD_0
  v_mfma_f32_16x16x32_bf16 v[84:87], a[236:239], a[8:11], v[84:87]
  s_waitcnt lgkmcnt(3)
  v_rcp_f16_sdwa v13, v13 dst_sel:WORD_0 dst_unused:UNUSED_PRESERVE src0_sel:WORD_0
  v_rcp_f16_sdwa v15, v15 dst_sel:WORD_0 dst_unused:UNUSED_PRESERVE src0_sel:WORD_0
  v_mfma_f32_16x16x32_bf16 v[72:75], a[240:243], a[12:15], v[72:75]
  ds_read_b128 a[232:235], v1 offset:12288
  buffer_load_dwordx4 v2, s[8:11], s31 offen offset:2048 lds
  v_rcp_f16_sdwa v9, v9 dst_sel:WORD_1 dst_unused:UNUSED_PRESERVE src0_sel:WORD_1
  v_mfma_f32_16x16x32_bf16 v[76:79], a[240:243], a[36:39], v[76:79]
  v_rcp_f16_sdwa v11, v11 dst_sel:WORD_1 dst_unused:UNUSED_PRESERVE src0_sel:WORD_1
  v_mfma_f32_16x16x32_bf16 v[80:83], a[240:243], a[60:63], v[80:83]
  v_rcp_f16_sdwa v13, v13 dst_sel:WORD_1 dst_unused:UNUSED_PRESERVE src0_sel:WORD_1
  v_mfma_f32_16x16x32_bf16 v[92:95], a[244:247], a[60:63], v[92:95]
  ds_read_b128 a[236:239], v1 offset:13312
  buffer_load_dwordx4 v2, s[8:11], s31 offen offset:3072 lds
  v_rcp_f16_sdwa v15, v15 dst_sel:WORD_1 dst_unused:UNUSED_PRESERVE src0_sel:WORD_1
  v_mfma_f32_16x16x32_bf16 v[88:91], a[244:247], a[36:39], v[88:91]
  s_add_u32 m0, s29, 57344
  v_pk_mul_f16 v24, v8, v9
  v_pk_mul_f16 v25, v10, v11
  v_mfma_f32_16x16x32_bf16 v[84:87], a[244:247], a[12:15], v[84:87]
  s_add_u32 s31, s29, 352256
  v_pk_mul_f16 v28, v12, v13
  v_pk_mul_f16 v29, v14, v15
  v_mfma_f32_16x16x32_bf16 v[72:75], a[216:219], a[16:19], v[72:75]
  ds_read_b128 a[240:243], v1 offset:14336
  buffer_load_dwordx4 v2, s[8:11], s31 offen offset:0 lds
  v_cvt_pk_f16_f32 v16, v56, v57
  v_cvt_pk_f16_f32 v18, v58, v59
  v_mfma_f32_16x16x32_bf16 v[76:79], a[216:219], a[40:43], v[76:79]
  v_cvt_pk_f16_f32 v20, v60, v61
  v_cvt_pk_f16_f32 v22, v62, v63
  v_mfma_f32_16x16x32_bf16 v[80:83], a[216:219], a[64:67], v[80:83]
  s_waitcnt lgkmcnt(3)
  v_pk_fma_f16 v17, v16, v16, s34 neg_lo:[1,0,0] neg_hi:[1,0,0]
  v_pk_fma_f16 v19, v18, v18, s34 neg_lo:[1,0,0] neg_hi:[1,0,0]
  v_pk_fma_f16 v21, v20, v20, s34 neg_lo:[1,0,0] neg_hi:[1,0,0]
  v_mfma_f32_16x16x32_bf16 v[92:95], a[220:223], a[64:67], v[92:95]
  ds_read_b128 a[244:247], v1 offset:15360
  buffer_load_dwordx4 v2, s[8:11], s31 offen offset:1024 lds
  v_pk_fma_f16 v23, v22, v22, s34 neg_lo:[1,0,0] neg_hi:[1,0,0]
  v_pk_mul_f16 v17, v17, v16
  v_mfma_f32_16x16x32_bf16 v[88:91], a[220:223], a[40:43], v[88:91]
  v_pk_mul_f16 v19, v19, v18
  v_pk_mul_f16 v21, v21, v20
  v_mfma_f32_16x16x32_bf16 v[84:87], a[220:223], a[16:19], v[84:87]
  v_pk_mul_f16 v23, v23, v22
  v_exp_f16_sdwa v17, v17 dst_sel:WORD_0 dst_unused:UNUSED_PRESERVE src0_sel:WORD_0
  v_mfma_f32_16x16x32_bf16 v[72:75], a[224:227], a[20:23], v[72:75]
  ds_read_b128 a[216:219], v1 offset:16384
  buffer_load_dwordx4 v2, s[8:11], s31 offen offset:2048 lds
  v_exp_f16_sdwa v19, v19 dst_sel:WORD_0 dst_unused:UNUSED_PRESERVE src0_sel:WORD_0
  v_mfma_f32_16x16x32_bf16 v[76:79], a[224:227], a[44:47], v[76:79]
  v_exp_f16_sdwa v21, v21 dst_sel:WORD_0 dst_unused:UNUSED_PRESERVE src0_sel:WORD_0
  v_mfma_f32_16x16x32_bf16 v[80:83], a[224:227], a[68:71], v[80:83]
  v_exp_f16_sdwa v23, v23 dst_sel:WORD_0 dst_unused:UNUSED_PRESERVE src0_sel:WORD_0
  v_mfma_f32_16x16x32_bf16 v[92:95], a[228:231], a[68:71], v[92:95]
  ds_read_b128 a[220:223], v1 offset:17408
  buffer_load_dwordx4 v2, s[8:11], s31 offen offset:3072 lds
  v_exp_f16_sdwa v17, v17 dst_sel:WORD_1 dst_unused:UNUSED_PRESERVE src0_sel:WORD_1
  v_mfma_f32_16x16x32_bf16 v[88:91], a[228:231], a[44:47], v[88:91]
  v_exp_f16_sdwa v19, v19 dst_sel:WORD_1 dst_unused:UNUSED_PRESERVE src0_sel:WORD_1
  v_mfma_f32_16x16x32_bf16 v[84:87], a[228:231], a[20:23], v[84:87]
  s_waitcnt lgkmcnt(3)
  v_exp_f16_sdwa v21, v21 dst_sel:WORD_1 dst_unused:UNUSED_PRESERVE src0_sel:WORD_1
  v_mfma_f32_16x16x32_f16 v[96:99], a[232:235], v[36:39], v[96:99]
  ds_read_b128 a[224:227], v1 offset:18432
  v_exp_f16_sdwa v23, v23 dst_sel:WORD_1 dst_unused:UNUSED_PRESERVE src0_sel:WORD_1
  v_mfma_f32_16x16x32_f16 v[100:103], a[232:235], v[40:43], v[100:103]
  v_pk_fma_f16 v17, v17, s35, s35
  v_pk_fma_f16 v19, v19, s35, s35
  v_mfma_f32_16x16x32_f16 v[104:107], a[232:235], v[44:47], v[104:107]
  v_pk_fma_f16 v21, v21, s35, s35
  v_pk_fma_f16 v23, v23, s35, s35
  v_mfma_f32_16x16x32_f16 v[116:119], a[236:239], v[44:47], v[116:119]
  ds_read_b128 a[228:231], v1 offset:19456
  v_rcp_f16_sdwa v17, v17 dst_sel:WORD_0 dst_unused:UNUSED_PRESERVE src0_sel:WORD_0
  v_mfma_f32_16x16x32_f16 v[112:115], a[236:239], v[40:43], v[112:115]
  v_rcp_f16_sdwa v19, v19 dst_sel:WORD_0 dst_unused:UNUSED_PRESERVE src0_sel:WORD_0
  v_mfma_f32_16x16x32_f16 v[108:111], a[236:239], v[36:39], v[108:111]
  v_rcp_f16_sdwa v21, v21 dst_sel:WORD_0 dst_unused:UNUSED_PRESERVE src0_sel:WORD_0
  v_rcp_f16_sdwa v23, v23 dst_sel:WORD_0 dst_unused:UNUSED_PRESERVE src0_sel:WORD_0
  v_mfma_f32_16x16x32_f16 v[120:123], a[240:243], v[36:39], v[120:123]
  ds_read_b128 a[232:235], v1 offset:20480
  v_rcp_f16_sdwa v17, v17 dst_sel:WORD_1 dst_unused:UNUSED_PRESERVE src0_sel:WORD_1
  v_mfma_f32_16x16x32_f16 v[124:127], a[240:243], v[40:43], v[124:127]
  v_rcp_f16_sdwa v19, v19 dst_sel:WORD_1 dst_unused:UNUSED_PRESERVE src0_sel:WORD_1
  v_mfma_f32_16x16x32_f16 v[128:131], a[240:243], v[44:47], v[128:131]
  s_waitcnt lgkmcnt(3)
  v_rcp_f16_sdwa v21, v21 dst_sel:WORD_1 dst_unused:UNUSED_PRESERVE src0_sel:WORD_1
  v_mfma_f32_16x16x32_f16 v[140:143], a[244:247], v[44:47], v[140:143]
  ds_read_b128 a[236:239], v1 offset:21504
  v_rcp_f16_sdwa v23, v23 dst_sel:WORD_1 dst_unused:UNUSED_PRESERVE src0_sel:WORD_1
  v_mfma_f32_16x16x32_f16 v[136:139], a[244:247], v[40:43], v[136:139]
  v_pk_mul_f16 v32, v16, v17
  v_pk_mul_f16 v33, v18, v19
  v_mfma_f32_16x16x32_f16 v[132:135], a[244:247], v[36:39], v[132:135]
  v_pk_mul_f16 v26, v20, v21
  v_pk_mul_f16 v27, v22, v23
  v_mfma_f32_16x16x32_f16 v[144:147], a[216:219], v[36:39], v[144:147]
  ds_read_b128 a[240:243], v1 offset:22528
  v_cvt_pk_f16_f32 v8, v64, v65
  v_cvt_pk_f16_f32 v10, v66, v67
  v_mfma_f32_16x16x32_f16 v[148:151], a[216:219], v[40:43], v[148:151]
  v_cvt_pk_f16_f32 v12, v68, v69
  v_cvt_pk_f16_f32 v14, v70, v71
  v_mfma_f32_16x16x32_f16 v[152:155], a[216:219], v[44:47], v[152:155]
  v_pk_fma_f16 v9, v8, v8, s34 neg_lo:[1,0,0] neg_hi:[1,0,0]
  v_pk_fma_f16 v11, v10, v10, s34 neg_lo:[1,0,0] neg_hi:[1,0,0]
  v_pk_fma_f16 v13, v12, v12, s34 neg_lo:[1,0,0] neg_hi:[1,0,0]
  v_mfma_f32_16x16x32_f16 v[164:167], a[220:223], v[44:47], v[164:167]
  ds_read_b128 a[244:247], v1 offset:23552
  v_pk_fma_f16 v15, v14, v14, s34 neg_lo:[1,0,0] neg_hi:[1,0,0]
  v_pk_mul_f16 v9, v9, v8
  v_mfma_f32_16x16x32_f16 v[160:163], a[220:223], v[40:43], v[160:163]
  v_pk_mul_f16 v11, v11, v10
  v_pk_mul_f16 v13, v13, v12
  v_mfma_f32_16x16x32_f16 v[156:159], a[220:223], v[36:39], v[156:159]
  s_waitcnt lgkmcnt(3)
  v_pk_mul_f16 v15, v15, v14
  v_exp_f16_sdwa v9, v9 dst_sel:WORD_0 dst_unused:UNUSED_PRESERVE src0_sel:WORD_0
  v_mfma_f32_16x16x32_f16 v[168:171], a[224:227], v[36:39], v[168:171]
  ds_read_b128 a[216:219], v1 offset:24576
  v_exp_f16_sdwa v11, v11 dst_sel:WORD_0 dst_unused:UNUSED_PRESERVE src0_sel:WORD_0
  v_mfma_f32_16x16x32_f16 v[172:175], a[224:227], v[40:43], v[172:175]
  v_exp_f16_sdwa v13, v13 dst_sel:WORD_0 dst_unused:UNUSED_PRESERVE src0_sel:WORD_0
  v_mfma_f32_16x16x32_f16 v[176:179], a[224:227], v[44:47], v[176:179]
  v_exp_f16_sdwa v15, v15 dst_sel:WORD_0 dst_unused:UNUSED_PRESERVE src0_sel:WORD_0
  v_mfma_f32_16x16x32_f16 v[188:191], a[228:231], v[44:47], v[188:191]
  ds_read_b128 a[220:223], v1 offset:25600
  v_exp_f16_sdwa v9, v9 dst_sel:WORD_1 dst_unused:UNUSED_PRESERVE src0_sel:WORD_1
  v_mfma_f32_16x16x32_f16 v[184:187], a[228:231], v[40:43], v[184:187]
  v_exp_f16_sdwa v11, v11 dst_sel:WORD_1 dst_unused:UNUSED_PRESERVE src0_sel:WORD_1
  v_mfma_f32_16x16x32_f16 v[180:183], a[228:231], v[36:39], v[180:183]
  v_exp_f16_sdwa v13, v13 dst_sel:WORD_1 dst_unused:UNUSED_PRESERVE src0_sel:WORD_1
  v_mfma_f32_16x16x32_f16 v[192:195], a[232:235], v[36:39], v[192:195]
  ds_read_b128 a[224:227], v1 offset:26624
  v_exp_f16_sdwa v15, v15 dst_sel:WORD_1 dst_unused:UNUSED_PRESERVE src0_sel:WORD_1
  v_mfma_f32_16x16x32_f16 v[196:199], a[232:235], v[40:43], v[196:199]
  v_pk_fma_f16 v9, v9, s35, s35
  v_pk_fma_f16 v11, v11, s35, s35
  v_mfma_f32_16x16x32_f16 v[200:203], a[232:235], v[44:47], v[200:203]
  s_waitcnt lgkmcnt(3)
  v_pk_fma_f16 v13, v13, s35, s35
  v_pk_fma_f16 v15, v15, s35, s35
  v_mfma_f32_16x16x32_f16 v[212:215], a[236:239], v[44:47], v[212:215]
  ds_read_b128 a[228:231], v1 offset:27648
  v_rcp_f16_sdwa v9, v9 dst_sel:WORD_0 dst_unused:UNUSED_PRESERVE src0_sel:WORD_0
  v_mfma_f32_16x16x32_f16 v[208:211], a[236:239], v[40:43], v[208:211]
  v_rcp_f16_sdwa v11, v11 dst_sel:WORD_0 dst_unused:UNUSED_PRESERVE src0_sel:WORD_0
  v_mfma_f32_16x16x32_f16 v[204:207], a[236:239], v[36:39], v[204:207]
  v_rcp_f16_sdwa v13, v13 dst_sel:WORD_0 dst_unused:UNUSED_PRESERVE src0_sel:WORD_0
  v_rcp_f16_sdwa v15, v15 dst_sel:WORD_0 dst_unused:UNUSED_PRESERVE src0_sel:WORD_0
  v_mfma_f32_16x16x32_f16 v[216:219], a[240:243], v[36:39], v[216:219]
  ds_read_b128 a[232:235], v1 offset:28672
  v_rcp_f16_sdwa v9, v9 dst_sel:WORD_1 dst_unused:UNUSED_PRESERVE src0_sel:WORD_1
  v_mfma_f32_16x16x32_f16 v[220:223], a[240:243], v[40:43], v[220:223]
  v_rcp_f16_sdwa v11, v11 dst_sel:WORD_1 dst_unused:UNUSED_PRESERVE src0_sel:WORD_1
  v_mfma_f32_16x16x32_f16 v[224:227], a[240:243], v[44:47], v[224:227]
  v_rcp_f16_sdwa v13, v13 dst_sel:WORD_1 dst_unused:UNUSED_PRESERVE src0_sel:WORD_1
  v_mfma_f32_16x16x32_f16 v[236:239], a[244:247], v[44:47], v[236:239]
  ds_read_b128 a[236:239], v1 offset:29696
  v_rcp_f16_sdwa v15, v15 dst_sel:WORD_1 dst_unused:UNUSED_PRESERVE src0_sel:WORD_1
  v_mfma_f32_16x16x32_f16 v[232:235], a[244:247], v[40:43], v[232:235]
  v_pk_mul_f16 v30, v8, v9
  v_pk_mul_f16 v31, v10, v11
  v_mfma_f32_16x16x32_f16 v[228:231], a[244:247], v[36:39], v[228:231]
  s_waitcnt lgkmcnt(3)
  v_pk_mul_f16 v34, v12, v13
  v_pk_mul_f16 v35, v14, v15
  v_mfma_f32_16x16x32_bf16 v[48:51], a[216:219], a[0:3], 0
  ds_read_b128 a[240:243], v1 offset:30720
  v_cvt_pk_f16_f32 v8, v72, v73
  v_cvt_pk_f16_f32 v10, v74, v75
  v_mfma_f32_16x16x32_bf16 v[52:55], a[216:219], a[24:27], 0
  v_cvt_pk_f16_f32 v12, v76, v77
  v_cvt_pk_f16_f32 v14, v78, v79
  v_mfma_f32_16x16x32_bf16 v[56:59], a[216:219], a[48:51], 0
  v_pk_fma_f16 v9, v8, v8, s34 neg_lo:[1,0,0] neg_hi:[1,0,0]
  v_pk_fma_f16 v11, v10, v10, s34 neg_lo:[1,0,0] neg_hi:[1,0,0]
  v_pk_fma_f16 v13, v12, v12, s34 neg_lo:[1,0,0] neg_hi:[1,0,0]
  v_mfma_f32_16x16x32_bf16 v[68:71], a[220:223], a[48:51], 0
  ds_read_b128 a[244:247], v1 offset:31744
  v_pk_fma_f16 v15, v14, v14, s34 neg_lo:[1,0,0] neg_hi:[1,0,0]
  v_pk_mul_f16 v9, v9, v8
  v_mfma_f32_16x16x32_bf16 v[64:67], a[220:223], a[24:27], 0
  buffer_load_dwordx4 a[144:147], v3, s[16:19], s95 offen offset:0
  v_pk_mul_f16 v11, v11, v10
  v_pk_mul_f16 v13, v13, v12
  v_mfma_f32_16x16x32_bf16 v[60:63], a[220:223], a[0:3], 0
  v_pk_mul_f16 v15, v15, v14
  v_exp_f16_sdwa v9, v9 dst_sel:WORD_0 dst_unused:UNUSED_PRESERVE src0_sel:WORD_0
  v_mfma_f32_16x16x32_bf16 v[48:51], a[224:227], a[4:7], v[48:51]
  ds_read_b128 a[216:219], v1 offset:32768
  v_exp_f16_sdwa v11, v11 dst_sel:WORD_0 dst_unused:UNUSED_PRESERVE src0_sel:WORD_0
  v_mfma_f32_16x16x32_bf16 v[52:55], a[224:227], a[28:31], v[52:55]
  v_exp_f16_sdwa v13, v13 dst_sel:WORD_0 dst_unused:UNUSED_PRESERVE src0_sel:WORD_0
  v_mfma_f32_16x16x32_bf16 v[56:59], a[224:227], a[52:55], v[56:59]
  s_waitcnt lgkmcnt(3)
  v_exp_f16_sdwa v15, v15 dst_sel:WORD_0 dst_unused:UNUSED_PRESERVE src0_sel:WORD_0
  v_mfma_f32_16x16x32_bf16 v[68:71], a[228:231], a[52:55], v[68:71]
  ds_read_b128 a[220:223], v1 offset:33792
  v_exp_f16_sdwa v9, v9 dst_sel:WORD_1 dst_unused:UNUSED_PRESERVE src0_sel:WORD_1
  v_mfma_f32_16x16x32_bf16 v[64:67], a[228:231], a[28:31], v[64:67]
  v_exp_f16_sdwa v11, v11 dst_sel:WORD_1 dst_unused:UNUSED_PRESERVE src0_sel:WORD_1
  v_mfma_f32_16x16x32_bf16 v[60:63], a[228:231], a[4:7], v[60:63]
  v_exp_f16_sdwa v13, v13 dst_sel:WORD_1 dst_unused:UNUSED_PRESERVE src0_sel:WORD_1
  v_mfma_f32_16x16x32_bf16 v[48:51], a[232:235], a[8:11], v[48:51]
  ds_read_b128 a[224:227], v1 offset:34816
  v_exp_f16_sdwa v15, v15 dst_sel:WORD_1 dst_unused:UNUSED_PRESERVE src0_sel:WORD_1
  v_mfma_f32_16x16x32_bf16 v[52:55], a[232:235], a[32:35], v[52:55]
  buffer_load_dwordx4 a[148:151], v3, s[16:19], s95 offen offset:64
  v_pk_fma_f16 v9, v9, s35, s35
  v_pk_fma_f16 v11, v11, s35, s35
  v_mfma_f32_16x16x32_bf16 v[56:59], a[232:235], a[56:59], v[56:59]
  v_pk_fma_f16 v13, v13, s35, s35
  v_pk_fma_f16 v15, v15, s35, s35
  v_mfma_f32_16x16x32_bf16 v[68:71], a[236:239], a[56:59], v[68:71]
  ds_read_b128 a[228:231], v1 offset:35840
  v_rcp_f16_sdwa v9, v9 dst_sel:WORD_0 dst_unused:UNUSED_PRESERVE src0_sel:WORD_0
  v_mfma_f32_16x16x32_bf16 v[64:67], a[236:239], a[32:35], v[64:67]
  v_rcp_f16_sdwa v11, v11 dst_sel:WORD_0 dst_unused:UNUSED_PRESERVE src0_sel:WORD_0
  v_mfma_f32_16x16x32_bf16 v[60:63], a[236:239], a[8:11], v[60:63]
  s_waitcnt lgkmcnt(3)
  v_rcp_f16_sdwa v13, v13 dst_sel:WORD_0 dst_unused:UNUSED_PRESERVE src0_sel:WORD_0
  v_rcp_f16_sdwa v15, v15 dst_sel:WORD_0 dst_unused:UNUSED_PRESERVE src0_sel:WORD_0
  v_mfma_f32_16x16x32_bf16 v[48:51], a[240:243], a[12:15], v[48:51]
  ds_read_b128 a[232:235], v1 offset:36864
  v_rcp_f16_sdwa v9, v9 dst_sel:WORD_1 dst_unused:UNUSED_PRESERVE src0_sel:WORD_1
  v_mfma_f32_16x16x32_bf16 v[52:55], a[240:243], a[36:39], v[52:55]
  v_rcp_f16_sdwa v11, v11 dst_sel:WORD_1 dst_unused:UNUSED_PRESERVE src0_sel:WORD_1
  v_mfma_f32_16x16x32_bf16 v[56:59], a[240:243], a[60:63], v[56:59]
  v_rcp_f16_sdwa v13, v13 dst_sel:WORD_1 dst_unused:UNUSED_PRESERVE src0_sel:WORD_1
  v_mfma_f32_16x16x32_bf16 v[68:71], a[244:247], a[60:63], v[68:71]
  ds_read_b128 a[236:239], v1 offset:37888
  v_rcp_f16_sdwa v15, v15 dst_sel:WORD_1 dst_unused:UNUSED_PRESERVE src0_sel:WORD_1
  v_mfma_f32_16x16x32_bf16 v[64:67], a[244:247], a[36:39], v[64:67]
  buffer_load_dwordx4 a[152:155], v3, s[16:19], s95 offen offset:128
  v_pk_mul_f16 v36, v8, v9
  v_pk_mul_f16 v37, v10, v11
  v_mfma_f32_16x16x32_bf16 v[60:63], a[244:247], a[12:15], v[60:63]
  v_pk_mul_f16 v40, v12, v13
  v_pk_mul_f16 v41, v14, v15
  v_mfma_f32_16x16x32_bf16 v[48:51], a[216:219], a[16:19], v[48:51]
  ds_read_b128 a[240:243], v1 offset:38912
  v_cvt_pk_f16_f32 v16, v80, v81
  v_cvt_pk_f16_f32 v18, v82, v83
  v_mfma_f32_16x16x32_bf16 v[52:55], a[216:219], a[40:43], v[52:55]
  v_cvt_pk_f16_f32 v20, v84, v85
  v_cvt_pk_f16_f32 v22, v86, v87
  v_mfma_f32_16x16x32_bf16 v[56:59], a[216:219], a[64:67], v[56:59]
  s_waitcnt lgkmcnt(3)
  v_pk_fma_f16 v17, v16, v16, s34 neg_lo:[1,0,0] neg_hi:[1,0,0]
  v_pk_fma_f16 v19, v18, v18, s34 neg_lo:[1,0,0] neg_hi:[1,0,0]
  v_pk_fma_f16 v21, v20, v20, s34 neg_lo:[1,0,0] neg_hi:[1,0,0]
  v_mfma_f32_16x16x32_bf16 v[68:71], a[220:223], a[64:67], v[68:71]
  ds_read_b128 a[244:247], v1 offset:39936
  v_pk_fma_f16 v23, v22, v22, s34 neg_lo:[1,0,0] neg_hi:[1,0,0]
  v_pk_mul_f16 v17, v17, v16
  v_mfma_f32_16x16x32_bf16 v[64:67], a[220:223], a[40:43], v[64:67]
  v_pk_mul_f16 v19, v19, v18
  v_pk_mul_f16 v21, v21, v20
  v_mfma_f32_16x16x32_bf16 v[60:63], a[220:223], a[16:19], v[60:63]
  v_pk_mul_f16 v23, v23, v22
  v_exp_f16_sdwa v17, v17 dst_sel:WORD_0 dst_unused:UNUSED_PRESERVE src0_sel:WORD_0
  v_mfma_f32_16x16x32_bf16 v[48:51], a[224:227], a[20:23], v[48:51]
  ds_read_b128 a[216:219], v1 offset:40960
  v_exp_f16_sdwa v19, v19 dst_sel:WORD_0 dst_unused:UNUSED_PRESERVE src0_sel:WORD_0
  v_mfma_f32_16x16x32_bf16 v[52:55], a[224:227], a[44:47], v[52:55]
  buffer_load_dwordx4 a[156:159], v3, s[16:19], s95 offen offset:192
  v_exp_f16_sdwa v21, v21 dst_sel:WORD_0 dst_unused:UNUSED_PRESERVE src0_sel:WORD_0
  v_mfma_f32_16x16x32_bf16 v[56:59], a[224:227], a[68:71], v[56:59]
  v_exp_f16_sdwa v23, v23 dst_sel:WORD_0 dst_unused:UNUSED_PRESERVE src0_sel:WORD_0
  v_mfma_f32_16x16x32_bf16 v[68:71], a[228:231], a[68:71], v[68:71]
  ds_read_b128 a[220:223], v1 offset:41984
  v_exp_f16_sdwa v17, v17 dst_sel:WORD_1 dst_unused:UNUSED_PRESERVE src0_sel:WORD_1
  v_mfma_f32_16x16x32_bf16 v[64:67], a[228:231], a[44:47], v[64:67]
  v_exp_f16_sdwa v19, v19 dst_sel:WORD_1 dst_unused:UNUSED_PRESERVE src0_sel:WORD_1
  v_mfma_f32_16x16x32_bf16 v[60:63], a[228:231], a[20:23], v[60:63]
  s_waitcnt lgkmcnt(3)
  v_exp_f16_sdwa v21, v21 dst_sel:WORD_1 dst_unused:UNUSED_PRESERVE src0_sel:WORD_1
  v_mfma_f32_16x16x32_f16 v[96:99], a[232:235], v[24:27], v[96:99]
  ds_read_b128 a[224:227], v1 offset:43008
  v_exp_f16_sdwa v23, v23 dst_sel:WORD_1 dst_unused:UNUSED_PRESERVE src0_sel:WORD_1
  v_mfma_f32_16x16x32_f16 v[100:103], a[232:235], v[28:31], v[100:103]
  v_pk_fma_f16 v17, v17, s35, s35
  v_pk_fma_f16 v19, v19, s35, s35
  v_mfma_f32_16x16x32_f16 v[104:107], a[232:235], v[32:35], v[104:107]
  v_pk_fma_f16 v21, v21, s35, s35
  v_pk_fma_f16 v23, v23, s35, s35
  v_mfma_f32_16x16x32_f16 v[116:119], a[236:239], v[32:35], v[116:119]
  ds_read_b128 a[228:231], v1 offset:44032
  v_rcp_f16_sdwa v17, v17 dst_sel:WORD_0 dst_unused:UNUSED_PRESERVE src0_sel:WORD_0
  v_mfma_f32_16x16x32_f16 v[112:115], a[236:239], v[28:31], v[112:115]
  v_rcp_f16_sdwa v19, v19 dst_sel:WORD_0 dst_unused:UNUSED_PRESERVE src0_sel:WORD_0
  v_mfma_f32_16x16x32_f16 v[108:111], a[236:239], v[24:27], v[108:111]
  v_rcp_f16_sdwa v21, v21 dst_sel:WORD_0 dst_unused:UNUSED_PRESERVE src0_sel:WORD_0
  v_rcp_f16_sdwa v23, v23 dst_sel:WORD_0 dst_unused:UNUSED_PRESERVE src0_sel:WORD_0
  v_mfma_f32_16x16x32_f16 v[120:123], a[240:243], v[24:27], v[120:123]
  ds_read_b128 a[232:235], v1 offset:45056
  v_rcp_f16_sdwa v17, v17 dst_sel:WORD_1 dst_unused:UNUSED_PRESERVE src0_sel:WORD_1
  v_mfma_f32_16x16x32_f16 v[124:127], a[240:243], v[28:31], v[124:127]
  v_rcp_f16_sdwa v19, v19 dst_sel:WORD_1 dst_unused:UNUSED_PRESERVE src0_sel:WORD_1
  v_mfma_f32_16x16x32_f16 v[128:131], a[240:243], v[32:35], v[128:131]
  s_waitcnt lgkmcnt(3)
  v_rcp_f16_sdwa v21, v21 dst_sel:WORD_1 dst_unused:UNUSED_PRESERVE src0_sel:WORD_1
  v_mfma_f32_16x16x32_f16 v[140:143], a[244:247], v[32:35], v[140:143]
  ds_read_b128 a[236:239], v1 offset:46080
  v_rcp_f16_sdwa v23, v23 dst_sel:WORD_1 dst_unused:UNUSED_PRESERVE src0_sel:WORD_1
  v_mfma_f32_16x16x32_f16 v[136:139], a[244:247], v[28:31], v[136:139]
  v_pk_mul_f16 v44, v16, v17
  v_pk_mul_f16 v45, v18, v19
  v_mfma_f32_16x16x32_f16 v[132:135], a[244:247], v[24:27], v[132:135]
  v_pk_mul_f16 v38, v20, v21
  v_pk_mul_f16 v39, v22, v23
  v_mfma_f32_16x16x32_f16 v[144:147], a[216:219], v[24:27], v[144:147]
  ds_read_b128 a[240:243], v1 offset:47104
  ds_read_b128 a[244:247], v1 offset:48128
  v_cvt_pk_f16_f32 v8, v88, v89
  v_cvt_pk_f16_f32 v10, v90, v91
  v_mfma_f32_16x16x32_f16 v[148:151], a[216:219], v[28:31], v[148:151]
  v_cvt_pk_f16_f32 v12, v92, v93
  v_cvt_pk_f16_f32 v14, v94, v95
  v_mfma_f32_16x16x32_f16 v[152:155], a[216:219], v[32:35], v[152:155]
  v_pk_fma_f16 v9, v8, v8, s34 neg_lo:[1,0,0] neg_hi:[1,0,0]
  v_pk_fma_f16 v11, v10, v10, s34 neg_lo:[1,0,0] neg_hi:[1,0,0]
  v_pk_fma_f16 v13, v12, v12, s34 neg_lo:[1,0,0] neg_hi:[1,0,0]
  v_mfma_f32_16x16x32_f16 v[164:167], a[220:223], v[32:35], v[164:167]
  v_pk_fma_f16 v15, v14, v14, s34 neg_lo:[1,0,0] neg_hi:[1,0,0]
  v_pk_mul_f16 v9, v9, v8
  v_mfma_f32_16x16x32_f16 v[160:163], a[220:223], v[28:31], v[160:163]
  v_pk_mul_f16 v11, v11, v10
  v_pk_mul_f16 v13, v13, v12
  v_mfma_f32_16x16x32_f16 v[156:159], a[220:223], v[24:27], v[156:159]
  s_waitcnt lgkmcnt(3)
  v_pk_mul_f16 v15, v15, v14
  v_exp_f16_sdwa v9, v9 dst_sel:WORD_0 dst_unused:UNUSED_PRESERVE src0_sel:WORD_0
  v_mfma_f32_16x16x32_f16 v[168:171], a[224:227], v[24:27], v[168:171]
  s_waitcnt lgkmcnt(0)
  s_waitcnt vmcnt(4)
  s_barrier
  ds_read_b128 a[216:219], v4 offset:0
  v_exp_f16_sdwa v11, v11 dst_sel:WORD_0 dst_unused:UNUSED_PRESERVE src0_sel:WORD_0
  v_mfma_f32_16x16x32_f16 v[172:175], a[224:227], v[28:31], v[172:175]
  v_exp_f16_sdwa v13, v13 dst_sel:WORD_0 dst_unused:UNUSED_PRESERVE src0_sel:WORD_0
  v_mfma_f32_16x16x32_f16 v[176:179], a[224:227], v[32:35], v[176:179]
  v_exp_f16_sdwa v15, v15 dst_sel:WORD_0 dst_unused:UNUSED_PRESERVE src0_sel:WORD_0
  v_mfma_f32_16x16x32_f16 v[188:191], a[228:231], v[32:35], v[188:191]
  ds_read_b128 a[220:223], v4 offset:1024
  v_exp_f16_sdwa v9, v9 dst_sel:WORD_1 dst_unused:UNUSED_PRESERVE src0_sel:WORD_1
  v_mfma_f32_16x16x32_f16 v[184:187], a[228:231], v[28:31], v[184:187]
  v_exp_f16_sdwa v11, v11 dst_sel:WORD_1 dst_unused:UNUSED_PRESERVE src0_sel:WORD_1
  v_mfma_f32_16x16x32_f16 v[180:183], a[228:231], v[24:27], v[180:183]
  v_exp_f16_sdwa v13, v13 dst_sel:WORD_1 dst_unused:UNUSED_PRESERVE src0_sel:WORD_1
  v_mfma_f32_16x16x32_f16 v[192:195], a[232:235], v[24:27], v[192:195]
  ds_read_b128 a[224:227], v4 offset:2048
  v_exp_f16_sdwa v15, v15 dst_sel:WORD_1 dst_unused:UNUSED_PRESERVE src0_sel:WORD_1
  v_mfma_f32_16x16x32_f16 v[196:199], a[232:235], v[28:31], v[196:199]
  v_pk_fma_f16 v9, v9, s35, s35
  v_pk_fma_f16 v11, v11, s35, s35
  v_mfma_f32_16x16x32_f16 v[200:203], a[232:235], v[32:35], v[200:203]
  v_pk_fma_f16 v13, v13, s35, s35
  v_pk_fma_f16 v15, v15, s35, s35
  v_mfma_f32_16x16x32_f16 v[212:215], a[236:239], v[32:35], v[212:215]
  ds_read_b128 a[228:231], v4 offset:3072
  v_rcp_f16_sdwa v9, v9 dst_sel:WORD_0 dst_unused:UNUSED_PRESERVE src0_sel:WORD_0
  v_mfma_f32_16x16x32_f16 v[208:211], a[236:239], v[28:31], v[208:211]
  v_rcp_f16_sdwa v11, v11 dst_sel:WORD_0 dst_unused:UNUSED_PRESERVE src0_sel:WORD_0
  v_mfma_f32_16x16x32_f16 v[204:207], a[236:239], v[24:27], v[204:207]
  v_rcp_f16_sdwa v13, v13 dst_sel:WORD_0 dst_unused:UNUSED_PRESERVE src0_sel:WORD_0
  v_rcp_f16_sdwa v15, v15 dst_sel:WORD_0 dst_unused:UNUSED_PRESERVE src0_sel:WORD_0
  v_mfma_f32_16x16x32_f16 v[216:219], a[240:243], v[24:27], v[216:219]
  ds_read_b128 a[232:235], v4 offset:4096
  v_rcp_f16_sdwa v9, v9 dst_sel:WORD_1 dst_unused:UNUSED_PRESERVE src0_sel:WORD_1
  v_mfma_f32_16x16x32_f16 v[220:223], a[240:243], v[28:31], v[220:223]
  v_rcp_f16_sdwa v11, v11 dst_sel:WORD_1 dst_unused:UNUSED_PRESERVE src0_sel:WORD_1
  v_mfma_f32_16x16x32_f16 v[224:227], a[240:243], v[32:35], v[224:227]
  v_rcp_f16_sdwa v13, v13 dst_sel:WORD_1 dst_unused:UNUSED_PRESERVE src0_sel:WORD_1
  v_mfma_f32_16x16x32_f16 v[236:239], a[244:247], v[32:35], v[236:239]
  ds_read_b128 a[236:239], v4 offset:5120
  v_rcp_f16_sdwa v15, v15 dst_sel:WORD_1 dst_unused:UNUSED_PRESERVE src0_sel:WORD_1
  v_mfma_f32_16x16x32_f16 v[232:235], a[244:247], v[28:31], v[232:235]
  v_pk_mul_f16 v42, v8, v9
  v_pk_mul_f16 v43, v10, v11
  v_mfma_f32_16x16x32_f16 v[228:231], a[244:247], v[24:27], v[228:231]
  s_waitcnt lgkmcnt(3)
  v_pk_mul_f16 v46, v12, v13
  v_pk_mul_f16 v47, v14, v15
  v_mfma_f32_16x16x32_bf16 v[72:75], a[216:219], a[0:3], 0
  ds_read_b128 a[240:243], v4 offset:6144
  s_add_u32 m0, s29, 0
  s_add_u32 s31, s29, 393216
  buffer_load_dwordx4 v2, s[8:11], s31 offen offset:0 lds
  v_cvt_pk_f16_f32 v8, v48, v49
  v_cvt_pk_f16_f32 v10, v50, v51
  v_mfma_f32_16x16x32_bf16 v[76:79], a[216:219], a[24:27], 0
  v_cvt_pk_f16_f32 v12, v52, v53
  v_cvt_pk_f16_f32 v14, v54, v55
  v_mfma_f32_16x16x32_bf16 v[80:83], a[216:219], a[48:51], 0
  v_pk_fma_f16 v9, v8, v8, s34 neg_lo:[1,0,0] neg_hi:[1,0,0]
  v_pk_fma_f16 v11, v10, v10, s34 neg_lo:[1,0,0] neg_hi:[1,0,0]
  v_pk_fma_f16 v13, v12, v12, s34 neg_lo:[1,0,0] neg_hi:[1,0,0]
  v_mfma_f32_16x16x32_bf16 v[92:95], a[220:223], a[48:51], 0
  ds_read_b128 a[244:247], v4 offset:7168
  buffer_load_dwordx4 v2, s[8:11], s31 offen offset:1024 lds
  v_pk_fma_f16 v15, v14, v14, s34 neg_lo:[1,0,0] neg_hi:[1,0,0]
  v_pk_mul_f16 v9, v9, v8
  v_mfma_f32_16x16x32_bf16 v[88:91], a[220:223], a[24:27], 0
  v_pk_mul_f16 v11, v11, v10
  v_pk_mul_f16 v13, v13, v12
  v_mfma_f32_16x16x32_bf16 v[84:87], a[220:223], a[0:3], 0
  v_pk_mul_f16 v15, v15, v14
  v_exp_f16_sdwa v9, v9 dst_sel:WORD_0 dst_unused:UNUSED_PRESERVE src0_sel:WORD_0
  v_mfma_f32_16x16x32_bf16 v[72:75], a[224:227], a[4:7], v[72:75]
  ds_read_b128 a[216:219], v4 offset:8192
  buffer_load_dwordx4 v2, s[8:11], s31 offen offset:2048 lds
  v_exp_f16_sdwa v11, v11 dst_sel:WORD_0 dst_unused:UNUSED_PRESERVE src0_sel:WORD_0
  v_mfma_f32_16x16x32_bf16 v[76:79], a[224:227], a[28:31], v[76:79]
  v_exp_f16_sdwa v13, v13 dst_sel:WORD_0 dst_unused:UNUSED_PRESERVE src0_sel:WORD_0
  v_mfma_f32_16x16x32_bf16 v[80:83], a[224:227], a[52:55], v[80:83]
  s_waitcnt lgkmcnt(3)
  v_exp_f16_sdwa v15, v15 dst_sel:WORD_0 dst_unused:UNUSED_PRESERVE src0_sel:WORD_0
  v_mfma_f32_16x16x32_bf16 v[92:95], a[228:231], a[52:55], v[92:95]
  ds_read_b128 a[220:223], v4 offset:9216
  buffer_load_dwordx4 v2, s[8:11], s31 offen offset:3072 lds
  v_exp_f16_sdwa v9, v9 dst_sel:WORD_1 dst_unused:UNUSED_PRESERVE src0_sel:WORD_1
  v_mfma_f32_16x16x32_bf16 v[88:91], a[228:231], a[28:31], v[88:91]
  s_add_u32 m0, s29, 4096
  v_exp_f16_sdwa v11, v11 dst_sel:WORD_1 dst_unused:UNUSED_PRESERVE src0_sel:WORD_1
  v_mfma_f32_16x16x32_bf16 v[84:87], a[228:231], a[4:7], v[84:87]
  s_add_u32 s31, s29, 397312
  v_exp_f16_sdwa v13, v13 dst_sel:WORD_1 dst_unused:UNUSED_PRESERVE src0_sel:WORD_1
  v_mfma_f32_16x16x32_bf16 v[72:75], a[232:235], a[8:11], v[72:75]
  ds_read_b128 a[224:227], v4 offset:10240
  buffer_load_dwordx4 v2, s[8:11], s31 offen offset:0 lds
  v_exp_f16_sdwa v15, v15 dst_sel:WORD_1 dst_unused:UNUSED_PRESERVE src0_sel:WORD_1
  v_mfma_f32_16x16x32_bf16 v[76:79], a[232:235], a[32:35], v[76:79]
  v_pk_fma_f16 v9, v9, s35, s35
  v_pk_fma_f16 v11, v11, s35, s35
  v_mfma_f32_16x16x32_bf16 v[80:83], a[232:235], a[56:59], v[80:83]
  v_pk_fma_f16 v13, v13, s35, s35
  v_pk_fma_f16 v15, v15, s35, s35
  v_mfma_f32_16x16x32_bf16 v[92:95], a[236:239], a[56:59], v[92:95]
  ds_read_b128 a[228:231], v4 offset:11264
  buffer_load_dwordx4 v2, s[8:11], s31 offen offset:1024 lds
  v_rcp_f16_sdwa v9, v9 dst_sel:WORD_0 dst_unused:UNUSED_PRESERVE src0_sel:WORD_0
  v_mfma_f32_16x16x32_bf16 v[88:91], a[236:239], a[32:35], v[88:91]
  v_rcp_f16_sdwa v11, v11 dst_sel:WORD_0 dst_unused:UNUSED_PRESERVE src0_sel:WORD_0
  v_mfma_f32_16x16x32_bf16 v[84:87], a[236:239], a[8:11], v[84:87]
  s_waitcnt lgkmcnt(3)
  v_rcp_f16_sdwa v13, v13 dst_sel:WORD_0 dst_unused:UNUSED_PRESERVE src0_sel:WORD_0
  v_rcp_f16_sdwa v15, v15 dst_sel:WORD_0 dst_unused:UNUSED_PRESERVE src0_sel:WORD_0
  v_mfma_f32_16x16x32_bf16 v[72:75], a[240:243], a[12:15], v[72:75]
  ds_read_b128 a[232:235], v4 offset:12288
  buffer_load_dwordx4 v2, s[8:11], s31 offen offset:2048 lds
  v_rcp_f16_sdwa v9, v9 dst_sel:WORD_1 dst_unused:UNUSED_PRESERVE src0_sel:WORD_1
  v_mfma_f32_16x16x32_bf16 v[76:79], a[240:243], a[36:39], v[76:79]
  v_rcp_f16_sdwa v11, v11 dst_sel:WORD_1 dst_unused:UNUSED_PRESERVE src0_sel:WORD_1
  v_mfma_f32_16x16x32_bf16 v[80:83], a[240:243], a[60:63], v[80:83]
  v_rcp_f16_sdwa v13, v13 dst_sel:WORD_1 dst_unused:UNUSED_PRESERVE src0_sel:WORD_1
  v_mfma_f32_16x16x32_bf16 v[92:95], a[244:247], a[60:63], v[92:95]
  ds_read_b128 a[236:239], v4 offset:13312
  buffer_load_dwordx4 v2, s[8:11], s31 offen offset:3072 lds
  v_rcp_f16_sdwa v15, v15 dst_sel:WORD_1 dst_unused:UNUSED_PRESERVE src0_sel:WORD_1
  v_mfma_f32_16x16x32_bf16 v[88:91], a[244:247], a[36:39], v[88:91]
  s_add_u32 m0, s29, 8192
  v_pk_mul_f16 v24, v8, v9
  v_pk_mul_f16 v25, v10, v11
  v_mfma_f32_16x16x32_bf16 v[84:87], a[244:247], a[12:15], v[84:87]
  s_add_u32 s31, s29, 401408
  v_pk_mul_f16 v28, v12, v13
  v_pk_mul_f16 v29, v14, v15
  v_mfma_f32_16x16x32_bf16 v[72:75], a[216:219], a[16:19], v[72:75]
  ds_read_b128 a[240:243], v4 offset:14336
  buffer_load_dwordx4 v2, s[8:11], s31 offen offset:0 lds
  v_cvt_pk_f16_f32 v16, v56, v57
  v_cvt_pk_f16_f32 v18, v58, v59
  v_mfma_f32_16x16x32_bf16 v[76:79], a[216:219], a[40:43], v[76:79]
  v_cvt_pk_f16_f32 v20, v60, v61
  v_cvt_pk_f16_f32 v22, v62, v63
  v_mfma_f32_16x16x32_bf16 v[80:83], a[216:219], a[64:67], v[80:83]
  s_waitcnt lgkmcnt(3)
  v_pk_fma_f16 v17, v16, v16, s34 neg_lo:[1,0,0] neg_hi:[1,0,0]
  v_pk_fma_f16 v19, v18, v18, s34 neg_lo:[1,0,0] neg_hi:[1,0,0]
  v_pk_fma_f16 v21, v20, v20, s34 neg_lo:[1,0,0] neg_hi:[1,0,0]
  v_mfma_f32_16x16x32_bf16 v[92:95], a[220:223], a[64:67], v[92:95]
  ds_read_b128 a[244:247], v4 offset:15360
  buffer_load_dwordx4 v2, s[8:11], s31 offen offset:1024 lds
  v_pk_fma_f16 v23, v22, v22, s34 neg_lo:[1,0,0] neg_hi:[1,0,0]
  v_pk_mul_f16 v17, v17, v16
  v_mfma_f32_16x16x32_bf16 v[88:91], a[220:223], a[40:43], v[88:91]
  v_pk_mul_f16 v19, v19, v18
  v_pk_mul_f16 v21, v21, v20
  v_mfma_f32_16x16x32_bf16 v[84:87], a[220:223], a[16:19], v[84:87]
  v_pk_mul_f16 v23, v23, v22
  v_exp_f16_sdwa v17, v17 dst_sel:WORD_0 dst_unused:UNUSED_PRESERVE src0_sel:WORD_0
  v_mfma_f32_16x16x32_bf16 v[72:75], a[224:227], a[20:23], v[72:75]
  ds_read_b128 a[216:219], v4 offset:16384
  buffer_load_dwordx4 v2, s[8:11], s31 offen offset:2048 lds
  v_exp_f16_sdwa v19, v19 dst_sel:WORD_0 dst_unused:UNUSED_PRESERVE src0_sel:WORD_0
  v_mfma_f32_16x16x32_bf16 v[76:79], a[224:227], a[44:47], v[76:79]
  v_exp_f16_sdwa v21, v21 dst_sel:WORD_0 dst_unused:UNUSED_PRESERVE src0_sel:WORD_0
  v_mfma_f32_16x16x32_bf16 v[80:83], a[224:227], a[68:71], v[80:83]
  v_exp_f16_sdwa v23, v23 dst_sel:WORD_0 dst_unused:UNUSED_PRESERVE src0_sel:WORD_0
  v_mfma_f32_16x16x32_bf16 v[92:95], a[228:231], a[68:71], v[92:95]
  ds_read_b128 a[220:223], v4 offset:17408
  buffer_load_dwordx4 v2, s[8:11], s31 offen offset:3072 lds
  v_exp_f16_sdwa v17, v17 dst_sel:WORD_1 dst_unused:UNUSED_PRESERVE src0_sel:WORD_1
  v_mfma_f32_16x16x32_bf16 v[88:91], a[228:231], a[44:47], v[88:91]
  v_exp_f16_sdwa v19, v19 dst_sel:WORD_1 dst_unused:UNUSED_PRESERVE src0_sel:WORD_1
  v_mfma_f32_16x16x32_bf16 v[84:87], a[228:231], a[20:23], v[84:87]
  s_waitcnt lgkmcnt(3)
  v_exp_f16_sdwa v21, v21 dst_sel:WORD_1 dst_unused:UNUSED_PRESERVE src0_sel:WORD_1
  v_mfma_f32_16x16x32_f16 v[96:99], a[232:235], v[36:39], v[96:99]
  ds_read_b128 a[224:227], v4 offset:18432
  v_exp_f16_sdwa v23, v23 dst_sel:WORD_1 dst_unused:UNUSED_PRESERVE src0_sel:WORD_1
  v_mfma_f32_16x16x32_f16 v[100:103], a[232:235], v[40:43], v[100:103]
  v_pk_fma_f16 v17, v17, s35, s35
  v_pk_fma_f16 v19, v19, s35, s35
  v_mfma_f32_16x16x32_f16 v[104:107], a[232:235], v[44:47], v[104:107]
  v_pk_fma_f16 v21, v21, s35, s35
  v_pk_fma_f16 v23, v23, s35, s35
  v_mfma_f32_16x16x32_f16 v[116:119], a[236:239], v[44:47], v[116:119]
  ds_read_b128 a[228:231], v4 offset:19456
  v_rcp_f16_sdwa v17, v17 dst_sel:WORD_0 dst_unused:UNUSED_PRESERVE src0_sel:WORD_0
  v_mfma_f32_16x16x32_f16 v[112:115], a[236:239], v[40:43], v[112:115]
  v_rcp_f16_sdwa v19, v19 dst_sel:WORD_0 dst_unused:UNUSED_PRESERVE src0_sel:WORD_0
  v_mfma_f32_16x16x32_f16 v[108:111], a[236:239], v[36:39], v[108:111]
  v_rcp_f16_sdwa v21, v21 dst_sel:WORD_0 dst_unused:UNUSED_PRESERVE src0_sel:WORD_0
  v_rcp_f16_sdwa v23, v23 dst_sel:WORD_0 dst_unused:UNUSED_PRESERVE src0_sel:WORD_0
  v_mfma_f32_16x16x32_f16 v[120:123], a[240:243], v[36:39], v[120:123]
  ds_read_b128 a[232:235], v4 offset:20480
  v_rcp_f16_sdwa v17, v17 dst_sel:WORD_1 dst_unused:UNUSED_PRESERVE src0_sel:WORD_1
  v_mfma_f32_16x16x32_f16 v[124:127], a[240:243], v[40:43], v[124:127]
  v_rcp_f16_sdwa v19, v19 dst_sel:WORD_1 dst_unused:UNUSED_PRESERVE src0_sel:WORD_1
  v_mfma_f32_16x16x32_f16 v[128:131], a[240:243], v[44:47], v[128:131]
  s_waitcnt lgkmcnt(3)
  v_rcp_f16_sdwa v21, v21 dst_sel:WORD_1 dst_unused:UNUSED_PRESERVE src0_sel:WORD_1
  v_mfma_f32_16x16x32_f16 v[140:143], a[244:247], v[44:47], v[140:143]
  ds_read_b128 a[236:239], v4 offset:21504
  v_rcp_f16_sdwa v23, v23 dst_sel:WORD_1 dst_unused:UNUSED_PRESERVE src0_sel:WORD_1
  v_mfma_f32_16x16x32_f16 v[136:139], a[244:247], v[40:43], v[136:139]
  v_pk_mul_f16 v32, v16, v17
  v_pk_mul_f16 v33, v18, v19
  v_mfma_f32_16x16x32_f16 v[132:135], a[244:247], v[36:39], v[132:135]
  v_pk_mul_f16 v26, v20, v21
  v_pk_mul_f16 v27, v22, v23
  v_mfma_f32_16x16x32_f16 v[144:147], a[216:219], v[36:39], v[144:147]
  ds_read_b128 a[240:243], v4 offset:22528
  v_cvt_pk_f16_f32 v8, v64, v65
  v_cvt_pk_f16_f32 v10, v66, v67
  v_mfma_f32_16x16x32_f16 v[148:151], a[216:219], v[40:43], v[148:151]
  v_cvt_pk_f16_f32 v12, v68, v69
  v_cvt_pk_f16_f32 v14, v70, v71
  v_mfma_f32_16x16x32_f16 v[152:155], a[216:219], v[44:47], v[152:155]
  v_pk_fma_f16 v9, v8, v8, s34 neg_lo:[1,0,0] neg_hi:[1,0,0]
  v_pk_fma_f16 v11, v10, v10, s34 neg_lo:[1,0,0] neg_hi:[1,0,0]
  v_pk_fma_f16 v13, v12, v12, s34 neg_lo:[1,0,0] neg_hi:[1,0,0]
  v_mfma_f32_16x16x32_f16 v[164:167], a[220:223], v[44:47], v[164:167]
  ds_read_b128 a[244:247], v4 offset:23552
  v_pk_fma_f16 v15, v14, v14, s34 neg_lo:[1,0,0] neg_hi:[1,0,0]
  v_pk_mul_f16 v9, v9, v8
  v_mfma_f32_16x16x32_f16 v[160:163], a[220:223], v[40:43], v[160:163]
  v_pk_mul_f16 v11, v11, v10
  v_pk_mul_f16 v13, v13, v12
  v_mfma_f32_16x16x32_f16 v[156:159], a[220:223], v[36:39], v[156:159]
  s_waitcnt lgkmcnt(3)
  v_pk_mul_f16 v15, v15, v14
  v_exp_f16_sdwa v9, v9 dst_sel:WORD_0 dst_unused:UNUSED_PRESERVE src0_sel:WORD_0
  v_mfma_f32_16x16x32_f16 v[168:171], a[224:227], v[36:39], v[168:171]
  ds_read_b128 a[216:219], v4 offset:24576
  v_exp_f16_sdwa v11, v11 dst_sel:WORD_0 dst_unused:UNUSED_PRESERVE src0_sel:WORD_0
  v_mfma_f32_16x16x32_f16 v[172:175], a[224:227], v[40:43], v[172:175]
  v_exp_f16_sdwa v13, v13 dst_sel:WORD_0 dst_unused:UNUSED_PRESERVE src0_sel:WORD_0
  v_mfma_f32_16x16x32_f16 v[176:179], a[224:227], v[44:47], v[176:179]
  v_exp_f16_sdwa v15, v15 dst_sel:WORD_0 dst_unused:UNUSED_PRESERVE src0_sel:WORD_0
  v_mfma_f32_16x16x32_f16 v[188:191], a[228:231], v[44:47], v[188:191]
  ds_read_b128 a[220:223], v4 offset:25600
  v_exp_f16_sdwa v9, v9 dst_sel:WORD_1 dst_unused:UNUSED_PRESERVE src0_sel:WORD_1
  v_mfma_f32_16x16x32_f16 v[184:187], a[228:231], v[40:43], v[184:187]
  v_exp_f16_sdwa v11, v11 dst_sel:WORD_1 dst_unused:UNUSED_PRESERVE src0_sel:WORD_1
  v_mfma_f32_16x16x32_f16 v[180:183], a[228:231], v[36:39], v[180:183]
  v_exp_f16_sdwa v13, v13 dst_sel:WORD_1 dst_unused:UNUSED_PRESERVE src0_sel:WORD_1
  v_mfma_f32_16x16x32_f16 v[192:195], a[232:235], v[36:39], v[192:195]
  ds_read_b128 a[224:227], v4 offset:26624
  v_exp_f16_sdwa v15, v15 dst_sel:WORD_1 dst_unused:UNUSED_PRESERVE src0_sel:WORD_1
  v_mfma_f32_16x16x32_f16 v[196:199], a[232:235], v[40:43], v[196:199]
  v_pk_fma_f16 v9, v9, s35, s35
  v_pk_fma_f16 v11, v11, s35, s35
  v_mfma_f32_16x16x32_f16 v[200:203], a[232:235], v[44:47], v[200:203]
  s_waitcnt lgkmcnt(3)
  v_pk_fma_f16 v13, v13, s35, s35
  v_pk_fma_f16 v15, v15, s35, s35
  v_mfma_f32_16x16x32_f16 v[212:215], a[236:239], v[44:47], v[212:215]
  ds_read_b128 a[228:231], v4 offset:27648
  v_rcp_f16_sdwa v9, v9 dst_sel:WORD_0 dst_unused:UNUSED_PRESERVE src0_sel:WORD_0
  v_mfma_f32_16x16x32_f16 v[208:211], a[236:239], v[40:43], v[208:211]
  v_rcp_f16_sdwa v11, v11 dst_sel:WORD_0 dst_unused:UNUSED_PRESERVE src0_sel:WORD_0
  v_mfma_f32_16x16x32_f16 v[204:207], a[236:239], v[36:39], v[204:207]
  v_rcp_f16_sdwa v13, v13 dst_sel:WORD_0 dst_unused:UNUSED_PRESERVE src0_sel:WORD_0
  v_rcp_f16_sdwa v15, v15 dst_sel:WORD_0 dst_unused:UNUSED_PRESERVE src0_sel:WORD_0
  v_mfma_f32_16x16x32_f16 v[216:219], a[240:243], v[36:39], v[216:219]
  ds_read_b128 a[232:235], v4 offset:28672
  v_rcp_f16_sdwa v9, v9 dst_sel:WORD_1 dst_unused:UNUSED_PRESERVE src0_sel:WORD_1
  v_mfma_f32_16x16x32_f16 v[220:223], a[240:243], v[40:43], v[220:223]
  v_rcp_f16_sdwa v11, v11 dst_sel:WORD_1 dst_unused:UNUSED_PRESERVE src0_sel:WORD_1
  v_mfma_f32_16x16x32_f16 v[224:227], a[240:243], v[44:47], v[224:227]
  v_rcp_f16_sdwa v13, v13 dst_sel:WORD_1 dst_unused:UNUSED_PRESERVE src0_sel:WORD_1
  v_mfma_f32_16x16x32_f16 v[236:239], a[244:247], v[44:47], v[236:239]
  ds_read_b128 a[236:239], v4 offset:29696
  v_rcp_f16_sdwa v15, v15 dst_sel:WORD_1 dst_unused:UNUSED_PRESERVE src0_sel:WORD_1
  v_mfma_f32_16x16x32_f16 v[232:235], a[244:247], v[40:43], v[232:235]
  v_pk_mul_f16 v30, v8, v9
  v_pk_mul_f16 v31, v10, v11
  v_mfma_f32_16x16x32_f16 v[228:231], a[244:247], v[36:39], v[228:231]
  s_waitcnt lgkmcnt(3)
  v_pk_mul_f16 v34, v12, v13
  v_pk_mul_f16 v35, v14, v15
  v_mfma_f32_16x16x32_bf16 v[48:51], a[216:219], a[0:3], 0
  ds_read_b128 a[240:243], v4 offset:30720
  v_cvt_pk_f16_f32 v8, v72, v73
  v_cvt_pk_f16_f32 v10, v74, v75
  v_mfma_f32_16x16x32_bf16 v[52:55], a[216:219], a[24:27], 0
  v_cvt_pk_f16_f32 v12, v76, v77
  v_cvt_pk_f16_f32 v14, v78, v79
  v_mfma_f32_16x16x32_bf16 v[56:59], a[216:219], a[48:51], 0
  v_pk_fma_f16 v9, v8, v8, s34 neg_lo:[1,0,0] neg_hi:[1,0,0]
  v_pk_fma_f16 v11, v10, v10, s34 neg_lo:[1,0,0] neg_hi:[1,0,0]
  v_pk_fma_f16 v13, v12, v12, s34 neg_lo:[1,0,0] neg_hi:[1,0,0]
  v_mfma_f32_16x16x32_bf16 v[68:71], a[220:223], a[48:51], 0
  ds_read_b128 a[244:247], v4 offset:31744
  v_pk_fma_f16 v15, v14, v14, s34 neg_lo:[1,0,0] neg_hi:[1,0,0]
  v_pk_mul_f16 v9, v9, v8
  v_mfma_f32_16x16x32_bf16 v[64:67], a[220:223], a[24:27], 0
  buffer_load_dwordx4 a[160:163], v3, s[16:19], s95 offen offset:256
  v_pk_mul_f16 v11, v11, v10
  v_pk_mul_f16 v13, v13, v12
  v_mfma_f32_16x16x32_bf16 v[60:63], a[220:223], a[0:3], 0
  v_pk_mul_f16 v15, v15, v14
  v_exp_f16_sdwa v9, v9 dst_sel:WORD_0 dst_unused:UNUSED_PRESERVE src0_sel:WORD_0
  v_mfma_f32_16x16x32_bf16 v[48:51], a[224:227], a[4:7], v[48:51]
  ds_read_b128 a[216:219], v4 offset:32768
  v_exp_f16_sdwa v11, v11 dst_sel:WORD_0 dst_unused:UNUSED_PRESERVE src0_sel:WORD_0
  v_mfma_f32_16x16x32_bf16 v[52:55], a[224:227], a[28:31], v[52:55]
  v_exp_f16_sdwa v13, v13 dst_sel:WORD_0 dst_unused:UNUSED_PRESERVE src0_sel:WORD_0
  v_mfma_f32_16x16x32_bf16 v[56:59], a[224:227], a[52:55], v[56:59]
  s_waitcnt lgkmcnt(3)
  v_exp_f16_sdwa v15, v15 dst_sel:WORD_0 dst_unused:UNUSED_PRESERVE src0_sel:WORD_0
  v_mfma_f32_16x16x32_bf16 v[68:71], a[228:231], a[52:55], v[68:71]
  ds_read_b128 a[220:223], v4 offset:33792
  v_exp_f16_sdwa v9, v9 dst_sel:WORD_1 dst_unused:UNUSED_PRESERVE src0_sel:WORD_1
  v_mfma_f32_16x16x32_bf16 v[64:67], a[228:231], a[28:31], v[64:67]
  v_exp_f16_sdwa v11, v11 dst_sel:WORD_1 dst_unused:UNUSED_PRESERVE src0_sel:WORD_1
  v_mfma_f32_16x16x32_bf16 v[60:63], a[228:231], a[4:7], v[60:63]
  v_exp_f16_sdwa v13, v13 dst_sel:WORD_1 dst_unused:UNUSED_PRESERVE src0_sel:WORD_1
  v_mfma_f32_16x16x32_bf16 v[48:51], a[232:235], a[8:11], v[48:51]
  ds_read_b128 a[224:227], v4 offset:34816
  v_exp_f16_sdwa v15, v15 dst_sel:WORD_1 dst_unused:UNUSED_PRESERVE src0_sel:WORD_1
  v_mfma_f32_16x16x32_bf16 v[52:55], a[232:235], a[32:35], v[52:55]
  buffer_load_dwordx4 a[164:167], v3, s[16:19], s95 offen offset:320
  v_pk_fma_f16 v9, v9, s35, s35
  v_pk_fma_f16 v11, v11, s35, s35
  v_mfma_f32_16x16x32_bf16 v[56:59], a[232:235], a[56:59], v[56:59]
  v_pk_fma_f16 v13, v13, s35, s35
  v_pk_fma_f16 v15, v15, s35, s35
  v_mfma_f32_16x16x32_bf16 v[68:71], a[236:239], a[56:59], v[68:71]
  ds_read_b128 a[228:231], v4 offset:35840
  v_rcp_f16_sdwa v9, v9 dst_sel:WORD_0 dst_unused:UNUSED_PRESERVE src0_sel:WORD_0
  v_mfma_f32_16x16x32_bf16 v[64:67], a[236:239], a[32:35], v[64:67]
  v_rcp_f16_sdwa v11, v11 dst_sel:WORD_0 dst_unused:UNUSED_PRESERVE src0_sel:WORD_0
  v_mfma_f32_16x16x32_bf16 v[60:63], a[236:239], a[8:11], v[60:63]
  s_waitcnt lgkmcnt(3)
  v_rcp_f16_sdwa v13, v13 dst_sel:WORD_0 dst_unused:UNUSED_PRESERVE src0_sel:WORD_0
  v_rcp_f16_sdwa v15, v15 dst_sel:WORD_0 dst_unused:UNUSED_PRESERVE src0_sel:WORD_0
  v_mfma_f32_16x16x32_bf16 v[48:51], a[240:243], a[12:15], v[48:51]
  ds_read_b128 a[232:235], v4 offset:36864
  v_rcp_f16_sdwa v9, v9 dst_sel:WORD_1 dst_unused:UNUSED_PRESERVE src0_sel:WORD_1
  v_mfma_f32_16x16x32_bf16 v[52:55], a[240:243], a[36:39], v[52:55]
  v_rcp_f16_sdwa v11, v11 dst_sel:WORD_1 dst_unused:UNUSED_PRESERVE src0_sel:WORD_1
  v_mfma_f32_16x16x32_bf16 v[56:59], a[240:243], a[60:63], v[56:59]
  v_rcp_f16_sdwa v13, v13 dst_sel:WORD_1 dst_unused:UNUSED_PRESERVE src0_sel:WORD_1
  v_mfma_f32_16x16x32_bf16 v[68:71], a[244:247], a[60:63], v[68:71]
  ds_read_b128 a[236:239], v4 offset:37888
  v_rcp_f16_sdwa v15, v15 dst_sel:WORD_1 dst_unused:UNUSED_PRESERVE src0_sel:WORD_1
  v_mfma_f32_16x16x32_bf16 v[64:67], a[244:247], a[36:39], v[64:67]
  buffer_load_dwordx4 a[168:171], v3, s[16:19], s96 offen offset:0
  v_pk_mul_f16 v36, v8, v9
  v_pk_mul_f16 v37, v10, v11
  v_mfma_f32_16x16x32_bf16 v[60:63], a[244:247], a[12:15], v[60:63]
  v_pk_mul_f16 v40, v12, v13
  v_pk_mul_f16 v41, v14, v15
  v_mfma_f32_16x16x32_bf16 v[48:51], a[216:219], a[16:19], v[48:51]
  ds_read_b128 a[240:243], v4 offset:38912
  v_cvt_pk_f16_f32 v16, v80, v81
  v_cvt_pk_f16_f32 v18, v82, v83
  v_mfma_f32_16x16x32_bf16 v[52:55], a[216:219], a[40:43], v[52:55]
  v_cvt_pk_f16_f32 v20, v84, v85
  v_cvt_pk_f16_f32 v22, v86, v87
  v_mfma_f32_16x16x32_bf16 v[56:59], a[216:219], a[64:67], v[56:59]
  s_waitcnt lgkmcnt(3)
  v_pk_fma_f16 v17, v16, v16, s34 neg_lo:[1,0,0] neg_hi:[1,0,0]
  v_pk_fma_f16 v19, v18, v18, s34 neg_lo:[1,0,0] neg_hi:[1,0,0]
  v_pk_fma_f16 v21, v20, v20, s34 neg_lo:[1,0,0] neg_hi:[1,0,0]
  v_mfma_f32_16x16x32_bf16 v[68:71], a[220:223], a[64:67], v[68:71]
  ds_read_b128 a[244:247], v4 offset:39936
  v_pk_fma_f16 v23, v22, v22, s34 neg_lo:[1,0,0] neg_hi:[1,0,0]
  v_pk_mul_f16 v17, v17, v16
  v_mfma_f32_16x16x32_bf16 v[64:67], a[220:223], a[40:43], v[64:67]
  v_pk_mul_f16 v19, v19, v18
  v_pk_mul_f16 v21, v21, v20
  v_mfma_f32_16x16x32_bf16 v[60:63], a[220:223], a[16:19], v[60:63]
  v_pk_mul_f16 v23, v23, v22
  v_exp_f16_sdwa v17, v17 dst_sel:WORD_0 dst_unused:UNUSED_PRESERVE src0_sel:WORD_0
  v_mfma_f32_16x16x32_bf16 v[48:51], a[224:227], a[20:23], v[48:51]
  ds_read_b128 a[216:219], v4 offset:40960
  v_exp_f16_sdwa v19, v19 dst_sel:WORD_0 dst_unused:UNUSED_PRESERVE src0_sel:WORD_0
  v_mfma_f32_16x16x32_bf16 v[52:55], a[224:227], a[44:47], v[52:55]
  buffer_load_dwordx4 a[172:175], v3, s[16:19], s96 offen offset:64
  v_exp_f16_sdwa v21, v21 dst_sel:WORD_0 dst_unused:UNUSED_PRESERVE src0_sel:WORD_0
  v_mfma_f32_16x16x32_bf16 v[56:59], a[224:227], a[68:71], v[56:59]
  v_exp_f16_sdwa v23, v23 dst_sel:WORD_0 dst_unused:UNUSED_PRESERVE src0_sel:WORD_0
  v_mfma_f32_16x16x32_bf16 v[68:71], a[228:231], a[68:71], v[68:71]
  ds_read_b128 a[220:223], v4 offset:41984
  v_exp_f16_sdwa v17, v17 dst_sel:WORD_1 dst_unused:UNUSED_PRESERVE src0_sel:WORD_1
  v_mfma_f32_16x16x32_bf16 v[64:67], a[228:231], a[44:47], v[64:67]
  v_exp_f16_sdwa v19, v19 dst_sel:WORD_1 dst_unused:UNUSED_PRESERVE src0_sel:WORD_1
  v_mfma_f32_16x16x32_bf16 v[60:63], a[228:231], a[20:23], v[60:63]
  s_waitcnt lgkmcnt(3)
  v_exp_f16_sdwa v21, v21 dst_sel:WORD_1 dst_unused:UNUSED_PRESERVE src0_sel:WORD_1
  v_mfma_f32_16x16x32_f16 v[96:99], a[232:235], v[24:27], v[96:99]
  ds_read_b128 a[224:227], v4 offset:43008
  v_exp_f16_sdwa v23, v23 dst_sel:WORD_1 dst_unused:UNUSED_PRESERVE src0_sel:WORD_1
  v_mfma_f32_16x16x32_f16 v[100:103], a[232:235], v[28:31], v[100:103]
  v_pk_fma_f16 v17, v17, s35, s35
  v_pk_fma_f16 v19, v19, s35, s35
  v_mfma_f32_16x16x32_f16 v[104:107], a[232:235], v[32:35], v[104:107]
  v_pk_fma_f16 v21, v21, s35, s35
  v_pk_fma_f16 v23, v23, s35, s35
  v_mfma_f32_16x16x32_f16 v[116:119], a[236:239], v[32:35], v[116:119]
  ds_read_b128 a[228:231], v4 offset:44032
  v_rcp_f16_sdwa v17, v17 dst_sel:WORD_0 dst_unused:UNUSED_PRESERVE src0_sel:WORD_0
  v_mfma_f32_16x16x32_f16 v[112:115], a[236:239], v[28:31], v[112:115]
  v_rcp_f16_sdwa v19, v19 dst_sel:WORD_0 dst_unused:UNUSED_PRESERVE src0_sel:WORD_0
  v_mfma_f32_16x16x32_f16 v[108:111], a[236:239], v[24:27], v[108:111]
  v_rcp_f16_sdwa v21, v21 dst_sel:WORD_0 dst_unused:UNUSED_PRESERVE src0_sel:WORD_0
  v_rcp_f16_sdwa v23, v23 dst_sel:WORD_0 dst_unused:UNUSED_PRESERVE src0_sel:WORD_0
  v_mfma_f32_16x16x32_f16 v[120:123], a[240:243], v[24:27], v[120:123]
  ds_read_b128 a[232:235], v4 offset:45056
  v_rcp_f16_sdwa v17, v17 dst_sel:WORD_1 dst_unused:UNUSED_PRESERVE src0_sel:WORD_1
  v_mfma_f32_16x16x32_f16 v[124:127], a[240:243], v[28:31], v[124:127]
  v_rcp_f16_sdwa v19, v19 dst_sel:WORD_1 dst_unused:UNUSED_PRESERVE src0_sel:WORD_1
  v_mfma_f32_16x16x32_f16 v[128:131], a[240:243], v[32:35], v[128:131]
  s_waitcnt lgkmcnt(3)
  v_rcp_f16_sdwa v21, v21 dst_sel:WORD_1 dst_unused:UNUSED_PRESERVE src0_sel:WORD_1
  v_mfma_f32_16x16x32_f16 v[140:143], a[244:247], v[32:35], v[140:143]
  ds_read_b128 a[236:239], v4 offset:46080
  v_rcp_f16_sdwa v23, v23 dst_sel:WORD_1 dst_unused:UNUSED_PRESERVE src0_sel:WORD_1
  v_mfma_f32_16x16x32_f16 v[136:139], a[244:247], v[28:31], v[136:139]
  v_pk_mul_f16 v44, v16, v17
  v_pk_mul_f16 v45, v18, v19
  v_mfma_f32_16x16x32_f16 v[132:135], a[244:247], v[24:27], v[132:135]
  v_pk_mul_f16 v38, v20, v21
  v_pk_mul_f16 v39, v22, v23
  v_mfma_f32_16x16x32_f16 v[144:147], a[216:219], v[24:27], v[144:147]
  ds_read_b128 a[240:243], v4 offset:47104
  ds_read_b128 a[244:247], v4 offset:48128
  v_cvt_pk_f16_f32 v8, v88, v89
  v_cvt_pk_f16_f32 v10, v90, v91
  v_mfma_f32_16x16x32_f16 v[148:151], a[216:219], v[28:31], v[148:151]
  v_cvt_pk_f16_f32 v12, v92, v93
  v_cvt_pk_f16_f32 v14, v94, v95
  v_mfma_f32_16x16x32_f16 v[152:155], a[216:219], v[32:35], v[152:155]
  v_pk_fma_f16 v9, v8, v8, s34 neg_lo:[1,0,0] neg_hi:[1,0,0]
  v_pk_fma_f16 v11, v10, v10, s34 neg_lo:[1,0,0] neg_hi:[1,0,0]
  v_pk_fma_f16 v13, v12, v12, s34 neg_lo:[1,0,0] neg_hi:[1,0,0]
  v_mfma_f32_16x16x32_f16 v[164:167], a[220:223], v[32:35], v[164:167]
  v_pk_fma_f16 v15, v14, v14, s34 neg_lo:[1,0,0] neg_hi:[1,0,0]
  v_pk_mul_f16 v9, v9, v8
  v_mfma_f32_16x16x32_f16 v[160:163], a[220:223], v[28:31], v[160:163]
  v_pk_mul_f16 v11, v11, v10
  v_pk_mul_f16 v13, v13, v12
  v_mfma_f32_16x16x32_f16 v[156:159], a[220:223], v[24:27], v[156:159]
  s_waitcnt lgkmcnt(3)
  v_pk_mul_f16 v15, v15, v14
  v_exp_f16_sdwa v9, v9 dst_sel:WORD_0 dst_unused:UNUSED_PRESERVE src0_sel:WORD_0
  v_mfma_f32_16x16x32_f16 v[168:171], a[224:227], v[24:27], v[168:171]
  s_waitcnt lgkmcnt(0)
  s_waitcnt vmcnt(4)
  s_barrier
  ds_read_b128 a[216:219], v1 offset:0
  v_exp_f16_sdwa v11, v11 dst_sel:WORD_0 dst_unused:UNUSED_PRESERVE src0_sel:WORD_0
  v_mfma_f32_16x16x32_f16 v[172:175], a[224:227], v[28:31], v[172:175]
  v_exp_f16_sdwa v13, v13 dst_sel:WORD_0 dst_unused:UNUSED_PRESERVE src0_sel:WORD_0
  v_mfma_f32_16x16x32_f16 v[176:179], a[224:227], v[32:35], v[176:179]
  v_exp_f16_sdwa v15, v15 dst_sel:WORD_0 dst_unused:UNUSED_PRESERVE src0_sel:WORD_0
  v_mfma_f32_16x16x32_f16 v[188:191], a[228:231], v[32:35], v[188:191]
  ds_read_b128 a[220:223], v1 offset:1024
  v_exp_f16_sdwa v9, v9 dst_sel:WORD_1 dst_unused:UNUSED_PRESERVE src0_sel:WORD_1
  v_mfma_f32_16x16x32_f16 v[184:187], a[228:231], v[28:31], v[184:187]
  v_exp_f16_sdwa v11, v11 dst_sel:WORD_1 dst_unused:UNUSED_PRESERVE src0_sel:WORD_1
  v_mfma_f32_16x16x32_f16 v[180:183], a[228:231], v[24:27], v[180:183]
  v_exp_f16_sdwa v13, v13 dst_sel:WORD_1 dst_unused:UNUSED_PRESERVE src0_sel:WORD_1
  v_mfma_f32_16x16x32_f16 v[192:195], a[232:235], v[24:27], v[192:195]
  ds_read_b128 a[224:227], v1 offset:2048
  v_exp_f16_sdwa v15, v15 dst_sel:WORD_1 dst_unused:UNUSED_PRESERVE src0_sel:WORD_1
  v_mfma_f32_16x16x32_f16 v[196:199], a[232:235], v[28:31], v[196:199]
  v_pk_fma_f16 v9, v9, s35, s35
  v_pk_fma_f16 v11, v11, s35, s35
  v_mfma_f32_16x16x32_f16 v[200:203], a[232:235], v[32:35], v[200:203]
  v_pk_fma_f16 v13, v13, s35, s35
  v_pk_fma_f16 v15, v15, s35, s35
  v_mfma_f32_16x16x32_f16 v[212:215], a[236:239], v[32:35], v[212:215]
  ds_read_b128 a[228:231], v1 offset:3072
  v_rcp_f16_sdwa v9, v9 dst_sel:WORD_0 dst_unused:UNUSED_PRESERVE src0_sel:WORD_0
  v_mfma_f32_16x16x32_f16 v[208:211], a[236:239], v[28:31], v[208:211]
  v_rcp_f16_sdwa v11, v11 dst_sel:WORD_0 dst_unused:UNUSED_PRESERVE src0_sel:WORD_0
  v_mfma_f32_16x16x32_f16 v[204:207], a[236:239], v[24:27], v[204:207]
  v_rcp_f16_sdwa v13, v13 dst_sel:WORD_0 dst_unused:UNUSED_PRESERVE src0_sel:WORD_0
  v_rcp_f16_sdwa v15, v15 dst_sel:WORD_0 dst_unused:UNUSED_PRESERVE src0_sel:WORD_0
  v_mfma_f32_16x16x32_f16 v[216:219], a[240:243], v[24:27], v[216:219]
  ds_read_b128 a[232:235], v1 offset:4096
  v_rcp_f16_sdwa v9, v9 dst_sel:WORD_1 dst_unused:UNUSED_PRESERVE src0_sel:WORD_1
  v_mfma_f32_16x16x32_f16 v[220:223], a[240:243], v[28:31], v[220:223]
  v_rcp_f16_sdwa v11, v11 dst_sel:WORD_1 dst_unused:UNUSED_PRESERVE src0_sel:WORD_1
  v_mfma_f32_16x16x32_f16 v[224:227], a[240:243], v[32:35], v[224:227]
  v_rcp_f16_sdwa v13, v13 dst_sel:WORD_1 dst_unused:UNUSED_PRESERVE src0_sel:WORD_1
  v_mfma_f32_16x16x32_f16 v[236:239], a[244:247], v[32:35], v[236:239]
  ds_read_b128 a[236:239], v1 offset:5120
  v_rcp_f16_sdwa v15, v15 dst_sel:WORD_1 dst_unused:UNUSED_PRESERVE src0_sel:WORD_1
  v_mfma_f32_16x16x32_f16 v[232:235], a[244:247], v[28:31], v[232:235]
  v_pk_mul_f16 v42, v8, v9
  v_pk_mul_f16 v43, v10, v11
  v_mfma_f32_16x16x32_f16 v[228:231], a[244:247], v[24:27], v[228:231]
  s_waitcnt lgkmcnt(3)
  v_pk_mul_f16 v46, v12, v13
  v_pk_mul_f16 v47, v14, v15
  v_mfma_f32_16x16x32_bf16 v[72:75], a[216:219], a[0:3], 0
  ds_read_b128 a[240:243], v1 offset:6144
  s_add_u32 m0, s29, 49152
  s_add_u32 s31, s29, 442368
  buffer_load_dwordx4 v2, s[8:11], s31 offen offset:0 lds
  v_cvt_pk_f16_f32 v8, v48, v49
  v_cvt_pk_f16_f32 v10, v50, v51
  v_mfma_f32_16x16x32_bf16 v[76:79], a[216:219], a[24:27], 0
  v_cvt_pk_f16_f32 v12, v52, v53
  v_cvt_pk_f16_f32 v14, v54, v55
  v_mfma_f32_16x16x32_bf16 v[80:83], a[216:219], a[48:51], 0
  v_pk_fma_f16 v9, v8, v8, s34 neg_lo:[1,0,0] neg_hi:[1,0,0]
  v_pk_fma_f16 v11, v10, v10, s34 neg_lo:[1,0,0] neg_hi:[1,0,0]
  v_pk_fma_f16 v13, v12, v12, s34 neg_lo:[1,0,0] neg_hi:[1,0,0]
  v_mfma_f32_16x16x32_bf16 v[92:95], a[220:223], a[48:51], 0
  ds_read_b128 a[244:247], v1 offset:7168
  buffer_load_dwordx4 v2, s[8:11], s31 offen offset:1024 lds
  v_pk_fma_f16 v15, v14, v14, s34 neg_lo:[1,0,0] neg_hi:[1,0,0]
  v_pk_mul_f16 v9, v9, v8
  v_mfma_f32_16x16x32_bf16 v[88:91], a[220:223], a[24:27], 0
  v_pk_mul_f16 v11, v11, v10
  v_pk_mul_f16 v13, v13, v12
  v_mfma_f32_16x16x32_bf16 v[84:87], a[220:223], a[0:3], 0
  v_pk_mul_f16 v15, v15, v14
  v_exp_f16_sdwa v9, v9 dst_sel:WORD_0 dst_unused:UNUSED_PRESERVE src0_sel:WORD_0
  v_mfma_f32_16x16x32_bf16 v[72:75], a[224:227], a[4:7], v[72:75]
  ds_read_b128 a[216:219], v1 offset:8192
  buffer_load_dwordx4 v2, s[8:11], s31 offen offset:2048 lds
  v_exp_f16_sdwa v11, v11 dst_sel:WORD_0 dst_unused:UNUSED_PRESERVE src0_sel:WORD_0
  v_mfma_f32_16x16x32_bf16 v[76:79], a[224:227], a[28:31], v[76:79]
  v_exp_f16_sdwa v13, v13 dst_sel:WORD_0 dst_unused:UNUSED_PRESERVE src0_sel:WORD_0
  v_mfma_f32_16x16x32_bf16 v[80:83], a[224:227], a[52:55], v[80:83]
  s_waitcnt lgkmcnt(3)
  v_exp_f16_sdwa v15, v15 dst_sel:WORD_0 dst_unused:UNUSED_PRESERVE src0_sel:WORD_0
  v_mfma_f32_16x16x32_bf16 v[92:95], a[228:231], a[52:55], v[92:95]
  ds_read_b128 a[220:223], v1 offset:9216
  buffer_load_dwordx4 v2, s[8:11], s31 offen offset:3072 lds
  v_exp_f16_sdwa v9, v9 dst_sel:WORD_1 dst_unused:UNUSED_PRESERVE src0_sel:WORD_1
  v_mfma_f32_16x16x32_bf16 v[88:91], a[228:231], a[28:31], v[88:91]
  s_add_u32 m0, s29, 53248
  v_exp_f16_sdwa v11, v11 dst_sel:WORD_1 dst_unused:UNUSED_PRESERVE src0_sel:WORD_1
  v_mfma_f32_16x16x32_bf16 v[84:87], a[228:231], a[4:7], v[84:87]
  s_add_u32 s31, s29, 446464
  v_exp_f16_sdwa v13, v13 dst_sel:WORD_1 dst_unused:UNUSED_PRESERVE src0_sel:WORD_1
  v_mfma_f32_16x16x32_bf16 v[72:75], a[232:235], a[8:11], v[72:75]
  ds_read_b128 a[224:227], v1 offset:10240
  buffer_load_dwordx4 v2, s[8:11], s31 offen offset:0 lds
  v_exp_f16_sdwa v15, v15 dst_sel:WORD_1 dst_unused:UNUSED_PRESERVE src0_sel:WORD_1
  v_mfma_f32_16x16x32_bf16 v[76:79], a[232:235], a[32:35], v[76:79]
  v_pk_fma_f16 v9, v9, s35, s35
  v_pk_fma_f16 v11, v11, s35, s35
  v_mfma_f32_16x16x32_bf16 v[80:83], a[232:235], a[56:59], v[80:83]
  v_pk_fma_f16 v13, v13, s35, s35
  v_pk_fma_f16 v15, v15, s35, s35
  v_mfma_f32_16x16x32_bf16 v[92:95], a[236:239], a[56:59], v[92:95]
  ds_read_b128 a[228:231], v1 offset:11264
  buffer_load_dwordx4 v2, s[8:11], s31 offen offset:1024 lds
  v_rcp_f16_sdwa v9, v9 dst_sel:WORD_0 dst_unused:UNUSED_PRESERVE src0_sel:WORD_0
  v_mfma_f32_16x16x32_bf16 v[88:91], a[236:239], a[32:35], v[88:91]
  v_rcp_f16_sdwa v11, v11 dst_sel:WORD_0 dst_unused:UNUSED_PRESERVE src0_sel:WORD_0
  v_mfma_f32_16x16x32_bf16 v[84:87], a[236:239], a[8:11], v[84:87]
  s_waitcnt lgkmcnt(3)
  v_rcp_f16_sdwa v13, v13 dst_sel:WORD_0 dst_unused:UNUSED_PRESERVE src0_sel:WORD_0
  v_rcp_f16_sdwa v15, v15 dst_sel:WORD_0 dst_unused:UNUSED_PRESERVE src0_sel:WORD_0
  v_mfma_f32_16x16x32_bf16 v[72:75], a[240:243], a[12:15], v[72:75]
  ds_read_b128 a[232:235], v1 offset:12288
  buffer_load_dwordx4 v2, s[8:11], s31 offen offset:2048 lds
  v_rcp_f16_sdwa v9, v9 dst_sel:WORD_1 dst_unused:UNUSED_PRESERVE src0_sel:WORD_1
  v_mfma_f32_16x16x32_bf16 v[76:79], a[240:243], a[36:39], v[76:79]
  v_rcp_f16_sdwa v11, v11 dst_sel:WORD_1 dst_unused:UNUSED_PRESERVE src0_sel:WORD_1
  v_mfma_f32_16x16x32_bf16 v[80:83], a[240:243], a[60:63], v[80:83]
  v_rcp_f16_sdwa v13, v13 dst_sel:WORD_1 dst_unused:UNUSED_PRESERVE src0_sel:WORD_1
  v_mfma_f32_16x16x32_bf16 v[92:95], a[244:247], a[60:63], v[92:95]
  ds_read_b128 a[236:239], v1 offset:13312
  buffer_load_dwordx4 v2, s[8:11], s31 offen offset:3072 lds
  v_rcp_f16_sdwa v15, v15 dst_sel:WORD_1 dst_unused:UNUSED_PRESERVE src0_sel:WORD_1
  v_mfma_f32_16x16x32_bf16 v[88:91], a[244:247], a[36:39], v[88:91]
  s_add_u32 m0, s29, 57344
  v_pk_mul_f16 v24, v8, v9
  v_pk_mul_f16 v25, v10, v11
  v_mfma_f32_16x16x32_bf16 v[84:87], a[244:247], a[12:15], v[84:87]
  s_add_u32 s31, s29, 450560
  v_pk_mul_f16 v28, v12, v13
  v_pk_mul_f16 v29, v14, v15
  v_mfma_f32_16x16x32_bf16 v[72:75], a[216:219], a[16:19], v[72:75]
  ds_read_b128 a[240:243], v1 offset:14336
  buffer_load_dwordx4 v2, s[8:11], s31 offen offset:0 lds
  v_cvt_pk_f16_f32 v16, v56, v57
  v_cvt_pk_f16_f32 v18, v58, v59
  v_mfma_f32_16x16x32_bf16 v[76:79], a[216:219], a[40:43], v[76:79]
  v_cvt_pk_f16_f32 v20, v60, v61
  v_cvt_pk_f16_f32 v22, v62, v63
  v_mfma_f32_16x16x32_bf16 v[80:83], a[216:219], a[64:67], v[80:83]
  s_waitcnt lgkmcnt(3)
  v_pk_fma_f16 v17, v16, v16, s34 neg_lo:[1,0,0] neg_hi:[1,0,0]
  v_pk_fma_f16 v19, v18, v18, s34 neg_lo:[1,0,0] neg_hi:[1,0,0]
  v_pk_fma_f16 v21, v20, v20, s34 neg_lo:[1,0,0] neg_hi:[1,0,0]
  v_mfma_f32_16x16x32_bf16 v[92:95], a[220:223], a[64:67], v[92:95]
  ds_read_b128 a[244:247], v1 offset:15360
  buffer_load_dwordx4 v2, s[8:11], s31 offen offset:1024 lds
  v_pk_fma_f16 v23, v22, v22, s34 neg_lo:[1,0,0] neg_hi:[1,0,0]
  v_pk_mul_f16 v17, v17, v16
  v_mfma_f32_16x16x32_bf16 v[88:91], a[220:223], a[40:43], v[88:91]
  v_pk_mul_f16 v19, v19, v18
  v_pk_mul_f16 v21, v21, v20
  v_mfma_f32_16x16x32_bf16 v[84:87], a[220:223], a[16:19], v[84:87]
  v_pk_mul_f16 v23, v23, v22
  v_exp_f16_sdwa v17, v17 dst_sel:WORD_0 dst_unused:UNUSED_PRESERVE src0_sel:WORD_0
  v_mfma_f32_16x16x32_bf16 v[72:75], a[224:227], a[20:23], v[72:75]
  ds_read_b128 a[216:219], v1 offset:16384
  buffer_load_dwordx4 v2, s[8:11], s31 offen offset:2048 lds
  v_exp_f16_sdwa v19, v19 dst_sel:WORD_0 dst_unused:UNUSED_PRESERVE src0_sel:WORD_0
  v_mfma_f32_16x16x32_bf16 v[76:79], a[224:227], a[44:47], v[76:79]
  v_exp_f16_sdwa v21, v21 dst_sel:WORD_0 dst_unused:UNUSED_PRESERVE src0_sel:WORD_0
  v_mfma_f32_16x16x32_bf16 v[80:83], a[224:227], a[68:71], v[80:83]
  v_exp_f16_sdwa v23, v23 dst_sel:WORD_0 dst_unused:UNUSED_PRESERVE src0_sel:WORD_0
  v_mfma_f32_16x16x32_bf16 v[92:95], a[228:231], a[68:71], v[92:95]
  ds_read_b128 a[220:223], v1 offset:17408
  buffer_load_dwordx4 v2, s[8:11], s31 offen offset:3072 lds
  v_exp_f16_sdwa v17, v17 dst_sel:WORD_1 dst_unused:UNUSED_PRESERVE src0_sel:WORD_1
  v_mfma_f32_16x16x32_bf16 v[88:91], a[228:231], a[44:47], v[88:91]
  v_exp_f16_sdwa v19, v19 dst_sel:WORD_1 dst_unused:UNUSED_PRESERVE src0_sel:WORD_1
  v_mfma_f32_16x16x32_bf16 v[84:87], a[228:231], a[20:23], v[84:87]
  s_waitcnt lgkmcnt(3)
  v_exp_f16_sdwa v21, v21 dst_sel:WORD_1 dst_unused:UNUSED_PRESERVE src0_sel:WORD_1
  v_mfma_f32_16x16x32_f16 v[96:99], a[232:235], v[36:39], v[96:99]
  ds_read_b128 a[224:227], v1 offset:18432
  v_exp_f16_sdwa v23, v23 dst_sel:WORD_1 dst_unused:UNUSED_PRESERVE src0_sel:WORD_1
  v_mfma_f32_16x16x32_f16 v[100:103], a[232:235], v[40:43], v[100:103]
  v_pk_fma_f16 v17, v17, s35, s35
  v_pk_fma_f16 v19, v19, s35, s35
  v_mfma_f32_16x16x32_f16 v[104:107], a[232:235], v[44:47], v[104:107]
  v_pk_fma_f16 v21, v21, s35, s35
  v_pk_fma_f16 v23, v23, s35, s35
  v_mfma_f32_16x16x32_f16 v[116:119], a[236:239], v[44:47], v[116:119]
  ds_read_b128 a[228:231], v1 offset:19456
  v_rcp_f16_sdwa v17, v17 dst_sel:WORD_0 dst_unused:UNUSED_PRESERVE src0_sel:WORD_0
  v_mfma_f32_16x16x32_f16 v[112:115], a[236:239], v[40:43], v[112:115]
  v_rcp_f16_sdwa v19, v19 dst_sel:WORD_0 dst_unused:UNUSED_PRESERVE src0_sel:WORD_0
  v_mfma_f32_16x16x32_f16 v[108:111], a[236:239], v[36:39], v[108:111]
  v_rcp_f16_sdwa v21, v21 dst_sel:WORD_0 dst_unused:UNUSED_PRESERVE src0_sel:WORD_0
  v_rcp_f16_sdwa v23, v23 dst_sel:WORD_0 dst_unused:UNUSED_PRESERVE src0_sel:WORD_0
  v_mfma_f32_16x16x32_f16 v[120:123], a[240:243], v[36:39], v[120:123]
  ds_read_b128 a[232:235], v1 offset:20480
  v_rcp_f16_sdwa v17, v17 dst_sel:WORD_1 dst_unused:UNUSED_PRESERVE src0_sel:WORD_1
  v_mfma_f32_16x16x32_f16 v[124:127], a[240:243], v[40:43], v[124:127]
  v_rcp_f16_sdwa v19, v19 dst_sel:WORD_1 dst_unused:UNUSED_PRESERVE src0_sel:WORD_1
  v_mfma_f32_16x16x32_f16 v[128:131], a[240:243], v[44:47], v[128:131]
  s_waitcnt lgkmcnt(3)
  v_rcp_f16_sdwa v21, v21 dst_sel:WORD_1 dst_unused:UNUSED_PRESERVE src0_sel:WORD_1
  v_mfma_f32_16x16x32_f16 v[140:143], a[244:247], v[44:47], v[140:143]
  ds_read_b128 a[236:239], v1 offset:21504
  v_rcp_f16_sdwa v23, v23 dst_sel:WORD_1 dst_unused:UNUSED_PRESERVE src0_sel:WORD_1
  v_mfma_f32_16x16x32_f16 v[136:139], a[244:247], v[40:43], v[136:139]
  v_pk_mul_f16 v32, v16, v17
  v_pk_mul_f16 v33, v18, v19
  v_mfma_f32_16x16x32_f16 v[132:135], a[244:247], v[36:39], v[132:135]
  v_pk_mul_f16 v26, v20, v21
  v_pk_mul_f16 v27, v22, v23
  v_mfma_f32_16x16x32_f16 v[144:147], a[216:219], v[36:39], v[144:147]
  ds_read_b128 a[240:243], v1 offset:22528
  v_cvt_pk_f16_f32 v8, v64, v65
  v_cvt_pk_f16_f32 v10, v66, v67
  v_mfma_f32_16x16x32_f16 v[148:151], a[216:219], v[40:43], v[148:151]
  v_cvt_pk_f16_f32 v12, v68, v69
  v_cvt_pk_f16_f32 v14, v70, v71
  v_mfma_f32_16x16x32_f16 v[152:155], a[216:219], v[44:47], v[152:155]
  v_pk_fma_f16 v9, v8, v8, s34 neg_lo:[1,0,0] neg_hi:[1,0,0]
  v_pk_fma_f16 v11, v10, v10, s34 neg_lo:[1,0,0] neg_hi:[1,0,0]
  v_pk_fma_f16 v13, v12, v12, s34 neg_lo:[1,0,0] neg_hi:[1,0,0]
  v_mfma_f32_16x16x32_f16 v[164:167], a[220:223], v[44:47], v[164:167]
  ds_read_b128 a[244:247], v1 offset:23552
  v_pk_fma_f16 v15, v14, v14, s34 neg_lo:[1,0,0] neg_hi:[1,0,0]
  v_pk_mul_f16 v9, v9, v8
  v_mfma_f32_16x16x32_f16 v[160:163], a[220:223], v[40:43], v[160:163]
  v_pk_mul_f16 v11, v11, v10
  v_pk_mul_f16 v13, v13, v12
  v_mfma_f32_16x16x32_f16 v[156:159], a[220:223], v[36:39], v[156:159]
  s_waitcnt lgkmcnt(3)
  v_pk_mul_f16 v15, v15, v14
  v_exp_f16_sdwa v9, v9 dst_sel:WORD_0 dst_unused:UNUSED_PRESERVE src0_sel:WORD_0
  v_mfma_f32_16x16x32_f16 v[168:171], a[224:227], v[36:39], v[168:171]
  ds_read_b128 a[216:219], v1 offset:24576
  v_exp_f16_sdwa v11, v11 dst_sel:WORD_0 dst_unused:UNUSED_PRESERVE src0_sel:WORD_0
  v_mfma_f32_16x16x32_f16 v[172:175], a[224:227], v[40:43], v[172:175]
  v_exp_f16_sdwa v13, v13 dst_sel:WORD_0 dst_unused:UNUSED_PRESERVE src0_sel:WORD_0
  v_mfma_f32_16x16x32_f16 v[176:179], a[224:227], v[44:47], v[176:179]
  v_exp_f16_sdwa v15, v15 dst_sel:WORD_0 dst_unused:UNUSED_PRESERVE src0_sel:WORD_0
  v_mfma_f32_16x16x32_f16 v[188:191], a[228:231], v[44:47], v[188:191]
  ds_read_b128 a[220:223], v1 offset:25600
  v_exp_f16_sdwa v9, v9 dst_sel:WORD_1 dst_unused:UNUSED_PRESERVE src0_sel:WORD_1
  v_mfma_f32_16x16x32_f16 v[184:187], a[228:231], v[40:43], v[184:187]
  v_exp_f16_sdwa v11, v11 dst_sel:WORD_1 dst_unused:UNUSED_PRESERVE src0_sel:WORD_1
  v_mfma_f32_16x16x32_f16 v[180:183], a[228:231], v[36:39], v[180:183]
  v_exp_f16_sdwa v13, v13 dst_sel:WORD_1 dst_unused:UNUSED_PRESERVE src0_sel:WORD_1
  v_mfma_f32_16x16x32_f16 v[192:195], a[232:235], v[36:39], v[192:195]
  ds_read_b128 a[224:227], v1 offset:26624
  v_exp_f16_sdwa v15, v15 dst_sel:WORD_1 dst_unused:UNUSED_PRESERVE src0_sel:WORD_1
  v_mfma_f32_16x16x32_f16 v[196:199], a[232:235], v[40:43], v[196:199]
  v_pk_fma_f16 v9, v9, s35, s35
  v_pk_fma_f16 v11, v11, s35, s35
  v_mfma_f32_16x16x32_f16 v[200:203], a[232:235], v[44:47], v[200:203]
  s_waitcnt lgkmcnt(3)
  v_pk_fma_f16 v13, v13, s35, s35
  v_pk_fma_f16 v15, v15, s35, s35
  v_mfma_f32_16x16x32_f16 v[212:215], a[236:239], v[44:47], v[212:215]
  ds_read_b128 a[228:231], v1 offset:27648
  v_rcp_f16_sdwa v9, v9 dst_sel:WORD_0 dst_unused:UNUSED_PRESERVE src0_sel:WORD_0
  v_mfma_f32_16x16x32_f16 v[208:211], a[236:239], v[40:43], v[208:211]
  v_rcp_f16_sdwa v11, v11 dst_sel:WORD_0 dst_unused:UNUSED_PRESERVE src0_sel:WORD_0
  v_mfma_f32_16x16x32_f16 v[204:207], a[236:239], v[36:39], v[204:207]
  v_rcp_f16_sdwa v13, v13 dst_sel:WORD_0 dst_unused:UNUSED_PRESERVE src0_sel:WORD_0
  v_rcp_f16_sdwa v15, v15 dst_sel:WORD_0 dst_unused:UNUSED_PRESERVE src0_sel:WORD_0
  v_mfma_f32_16x16x32_f16 v[216:219], a[240:243], v[36:39], v[216:219]
  ds_read_b128 a[232:235], v1 offset:28672
  v_rcp_f16_sdwa v9, v9 dst_sel:WORD_1 dst_unused:UNUSED_PRESERVE src0_sel:WORD_1
  v_mfma_f32_16x16x32_f16 v[220:223], a[240:243], v[40:43], v[220:223]
  v_rcp_f16_sdwa v11, v11 dst_sel:WORD_1 dst_unused:UNUSED_PRESERVE src0_sel:WORD_1
  v_mfma_f32_16x16x32_f16 v[224:227], a[240:243], v[44:47], v[224:227]
  v_rcp_f16_sdwa v13, v13 dst_sel:WORD_1 dst_unused:UNUSED_PRESERVE src0_sel:WORD_1
  v_mfma_f32_16x16x32_f16 v[236:239], a[244:247], v[44:47], v[236:239]
  ds_read_b128 a[236:239], v1 offset:29696
  v_rcp_f16_sdwa v15, v15 dst_sel:WORD_1 dst_unused:UNUSED_PRESERVE src0_sel:WORD_1
  v_mfma_f32_16x16x32_f16 v[232:235], a[244:247], v[40:43], v[232:235]
  v_pk_mul_f16 v30, v8, v9
  v_pk_mul_f16 v31, v10, v11
  v_mfma_f32_16x16x32_f16 v[228:231], a[244:247], v[36:39], v[228:231]
  s_waitcnt lgkmcnt(3)
  v_pk_mul_f16 v34, v12, v13
  v_pk_mul_f16 v35, v14, v15
  v_mfma_f32_16x16x32_bf16 v[48:51], a[216:219], a[0:3], 0
  ds_read_b128 a[240:243], v1 offset:30720
  v_cvt_pk_f16_f32 v8, v72, v73
  v_cvt_pk_f16_f32 v10, v74, v75
  v_mfma_f32_16x16x32_bf16 v[52:55], a[216:219], a[24:27], 0
  v_cvt_pk_f16_f32 v12, v76, v77
  v_cvt_pk_f16_f32 v14, v78, v79
  v_mfma_f32_16x16x32_bf16 v[56:59], a[216:219], a[48:51], 0
  v_pk_fma_f16 v9, v8, v8, s34 neg_lo:[1,0,0] neg_hi:[1,0,0]
  v_pk_fma_f16 v11, v10, v10, s34 neg_lo:[1,0,0] neg_hi:[1,0,0]
  v_pk_fma_f16 v13, v12, v12, s34 neg_lo:[1,0,0] neg_hi:[1,0,0]
  v_mfma_f32_16x16x32_bf16 v[68:71], a[220:223], a[48:51], 0
  ds_read_b128 a[244:247], v1 offset:31744
  v_pk_fma_f16 v15, v14, v14, s34 neg_lo:[1,0,0] neg_hi:[1,0,0]
  v_pk_mul_f16 v9, v9, v8
  v_mfma_f32_16x16x32_bf16 v[64:67], a[220:223], a[24:27], 0
  buffer_load_dwordx4 a[176:179], v3, s[16:19], s96 offen offset:128
  v_pk_mul_f16 v11, v11, v10
  v_pk_mul_f16 v13, v13, v12
  v_mfma_f32_16x16x32_bf16 v[60:63], a[220:223], a[0:3], 0
  v_pk_mul_f16 v15, v15, v14
  v_exp_f16_sdwa v9, v9 dst_sel:WORD_0 dst_unused:UNUSED_PRESERVE src0_sel:WORD_0
  v_mfma_f32_16x16x32_bf16 v[48:51], a[224:227], a[4:7], v[48:51]
  ds_read_b128 a[216:219], v1 offset:32768
  v_exp_f16_sdwa v11, v11 dst_sel:WORD_0 dst_unused:UNUSED_PRESERVE src0_sel:WORD_0
  v_mfma_f32_16x16x32_bf16 v[52:55], a[224:227], a[28:31], v[52:55]
  v_exp_f16_sdwa v13, v13 dst_sel:WORD_0 dst_unused:UNUSED_PRESERVE src0_sel:WORD_0
  v_mfma_f32_16x16x32_bf16 v[56:59], a[224:227], a[52:55], v[56:59]
  s_waitcnt lgkmcnt(3)
  v_exp_f16_sdwa v15, v15 dst_sel:WORD_0 dst_unused:UNUSED_PRESERVE src0_sel:WORD_0
  v_mfma_f32_16x16x32_bf16 v[68:71], a[228:231], a[52:55], v[68:71]
  ds_read_b128 a[220:223], v1 offset:33792
  v_exp_f16_sdwa v9, v9 dst_sel:WORD_1 dst_unused:UNUSED_PRESERVE src0_sel:WORD_1
  v_mfma_f32_16x16x32_bf16 v[64:67], a[228:231], a[28:31], v[64:67]
  v_exp_f16_sdwa v11, v11 dst_sel:WORD_1 dst_unused:UNUSED_PRESERVE src0_sel:WORD_1
  v_mfma_f32_16x16x32_bf16 v[60:63], a[228:231], a[4:7], v[60:63]
  v_exp_f16_sdwa v13, v13 dst_sel:WORD_1 dst_unused:UNUSED_PRESERVE src0_sel:WORD_1
  v_mfma_f32_16x16x32_bf16 v[48:51], a[232:235], a[8:11], v[48:51]
  ds_read_b128 a[224:227], v1 offset:34816
  v_exp_f16_sdwa v15, v15 dst_sel:WORD_1 dst_unused:UNUSED_PRESERVE src0_sel:WORD_1
  v_mfma_f32_16x16x32_bf16 v[52:55], a[232:235], a[32:35], v[52:55]
  buffer_load_dwordx4 a[180:183], v3, s[16:19], s96 offen offset:192
  v_pk_fma_f16 v9, v9, s35, s35
  v_pk_fma_f16 v11, v11, s35, s35
  v_mfma_f32_16x16x32_bf16 v[56:59], a[232:235], a[56:59], v[56:59]
  v_pk_fma_f16 v13, v13, s35, s35
  v_pk_fma_f16 v15, v15, s35, s35
  v_mfma_f32_16x16x32_bf16 v[68:71], a[236:239], a[56:59], v[68:71]
  ds_read_b128 a[228:231], v1 offset:35840
  v_rcp_f16_sdwa v9, v9 dst_sel:WORD_0 dst_unused:UNUSED_PRESERVE src0_sel:WORD_0
  v_mfma_f32_16x16x32_bf16 v[64:67], a[236:239], a[32:35], v[64:67]
  v_rcp_f16_sdwa v11, v11 dst_sel:WORD_0 dst_unused:UNUSED_PRESERVE src0_sel:WORD_0
  v_mfma_f32_16x16x32_bf16 v[60:63], a[236:239], a[8:11], v[60:63]
  s_waitcnt lgkmcnt(3)
  v_rcp_f16_sdwa v13, v13 dst_sel:WORD_0 dst_unused:UNUSED_PRESERVE src0_sel:WORD_0
  v_rcp_f16_sdwa v15, v15 dst_sel:WORD_0 dst_unused:UNUSED_PRESERVE src0_sel:WORD_0
  v_mfma_f32_16x16x32_bf16 v[48:51], a[240:243], a[12:15], v[48:51]
  ds_read_b128 a[232:235], v1 offset:36864
  v_rcp_f16_sdwa v9, v9 dst_sel:WORD_1 dst_unused:UNUSED_PRESERVE src0_sel:WORD_1
  v_mfma_f32_16x16x32_bf16 v[52:55], a[240:243], a[36:39], v[52:55]
  v_rcp_f16_sdwa v11, v11 dst_sel:WORD_1 dst_unused:UNUSED_PRESERVE src0_sel:WORD_1
  v_mfma_f32_16x16x32_bf16 v[56:59], a[240:243], a[60:63], v[56:59]
  v_rcp_f16_sdwa v13, v13 dst_sel:WORD_1 dst_unused:UNUSED_PRESERVE src0_sel:WORD_1
  v_mfma_f32_16x16x32_bf16 v[68:71], a[244:247], a[60:63], v[68:71]
  ds_read_b128 a[236:239], v1 offset:37888
  v_rcp_f16_sdwa v15, v15 dst_sel:WORD_1 dst_unused:UNUSED_PRESERVE src0_sel:WORD_1
  v_mfma_f32_16x16x32_bf16 v[64:67], a[244:247], a[36:39], v[64:67]
  buffer_load_dwordx4 a[184:187], v3, s[16:19], s96 offen offset:256
  v_pk_mul_f16 v36, v8, v9
  v_pk_mul_f16 v37, v10, v11
  v_mfma_f32_16x16x32_bf16 v[60:63], a[244:247], a[12:15], v[60:63]
  v_pk_mul_f16 v40, v12, v13
  v_pk_mul_f16 v41, v14, v15
  v_mfma_f32_16x16x32_bf16 v[48:51], a[216:219], a[16:19], v[48:51]
  ds_read_b128 a[240:243], v1 offset:38912
  v_cvt_pk_f16_f32 v16, v80, v81
  v_cvt_pk_f16_f32 v18, v82, v83
  v_mfma_f32_16x16x32_bf16 v[52:55], a[216:219], a[40:43], v[52:55]
  v_cvt_pk_f16_f32 v20, v84, v85
  v_cvt_pk_f16_f32 v22, v86, v87
  v_mfma_f32_16x16x32_bf16 v[56:59], a[216:219], a[64:67], v[56:59]
  s_waitcnt lgkmcnt(3)
  v_pk_fma_f16 v17, v16, v16, s34 neg_lo:[1,0,0] neg_hi:[1,0,0]
  v_pk_fma_f16 v19, v18, v18, s34 neg_lo:[1,0,0] neg_hi:[1,0,0]
  v_pk_fma_f16 v21, v20, v20, s34 neg_lo:[1,0,0] neg_hi:[1,0,0]
  v_mfma_f32_16x16x32_bf16 v[68:71], a[220:223], a[64:67], v[68:71]
  ds_read_b128 a[244:247], v1 offset:39936
  v_pk_fma_f16 v23, v22, v22, s34 neg_lo:[1,0,0] neg_hi:[1,0,0]
  v_pk_mul_f16 v17, v17, v16
  v_mfma_f32_16x16x32_bf16 v[64:67], a[220:223], a[40:43], v[64:67]
  v_pk_mul_f16 v19, v19, v18
  v_pk_mul_f16 v21, v21, v20
  v_mfma_f32_16x16x32_bf16 v[60:63], a[220:223], a[16:19], v[60:63]
  v_pk_mul_f16 v23, v23, v22
  v_exp_f16_sdwa v17, v17 dst_sel:WORD_0 dst_unused:UNUSED_PRESERVE src0_sel:WORD_0
  v_mfma_f32_16x16x32_bf16 v[48:51], a[224:227], a[20:23], v[48:51]
  ds_read_b128 a[216:219], v1 offset:40960
  v_exp_f16_sdwa v19, v19 dst_sel:WORD_0 dst_unused:UNUSED_PRESERVE src0_sel:WORD_0
  v_mfma_f32_16x16x32_bf16 v[52:55], a[224:227], a[44:47], v[52:55]
  buffer_load_dwordx4 a[188:191], v3, s[16:19], s96 offen offset:320
  v_exp_f16_sdwa v21, v21 dst_sel:WORD_0 dst_unused:UNUSED_PRESERVE src0_sel:WORD_0
  v_mfma_f32_16x16x32_bf16 v[56:59], a[224:227], a[68:71], v[56:59]
  v_exp_f16_sdwa v23, v23 dst_sel:WORD_0 dst_unused:UNUSED_PRESERVE src0_sel:WORD_0
  v_mfma_f32_16x16x32_bf16 v[68:71], a[228:231], a[68:71], v[68:71]
  ds_read_b128 a[220:223], v1 offset:41984
  v_exp_f16_sdwa v17, v17 dst_sel:WORD_1 dst_unused:UNUSED_PRESERVE src0_sel:WORD_1
  v_mfma_f32_16x16x32_bf16 v[64:67], a[228:231], a[44:47], v[64:67]
  v_exp_f16_sdwa v19, v19 dst_sel:WORD_1 dst_unused:UNUSED_PRESERVE src0_sel:WORD_1
  v_mfma_f32_16x16x32_bf16 v[60:63], a[228:231], a[20:23], v[60:63]
  s_waitcnt lgkmcnt(3)
  v_exp_f16_sdwa v21, v21 dst_sel:WORD_1 dst_unused:UNUSED_PRESERVE src0_sel:WORD_1
  v_mfma_f32_16x16x32_f16 v[96:99], a[232:235], v[24:27], v[96:99]
  ds_read_b128 a[224:227], v1 offset:43008
  v_exp_f16_sdwa v23, v23 dst_sel:WORD_1 dst_unused:UNUSED_PRESERVE src0_sel:WORD_1
  v_mfma_f32_16x16x32_f16 v[100:103], a[232:235], v[28:31], v[100:103]
  v_pk_fma_f16 v17, v17, s35, s35
  v_pk_fma_f16 v19, v19, s35, s35
  v_mfma_f32_16x16x32_f16 v[104:107], a[232:235], v[32:35], v[104:107]
  v_pk_fma_f16 v21, v21, s35, s35
  v_pk_fma_f16 v23, v23, s35, s35
  v_mfma_f32_16x16x32_f16 v[116:119], a[236:239], v[32:35], v[116:119]
  ds_read_b128 a[228:231], v1 offset:44032
  v_rcp_f16_sdwa v17, v17 dst_sel:WORD_0 dst_unused:UNUSED_PRESERVE src0_sel:WORD_0
  v_mfma_f32_16x16x32_f16 v[112:115], a[236:239], v[28:31], v[112:115]
  v_rcp_f16_sdwa v19, v19 dst_sel:WORD_0 dst_unused:UNUSED_PRESERVE src0_sel:WORD_0
  v_mfma_f32_16x16x32_f16 v[108:111], a[236:239], v[24:27], v[108:111]
  v_rcp_f16_sdwa v21, v21 dst_sel:WORD_0 dst_unused:UNUSED_PRESERVE src0_sel:WORD_0
  v_rcp_f16_sdwa v23, v23 dst_sel:WORD_0 dst_unused:UNUSED_PRESERVE src0_sel:WORD_0
  v_mfma_f32_16x16x32_f16 v[120:123], a[240:243], v[24:27], v[120:123]
  ds_read_b128 a[232:235], v1 offset:45056
  v_rcp_f16_sdwa v17, v17 dst_sel:WORD_1 dst_unused:UNUSED_PRESERVE src0_sel:WORD_1
  v_mfma_f32_16x16x32_f16 v[124:127], a[240:243], v[28:31], v[124:127]
  v_rcp_f16_sdwa v19, v19 dst_sel:WORD_1 dst_unused:UNUSED_PRESERVE src0_sel:WORD_1
  v_mfma_f32_16x16x32_f16 v[128:131], a[240:243], v[32:35], v[128:131]
  s_waitcnt lgkmcnt(3)
  v_rcp_f16_sdwa v21, v21 dst_sel:WORD_1 dst_unused:UNUSED_PRESERVE src0_sel:WORD_1
  v_mfma_f32_16x16x32_f16 v[140:143], a[244:247], v[32:35], v[140:143]
  ds_read_b128 a[236:239], v1 offset:46080
  v_rcp_f16_sdwa v23, v23 dst_sel:WORD_1 dst_unused:UNUSED_PRESERVE src0_sel:WORD_1
  v_mfma_f32_16x16x32_f16 v[136:139], a[244:247], v[28:31], v[136:139]
  v_pk_mul_f16 v44, v16, v17
  v_pk_mul_f16 v45, v18, v19
  v_mfma_f32_16x16x32_f16 v[132:135], a[244:247], v[24:27], v[132:135]
  v_pk_mul_f16 v38, v20, v21
  v_pk_mul_f16 v39, v22, v23
  v_mfma_f32_16x16x32_f16 v[144:147], a[216:219], v[24:27], v[144:147]
  ds_read_b128 a[240:243], v1 offset:47104
  ds_read_b128 a[244:247], v1 offset:48128
  v_cvt_pk_f16_f32 v8, v88, v89
  v_cvt_pk_f16_f32 v10, v90, v91
  v_mfma_f32_16x16x32_f16 v[148:151], a[216:219], v[28:31], v[148:151]
  v_cvt_pk_f16_f32 v12, v92, v93
  v_cvt_pk_f16_f32 v14, v94, v95
  v_mfma_f32_16x16x32_f16 v[152:155], a[216:219], v[32:35], v[152:155]
  v_pk_fma_f16 v9, v8, v8, s34 neg_lo:[1,0,0] neg_hi:[1,0,0]
  v_pk_fma_f16 v11, v10, v10, s34 neg_lo:[1,0,0] neg_hi:[1,0,0]
  v_pk_fma_f16 v13, v12, v12, s34 neg_lo:[1,0,0] neg_hi:[1,0,0]
  v_mfma_f32_16x16x32_f16 v[164:167], a[220:223], v[32:35], v[164:167]
  v_pk_fma_f16 v15, v14, v14, s34 neg_lo:[1,0,0] neg_hi:[1,0,0]
  v_pk_mul_f16 v9, v9, v8
  v_mfma_f32_16x16x32_f16 v[160:163], a[220:223], v[28:31], v[160:163]
  v_pk_mul_f16 v11, v11, v10
  v_pk_mul_f16 v13, v13, v12
  v_mfma_f32_16x16x32_f16 v[156:159], a[220:223], v[24:27], v[156:159]
  s_waitcnt lgkmcnt(3)
  v_pk_mul_f16 v15, v15, v14
  v_exp_f16_sdwa v9, v9 dst_sel:WORD_0 dst_unused:UNUSED_PRESERVE src0_sel:WORD_0
  v_mfma_f32_16x16x32_f16 v[168:171], a[224:227], v[24:27], v[168:171]
  s_waitcnt lgkmcnt(0)
  s_waitcnt vmcnt(4)
  s_barrier
  ds_read_b128 a[216:219], v4 offset:0
  v_exp_f16_sdwa v11, v11 dst_sel:WORD_0 dst_unused:UNUSED_PRESERVE src0_sel:WORD_0
  v_mfma_f32_16x16x32_f16 v[172:175], a[224:227], v[28:31], v[172:175]
  v_exp_f16_sdwa v13, v13 dst_sel:WORD_0 dst_unused:UNUSED_PRESERVE src0_sel:WORD_0
  v_mfma_f32_16x16x32_f16 v[176:179], a[224:227], v[32:35], v[176:179]
  v_exp_f16_sdwa v15, v15 dst_sel:WORD_0 dst_unused:UNUSED_PRESERVE src0_sel:WORD_0
  v_mfma_f32_16x16x32_f16 v[188:191], a[228:231], v[32:35], v[188:191]
  ds_read_b128 a[220:223], v4 offset:1024
  v_exp_f16_sdwa v9, v9 dst_sel:WORD_1 dst_unused:UNUSED_PRESERVE src0_sel:WORD_1
  v_mfma_f32_16x16x32_f16 v[184:187], a[228:231], v[28:31], v[184:187]
  v_exp_f16_sdwa v11, v11 dst_sel:WORD_1 dst_unused:UNUSED_PRESERVE src0_sel:WORD_1
  v_mfma_f32_16x16x32_f16 v[180:183], a[228:231], v[24:27], v[180:183]
  v_exp_f16_sdwa v13, v13 dst_sel:WORD_1 dst_unused:UNUSED_PRESERVE src0_sel:WORD_1
  v_mfma_f32_16x16x32_f16 v[192:195], a[232:235], v[24:27], v[192:195]
  ds_read_b128 a[224:227], v4 offset:2048
  v_exp_f16_sdwa v15, v15 dst_sel:WORD_1 dst_unused:UNUSED_PRESERVE src0_sel:WORD_1
  v_mfma_f32_16x16x32_f16 v[196:199], a[232:235], v[28:31], v[196:199]
  v_pk_fma_f16 v9, v9, s35, s35
  v_pk_fma_f16 v11, v11, s35, s35
  v_mfma_f32_16x16x32_f16 v[200:203], a[232:235], v[32:35], v[200:203]
  v_pk_fma_f16 v13, v13, s35, s35
  v_pk_fma_f16 v15, v15, s35, s35
  v_mfma_f32_16x16x32_f16 v[212:215], a[236:239], v[32:35], v[212:215]
  ds_read_b128 a[228:231], v4 offset:3072
  v_rcp_f16_sdwa v9, v9 dst_sel:WORD_0 dst_unused:UNUSED_PRESERVE src0_sel:WORD_0
  v_mfma_f32_16x16x32_f16 v[208:211], a[236:239], v[28:31], v[208:211]
  v_rcp_f16_sdwa v11, v11 dst_sel:WORD_0 dst_unused:UNUSED_PRESERVE src0_sel:WORD_0
  v_mfma_f32_16x16x32_f16 v[204:207], a[236:239], v[24:27], v[204:207]
  v_rcp_f16_sdwa v13, v13 dst_sel:WORD_0 dst_unused:UNUSED_PRESERVE src0_sel:WORD_0
  v_rcp_f16_sdwa v15, v15 dst_sel:WORD_0 dst_unused:UNUSED_PRESERVE src0_sel:WORD_0
  v_mfma_f32_16x16x32_f16 v[216:219], a[240:243], v[24:27], v[216:219]
  ds_read_b128 a[232:235], v4 offset:4096
  v_rcp_f16_sdwa v9, v9 dst_sel:WORD_1 dst_unused:UNUSED_PRESERVE src0_sel:WORD_1
  v_mfma_f32_16x16x32_f16 v[220:223], a[240:243], v[28:31], v[220:223]
  v_rcp_f16_sdwa v11, v11 dst_sel:WORD_1 dst_unused:UNUSED_PRESERVE src0_sel:WORD_1
  v_mfma_f32_16x16x32_f16 v[224:227], a[240:243], v[32:35], v[224:227]
  v_rcp_f16_sdwa v13, v13 dst_sel:WORD_1 dst_unused:UNUSED_PRESERVE src0_sel:WORD_1
  v_mfma_f32_16x16x32_f16 v[236:239], a[244:247], v[32:35], v[236:239]
  ds_read_b128 a[236:239], v4 offset:5120
  v_rcp_f16_sdwa v15, v15 dst_sel:WORD_1 dst_unused:UNUSED_PRESERVE src0_sel:WORD_1
  v_mfma_f32_16x16x32_f16 v[232:235], a[244:247], v[28:31], v[232:235]
  v_pk_mul_f16 v42, v8, v9
  v_pk_mul_f16 v43, v10, v11
  v_mfma_f32_16x16x32_f16 v[228:231], a[244:247], v[24:27], v[228:231]
  s_waitcnt lgkmcnt(3)
  v_pk_mul_f16 v46, v12, v13
  v_pk_mul_f16 v47, v14, v15
  v_mfma_f32_16x16x32_bf16 v[72:75], a[216:219], a[0:3], 0
  ds_read_b128 a[240:243], v4 offset:6144
  s_add_u32 m0, s29, 0
  s_add_u32 s31, s29, 491520
  buffer_load_dwordx4 v2, s[8:11], s31 offen offset:0 lds
  v_cvt_pk_f16_f32 v8, v48, v49
  v_cvt_pk_f16_f32 v10, v50, v51
  v_mfma_f32_16x16x32_bf16 v[76:79], a[216:219], a[24:27], 0
  v_cvt_pk_f16_f32 v12, v52, v53
  v_cvt_pk_f16_f32 v14, v54, v55
  v_mfma_f32_16x16x32_bf16 v[80:83], a[216:219], a[48:51], 0
  v_pk_fma_f16 v9, v8, v8, s34 neg_lo:[1,0,0] neg_hi:[1,0,0]
  v_pk_fma_f16 v11, v10, v10, s34 neg_lo:[1,0,0] neg_hi:[1,0,0]
  v_pk_fma_f16 v13, v12, v12, s34 neg_lo:[1,0,0] neg_hi:[1,0,0]
  v_mfma_f32_16x16x32_bf16 v[92:95], a[220:223], a[48:51], 0
  ds_read_b128 a[244:247], v4 offset:7168
  buffer_load_dwordx4 v2, s[8:11], s31 offen offset:1024 lds
  v_pk_fma_f16 v15, v14, v14, s34 neg_lo:[1,0,0] neg_hi:[1,0,0]
  v_pk_mul_f16 v9, v9, v8
  v_mfma_f32_16x16x32_bf16 v[88:91], a[220:223], a[24:27], 0
  v_pk_mul_f16 v11, v11, v10
  v_pk_mul_f16 v13, v13, v12
  v_mfma_f32_16x16x32_bf16 v[84:87], a[220:223], a[0:3], 0
  v_pk_mul_f16 v15, v15, v14
  v_exp_f16_sdwa v9, v9 dst_sel:WORD_0 dst_unused:UNUSED_PRESERVE src0_sel:WORD_0
  v_mfma_f32_16x16x32_bf16 v[72:75], a[224:227], a[4:7], v[72:75]
  ds_read_b128 a[216:219], v4 offset:8192
  buffer_load_dwordx4 v2, s[8:11], s31 offen offset:2048 lds
  v_exp_f16_sdwa v11, v11 dst_sel:WORD_0 dst_unused:UNUSED_PRESERVE src0_sel:WORD_0
  v_mfma_f32_16x16x32_bf16 v[76:79], a[224:227], a[28:31], v[76:79]
  v_exp_f16_sdwa v13, v13 dst_sel:WORD_0 dst_unused:UNUSED_PRESERVE src0_sel:WORD_0
  v_mfma_f32_16x16x32_bf16 v[80:83], a[224:227], a[52:55], v[80:83]
  s_waitcnt lgkmcnt(3)
  v_exp_f16_sdwa v15, v15 dst_sel:WORD_0 dst_unused:UNUSED_PRESERVE src0_sel:WORD_0
  v_mfma_f32_16x16x32_bf16 v[92:95], a[228:231], a[52:55], v[92:95]
  ds_read_b128 a[220:223], v4 offset:9216
  buffer_load_dwordx4 v2, s[8:11], s31 offen offset:3072 lds
  v_exp_f16_sdwa v9, v9 dst_sel:WORD_1 dst_unused:UNUSED_PRESERVE src0_sel:WORD_1
  v_mfma_f32_16x16x32_bf16 v[88:91], a[228:231], a[28:31], v[88:91]
  s_add_u32 m0, s29, 4096
  v_exp_f16_sdwa v11, v11 dst_sel:WORD_1 dst_unused:UNUSED_PRESERVE src0_sel:WORD_1
  v_mfma_f32_16x16x32_bf16 v[84:87], a[228:231], a[4:7], v[84:87]
  s_add_u32 s31, s29, 495616
  v_exp_f16_sdwa v13, v13 dst_sel:WORD_1 dst_unused:UNUSED_PRESERVE src0_sel:WORD_1
  v_mfma_f32_16x16x32_bf16 v[72:75], a[232:235], a[8:11], v[72:75]
  ds_read_b128 a[224:227], v4 offset:10240
  buffer_load_dwordx4 v2, s[8:11], s31 offen offset:0 lds
  v_exp_f16_sdwa v15, v15 dst_sel:WORD_1 dst_unused:UNUSED_PRESERVE src0_sel:WORD_1
  v_mfma_f32_16x16x32_bf16 v[76:79], a[232:235], a[32:35], v[76:79]
  v_pk_fma_f16 v9, v9, s35, s35
  v_pk_fma_f16 v11, v11, s35, s35
  v_mfma_f32_16x16x32_bf16 v[80:83], a[232:235], a[56:59], v[80:83]
  v_pk_fma_f16 v13, v13, s35, s35
  v_pk_fma_f16 v15, v15, s35, s35
  v_mfma_f32_16x16x32_bf16 v[92:95], a[236:239], a[56:59], v[92:95]
  ds_read_b128 a[228:231], v4 offset:11264
  buffer_load_dwordx4 v2, s[8:11], s31 offen offset:1024 lds
  v_rcp_f16_sdwa v9, v9 dst_sel:WORD_0 dst_unused:UNUSED_PRESERVE src0_sel:WORD_0
  v_mfma_f32_16x16x32_bf16 v[88:91], a[236:239], a[32:35], v[88:91]
  v_rcp_f16_sdwa v11, v11 dst_sel:WORD_0 dst_unused:UNUSED_PRESERVE src0_sel:WORD_0
  v_mfma_f32_16x16x32_bf16 v[84:87], a[236:239], a[8:11], v[84:87]
  s_waitcnt lgkmcnt(3)
  v_rcp_f16_sdwa v13, v13 dst_sel:WORD_0 dst_unused:UNUSED_PRESERVE src0_sel:WORD_0
  v_rcp_f16_sdwa v15, v15 dst_sel:WORD_0 dst_unused:UNUSED_PRESERVE src0_sel:WORD_0
  v_mfma_f32_16x16x32_bf16 v[72:75], a[240:243], a[12:15], v[72:75]
  ds_read_b128 a[232:235], v4 offset:12288
  buffer_load_dwordx4 v2, s[8:11], s31 offen offset:2048 lds
  v_rcp_f16_sdwa v9, v9 dst_sel:WORD_1 dst_unused:UNUSED_PRESERVE src0_sel:WORD_1
  v_mfma_f32_16x16x32_bf16 v[76:79], a[240:243], a[36:39], v[76:79]
  v_rcp_f16_sdwa v11, v11 dst_sel:WORD_1 dst_unused:UNUSED_PRESERVE src0_sel:WORD_1
  v_mfma_f32_16x16x32_bf16 v[80:83], a[240:243], a[60:63], v[80:83]
  v_rcp_f16_sdwa v13, v13 dst_sel:WORD_1 dst_unused:UNUSED_PRESERVE src0_sel:WORD_1
  v_mfma_f32_16x16x32_bf16 v[92:95], a[244:247], a[60:63], v[92:95]
  ds_read_b128 a[236:239], v4 offset:13312
  buffer_load_dwordx4 v2, s[8:11], s31 offen offset:3072 lds
  v_rcp_f16_sdwa v15, v15 dst_sel:WORD_1 dst_unused:UNUSED_PRESERVE src0_sel:WORD_1
  v_mfma_f32_16x16x32_bf16 v[88:91], a[244:247], a[36:39], v[88:91]
  s_add_u32 m0, s29, 8192
  v_pk_mul_f16 v24, v8, v9
  v_pk_mul_f16 v25, v10, v11
  v_mfma_f32_16x16x32_bf16 v[84:87], a[244:247], a[12:15], v[84:87]
  s_add_u32 s31, s29, 499712
  v_pk_mul_f16 v28, v12, v13
  v_pk_mul_f16 v29, v14, v15
  v_mfma_f32_16x16x32_bf16 v[72:75], a[216:219], a[16:19], v[72:75]
  ds_read_b128 a[240:243], v4 offset:14336
  buffer_load_dwordx4 v2, s[8:11], s31 offen offset:0 lds
  v_cvt_pk_f16_f32 v16, v56, v57
  v_cvt_pk_f16_f32 v18, v58, v59
  v_mfma_f32_16x16x32_bf16 v[76:79], a[216:219], a[40:43], v[76:79]
  v_cvt_pk_f16_f32 v20, v60, v61
  v_cvt_pk_f16_f32 v22, v62, v63
  v_mfma_f32_16x16x32_bf16 v[80:83], a[216:219], a[64:67], v[80:83]
  s_waitcnt lgkmcnt(3)
  v_pk_fma_f16 v17, v16, v16, s34 neg_lo:[1,0,0] neg_hi:[1,0,0]
  v_pk_fma_f16 v19, v18, v18, s34 neg_lo:[1,0,0] neg_hi:[1,0,0]
  v_pk_fma_f16 v21, v20, v20, s34 neg_lo:[1,0,0] neg_hi:[1,0,0]
  v_mfma_f32_16x16x32_bf16 v[92:95], a[220:223], a[64:67], v[92:95]
  ds_read_b128 a[244:247], v4 offset:15360
  buffer_load_dwordx4 v2, s[8:11], s31 offen offset:1024 lds
  v_pk_fma_f16 v23, v22, v22, s34 neg_lo:[1,0,0] neg_hi:[1,0,0]
  v_pk_mul_f16 v17, v17, v16
  v_mfma_f32_16x16x32_bf16 v[88:91], a[220:223], a[40:43], v[88:91]
  v_pk_mul_f16 v19, v19, v18
  v_pk_mul_f16 v21, v21, v20
  v_mfma_f32_16x16x32_bf16 v[84:87], a[220:223], a[16:19], v[84:87]
  v_pk_mul_f16 v23, v23, v22
  v_exp_f16_sdwa v17, v17 dst_sel:WORD_0 dst_unused:UNUSED_PRESERVE src0_sel:WORD_0
  v_mfma_f32_16x16x32_bf16 v[72:75], a[224:227], a[20:23], v[72:75]
  ds_read_b128 a[216:219], v4 offset:16384
  buffer_load_dwordx4 v2, s[8:11], s31 offen offset:2048 lds
  v_exp_f16_sdwa v19, v19 dst_sel:WORD_0 dst_unused:UNUSED_PRESERVE src0_sel:WORD_0
  v_mfma_f32_16x16x32_bf16 v[76:79], a[224:227], a[44:47], v[76:79]
  v_exp_f16_sdwa v21, v21 dst_sel:WORD_0 dst_unused:UNUSED_PRESERVE src0_sel:WORD_0
  v_mfma_f32_16x16x32_bf16 v[80:83], a[224:227], a[68:71], v[80:83]
  v_exp_f16_sdwa v23, v23 dst_sel:WORD_0 dst_unused:UNUSED_PRESERVE src0_sel:WORD_0
  v_mfma_f32_16x16x32_bf16 v[92:95], a[228:231], a[68:71], v[92:95]
  ds_read_b128 a[220:223], v4 offset:17408
  buffer_load_dwordx4 v2, s[8:11], s31 offen offset:3072 lds
  v_exp_f16_sdwa v17, v17 dst_sel:WORD_1 dst_unused:UNUSED_PRESERVE src0_sel:WORD_1
  v_mfma_f32_16x16x32_bf16 v[88:91], a[228:231], a[44:47], v[88:91]
  v_exp_f16_sdwa v19, v19 dst_sel:WORD_1 dst_unused:UNUSED_PRESERVE src0_sel:WORD_1
  v_mfma_f32_16x16x32_bf16 v[84:87], a[228:231], a[20:23], v[84:87]
  s_waitcnt lgkmcnt(3)
  v_exp_f16_sdwa v21, v21 dst_sel:WORD_1 dst_unused:UNUSED_PRESERVE src0_sel:WORD_1
  v_mfma_f32_16x16x32_f16 v[96:99], a[232:235], v[36:39], v[96:99]
  ds_read_b128 a[224:227], v4 offset:18432
  v_exp_f16_sdwa v23, v23 dst_sel:WORD_1 dst_unused:UNUSED_PRESERVE src0_sel:WORD_1
  v_mfma_f32_16x16x32_f16 v[100:103], a[232:235], v[40:43], v[100:103]
  v_pk_fma_f16 v17, v17, s35, s35
  v_pk_fma_f16 v19, v19, s35, s35
  v_mfma_f32_16x16x32_f16 v[104:107], a[232:235], v[44:47], v[104:107]
  v_pk_fma_f16 v21, v21, s35, s35
  v_pk_fma_f16 v23, v23, s35, s35
  v_mfma_f32_16x16x32_f16 v[116:119], a[236:239], v[44:47], v[116:119]
  ds_read_b128 a[228:231], v4 offset:19456
  v_rcp_f16_sdwa v17, v17 dst_sel:WORD_0 dst_unused:UNUSED_PRESERVE src0_sel:WORD_0
  v_mfma_f32_16x16x32_f16 v[112:115], a[236:239], v[40:43], v[112:115]
  v_rcp_f16_sdwa v19, v19 dst_sel:WORD_0 dst_unused:UNUSED_PRESERVE src0_sel:WORD_0
  v_mfma_f32_16x16x32_f16 v[108:111], a[236:239], v[36:39], v[108:111]
  v_rcp_f16_sdwa v21, v21 dst_sel:WORD_0 dst_unused:UNUSED_PRESERVE src0_sel:WORD_0
  v_rcp_f16_sdwa v23, v23 dst_sel:WORD_0 dst_unused:UNUSED_PRESERVE src0_sel:WORD_0
  v_mfma_f32_16x16x32_f16 v[120:123], a[240:243], v[36:39], v[120:123]
  ds_read_b128 a[232:235], v4 offset:20480
  v_rcp_f16_sdwa v17, v17 dst_sel:WORD_1 dst_unused:UNUSED_PRESERVE src0_sel:WORD_1
  v_mfma_f32_16x16x32_f16 v[124:127], a[240:243], v[40:43], v[124:127]
  v_rcp_f16_sdwa v19, v19 dst_sel:WORD_1 dst_unused:UNUSED_PRESERVE src0_sel:WORD_1
  v_mfma_f32_16x16x32_f16 v[128:131], a[240:243], v[44:47], v[128:131]
  s_waitcnt lgkmcnt(3)
  v_rcp_f16_sdwa v21, v21 dst_sel:WORD_1 dst_unused:UNUSED_PRESERVE src0_sel:WORD_1
  v_mfma_f32_16x16x32_f16 v[140:143], a[244:247], v[44:47], v[140:143]
  ds_read_b128 a[236:239], v4 offset:21504
  v_rcp_f16_sdwa v23, v23 dst_sel:WORD_1 dst_unused:UNUSED_PRESERVE src0_sel:WORD_1
  v_mfma_f32_16x16x32_f16 v[136:139], a[244:247], v[40:43], v[136:139]
  v_pk_mul_f16 v32, v16, v17
  v_pk_mul_f16 v33, v18, v19
  v_mfma_f32_16x16x32_f16 v[132:135], a[244:247], v[36:39], v[132:135]
  v_pk_mul_f16 v26, v20, v21
  v_pk_mul_f16 v27, v22, v23
  v_mfma_f32_16x16x32_f16 v[144:147], a[216:219], v[36:39], v[144:147]
  ds_read_b128 a[240:243], v4 offset:22528
  v_cvt_pk_f16_f32 v8, v64, v65
  v_cvt_pk_f16_f32 v10, v66, v67
  v_mfma_f32_16x16x32_f16 v[148:151], a[216:219], v[40:43], v[148:151]
  v_cvt_pk_f16_f32 v12, v68, v69
  v_cvt_pk_f16_f32 v14, v70, v71
  v_mfma_f32_16x16x32_f16 v[152:155], a[216:219], v[44:47], v[152:155]
  v_pk_fma_f16 v9, v8, v8, s34 neg_lo:[1,0,0] neg_hi:[1,0,0]
  v_pk_fma_f16 v11, v10, v10, s34 neg_lo:[1,0,0] neg_hi:[1,0,0]
  v_pk_fma_f16 v13, v12, v12, s34 neg_lo:[1,0,0] neg_hi:[1,0,0]
  v_mfma_f32_16x16x32_f16 v[164:167], a[220:223], v[44:47], v[164:167]
  ds_read_b128 a[244:247], v4 offset:23552
  v_pk_fma_f16 v15, v14, v14, s34 neg_lo:[1,0,0] neg_hi:[1,0,0]
  v_pk_mul_f16 v9, v9, v8
  v_mfma_f32_16x16x32_f16 v[160:163], a[220:223], v[40:43], v[160:163]
  v_pk_mul_f16 v11, v11, v10
  v_pk_mul_f16 v13, v13, v12
  v_mfma_f32_16x16x32_f16 v[156:159], a[220:223], v[36:39], v[156:159]
  s_waitcnt lgkmcnt(3)
  v_pk_mul_f16 v15, v15, v14
  v_exp_f16_sdwa v9, v9 dst_sel:WORD_0 dst_unused:UNUSED_PRESERVE src0_sel:WORD_0
  v_mfma_f32_16x16x32_f16 v[168:171], a[224:227], v[36:39], v[168:171]
  ds_read_b128 a[216:219], v4 offset:24576
  v_exp_f16_sdwa v11, v11 dst_sel:WORD_0 dst_unused:UNUSED_PRESERVE src0_sel:WORD_0
  v_mfma_f32_16x16x32_f16 v[172:175], a[224:227], v[40:43], v[172:175]
  v_exp_f16_sdwa v13, v13 dst_sel:WORD_0 dst_unused:UNUSED_PRESERVE src0_sel:WORD_0
  v_mfma_f32_16x16x32_f16 v[176:179], a[224:227], v[44:47], v[176:179]
  v_exp_f16_sdwa v15, v15 dst_sel:WORD_0 dst_unused:UNUSED_PRESERVE src0_sel:WORD_0
  v_mfma_f32_16x16x32_f16 v[188:191], a[228:231], v[44:47], v[188:191]
  ds_read_b128 a[220:223], v4 offset:25600
  v_exp_f16_sdwa v9, v9 dst_sel:WORD_1 dst_unused:UNUSED_PRESERVE src0_sel:WORD_1
  v_mfma_f32_16x16x32_f16 v[184:187], a[228:231], v[40:43], v[184:187]
  v_exp_f16_sdwa v11, v11 dst_sel:WORD_1 dst_unused:UNUSED_PRESERVE src0_sel:WORD_1
  v_mfma_f32_16x16x32_f16 v[180:183], a[228:231], v[36:39], v[180:183]
  v_exp_f16_sdwa v13, v13 dst_sel:WORD_1 dst_unused:UNUSED_PRESERVE src0_sel:WORD_1
  v_mfma_f32_16x16x32_f16 v[192:195], a[232:235], v[36:39], v[192:195]
  ds_read_b128 a[224:227], v4 offset:26624
  v_exp_f16_sdwa v15, v15 dst_sel:WORD_1 dst_unused:UNUSED_PRESERVE src0_sel:WORD_1
  v_mfma_f32_16x16x32_f16 v[196:199], a[232:235], v[40:43], v[196:199]
  v_pk_fma_f16 v9, v9, s35, s35
  v_pk_fma_f16 v11, v11, s35, s35
  v_mfma_f32_16x16x32_f16 v[200:203], a[232:235], v[44:47], v[200:203]
  s_waitcnt lgkmcnt(3)
  v_pk_fma_f16 v13, v13, s35, s35
  v_pk_fma_f16 v15, v15, s35, s35
  v_mfma_f32_16x16x32_f16 v[212:215], a[236:239], v[44:47], v[212:215]
  ds_read_b128 a[228:231], v4 offset:27648
  v_rcp_f16_sdwa v9, v9 dst_sel:WORD_0 dst_unused:UNUSED_PRESERVE src0_sel:WORD_0
  v_mfma_f32_16x16x32_f16 v[208:211], a[236:239], v[40:43], v[208:211]
  v_rcp_f16_sdwa v11, v11 dst_sel:WORD_0 dst_unused:UNUSED_PRESERVE src0_sel:WORD_0
  v_mfma_f32_16x16x32_f16 v[204:207], a[236:239], v[36:39], v[204:207]
  v_rcp_f16_sdwa v13, v13 dst_sel:WORD_0 dst_unused:UNUSED_PRESERVE src0_sel:WORD_0
  v_rcp_f16_sdwa v15, v15 dst_sel:WORD_0 dst_unused:UNUSED_PRESERVE src0_sel:WORD_0
  v_mfma_f32_16x16x32_f16 v[216:219], a[240:243], v[36:39], v[216:219]
  ds_read_b128 a[232:235], v4 offset:28672
  v_rcp_f16_sdwa v9, v9 dst_sel:WORD_1 dst_unused:UNUSED_PRESERVE src0_sel:WORD_1
  v_mfma_f32_16x16x32_f16 v[220:223], a[240:243], v[40:43], v[220:223]
  v_rcp_f16_sdwa v11, v11 dst_sel:WORD_1 dst_unused:UNUSED_PRESERVE src0_sel:WORD_1
  v_mfma_f32_16x16x32_f16 v[224:227], a[240:243], v[44:47], v[224:227]
  v_rcp_f16_sdwa v13, v13 dst_sel:WORD_1 dst_unused:UNUSED_PRESERVE src0_sel:WORD_1
  v_mfma_f32_16x16x32_f16 v[236:239], a[244:247], v[44:47], v[236:239]
  ds_read_b128 a[236:239], v4 offset:29696
  v_rcp_f16_sdwa v15, v15 dst_sel:WORD_1 dst_unused:UNUSED_PRESERVE src0_sel:WORD_1
  v_mfma_f32_16x16x32_f16 v[232:235], a[244:247], v[40:43], v[232:235]
  v_pk_mul_f16 v30, v8, v9
  v_pk_mul_f16 v31, v10, v11
  v_mfma_f32_16x16x32_f16 v[228:231], a[244:247], v[36:39], v[228:231]
  s_waitcnt lgkmcnt(3)
  v_pk_mul_f16 v34, v12, v13
  v_pk_mul_f16 v35, v14, v15
  v_mfma_f32_16x16x32_bf16 v[48:51], a[216:219], a[0:3], 0
  ds_read_b128 a[240:243], v4 offset:30720
  v_cvt_pk_f16_f32 v8, v72, v73
  v_cvt_pk_f16_f32 v10, v74, v75
  v_mfma_f32_16x16x32_bf16 v[52:55], a[216:219], a[24:27], 0
  v_cvt_pk_f16_f32 v12, v76, v77
  v_cvt_pk_f16_f32 v14, v78, v79
  v_mfma_f32_16x16x32_bf16 v[56:59], a[216:219], a[48:51], 0
  v_pk_fma_f16 v9, v8, v8, s34 neg_lo:[1,0,0] neg_hi:[1,0,0]
  v_pk_fma_f16 v11, v10, v10, s34 neg_lo:[1,0,0] neg_hi:[1,0,0]
  v_pk_fma_f16 v13, v12, v12, s34 neg_lo:[1,0,0] neg_hi:[1,0,0]
  v_mfma_f32_16x16x32_bf16 v[68:71], a[220:223], a[48:51], 0
  ds_read_b128 a[244:247], v4 offset:31744
  v_pk_fma_f16 v15, v14, v14, s34 neg_lo:[1,0,0] neg_hi:[1,0,0]
  v_pk_mul_f16 v9, v9, v8
  v_mfma_f32_16x16x32_bf16 v[64:67], a[220:223], a[24:27], 0
  buffer_load_dwordx4 a[192:195], v3, s[16:19], s97 offen offset:0
  v_pk_mul_f16 v11, v11, v10
  v_pk_mul_f16 v13, v13, v12
  v_mfma_f32_16x16x32_bf16 v[60:63], a[220:223], a[0:3], 0
  v_pk_mul_f16 v15, v15, v14
  v_exp_f16_sdwa v9, v9 dst_sel:WORD_0 dst_unused:UNUSED_PRESERVE src0_sel:WORD_0
  v_mfma_f32_16x16x32_bf16 v[48:51], a[224:227], a[4:7], v[48:51]
  ds_read_b128 a[216:219], v4 offset:32768
  v_exp_f16_sdwa v11, v11 dst_sel:WORD_0 dst_unused:UNUSED_PRESERVE src0_sel:WORD_0
  v_mfma_f32_16x16x32_bf16 v[52:55], a[224:227], a[28:31], v[52:55]
  v_exp_f16_sdwa v13, v13 dst_sel:WORD_0 dst_unused:UNUSED_PRESERVE src0_sel:WORD_0
  v_mfma_f32_16x16x32_bf16 v[56:59], a[224:227], a[52:55], v[56:59]
  s_waitcnt lgkmcnt(3)
  v_exp_f16_sdwa v15, v15 dst_sel:WORD_0 dst_unused:UNUSED_PRESERVE src0_sel:WORD_0
  v_mfma_f32_16x16x32_bf16 v[68:71], a[228:231], a[52:55], v[68:71]
  ds_read_b128 a[220:223], v4 offset:33792
  v_exp_f16_sdwa v9, v9 dst_sel:WORD_1 dst_unused:UNUSED_PRESERVE src0_sel:WORD_1
  v_mfma_f32_16x16x32_bf16 v[64:67], a[228:231], a[28:31], v[64:67]
  v_exp_f16_sdwa v11, v11 dst_sel:WORD_1 dst_unused:UNUSED_PRESERVE src0_sel:WORD_1
  v_mfma_f32_16x16x32_bf16 v[60:63], a[228:231], a[4:7], v[60:63]
  v_exp_f16_sdwa v13, v13 dst_sel:WORD_1 dst_unused:UNUSED_PRESERVE src0_sel:WORD_1
  v_mfma_f32_16x16x32_bf16 v[48:51], a[232:235], a[8:11], v[48:51]
  ds_read_b128 a[224:227], v4 offset:34816
  v_exp_f16_sdwa v15, v15 dst_sel:WORD_1 dst_unused:UNUSED_PRESERVE src0_sel:WORD_1
  v_mfma_f32_16x16x32_bf16 v[52:55], a[232:235], a[32:35], v[52:55]
  buffer_load_dwordx4 a[196:199], v3, s[16:19], s97 offen offset:64
  v_pk_fma_f16 v9, v9, s35, s35
  v_pk_fma_f16 v11, v11, s35, s35
  v_mfma_f32_16x16x32_bf16 v[56:59], a[232:235], a[56:59], v[56:59]
  v_pk_fma_f16 v13, v13, s35, s35
  v_pk_fma_f16 v15, v15, s35, s35
  v_mfma_f32_16x16x32_bf16 v[68:71], a[236:239], a[56:59], v[68:71]
  ds_read_b128 a[228:231], v4 offset:35840
  v_rcp_f16_sdwa v9, v9 dst_sel:WORD_0 dst_unused:UNUSED_PRESERVE src0_sel:WORD_0
  v_mfma_f32_16x16x32_bf16 v[64:67], a[236:239], a[32:35], v[64:67]
  v_rcp_f16_sdwa v11, v11 dst_sel:WORD_0 dst_unused:UNUSED_PRESERVE src0_sel:WORD_0
  v_mfma_f32_16x16x32_bf16 v[60:63], a[236:239], a[8:11], v[60:63]
  s_waitcnt lgkmcnt(3)
  v_rcp_f16_sdwa v13, v13 dst_sel:WORD_0 dst_unused:UNUSED_PRESERVE src0_sel:WORD_0
  v_rcp_f16_sdwa v15, v15 dst_sel:WORD_0 dst_unused:UNUSED_PRESERVE src0_sel:WORD_0
  v_mfma_f32_16x16x32_bf16 v[48:51], a[240:243], a[12:15], v[48:51]
  ds_read_b128 a[232:235], v4 offset:36864
  v_rcp_f16_sdwa v9, v9 dst_sel:WORD_1 dst_unused:UNUSED_PRESERVE src0_sel:WORD_1
  v_mfma_f32_16x16x32_bf16 v[52:55], a[240:243], a[36:39], v[52:55]
  v_rcp_f16_sdwa v11, v11 dst_sel:WORD_1 dst_unused:UNUSED_PRESERVE src0_sel:WORD_1
  v_mfma_f32_16x16x32_bf16 v[56:59], a[240:243], a[60:63], v[56:59]
  v_rcp_f16_sdwa v13, v13 dst_sel:WORD_1 dst_unused:UNUSED_PRESERVE src0_sel:WORD_1
  v_mfma_f32_16x16x32_bf16 v[68:71], a[244:247], a[60:63], v[68:71]
  ds_read_b128 a[236:239], v4 offset:37888
  v_rcp_f16_sdwa v15, v15 dst_sel:WORD_1 dst_unused:UNUSED_PRESERVE src0_sel:WORD_1
  v_mfma_f32_16x16x32_bf16 v[64:67], a[244:247], a[36:39], v[64:67]
  buffer_load_dwordx4 a[200:203], v3, s[16:19], s97 offen offset:128
  v_pk_mul_f16 v36, v8, v9
  v_pk_mul_f16 v37, v10, v11
  v_mfma_f32_16x16x32_bf16 v[60:63], a[244:247], a[12:15], v[60:63]
  v_pk_mul_f16 v40, v12, v13
  v_pk_mul_f16 v41, v14, v15
  v_mfma_f32_16x16x32_bf16 v[48:51], a[216:219], a[16:19], v[48:51]
  ds_read_b128 a[240:243], v4 offset:38912
  v_cvt_pk_f16_f32 v16, v80, v81
  v_cvt_pk_f16_f32 v18, v82, v83
  v_mfma_f32_16x16x32_bf16 v[52:55], a[216:219], a[40:43], v[52:55]
  v_cvt_pk_f16_f32 v20, v84, v85
  v_cvt_pk_f16_f32 v22, v86, v87
  v_mfma_f32_16x16x32_bf16 v[56:59], a[216:219], a[64:67], v[56:59]
  s_waitcnt lgkmcnt(3)
  v_pk_fma_f16 v17, v16, v16, s34 neg_lo:[1,0,0] neg_hi:[1,0,0]
  v_pk_fma_f16 v19, v18, v18, s34 neg_lo:[1,0,0] neg_hi:[1,0,0]
  v_pk_fma_f16 v21, v20, v20, s34 neg_lo:[1,0,0] neg_hi:[1,0,0]
  v_mfma_f32_16x16x32_bf16 v[68:71], a[220:223], a[64:67], v[68:71]
  ds_read_b128 a[244:247], v4 offset:39936
  v_pk_fma_f16 v23, v22, v22, s34 neg_lo:[1,0,0] neg_hi:[1,0,0]
  v_pk_mul_f16 v17, v17, v16
  v_mfma_f32_16x16x32_bf16 v[64:67], a[220:223], a[40:43], v[64:67]
  v_pk_mul_f16 v19, v19, v18
  v_pk_mul_f16 v21, v21, v20
  v_mfma_f32_16x16x32_bf16 v[60:63], a[220:223], a[16:19], v[60:63]
  v_pk_mul_f16 v23, v23, v22
  v_exp_f16_sdwa v17, v17 dst_sel:WORD_0 dst_unused:UNUSED_PRESERVE src0_sel:WORD_0
  v_mfma_f32_16x16x32_bf16 v[48:51], a[224:227], a[20:23], v[48:51]
  ds_read_b128 a[216:219], v4 offset:40960
  v_exp_f16_sdwa v19, v19 dst_sel:WORD_0 dst_unused:UNUSED_PRESERVE src0_sel:WORD_0
  v_mfma_f32_16x16x32_bf16 v[52:55], a[224:227], a[44:47], v[52:55]
  v_exp_f16_sdwa v21, v21 dst_sel:WORD_0 dst_unused:UNUSED_PRESERVE src0_sel:WORD_0
  v_mfma_f32_16x16x32_bf16 v[56:59], a[224:227], a[68:71], v[56:59]
  v_exp_f16_sdwa v23, v23 dst_sel:WORD_0 dst_unused:UNUSED_PRESERVE src0_sel:WORD_0
  v_mfma_f32_16x16x32_bf16 v[68:71], a[228:231], a[68:71], v[68:71]
  ds_read_b128 a[220:223], v4 offset:41984
  v_exp_f16_sdwa v17, v17 dst_sel:WORD_1 dst_unused:UNUSED_PRESERVE src0_sel:WORD_1
  v_mfma_f32_16x16x32_bf16 v[64:67], a[228:231], a[44:47], v[64:67]
  v_exp_f16_sdwa v19, v19 dst_sel:WORD_1 dst_unused:UNUSED_PRESERVE src0_sel:WORD_1
  v_mfma_f32_16x16x32_bf16 v[60:63], a[228:231], a[20:23], v[60:63]
  s_waitcnt lgkmcnt(3)
  v_exp_f16_sdwa v21, v21 dst_sel:WORD_1 dst_unused:UNUSED_PRESERVE src0_sel:WORD_1
  v_mfma_f32_16x16x32_f16 v[96:99], a[232:235], v[24:27], v[96:99]
  ds_read_b128 a[224:227], v4 offset:43008
  v_exp_f16_sdwa v23, v23 dst_sel:WORD_1 dst_unused:UNUSED_PRESERVE src0_sel:WORD_1
  v_mfma_f32_16x16x32_f16 v[100:103], a[232:235], v[28:31], v[100:103]
  v_pk_fma_f16 v17, v17, s35, s35
  v_pk_fma_f16 v19, v19, s35, s35
  v_mfma_f32_16x16x32_f16 v[104:107], a[232:235], v[32:35], v[104:107]
  v_pk_fma_f16 v21, v21, s35, s35
  v_pk_fma_f16 v23, v23, s35, s35
  v_mfma_f32_16x16x32_f16 v[116:119], a[236:239], v[32:35], v[116:119]
  ds_read_b128 a[228:231], v4 offset:44032
  v_rcp_f16_sdwa v17, v17 dst_sel:WORD_0 dst_unused:UNUSED_PRESERVE src0_sel:WORD_0
  v_mfma_f32_16x16x32_f16 v[112:115], a[236:239], v[28:31], v[112:115]
  v_rcp_f16_sdwa v19, v19 dst_sel:WORD_0 dst_unused:UNUSED_PRESERVE src0_sel:WORD_0
  v_mfma_f32_16x16x32_f16 v[108:111], a[236:239], v[24:27], v[108:111]
  v_rcp_f16_sdwa v21, v21 dst_sel:WORD_0 dst_unused:UNUSED_PRESERVE src0_sel:WORD_0
  v_rcp_f16_sdwa v23, v23 dst_sel:WORD_0 dst_unused:UNUSED_PRESERVE src0_sel:WORD_0
  v_mfma_f32_16x16x32_f16 v[120:123], a[240:243], v[24:27], v[120:123]
  ds_read_b128 a[232:235], v4 offset:45056
  v_rcp_f16_sdwa v17, v17 dst_sel:WORD_1 dst_unused:UNUSED_PRESERVE src0_sel:WORD_1
  v_mfma_f32_16x16x32_f16 v[124:127], a[240:243], v[28:31], v[124:127]
  v_rcp_f16_sdwa v19, v19 dst_sel:WORD_1 dst_unused:UNUSED_PRESERVE src0_sel:WORD_1
  v_mfma_f32_16x16x32_f16 v[128:131], a[240:243], v[32:35], v[128:131]
  s_waitcnt lgkmcnt(3)
  v_rcp_f16_sdwa v21, v21 dst_sel:WORD_1 dst_unused:UNUSED_PRESERVE src0_sel:WORD_1
  v_mfma_f32_16x16x32_f16 v[140:143], a[244:247], v[32:35], v[140:143]
  ds_read_b128 a[236:239], v4 offset:46080
  v_rcp_f16_sdwa v23, v23 dst_sel:WORD_1 dst_unused:UNUSED_PRESERVE src0_sel:WORD_1
  v_mfma_f32_16x16x32_f16 v[136:139], a[244:247], v[28:31], v[136:139]
  v_pk_mul_f16 v44, v16, v17
  v_pk_mul_f16 v45, v18, v19
  v_mfma_f32_16x16x32_f16 v[132:135], a[244:247], v[24:27], v[132:135]
  v_pk_mul_f16 v38, v20, v21
  v_pk_mul_f16 v39, v22, v23
  v_mfma_f32_16x16x32_f16 v[144:147], a[216:219], v[24:27], v[144:147]
  ds_read_b128 a[240:243], v4 offset:47104
  ds_read_b128 a[244:247], v4 offset:48128
  v_cvt_pk_f16_f32 v8, v88, v89
  v_cvt_pk_f16_f32 v10, v90, v91
  v_mfma_f32_16x16x32_f16 v[148:151], a[216:219], v[28:31], v[148:151]
  v_cvt_pk_f16_f32 v12, v92, v93
  v_cvt_pk_f16_f32 v14, v94, v95
  v_mfma_f32_16x16x32_f16 v[152:155], a[216:219], v[32:35], v[152:155]
  v_pk_fma_f16 v9, v8, v8, s34 neg_lo:[1,0,0] neg_hi:[1,0,0]
  v_pk_fma_f16 v11, v10, v10, s34 neg_lo:[1,0,0] neg_hi:[1,0,0]
  v_pk_fma_f16 v13, v12, v12, s34 neg_lo:[1,0,0] neg_hi:[1,0,0]
  v_mfma_f32_16x16x32_f16 v[164:167], a[220:223], v[32:35], v[164:167]
  v_pk_fma_f16 v15, v14, v14, s34 neg_lo:[1,0,0] neg_hi:[1,0,0]
  v_pk_mul_f16 v9, v9, v8
  v_mfma_f32_16x16x32_f16 v[160:163], a[220:223], v[28:31], v[160:163]
  v_pk_mul_f16 v11, v11, v10
  v_pk_mul_f16 v13, v13, v12
  v_mfma_f32_16x16x32_f16 v[156:159], a[220:223], v[24:27], v[156:159]
  s_waitcnt lgkmcnt(3)
  v_pk_mul_f16 v15, v15, v14
  v_exp_f16_sdwa v9, v9 dst_sel:WORD_0 dst_unused:UNUSED_PRESERVE src0_sel:WORD_0
  v_mfma_f32_16x16x32_f16 v[168:171], a[224:227], v[24:27], v[168:171]
  s_waitcnt lgkmcnt(0)
  s_waitcnt vmcnt(3)
  s_barrier
  ds_read_b128 a[216:219], v1 offset:0
  v_exp_f16_sdwa v11, v11 dst_sel:WORD_0 dst_unused:UNUSED_PRESERVE src0_sel:WORD_0
  v_mfma_f32_16x16x32_f16 v[172:175], a[224:227], v[28:31], v[172:175]
  v_exp_f16_sdwa v13, v13 dst_sel:WORD_0 dst_unused:UNUSED_PRESERVE src0_sel:WORD_0
  v_mfma_f32_16x16x32_f16 v[176:179], a[224:227], v[32:35], v[176:179]
  v_exp_f16_sdwa v15, v15 dst_sel:WORD_0 dst_unused:UNUSED_PRESERVE src0_sel:WORD_0
  v_mfma_f32_16x16x32_f16 v[188:191], a[228:231], v[32:35], v[188:191]
  ds_read_b128 a[220:223], v1 offset:1024
  v_exp_f16_sdwa v9, v9 dst_sel:WORD_1 dst_unused:UNUSED_PRESERVE src0_sel:WORD_1
  v_mfma_f32_16x16x32_f16 v[184:187], a[228:231], v[28:31], v[184:187]
  v_exp_f16_sdwa v11, v11 dst_sel:WORD_1 dst_unused:UNUSED_PRESERVE src0_sel:WORD_1
  v_mfma_f32_16x16x32_f16 v[180:183], a[228:231], v[24:27], v[180:183]
  v_exp_f16_sdwa v13, v13 dst_sel:WORD_1 dst_unused:UNUSED_PRESERVE src0_sel:WORD_1
  v_mfma_f32_16x16x32_f16 v[192:195], a[232:235], v[24:27], v[192:195]
  ds_read_b128 a[224:227], v1 offset:2048
  v_exp_f16_sdwa v15, v15 dst_sel:WORD_1 dst_unused:UNUSED_PRESERVE src0_sel:WORD_1
  v_mfma_f32_16x16x32_f16 v[196:199], a[232:235], v[28:31], v[196:199]
  v_pk_fma_f16 v9, v9, s35, s35
  v_pk_fma_f16 v11, v11, s35, s35
  v_mfma_f32_16x16x32_f16 v[200:203], a[232:235], v[32:35], v[200:203]
  v_pk_fma_f16 v13, v13, s35, s35
  v_pk_fma_f16 v15, v15, s35, s35
  v_mfma_f32_16x16x32_f16 v[212:215], a[236:239], v[32:35], v[212:215]
  ds_read_b128 a[228:231], v1 offset:3072
  v_rcp_f16_sdwa v9, v9 dst_sel:WORD_0 dst_unused:UNUSED_PRESERVE src0_sel:WORD_0
  v_mfma_f32_16x16x32_f16 v[208:211], a[236:239], v[28:31], v[208:211]
  v_rcp_f16_sdwa v11, v11 dst_sel:WORD_0 dst_unused:UNUSED_PRESERVE src0_sel:WORD_0
  v_mfma_f32_16x16x32_f16 v[204:207], a[236:239], v[24:27], v[204:207]
  v_rcp_f16_sdwa v13, v13 dst_sel:WORD_0 dst_unused:UNUSED_PRESERVE src0_sel:WORD_0
  v_rcp_f16_sdwa v15, v15 dst_sel:WORD_0 dst_unused:UNUSED_PRESERVE src0_sel:WORD_0
  v_mfma_f32_16x16x32_f16 v[216:219], a[240:243], v[24:27], v[216:219]
  ds_read_b128 a[232:235], v1 offset:4096
  v_rcp_f16_sdwa v9, v9 dst_sel:WORD_1 dst_unused:UNUSED_PRESERVE src0_sel:WORD_1
  v_mfma_f32_16x16x32_f16 v[220:223], a[240:243], v[28:31], v[220:223]
  v_rcp_f16_sdwa v11, v11 dst_sel:WORD_1 dst_unused:UNUSED_PRESERVE src0_sel:WORD_1
  v_mfma_f32_16x16x32_f16 v[224:227], a[240:243], v[32:35], v[224:227]
  v_rcp_f16_sdwa v13, v13 dst_sel:WORD_1 dst_unused:UNUSED_PRESERVE src0_sel:WORD_1
  v_mfma_f32_16x16x32_f16 v[236:239], a[244:247], v[32:35], v[236:239]
  ds_read_b128 a[236:239], v1 offset:5120
  v_rcp_f16_sdwa v15, v15 dst_sel:WORD_1 dst_unused:UNUSED_PRESERVE src0_sel:WORD_1
  v_mfma_f32_16x16x32_f16 v[232:235], a[244:247], v[28:31], v[232:235]
  v_pk_mul_f16 v42, v8, v9
  v_pk_mul_f16 v43, v10, v11
  v_mfma_f32_16x16x32_f16 v[228:231], a[244:247], v[24:27], v[228:231]
  s_waitcnt lgkmcnt(3)
  v_pk_mul_f16 v46, v12, v13
  v_pk_mul_f16 v47, v14, v15
  v_mfma_f32_16x16x32_bf16 v[72:75], a[216:219], a[0:3], 0
  ds_read_b128 a[240:243], v1 offset:6144
  s_add_u32 m0, s29, 49152
  s_add_u32 s31, s29, 540672
  buffer_load_dwordx4 v2, s[8:11], s31 offen offset:0 lds
  v_cvt_pk_f16_f32 v8, v48, v49
  v_cvt_pk_f16_f32 v10, v50, v51
  v_mfma_f32_16x16x32_bf16 v[76:79], a[216:219], a[24:27], 0
  v_cvt_pk_f16_f32 v12, v52, v53
  v_cvt_pk_f16_f32 v14, v54, v55
  v_mfma_f32_16x16x32_bf16 v[80:83], a[216:219], a[48:51], 0
  v_pk_fma_f16 v9, v8, v8, s34 neg_lo:[1,0,0] neg_hi:[1,0,0]
  v_pk_fma_f16 v11, v10, v10, s34 neg_lo:[1,0,0] neg_hi:[1,0,0]
  v_pk_fma_f16 v13, v12, v12, s34 neg_lo:[1,0,0] neg_hi:[1,0,0]
  v_mfma_f32_16x16x32_bf16 v[92:95], a[220:223], a[48:51], 0
  ds_read_b128 a[244:247], v1 offset:7168
  buffer_load_dwordx4 v2, s[8:11], s31 offen offset:1024 lds
  v_pk_fma_f16 v15, v14, v14, s34 neg_lo:[1,0,0] neg_hi:[1,0,0]
  v_pk_mul_f16 v9, v9, v8
  v_mfma_f32_16x16x32_bf16 v[88:91], a[220:223], a[24:27], 0
  v_pk_mul_f16 v11, v11, v10
  v_pk_mul_f16 v13, v13, v12
  v_mfma_f32_16x16x32_bf16 v[84:87], a[220:223], a[0:3], 0
  v_pk_mul_f16 v15, v15, v14
  v_exp_f16_sdwa v9, v9 dst_sel:WORD_0 dst_unused:UNUSED_PRESERVE src0_sel:WORD_0
  v_mfma_f32_16x16x32_bf16 v[72:75], a[224:227], a[4:7], v[72:75]
  ds_read_b128 a[216:219], v1 offset:8192
  buffer_load_dwordx4 v2, s[8:11], s31 offen offset:2048 lds
  v_exp_f16_sdwa v11, v11 dst_sel:WORD_0 dst_unused:UNUSED_PRESERVE src0_sel:WORD_0
  v_mfma_f32_16x16x32_bf16 v[76:79], a[224:227], a[28:31], v[76:79]
  v_exp_f16_sdwa v13, v13 dst_sel:WORD_0 dst_unused:UNUSED_PRESERVE src0_sel:WORD_0
  v_mfma_f32_16x16x32_bf16 v[80:83], a[224:227], a[52:55], v[80:83]
  s_waitcnt lgkmcnt(3)
  v_exp_f16_sdwa v15, v15 dst_sel:WORD_0 dst_unused:UNUSED_PRESERVE src0_sel:WORD_0
  v_mfma_f32_16x16x32_bf16 v[92:95], a[228:231], a[52:55], v[92:95]
  ds_read_b128 a[220:223], v1 offset:9216
  buffer_load_dwordx4 v2, s[8:11], s31 offen offset:3072 lds
  v_exp_f16_sdwa v9, v9 dst_sel:WORD_1 dst_unused:UNUSED_PRESERVE src0_sel:WORD_1
  v_mfma_f32_16x16x32_bf16 v[88:91], a[228:231], a[28:31], v[88:91]
  s_add_u32 m0, s29, 53248
  v_exp_f16_sdwa v11, v11 dst_sel:WORD_1 dst_unused:UNUSED_PRESERVE src0_sel:WORD_1
  v_mfma_f32_16x16x32_bf16 v[84:87], a[228:231], a[4:7], v[84:87]
  s_add_u32 s31, s29, 544768
  v_exp_f16_sdwa v13, v13 dst_sel:WORD_1 dst_unused:UNUSED_PRESERVE src0_sel:WORD_1
  v_mfma_f32_16x16x32_bf16 v[72:75], a[232:235], a[8:11], v[72:75]
  ds_read_b128 a[224:227], v1 offset:10240
  buffer_load_dwordx4 v2, s[8:11], s31 offen offset:0 lds
  v_exp_f16_sdwa v15, v15 dst_sel:WORD_1 dst_unused:UNUSED_PRESERVE src0_sel:WORD_1
  v_mfma_f32_16x16x32_bf16 v[76:79], a[232:235], a[32:35], v[76:79]
  v_pk_fma_f16 v9, v9, s35, s35
  v_pk_fma_f16 v11, v11, s35, s35
  v_mfma_f32_16x16x32_bf16 v[80:83], a[232:235], a[56:59], v[80:83]
  v_pk_fma_f16 v13, v13, s35, s35
  v_pk_fma_f16 v15, v15, s35, s35
  v_mfma_f32_16x16x32_bf16 v[92:95], a[236:239], a[56:59], v[92:95]
  ds_read_b128 a[228:231], v1 offset:11264
  buffer_load_dwordx4 v2, s[8:11], s31 offen offset:1024 lds
  v_rcp_f16_sdwa v9, v9 dst_sel:WORD_0 dst_unused:UNUSED_PRESERVE src0_sel:WORD_0
  v_mfma_f32_16x16x32_bf16 v[88:91], a[236:239], a[32:35], v[88:91]
  v_rcp_f16_sdwa v11, v11 dst_sel:WORD_0 dst_unused:UNUSED_PRESERVE src0_sel:WORD_0
  v_mfma_f32_16x16x32_bf16 v[84:87], a[236:239], a[8:11], v[84:87]
  s_waitcnt lgkmcnt(3)
  v_rcp_f16_sdwa v13, v13 dst_sel:WORD_0 dst_unused:UNUSED_PRESERVE src0_sel:WORD_0
  v_rcp_f16_sdwa v15, v15 dst_sel:WORD_0 dst_unused:UNUSED_PRESERVE src0_sel:WORD_0
  v_mfma_f32_16x16x32_bf16 v[72:75], a[240:243], a[12:15], v[72:75]
  ds_read_b128 a[232:235], v1 offset:12288
  buffer_load_dwordx4 v2, s[8:11], s31 offen offset:2048 lds
  v_rcp_f16_sdwa v9, v9 dst_sel:WORD_1 dst_unused:UNUSED_PRESERVE src0_sel:WORD_1
  v_mfma_f32_16x16x32_bf16 v[76:79], a[240:243], a[36:39], v[76:79]
  v_rcp_f16_sdwa v11, v11 dst_sel:WORD_1 dst_unused:UNUSED_PRESERVE src0_sel:WORD_1
  v_mfma_f32_16x16x32_bf16 v[80:83], a[240:243], a[60:63], v[80:83]
  v_rcp_f16_sdwa v13, v13 dst_sel:WORD_1 dst_unused:UNUSED_PRESERVE src0_sel:WORD_1
  v_mfma_f32_16x16x32_bf16 v[92:95], a[244:247], a[60:63], v[92:95]
  ds_read_b128 a[236:239], v1 offset:13312
  buffer_load_dwordx4 v2, s[8:11], s31 offen offset:3072 lds
  v_rcp_f16_sdwa v15, v15 dst_sel:WORD_1 dst_unused:UNUSED_PRESERVE src0_sel:WORD_1
  v_mfma_f32_16x16x32_bf16 v[88:91], a[244:247], a[36:39], v[88:91]
  s_add_u32 m0, s29, 57344
  v_pk_mul_f16 v24, v8, v9
  v_pk_mul_f16 v25, v10, v11
  v_mfma_f32_16x16x32_bf16 v[84:87], a[244:247], a[12:15], v[84:87]
  s_add_u32 s31, s29, 548864
  v_pk_mul_f16 v28, v12, v13
  v_pk_mul_f16 v29, v14, v15
  v_mfma_f32_16x16x32_bf16 v[72:75], a[216:219], a[16:19], v[72:75]
  ds_read_b128 a[240:243], v1 offset:14336
  buffer_load_dwordx4 v2, s[8:11], s31 offen offset:0 lds
  v_cvt_pk_f16_f32 v16, v56, v57
  v_cvt_pk_f16_f32 v18, v58, v59
  v_mfma_f32_16x16x32_bf16 v[76:79], a[216:219], a[40:43], v[76:79]
  v_cvt_pk_f16_f32 v20, v60, v61
  v_cvt_pk_f16_f32 v22, v62, v63
  v_mfma_f32_16x16x32_bf16 v[80:83], a[216:219], a[64:67], v[80:83]
  s_waitcnt lgkmcnt(3)
  v_pk_fma_f16 v17, v16, v16, s34 neg_lo:[1,0,0] neg_hi:[1,0,0]
  v_pk_fma_f16 v19, v18, v18, s34 neg_lo:[1,0,0] neg_hi:[1,0,0]
  v_pk_fma_f16 v21, v20, v20, s34 neg_lo:[1,0,0] neg_hi:[1,0,0]
  v_mfma_f32_16x16x32_bf16 v[92:95], a[220:223], a[64:67], v[92:95]
  ds_read_b128 a[244:247], v1 offset:15360
  buffer_load_dwordx4 v2, s[8:11], s31 offen offset:1024 lds
  v_pk_fma_f16 v23, v22, v22, s34 neg_lo:[1,0,0] neg_hi:[1,0,0]
  v_pk_mul_f16 v17, v17, v16
  v_mfma_f32_16x16x32_bf16 v[88:91], a[220:223], a[40:43], v[88:91]
  v_pk_mul_f16 v19, v19, v18
  v_pk_mul_f16 v21, v21, v20
  v_mfma_f32_16x16x32_bf16 v[84:87], a[220:223], a[16:19], v[84:87]
  v_pk_mul_f16 v23, v23, v22
  v_exp_f16_sdwa v17, v17 dst_sel:WORD_0 dst_unused:UNUSED_PRESERVE src0_sel:WORD_0
  v_mfma_f32_16x16x32_bf16 v[72:75], a[224:227], a[20:23], v[72:75]
  ds_read_b128 a[216:219], v1 offset:16384
  buffer_load_dwordx4 v2, s[8:11], s31 offen offset:2048 lds
  v_exp_f16_sdwa v19, v19 dst_sel:WORD_0 dst_unused:UNUSED_PRESERVE src0_sel:WORD_0
  v_mfma_f32_16x16x32_bf16 v[76:79], a[224:227], a[44:47], v[76:79]
  v_exp_f16_sdwa v21, v21 dst_sel:WORD_0 dst_unused:UNUSED_PRESERVE src0_sel:WORD_0
  v_mfma_f32_16x16x32_bf16 v[80:83], a[224:227], a[68:71], v[80:83]
  v_exp_f16_sdwa v23, v23 dst_sel:WORD_0 dst_unused:UNUSED_PRESERVE src0_sel:WORD_0
  v_mfma_f32_16x16x32_bf16 v[92:95], a[228:231], a[68:71], v[92:95]
  ds_read_b128 a[220:223], v1 offset:17408
  buffer_load_dwordx4 v2, s[8:11], s31 offen offset:3072 lds
  v_exp_f16_sdwa v17, v17 dst_sel:WORD_1 dst_unused:UNUSED_PRESERVE src0_sel:WORD_1
  v_mfma_f32_16x16x32_bf16 v[88:91], a[228:231], a[44:47], v[88:91]
  v_exp_f16_sdwa v19, v19 dst_sel:WORD_1 dst_unused:UNUSED_PRESERVE src0_sel:WORD_1
  v_mfma_f32_16x16x32_bf16 v[84:87], a[228:231], a[20:23], v[84:87]
  s_waitcnt lgkmcnt(3)
  v_exp_f16_sdwa v21, v21 dst_sel:WORD_1 dst_unused:UNUSED_PRESERVE src0_sel:WORD_1
  v_mfma_f32_16x16x32_f16 v[96:99], a[232:235], v[36:39], v[96:99]
  ds_read_b128 a[224:227], v1 offset:18432
  v_exp_f16_sdwa v23, v23 dst_sel:WORD_1 dst_unused:UNUSED_PRESERVE src0_sel:WORD_1
  v_mfma_f32_16x16x32_f16 v[100:103], a[232:235], v[40:43], v[100:103]
  v_pk_fma_f16 v17, v17, s35, s35
  v_pk_fma_f16 v19, v19, s35, s35
  v_mfma_f32_16x16x32_f16 v[104:107], a[232:235], v[44:47], v[104:107]
  v_pk_fma_f16 v21, v21, s35, s35
  v_pk_fma_f16 v23, v23, s35, s35
  v_mfma_f32_16x16x32_f16 v[116:119], a[236:239], v[44:47], v[116:119]
  ds_read_b128 a[228:231], v1 offset:19456
  v_rcp_f16_sdwa v17, v17 dst_sel:WORD_0 dst_unused:UNUSED_PRESERVE src0_sel:WORD_0
  v_mfma_f32_16x16x32_f16 v[112:115], a[236:239], v[40:43], v[112:115]
  v_rcp_f16_sdwa v19, v19 dst_sel:WORD_0 dst_unused:UNUSED_PRESERVE src0_sel:WORD_0
  v_mfma_f32_16x16x32_f16 v[108:111], a[236:239], v[36:39], v[108:111]
  v_rcp_f16_sdwa v21, v21 dst_sel:WORD_0 dst_unused:UNUSED_PRESERVE src0_sel:WORD_0
  v_rcp_f16_sdwa v23, v23 dst_sel:WORD_0 dst_unused:UNUSED_PRESERVE src0_sel:WORD_0
  v_mfma_f32_16x16x32_f16 v[120:123], a[240:243], v[36:39], v[120:123]
  ds_read_b128 a[232:235], v1 offset:20480
  v_rcp_f16_sdwa v17, v17 dst_sel:WORD_1 dst_unused:UNUSED_PRESERVE src0_sel:WORD_1
  v_mfma_f32_16x16x32_f16 v[124:127], a[240:243], v[40:43], v[124:127]
  v_rcp_f16_sdwa v19, v19 dst_sel:WORD_1 dst_unused:UNUSED_PRESERVE src0_sel:WORD_1
  v_mfma_f32_16x16x32_f16 v[128:131], a[240:243], v[44:47], v[128:131]
  s_waitcnt lgkmcnt(3)
  v_rcp_f16_sdwa v21, v21 dst_sel:WORD_1 dst_unused:UNUSED_PRESERVE src0_sel:WORD_1
  v_mfma_f32_16x16x32_f16 v[140:143], a[244:247], v[44:47], v[140:143]
  ds_read_b128 a[236:239], v1 offset:21504
  v_rcp_f16_sdwa v23, v23 dst_sel:WORD_1 dst_unused:UNUSED_PRESERVE src0_sel:WORD_1
  v_mfma_f32_16x16x32_f16 v[136:139], a[244:247], v[40:43], v[136:139]
  v_pk_mul_f16 v32, v16, v17
  v_pk_mul_f16 v33, v18, v19
  v_mfma_f32_16x16x32_f16 v[132:135], a[244:247], v[36:39], v[132:135]
  v_pk_mul_f16 v26, v20, v21
  v_pk_mul_f16 v27, v22, v23
  v_mfma_f32_16x16x32_f16 v[144:147], a[216:219], v[36:39], v[144:147]
  ds_read_b128 a[240:243], v1 offset:22528
  v_cvt_pk_f16_f32 v8, v64, v65
  v_cvt_pk_f16_f32 v10, v66, v67
  v_mfma_f32_16x16x32_f16 v[148:151], a[216:219], v[40:43], v[148:151]
  v_cvt_pk_f16_f32 v12, v68, v69
  v_cvt_pk_f16_f32 v14, v70, v71
  v_mfma_f32_16x16x32_f16 v[152:155], a[216:219], v[44:47], v[152:155]
  v_pk_fma_f16 v9, v8, v8, s34 neg_lo:[1,0,0] neg_hi:[1,0,0]
  v_pk_fma_f16 v11, v10, v10, s34 neg_lo:[1,0,0] neg_hi:[1,0,0]
  v_pk_fma_f16 v13, v12, v12, s34 neg_lo:[1,0,0] neg_hi:[1,0,0]
  v_mfma_f32_16x16x32_f16 v[164:167], a[220:223], v[44:47], v[164:167]
  ds_read_b128 a[244:247], v1 offset:23552
  v_pk_fma_f16 v15, v14, v14, s34 neg_lo:[1,0,0] neg_hi:[1,0,0]
  v_pk_mul_f16 v9, v9, v8
  v_mfma_f32_16x16x32_f16 v[160:163], a[220:223], v[40:43], v[160:163]
  v_pk_mul_f16 v11, v11, v10
  v_pk_mul_f16 v13, v13, v12
  v_mfma_f32_16x16x32_f16 v[156:159], a[220:223], v[36:39], v[156:159]
  s_waitcnt lgkmcnt(3)
  v_pk_mul_f16 v15, v15, v14
  v_exp_f16_sdwa v9, v9 dst_sel:WORD_0 dst_unused:UNUSED_PRESERVE src0_sel:WORD_0
  v_mfma_f32_16x16x32_f16 v[168:171], a[224:227], v[36:39], v[168:171]
  ds_read_b128 a[216:219], v1 offset:24576
  v_exp_f16_sdwa v11, v11 dst_sel:WORD_0 dst_unused:UNUSED_PRESERVE src0_sel:WORD_0
  v_mfma_f32_16x16x32_f16 v[172:175], a[224:227], v[40:43], v[172:175]
  v_exp_f16_sdwa v13, v13 dst_sel:WORD_0 dst_unused:UNUSED_PRESERVE src0_sel:WORD_0
  v_mfma_f32_16x16x32_f16 v[176:179], a[224:227], v[44:47], v[176:179]
  v_exp_f16_sdwa v15, v15 dst_sel:WORD_0 dst_unused:UNUSED_PRESERVE src0_sel:WORD_0
  v_mfma_f32_16x16x32_f16 v[188:191], a[228:231], v[44:47], v[188:191]
  ds_read_b128 a[220:223], v1 offset:25600
  v_exp_f16_sdwa v9, v9 dst_sel:WORD_1 dst_unused:UNUSED_PRESERVE src0_sel:WORD_1
  v_mfma_f32_16x16x32_f16 v[184:187], a[228:231], v[40:43], v[184:187]
  v_exp_f16_sdwa v11, v11 dst_sel:WORD_1 dst_unused:UNUSED_PRESERVE src0_sel:WORD_1
  v_mfma_f32_16x16x32_f16 v[180:183], a[228:231], v[36:39], v[180:183]
  v_exp_f16_sdwa v13, v13 dst_sel:WORD_1 dst_unused:UNUSED_PRESERVE src0_sel:WORD_1
  v_mfma_f32_16x16x32_f16 v[192:195], a[232:235], v[36:39], v[192:195]
  ds_read_b128 a[224:227], v1 offset:26624
  v_exp_f16_sdwa v15, v15 dst_sel:WORD_1 dst_unused:UNUSED_PRESERVE src0_sel:WORD_1
  v_mfma_f32_16x16x32_f16 v[196:199], a[232:235], v[40:43], v[196:199]
  v_pk_fma_f16 v9, v9, s35, s35
  v_pk_fma_f16 v11, v11, s35, s35
  v_mfma_f32_16x16x32_f16 v[200:203], a[232:235], v[44:47], v[200:203]
  s_waitcnt lgkmcnt(3)
  v_pk_fma_f16 v13, v13, s35, s35
  v_pk_fma_f16 v15, v15, s35, s35
  v_mfma_f32_16x16x32_f16 v[212:215], a[236:239], v[44:47], v[212:215]
  ds_read_b128 a[228:231], v1 offset:27648
  v_rcp_f16_sdwa v9, v9 dst_sel:WORD_0 dst_unused:UNUSED_PRESERVE src0_sel:WORD_0
  v_mfma_f32_16x16x32_f16 v[208:211], a[236:239], v[40:43], v[208:211]
  v_rcp_f16_sdwa v11, v11 dst_sel:WORD_0 dst_unused:UNUSED_PRESERVE src0_sel:WORD_0
  v_mfma_f32_16x16x32_f16 v[204:207], a[236:239], v[36:39], v[204:207]
  v_rcp_f16_sdwa v13, v13 dst_sel:WORD_0 dst_unused:UNUSED_PRESERVE src0_sel:WORD_0
  v_rcp_f16_sdwa v15, v15 dst_sel:WORD_0 dst_unused:UNUSED_PRESERVE src0_sel:WORD_0
  v_mfma_f32_16x16x32_f16 v[216:219], a[240:243], v[36:39], v[216:219]
  ds_read_b128 a[232:235], v1 offset:28672
  v_rcp_f16_sdwa v9, v9 dst_sel:WORD_1 dst_unused:UNUSED_PRESERVE src0_sel:WORD_1
  v_mfma_f32_16x16x32_f16 v[220:223], a[240:243], v[40:43], v[220:223]
  v_rcp_f16_sdwa v11, v11 dst_sel:WORD_1 dst_unused:UNUSED_PRESERVE src0_sel:WORD_1
  v_mfma_f32_16x16x32_f16 v[224:227], a[240:243], v[44:47], v[224:227]
  v_rcp_f16_sdwa v13, v13 dst_sel:WORD_1 dst_unused:UNUSED_PRESERVE src0_sel:WORD_1
  v_mfma_f32_16x16x32_f16 v[236:239], a[244:247], v[44:47], v[236:239]
  ds_read_b128 a[236:239], v1 offset:29696
  v_rcp_f16_sdwa v15, v15 dst_sel:WORD_1 dst_unused:UNUSED_PRESERVE src0_sel:WORD_1
  v_mfma_f32_16x16x32_f16 v[232:235], a[244:247], v[40:43], v[232:235]
  v_pk_mul_f16 v30, v8, v9
  v_pk_mul_f16 v31, v10, v11
  v_mfma_f32_16x16x32_f16 v[228:231], a[244:247], v[36:39], v[228:231]
  s_waitcnt lgkmcnt(3)
  v_pk_mul_f16 v34, v12, v13
  v_pk_mul_f16 v35, v14, v15
  v_mfma_f32_16x16x32_bf16 v[48:51], a[216:219], a[0:3], 0
  ds_read_b128 a[240:243], v1 offset:30720
  v_cvt_pk_f16_f32 v8, v72, v73
  v_cvt_pk_f16_f32 v10, v74, v75
  v_mfma_f32_16x16x32_bf16 v[52:55], a[216:219], a[24:27], 0
  v_cvt_pk_f16_f32 v12, v76, v77
  v_cvt_pk_f16_f32 v14, v78, v79
  v_mfma_f32_16x16x32_bf16 v[56:59], a[216:219], a[48:51], 0
  v_pk_fma_f16 v9, v8, v8, s34 neg_lo:[1,0,0] neg_hi:[1,0,0]
  v_pk_fma_f16 v11, v10, v10, s34 neg_lo:[1,0,0] neg_hi:[1,0,0]
  v_pk_fma_f16 v13, v12, v12, s34 neg_lo:[1,0,0] neg_hi:[1,0,0]
  v_mfma_f32_16x16x32_bf16 v[68:71], a[220:223], a[48:51], 0
  ds_read_b128 a[244:247], v1 offset:31744
  v_pk_fma_f16 v15, v14, v14, s34 neg_lo:[1,0,0] neg_hi:[1,0,0]
  v_pk_mul_f16 v9, v9, v8
  v_mfma_f32_16x16x32_bf16 v[64:67], a[220:223], a[24:27], 0
  buffer_load_dwordx4 a[204:207], v3, s[16:19], s97 offen offset:192
  v_pk_mul_f16 v11, v11, v10
  v_pk_mul_f16 v13, v13, v12
  v_mfma_f32_16x16x32_bf16 v[60:63], a[220:223], a[0:3], 0
  v_pk_mul_f16 v15, v15, v14
  v_exp_f16_sdwa v9, v9 dst_sel:WORD_0 dst_unused:UNUSED_PRESERVE src0_sel:WORD_0
  v_mfma_f32_16x16x32_bf16 v[48:51], a[224:227], a[4:7], v[48:51]
  ds_read_b128 a[216:219], v1 offset:32768
  v_exp_f16_sdwa v11, v11 dst_sel:WORD_0 dst_unused:UNUSED_PRESERVE src0_sel:WORD_0
  v_mfma_f32_16x16x32_bf16 v[52:55], a[224:227], a[28:31], v[52:55]
  v_exp_f16_sdwa v13, v13 dst_sel:WORD_0 dst_unused:UNUSED_PRESERVE src0_sel:WORD_0
  v_mfma_f32_16x16x32_bf16 v[56:59], a[224:227], a[52:55], v[56:59]
  s_waitcnt lgkmcnt(3)
  v_exp_f16_sdwa v15, v15 dst_sel:WORD_0 dst_unused:UNUSED_PRESERVE src0_sel:WORD_0
  v_mfma_f32_16x16x32_bf16 v[68:71], a[228:231], a[52:55], v[68:71]
  ds_read_b128 a[220:223], v1 offset:33792
  v_exp_f16_sdwa v9, v9 dst_sel:WORD_1 dst_unused:UNUSED_PRESERVE src0_sel:WORD_1
  v_mfma_f32_16x16x32_bf16 v[64:67], a[228:231], a[28:31], v[64:67]
  v_exp_f16_sdwa v11, v11 dst_sel:WORD_1 dst_unused:UNUSED_PRESERVE src0_sel:WORD_1
  v_mfma_f32_16x16x32_bf16 v[60:63], a[228:231], a[4:7], v[60:63]
  v_exp_f16_sdwa v13, v13 dst_sel:WORD_1 dst_unused:UNUSED_PRESERVE src0_sel:WORD_1
  v_mfma_f32_16x16x32_bf16 v[48:51], a[232:235], a[8:11], v[48:51]
  ds_read_b128 a[224:227], v1 offset:34816
  v_exp_f16_sdwa v15, v15 dst_sel:WORD_1 dst_unused:UNUSED_PRESERVE src0_sel:WORD_1
  v_mfma_f32_16x16x32_bf16 v[52:55], a[232:235], a[32:35], v[52:55]
  buffer_load_dwordx4 a[208:211], v3, s[16:19], s97 offen offset:256
  v_pk_fma_f16 v9, v9, s35, s35
  v_pk_fma_f16 v11, v11, s35, s35
  v_mfma_f32_16x16x32_bf16 v[56:59], a[232:235], a[56:59], v[56:59]
  v_pk_fma_f16 v13, v13, s35, s35
  v_pk_fma_f16 v15, v15, s35, s35
  v_mfma_f32_16x16x32_bf16 v[68:71], a[236:239], a[56:59], v[68:71]
  ds_read_b128 a[228:231], v1 offset:35840
  v_rcp_f16_sdwa v9, v9 dst_sel:WORD_0 dst_unused:UNUSED_PRESERVE src0_sel:WORD_0
  v_mfma_f32_16x16x32_bf16 v[64:67], a[236:239], a[32:35], v[64:67]
  v_rcp_f16_sdwa v11, v11 dst_sel:WORD_0 dst_unused:UNUSED_PRESERVE src0_sel:WORD_0
  v_mfma_f32_16x16x32_bf16 v[60:63], a[236:239], a[8:11], v[60:63]
  s_waitcnt lgkmcnt(3)
  v_rcp_f16_sdwa v13, v13 dst_sel:WORD_0 dst_unused:UNUSED_PRESERVE src0_sel:WORD_0
  v_rcp_f16_sdwa v15, v15 dst_sel:WORD_0 dst_unused:UNUSED_PRESERVE src0_sel:WORD_0
  v_mfma_f32_16x16x32_bf16 v[48:51], a[240:243], a[12:15], v[48:51]
  ds_read_b128 a[232:235], v1 offset:36864
  v_rcp_f16_sdwa v9, v9 dst_sel:WORD_1 dst_unused:UNUSED_PRESERVE src0_sel:WORD_1
  v_mfma_f32_16x16x32_bf16 v[52:55], a[240:243], a[36:39], v[52:55]
  v_rcp_f16_sdwa v11, v11 dst_sel:WORD_1 dst_unused:UNUSED_PRESERVE src0_sel:WORD_1
  v_mfma_f32_16x16x32_bf16 v[56:59], a[240:243], a[60:63], v[56:59]
  v_rcp_f16_sdwa v13, v13 dst_sel:WORD_1 dst_unused:UNUSED_PRESERVE src0_sel:WORD_1
  v_mfma_f32_16x16x32_bf16 v[68:71], a[244:247], a[60:63], v[68:71]
  ds_read_b128 a[236:239], v1 offset:37888
  v_rcp_f16_sdwa v15, v15 dst_sel:WORD_1 dst_unused:UNUSED_PRESERVE src0_sel:WORD_1
  v_mfma_f32_16x16x32_bf16 v[64:67], a[244:247], a[36:39], v[64:67]
  buffer_load_dwordx4 a[212:215], v3, s[16:19], s97 offen offset:320
  v_pk_mul_f16 v36, v8, v9
  v_pk_mul_f16 v37, v10, v11
  v_mfma_f32_16x16x32_bf16 v[60:63], a[244:247], a[12:15], v[60:63]
  v_pk_mul_f16 v40, v12, v13
  v_pk_mul_f16 v41, v14, v15
  v_mfma_f32_16x16x32_bf16 v[48:51], a[216:219], a[16:19], v[48:51]
  ds_read_b128 a[240:243], v1 offset:38912
  v_cvt_pk_f16_f32 v16, v80, v81
  v_cvt_pk_f16_f32 v18, v82, v83
  v_mfma_f32_16x16x32_bf16 v[52:55], a[216:219], a[40:43], v[52:55]
  v_cvt_pk_f16_f32 v20, v84, v85
  v_cvt_pk_f16_f32 v22, v86, v87
  v_mfma_f32_16x16x32_bf16 v[56:59], a[216:219], a[64:67], v[56:59]
  s_waitcnt lgkmcnt(3)
  v_pk_fma_f16 v17, v16, v16, s34 neg_lo:[1,0,0] neg_hi:[1,0,0]
  v_pk_fma_f16 v19, v18, v18, s34 neg_lo:[1,0,0] neg_hi:[1,0,0]
  v_pk_fma_f16 v21, v20, v20, s34 neg_lo:[1,0,0] neg_hi:[1,0,0]
  v_mfma_f32_16x16x32_bf16 v[68:71], a[220:223], a[64:67], v[68:71]
  ds_read_b128 a[244:247], v1 offset:39936
  v_pk_fma_f16 v23, v22, v22, s34 neg_lo:[1,0,0] neg_hi:[1,0,0]
  v_pk_mul_f16 v17, v17, v16
  v_mfma_f32_16x16x32_bf16 v[64:67], a[220:223], a[40:43], v[64:67]
  v_pk_mul_f16 v19, v19, v18
  v_pk_mul_f16 v21, v21, v20
  v_mfma_f32_16x16x32_bf16 v[60:63], a[220:223], a[16:19], v[60:63]
  v_pk_mul_f16 v23, v23, v22
  v_exp_f16_sdwa v17, v17 dst_sel:WORD_0 dst_unused:UNUSED_PRESERVE src0_sel:WORD_0
  v_mfma_f32_16x16x32_bf16 v[48:51], a[224:227], a[20:23], v[48:51]
  ds_read_b128 a[216:219], v1 offset:40960
  v_exp_f16_sdwa v19, v19 dst_sel:WORD_0 dst_unused:UNUSED_PRESERVE src0_sel:WORD_0
  v_mfma_f32_16x16x32_bf16 v[52:55], a[224:227], a[44:47], v[52:55]
  v_exp_f16_sdwa v21, v21 dst_sel:WORD_0 dst_unused:UNUSED_PRESERVE src0_sel:WORD_0
  v_mfma_f32_16x16x32_bf16 v[56:59], a[224:227], a[68:71], v[56:59]
  v_exp_f16_sdwa v23, v23 dst_sel:WORD_0 dst_unused:UNUSED_PRESERVE src0_sel:WORD_0
  v_mfma_f32_16x16x32_bf16 v[68:71], a[228:231], a[68:71], v[68:71]
  ds_read_b128 a[220:223], v1 offset:41984
  v_exp_f16_sdwa v17, v17 dst_sel:WORD_1 dst_unused:UNUSED_PRESERVE src0_sel:WORD_1
  v_mfma_f32_16x16x32_bf16 v[64:67], a[228:231], a[44:47], v[64:67]
  v_exp_f16_sdwa v19, v19 dst_sel:WORD_1 dst_unused:UNUSED_PRESERVE src0_sel:WORD_1
  v_mfma_f32_16x16x32_bf16 v[60:63], a[228:231], a[20:23], v[60:63]
  s_waitcnt lgkmcnt(3)
  v_exp_f16_sdwa v21, v21 dst_sel:WORD_1 dst_unused:UNUSED_PRESERVE src0_sel:WORD_1
  v_mfma_f32_16x16x32_f16 v[96:99], a[232:235], v[24:27], v[96:99]
  ds_read_b128 a[224:227], v1 offset:43008
  v_exp_f16_sdwa v23, v23 dst_sel:WORD_1 dst_unused:UNUSED_PRESERVE src0_sel:WORD_1
  v_mfma_f32_16x16x32_f16 v[100:103], a[232:235], v[28:31], v[100:103]
  v_pk_fma_f16 v17, v17, s35, s35
  v_pk_fma_f16 v19, v19, s35, s35
  v_mfma_f32_16x16x32_f16 v[104:107], a[232:235], v[32:35], v[104:107]
  v_pk_fma_f16 v21, v21, s35, s35
  v_pk_fma_f16 v23, v23, s35, s35
  v_mfma_f32_16x16x32_f16 v[116:119], a[236:239], v[32:35], v[116:119]
  ds_read_b128 a[228:231], v1 offset:44032
  v_rcp_f16_sdwa v17, v17 dst_sel:WORD_0 dst_unused:UNUSED_PRESERVE src0_sel:WORD_0
  v_mfma_f32_16x16x32_f16 v[112:115], a[236:239], v[28:31], v[112:115]
  v_rcp_f16_sdwa v19, v19 dst_sel:WORD_0 dst_unused:UNUSED_PRESERVE src0_sel:WORD_0
  v_mfma_f32_16x16x32_f16 v[108:111], a[236:239], v[24:27], v[108:111]
  v_rcp_f16_sdwa v21, v21 dst_sel:WORD_0 dst_unused:UNUSED_PRESERVE src0_sel:WORD_0
  v_rcp_f16_sdwa v23, v23 dst_sel:WORD_0 dst_unused:UNUSED_PRESERVE src0_sel:WORD_0
  v_mfma_f32_16x16x32_f16 v[120:123], a[240:243], v[24:27], v[120:123]
  ds_read_b128 a[232:235], v1 offset:45056
  v_rcp_f16_sdwa v17, v17 dst_sel:WORD_1 dst_unused:UNUSED_PRESERVE src0_sel:WORD_1
  v_mfma_f32_16x16x32_f16 v[124:127], a[240:243], v[28:31], v[124:127]
  v_rcp_f16_sdwa v19, v19 dst_sel:WORD_1 dst_unused:UNUSED_PRESERVE src0_sel:WORD_1
  v_mfma_f32_16x16x32_f16 v[128:131], a[240:243], v[32:35], v[128:131]
  s_waitcnt lgkmcnt(3)
  v_rcp_f16_sdwa v21, v21 dst_sel:WORD_1 dst_unused:UNUSED_PRESERVE src0_sel:WORD_1
  v_mfma_f32_16x16x32_f16 v[140:143], a[244:247], v[32:35], v[140:143]
  ds_read_b128 a[236:239], v1 offset:46080
  v_rcp_f16_sdwa v23, v23 dst_sel:WORD_1 dst_unused:UNUSED_PRESERVE src0_sel:WORD_1
  v_mfma_f32_16x16x32_f16 v[136:139], a[244:247], v[28:31], v[136:139]
  v_pk_mul_f16 v44, v16, v17
  v_pk_mul_f16 v45, v18, v19
  v_mfma_f32_16x16x32_f16 v[132:135], a[244:247], v[24:27], v[132:135]
  v_pk_mul_f16 v38, v20, v21
  v_pk_mul_f16 v39, v22, v23
  v_mfma_f32_16x16x32_f16 v[144:147], a[216:219], v[24:27], v[144:147]
  ds_read_b128 a[240:243], v1 offset:47104
  ds_read_b128 a[244:247], v1 offset:48128
  v_cvt_pk_f16_f32 v8, v88, v89
  v_cvt_pk_f16_f32 v10, v90, v91
  v_mfma_f32_16x16x32_f16 v[148:151], a[216:219], v[28:31], v[148:151]
  v_cvt_pk_f16_f32 v12, v92, v93
  v_cvt_pk_f16_f32 v14, v94, v95
  v_mfma_f32_16x16x32_f16 v[152:155], a[216:219], v[32:35], v[152:155]
  v_pk_fma_f16 v9, v8, v8, s34 neg_lo:[1,0,0] neg_hi:[1,0,0]
  v_pk_fma_f16 v11, v10, v10, s34 neg_lo:[1,0,0] neg_hi:[1,0,0]
  v_pk_fma_f16 v13, v12, v12, s34 neg_lo:[1,0,0] neg_hi:[1,0,0]
  v_mfma_f32_16x16x32_f16 v[164:167], a[220:223], v[32:35], v[164:167]
  v_pk_fma_f16 v15, v14, v14, s34 neg_lo:[1,0,0] neg_hi:[1,0,0]
  v_pk_mul_f16 v9, v9, v8
  v_mfma_f32_16x16x32_f16 v[160:163], a[220:223], v[28:31], v[160:163]
  v_pk_mul_f16 v11, v11, v10
  v_pk_mul_f16 v13, v13, v12
  v_mfma_f32_16x16x32_f16 v[156:159], a[220:223], v[24:27], v[156:159]
  s_waitcnt lgkmcnt(3)
  v_pk_mul_f16 v15, v15, v14
  v_exp_f16_sdwa v9, v9 dst_sel:WORD_0 dst_unused:UNUSED_PRESERVE src0_sel:WORD_0
  v_mfma_f32_16x16x32_f16 v[168:171], a[224:227], v[24:27], v[168:171]
  s_waitcnt lgkmcnt(0)
  s_waitcnt vmcnt(3)
  s_barrier
  ds_read_b128 a[216:219], v4 offset:0
  v_exp_f16_sdwa v11, v11 dst_sel:WORD_0 dst_unused:UNUSED_PRESERVE src0_sel:WORD_0
  v_mfma_f32_16x16x32_f16 v[172:175], a[224:227], v[28:31], v[172:175]
  v_exp_f16_sdwa v13, v13 dst_sel:WORD_0 dst_unused:UNUSED_PRESERVE src0_sel:WORD_0
  v_mfma_f32_16x16x32_f16 v[176:179], a[224:227], v[32:35], v[176:179]
  v_exp_f16_sdwa v15, v15 dst_sel:WORD_0 dst_unused:UNUSED_PRESERVE src0_sel:WORD_0
  v_mfma_f32_16x16x32_f16 v[188:191], a[228:231], v[32:35], v[188:191]
  ds_read_b128 a[220:223], v4 offset:1024
  v_exp_f16_sdwa v9, v9 dst_sel:WORD_1 dst_unused:UNUSED_PRESERVE src0_sel:WORD_1
  v_mfma_f32_16x16x32_f16 v[184:187], a[228:231], v[28:31], v[184:187]
  v_exp_f16_sdwa v11, v11 dst_sel:WORD_1 dst_unused:UNUSED_PRESERVE src0_sel:WORD_1
  v_mfma_f32_16x16x32_f16 v[180:183], a[228:231], v[24:27], v[180:183]
  v_exp_f16_sdwa v13, v13 dst_sel:WORD_1 dst_unused:UNUSED_PRESERVE src0_sel:WORD_1
  v_mfma_f32_16x16x32_f16 v[192:195], a[232:235], v[24:27], v[192:195]
  ds_read_b128 a[224:227], v4 offset:2048
  v_exp_f16_sdwa v15, v15 dst_sel:WORD_1 dst_unused:UNUSED_PRESERVE src0_sel:WORD_1
  v_mfma_f32_16x16x32_f16 v[196:199], a[232:235], v[28:31], v[196:199]
  v_pk_fma_f16 v9, v9, s35, s35
  v_pk_fma_f16 v11, v11, s35, s35
  v_mfma_f32_16x16x32_f16 v[200:203], a[232:235], v[32:35], v[200:203]
  v_pk_fma_f16 v13, v13, s35, s35
  v_pk_fma_f16 v15, v15, s35, s35
  v_mfma_f32_16x16x32_f16 v[212:215], a[236:239], v[32:35], v[212:215]
  ds_read_b128 a[228:231], v4 offset:3072
  v_rcp_f16_sdwa v9, v9 dst_sel:WORD_0 dst_unused:UNUSED_PRESERVE src0_sel:WORD_0
  v_mfma_f32_16x16x32_f16 v[208:211], a[236:239], v[28:31], v[208:211]
  v_rcp_f16_sdwa v11, v11 dst_sel:WORD_0 dst_unused:UNUSED_PRESERVE src0_sel:WORD_0
  v_mfma_f32_16x16x32_f16 v[204:207], a[236:239], v[24:27], v[204:207]
  v_rcp_f16_sdwa v13, v13 dst_sel:WORD_0 dst_unused:UNUSED_PRESERVE src0_sel:WORD_0
  v_rcp_f16_sdwa v15, v15 dst_sel:WORD_0 dst_unused:UNUSED_PRESERVE src0_sel:WORD_0
  v_mfma_f32_16x16x32_f16 v[216:219], a[240:243], v[24:27], v[216:219]
  ds_read_b128 a[232:235], v4 offset:4096
  v_rcp_f16_sdwa v9, v9 dst_sel:WORD_1 dst_unused:UNUSED_PRESERVE src0_sel:WORD_1
  v_mfma_f32_16x16x32_f16 v[220:223], a[240:243], v[28:31], v[220:223]
  v_rcp_f16_sdwa v11, v11 dst_sel:WORD_1 dst_unused:UNUSED_PRESERVE src0_sel:WORD_1
  v_mfma_f32_16x16x32_f16 v[224:227], a[240:243], v[32:35], v[224:227]
  v_rcp_f16_sdwa v13, v13 dst_sel:WORD_1 dst_unused:UNUSED_PRESERVE src0_sel:WORD_1
  v_mfma_f32_16x16x32_f16 v[236:239], a[244:247], v[32:35], v[236:239]
  ds_read_b128 a[236:239], v4 offset:5120
  v_rcp_f16_sdwa v15, v15 dst_sel:WORD_1 dst_unused:UNUSED_PRESERVE src0_sel:WORD_1
  v_mfma_f32_16x16x32_f16 v[232:235], a[244:247], v[28:31], v[232:235]
  v_pk_mul_f16 v42, v8, v9
  v_pk_mul_f16 v43, v10, v11
  v_mfma_f32_16x16x32_f16 v[228:231], a[244:247], v[24:27], v[228:231]
  s_waitcnt lgkmcnt(3)
  v_pk_mul_f16 v46, v12, v13
  v_pk_mul_f16 v47, v14, v15
  v_mfma_f32_16x16x32_bf16 v[72:75], a[216:219], a[0:3], 0
  ds_read_b128 a[240:243], v4 offset:6144
  s_add_u32 m0, s29, 0
  s_add_u32 s31, s29, 0
  buffer_load_dwordx4 v2, s[8:11], s31 offen offset:0 lds
  v_cvt_pk_f16_f32 v8, v48, v49
  v_cvt_pk_f16_f32 v10, v50, v51
  v_mfma_f32_16x16x32_bf16 v[76:79], a[216:219], a[24:27], 0
  v_cvt_pk_f16_f32 v12, v52, v53
  v_cvt_pk_f16_f32 v14, v54, v55
  v_mfma_f32_16x16x32_bf16 v[80:83], a[216:219], a[48:51], 0
  v_pk_fma_f16 v9, v8, v8, s34 neg_lo:[1,0,0] neg_hi:[1,0,0]
  v_pk_fma_f16 v11, v10, v10, s34 neg_lo:[1,0,0] neg_hi:[1,0,0]
  v_pk_fma_f16 v13, v12, v12, s34 neg_lo:[1,0,0] neg_hi:[1,0,0]
  v_mfma_f32_16x16x32_bf16 v[92:95], a[220:223], a[48:51], 0
  ds_read_b128 a[244:247], v4 offset:7168
  buffer_load_dwordx4 v2, s[8:11], s31 offen offset:1024 lds
  v_pk_fma_f16 v15, v14, v14, s34 neg_lo:[1,0,0] neg_hi:[1,0,0]
  v_pk_mul_f16 v9, v9, v8
  v_mfma_f32_16x16x32_bf16 v[88:91], a[220:223], a[24:27], 0
  v_pk_mul_f16 v11, v11, v10
  v_pk_mul_f16 v13, v13, v12
  v_mfma_f32_16x16x32_bf16 v[84:87], a[220:223], a[0:3], 0
  v_pk_mul_f16 v15, v15, v14
  v_exp_f16_sdwa v9, v9 dst_sel:WORD_0 dst_unused:UNUSED_PRESERVE src0_sel:WORD_0
  v_mfma_f32_16x16x32_bf16 v[72:75], a[224:227], a[4:7], v[72:75]
  ds_read_b128 a[216:219], v4 offset:8192
  buffer_load_dwordx4 v2, s[8:11], s31 offen offset:2048 lds
  v_exp_f16_sdwa v11, v11 dst_sel:WORD_0 dst_unused:UNUSED_PRESERVE src0_sel:WORD_0
  v_mfma_f32_16x16x32_bf16 v[76:79], a[224:227], a[28:31], v[76:79]
  v_exp_f16_sdwa v13, v13 dst_sel:WORD_0 dst_unused:UNUSED_PRESERVE src0_sel:WORD_0
  v_mfma_f32_16x16x32_bf16 v[80:83], a[224:227], a[52:55], v[80:83]
  s_waitcnt lgkmcnt(3)
  v_exp_f16_sdwa v15, v15 dst_sel:WORD_0 dst_unused:UNUSED_PRESERVE src0_sel:WORD_0
  v_mfma_f32_16x16x32_bf16 v[92:95], a[228:231], a[52:55], v[92:95]
  ds_read_b128 a[220:223], v4 offset:9216
  buffer_load_dwordx4 v2, s[8:11], s31 offen offset:3072 lds
  v_exp_f16_sdwa v9, v9 dst_sel:WORD_1 dst_unused:UNUSED_PRESERVE src0_sel:WORD_1
  v_mfma_f32_16x16x32_bf16 v[88:91], a[228:231], a[28:31], v[88:91]
  s_add_u32 m0, s29, 4096
  v_exp_f16_sdwa v11, v11 dst_sel:WORD_1 dst_unused:UNUSED_PRESERVE src0_sel:WORD_1
  v_mfma_f32_16x16x32_bf16 v[84:87], a[228:231], a[4:7], v[84:87]
  s_add_u32 s31, s29, 4096
  v_exp_f16_sdwa v13, v13 dst_sel:WORD_1 dst_unused:UNUSED_PRESERVE src0_sel:WORD_1
  v_mfma_f32_16x16x32_bf16 v[72:75], a[232:235], a[8:11], v[72:75]
  ds_read_b128 a[224:227], v4 offset:10240
  buffer_load_dwordx4 v2, s[8:11], s31 offen offset:0 lds
  v_exp_f16_sdwa v15, v15 dst_sel:WORD_1 dst_unused:UNUSED_PRESERVE src0_sel:WORD_1
  v_mfma_f32_16x16x32_bf16 v[76:79], a[232:235], a[32:35], v[76:79]
  v_pk_fma_f16 v9, v9, s35, s35
  v_pk_fma_f16 v11, v11, s35, s35
  v_mfma_f32_16x16x32_bf16 v[80:83], a[232:235], a[56:59], v[80:83]
  v_pk_fma_f16 v13, v13, s35, s35
  v_pk_fma_f16 v15, v15, s35, s35
  v_mfma_f32_16x16x32_bf16 v[92:95], a[236:239], a[56:59], v[92:95]
  ds_read_b128 a[228:231], v4 offset:11264
  buffer_load_dwordx4 v2, s[8:11], s31 offen offset:1024 lds
  v_rcp_f16_sdwa v9, v9 dst_sel:WORD_0 dst_unused:UNUSED_PRESERVE src0_sel:WORD_0
  v_mfma_f32_16x16x32_bf16 v[88:91], a[236:239], a[32:35], v[88:91]
  v_rcp_f16_sdwa v11, v11 dst_sel:WORD_0 dst_unused:UNUSED_PRESERVE src0_sel:WORD_0
  v_mfma_f32_16x16x32_bf16 v[84:87], a[236:239], a[8:11], v[84:87]
  s_waitcnt lgkmcnt(3)
  v_rcp_f16_sdwa v13, v13 dst_sel:WORD_0 dst_unused:UNUSED_PRESERVE src0_sel:WORD_0
  v_rcp_f16_sdwa v15, v15 dst_sel:WORD_0 dst_unused:UNUSED_PRESERVE src0_sel:WORD_0
  v_mfma_f32_16x16x32_bf16 v[72:75], a[240:243], a[12:15], v[72:75]
  ds_read_b128 a[232:235], v4 offset:12288
  buffer_load_dwordx4 v2, s[8:11], s31 offen offset:2048 lds
  v_rcp_f16_sdwa v9, v9 dst_sel:WORD_1 dst_unused:UNUSED_PRESERVE src0_sel:WORD_1
  v_mfma_f32_16x16x32_bf16 v[76:79], a[240:243], a[36:39], v[76:79]
  v_rcp_f16_sdwa v11, v11 dst_sel:WORD_1 dst_unused:UNUSED_PRESERVE src0_sel:WORD_1
  v_mfma_f32_16x16x32_bf16 v[80:83], a[240:243], a[60:63], v[80:83]
  v_rcp_f16_sdwa v13, v13 dst_sel:WORD_1 dst_unused:UNUSED_PRESERVE src0_sel:WORD_1
  v_mfma_f32_16x16x32_bf16 v[92:95], a[244:247], a[60:63], v[92:95]
  ds_read_b128 a[236:239], v4 offset:13312
  buffer_load_dwordx4 v2, s[8:11], s31 offen offset:3072 lds
  v_rcp_f16_sdwa v15, v15 dst_sel:WORD_1 dst_unused:UNUSED_PRESERVE src0_sel:WORD_1
  v_mfma_f32_16x16x32_bf16 v[88:91], a[244:247], a[36:39], v[88:91]
  s_add_u32 m0, s29, 8192
  v_pk_mul_f16 v24, v8, v9
  v_pk_mul_f16 v25, v10, v11
  v_mfma_f32_16x16x32_bf16 v[84:87], a[244:247], a[12:15], v[84:87]
  s_add_u32 s31, s29, 8192
  v_pk_mul_f16 v28, v12, v13
  v_pk_mul_f16 v29, v14, v15
  v_mfma_f32_16x16x32_bf16 v[72:75], a[216:219], a[16:19], v[72:75]
  ds_read_b128 a[240:243], v4 offset:14336
  buffer_load_dwordx4 v2, s[8:11], s31 offen offset:0 lds
  v_cvt_pk_f16_f32 v16, v56, v57
  v_cvt_pk_f16_f32 v18, v58, v59
  v_mfma_f32_16x16x32_bf16 v[76:79], a[216:219], a[40:43], v[76:79]
  v_cvt_pk_f16_f32 v20, v60, v61
  v_cvt_pk_f16_f32 v22, v62, v63
  v_mfma_f32_16x16x32_bf16 v[80:83], a[216:219], a[64:67], v[80:83]
  s_waitcnt lgkmcnt(3)
  v_pk_fma_f16 v17, v16, v16, s34 neg_lo:[1,0,0] neg_hi:[1,0,0]
  v_pk_fma_f16 v19, v18, v18, s34 neg_lo:[1,0,0] neg_hi:[1,0,0]
  v_pk_fma_f16 v21, v20, v20, s34 neg_lo:[1,0,0] neg_hi:[1,0,0]
  v_mfma_f32_16x16x32_bf16 v[92:95], a[220:223], a[64:67], v[92:95]
  ds_read_b128 a[244:247], v4 offset:15360
  buffer_load_dwordx4 v2, s[8:11], s31 offen offset:1024 lds
  v_pk_fma_f16 v23, v22, v22, s34 neg_lo:[1,0,0] neg_hi:[1,0,0]
  v_pk_mul_f16 v17, v17, v16
  v_mfma_f32_16x16x32_bf16 v[88:91], a[220:223], a[40:43], v[88:91]
  v_pk_mul_f16 v19, v19, v18
  v_pk_mul_f16 v21, v21, v20
  v_mfma_f32_16x16x32_bf16 v[84:87], a[220:223], a[16:19], v[84:87]
  v_pk_mul_f16 v23, v23, v22
  v_exp_f16_sdwa v17, v17 dst_sel:WORD_0 dst_unused:UNUSED_PRESERVE src0_sel:WORD_0
  v_mfma_f32_16x16x32_bf16 v[72:75], a[224:227], a[20:23], v[72:75]
  ds_read_b128 a[216:219], v4 offset:16384
  buffer_load_dwordx4 v2, s[8:11], s31 offen offset:2048 lds
  v_exp_f16_sdwa v19, v19 dst_sel:WORD_0 dst_unused:UNUSED_PRESERVE src0_sel:WORD_0
  v_mfma_f32_16x16x32_bf16 v[76:79], a[224:227], a[44:47], v[76:79]
  v_exp_f16_sdwa v21, v21 dst_sel:WORD_0 dst_unused:UNUSED_PRESERVE src0_sel:WORD_0
  v_mfma_f32_16x16x32_bf16 v[80:83], a[224:227], a[68:71], v[80:83]
  v_exp_f16_sdwa v23, v23 dst_sel:WORD_0 dst_unused:UNUSED_PRESERVE src0_sel:WORD_0
  v_mfma_f32_16x16x32_bf16 v[92:95], a[228:231], a[68:71], v[92:95]
  ds_read_b128 a[220:223], v4 offset:17408
  buffer_load_dwordx4 v2, s[8:11], s31 offen offset:3072 lds
  v_exp_f16_sdwa v17, v17 dst_sel:WORD_1 dst_unused:UNUSED_PRESERVE src0_sel:WORD_1
  v_mfma_f32_16x16x32_bf16 v[88:91], a[228:231], a[44:47], v[88:91]
  v_exp_f16_sdwa v19, v19 dst_sel:WORD_1 dst_unused:UNUSED_PRESERVE src0_sel:WORD_1
  v_mfma_f32_16x16x32_bf16 v[84:87], a[228:231], a[20:23], v[84:87]
  s_waitcnt lgkmcnt(3)
  v_exp_f16_sdwa v21, v21 dst_sel:WORD_1 dst_unused:UNUSED_PRESERVE src0_sel:WORD_1
  v_mfma_f32_16x16x32_f16 v[96:99], a[232:235], v[36:39], v[96:99]
  ds_read_b128 a[224:227], v4 offset:18432
  v_exp_f16_sdwa v23, v23 dst_sel:WORD_1 dst_unused:UNUSED_PRESERVE src0_sel:WORD_1
  v_mfma_f32_16x16x32_f16 v[100:103], a[232:235], v[40:43], v[100:103]
  v_pk_fma_f16 v17, v17, s35, s35
  v_pk_fma_f16 v19, v19, s35, s35
  v_mfma_f32_16x16x32_f16 v[104:107], a[232:235], v[44:47], v[104:107]
  v_pk_fma_f16 v21, v21, s35, s35
  v_pk_fma_f16 v23, v23, s35, s35
  v_mfma_f32_16x16x32_f16 v[116:119], a[236:239], v[44:47], v[116:119]
  ds_read_b128 a[228:231], v4 offset:19456
  v_rcp_f16_sdwa v17, v17 dst_sel:WORD_0 dst_unused:UNUSED_PRESERVE src0_sel:WORD_0
  v_mfma_f32_16x16x32_f16 v[112:115], a[236:239], v[40:43], v[112:115]
  v_rcp_f16_sdwa v19, v19 dst_sel:WORD_0 dst_unused:UNUSED_PRESERVE src0_sel:WORD_0
  v_mfma_f32_16x16x32_f16 v[108:111], a[236:239], v[36:39], v[108:111]
  v_rcp_f16_sdwa v21, v21 dst_sel:WORD_0 dst_unused:UNUSED_PRESERVE src0_sel:WORD_0
  v_rcp_f16_sdwa v23, v23 dst_sel:WORD_0 dst_unused:UNUSED_PRESERVE src0_sel:WORD_0
  v_mfma_f32_16x16x32_f16 v[120:123], a[240:243], v[36:39], v[120:123]
  ds_read_b128 a[232:235], v4 offset:20480
  v_rcp_f16_sdwa v17, v17 dst_sel:WORD_1 dst_unused:UNUSED_PRESERVE src0_sel:WORD_1
  v_mfma_f32_16x16x32_f16 v[124:127], a[240:243], v[40:43], v[124:127]
  v_rcp_f16_sdwa v19, v19 dst_sel:WORD_1 dst_unused:UNUSED_PRESERVE src0_sel:WORD_1
  v_mfma_f32_16x16x32_f16 v[128:131], a[240:243], v[44:47], v[128:131]
  s_waitcnt lgkmcnt(3)
  v_rcp_f16_sdwa v21, v21 dst_sel:WORD_1 dst_unused:UNUSED_PRESERVE src0_sel:WORD_1
  v_mfma_f32_16x16x32_f16 v[140:143], a[244:247], v[44:47], v[140:143]
  ds_read_b128 a[236:239], v4 offset:21504
  v_rcp_f16_sdwa v23, v23 dst_sel:WORD_1 dst_unused:UNUSED_PRESERVE src0_sel:WORD_1
  v_mfma_f32_16x16x32_f16 v[136:139], a[244:247], v[40:43], v[136:139]
  v_pk_mul_f16 v32, v16, v17
  v_pk_mul_f16 v33, v18, v19
  v_mfma_f32_16x16x32_f16 v[132:135], a[244:247], v[36:39], v[132:135]
  v_pk_mul_f16 v26, v20, v21
  v_pk_mul_f16 v27, v22, v23
  v_mfma_f32_16x16x32_f16 v[144:147], a[216:219], v[36:39], v[144:147]
  ds_read_b128 a[240:243], v4 offset:22528
  v_cvt_pk_f16_f32 v8, v64, v65
  v_cvt_pk_f16_f32 v10, v66, v67
  v_mfma_f32_16x16x32_f16 v[148:151], a[216:219], v[40:43], v[148:151]
  v_cvt_pk_f16_f32 v12, v68, v69
  v_cvt_pk_f16_f32 v14, v70, v71
  v_mfma_f32_16x16x32_f16 v[152:155], a[216:219], v[44:47], v[152:155]
  v_pk_fma_f16 v9, v8, v8, s34 neg_lo:[1,0,0] neg_hi:[1,0,0]
  v_pk_fma_f16 v11, v10, v10, s34 neg_lo:[1,0,0] neg_hi:[1,0,0]
  v_pk_fma_f16 v13, v12, v12, s34 neg_lo:[1,0,0] neg_hi:[1,0,0]
  v_mfma_f32_16x16x32_f16 v[164:167], a[220:223], v[44:47], v[164:167]
  ds_read_b128 a[244:247], v4 offset:23552
  v_pk_fma_f16 v15, v14, v14, s34 neg_lo:[1,0,0] neg_hi:[1,0,0]
  v_pk_mul_f16 v9, v9, v8
  v_mfma_f32_16x16x32_f16 v[160:163], a[220:223], v[40:43], v[160:163]
  v_pk_mul_f16 v11, v11, v10
  v_pk_mul_f16 v13, v13, v12
  v_mfma_f32_16x16x32_f16 v[156:159], a[220:223], v[36:39], v[156:159]
  s_waitcnt lgkmcnt(3)
  v_pk_mul_f16 v15, v15, v14
  v_exp_f16_sdwa v9, v9 dst_sel:WORD_0 dst_unused:UNUSED_PRESERVE src0_sel:WORD_0
  v_mfma_f32_16x16x32_f16 v[168:171], a[224:227], v[36:39], v[168:171]
  ds_read_b128 a[216:219], v4 offset:24576
  v_exp_f16_sdwa v11, v11 dst_sel:WORD_0 dst_unused:UNUSED_PRESERVE src0_sel:WORD_0
  v_mfma_f32_16x16x32_f16 v[172:175], a[224:227], v[40:43], v[172:175]
  v_exp_f16_sdwa v13, v13 dst_sel:WORD_0 dst_unused:UNUSED_PRESERVE src0_sel:WORD_0
  v_mfma_f32_16x16x32_f16 v[176:179], a[224:227], v[44:47], v[176:179]
  v_exp_f16_sdwa v15, v15 dst_sel:WORD_0 dst_unused:UNUSED_PRESERVE src0_sel:WORD_0
  v_mfma_f32_16x16x32_f16 v[188:191], a[228:231], v[44:47], v[188:191]
  ds_read_b128 a[220:223], v4 offset:25600
  v_exp_f16_sdwa v9, v9 dst_sel:WORD_1 dst_unused:UNUSED_PRESERVE src0_sel:WORD_1
  v_mfma_f32_16x16x32_f16 v[184:187], a[228:231], v[40:43], v[184:187]
  v_exp_f16_sdwa v11, v11 dst_sel:WORD_1 dst_unused:UNUSED_PRESERVE src0_sel:WORD_1
  v_mfma_f32_16x16x32_f16 v[180:183], a[228:231], v[36:39], v[180:183]
  v_exp_f16_sdwa v13, v13 dst_sel:WORD_1 dst_unused:UNUSED_PRESERVE src0_sel:WORD_1
  v_mfma_f32_16x16x32_f16 v[192:195], a[232:235], v[36:39], v[192:195]
  ds_read_b128 a[224:227], v4 offset:26624
  v_exp_f16_sdwa v15, v15 dst_sel:WORD_1 dst_unused:UNUSED_PRESERVE src0_sel:WORD_1
  v_mfma_f32_16x16x32_f16 v[196:199], a[232:235], v[40:43], v[196:199]
  v_pk_fma_f16 v9, v9, s35, s35
  v_pk_fma_f16 v11, v11, s35, s35
  v_mfma_f32_16x16x32_f16 v[200:203], a[232:235], v[44:47], v[200:203]
  s_waitcnt lgkmcnt(3)
  v_pk_fma_f16 v13, v13, s35, s35
  v_pk_fma_f16 v15, v15, s35, s35
  v_mfma_f32_16x16x32_f16 v[212:215], a[236:239], v[44:47], v[212:215]
  ds_read_b128 a[228:231], v4 offset:27648
  v_rcp_f16_sdwa v9, v9 dst_sel:WORD_0 dst_unused:UNUSED_PRESERVE src0_sel:WORD_0
  v_mfma_f32_16x16x32_f16 v[208:211], a[236:239], v[40:43], v[208:211]
  v_rcp_f16_sdwa v11, v11 dst_sel:WORD_0 dst_unused:UNUSED_PRESERVE src0_sel:WORD_0
  v_mfma_f32_16x16x32_f16 v[204:207], a[236:239], v[36:39], v[204:207]
  v_rcp_f16_sdwa v13, v13 dst_sel:WORD_0 dst_unused:UNUSED_PRESERVE src0_sel:WORD_0
  v_rcp_f16_sdwa v15, v15 dst_sel:WORD_0 dst_unused:UNUSED_PRESERVE src0_sel:WORD_0
  v_mfma_f32_16x16x32_f16 v[216:219], a[240:243], v[36:39], v[216:219]
  ds_read_b128 a[232:235], v4 offset:28672
  v_rcp_f16_sdwa v9, v9 dst_sel:WORD_1 dst_unused:UNUSED_PRESERVE src0_sel:WORD_1
  v_mfma_f32_16x16x32_f16 v[220:223], a[240:243], v[40:43], v[220:223]
  v_rcp_f16_sdwa v11, v11 dst_sel:WORD_1 dst_unused:UNUSED_PRESERVE src0_sel:WORD_1
  v_mfma_f32_16x16x32_f16 v[224:227], a[240:243], v[44:47], v[224:227]
  v_rcp_f16_sdwa v13, v13 dst_sel:WORD_1 dst_unused:UNUSED_PRESERVE src0_sel:WORD_1
  v_mfma_f32_16x16x32_f16 v[236:239], a[244:247], v[44:47], v[236:239]
  ds_read_b128 a[236:239], v4 offset:29696
  v_rcp_f16_sdwa v15, v15 dst_sel:WORD_1 dst_unused:UNUSED_PRESERVE src0_sel:WORD_1
  v_mfma_f32_16x16x32_f16 v[232:235], a[244:247], v[40:43], v[232:235]
  v_pk_mul_f16 v30, v8, v9
  v_pk_mul_f16 v31, v10, v11
  v_mfma_f32_16x16x32_f16 v[228:231], a[244:247], v[36:39], v[228:231]
  s_waitcnt lgkmcnt(3)
  v_pk_mul_f16 v34, v12, v13
  v_pk_mul_f16 v35, v14, v15
  s_cmp_eq_u32 s24, 0
  s_cbranch_scc1 fused_kernel_hs0
  s_cmp_eq_u32 s24, 1
  s_cbranch_scc0 fused_kernel_hsd
  ds_read_b128 a[0:3], v5 offset:0
  ds_read_b128 a[4:7], v5 offset:1024
  ds_read_b128 a[8:11], v5 offset:2048
  ds_read_b128 a[12:15], v5 offset:3072
  ds_read_b128 a[16:19], v5 offset:4096
  ds_read_b128 a[20:23], v5 offset:5120
  ds_read_b128 a[24:27], v5 offset:6144
  ds_read_b128 a[28:31], v5 offset:7168
  ds_read_b128 a[32:35], v5 offset:8192
  ds_read_b128 a[36:39], v5 offset:9216
  ds_read_b128 a[40:43], v5 offset:10240
  ds_read_b128 a[44:47], v5 offset:11264
  ds_read_b128 a[48:51], v5 offset:12288
  ds_read_b128 a[52:55], v5 offset:13312
  ds_read_b128 a[56:59], v5 offset:14336
  ds_read_b128 a[60:63], v5 offset:15360
  v_accvgpr_write_b32 a64, v240
  v_accvgpr_write_b32 a65, v241
  v_accvgpr_write_b32 a66, v242
  v_accvgpr_write_b32 a67, v243
  v_accvgpr_write_b32 a68, v244
  v_accvgpr_write_b32 a69, v245
  v_accvgpr_write_b32 a70, v246
  v_accvgpr_write_b32 a71, v247
  s_waitcnt lgkmcnt(0)
  s_branch fused_kernel_hsd
fused_kernel_hs0:
  v_accvgpr_mov_b32 a0, a72
  v_accvgpr_mov_b32 a1, a73
  v_accvgpr_mov_b32 a2, a74
  v_accvgpr_mov_b32 a3, a75
  v_accvgpr_mov_b32 a4, a76
  v_accvgpr_mov_b32 a5, a77
  v_accvgpr_mov_b32 a6, a78
  v_accvgpr_mov_b32 a7, a79
  v_accvgpr_mov_b32 a8, a80
  v_accvgpr_mov_b32 a9, a81
  v_accvgpr_mov_b32 a10, a82
  v_accvgpr_mov_b32 a11, a83
  v_accvgpr_mov_b32 a12, a84
  v_accvgpr_mov_b32 a13, a85
  v_accvgpr_mov_b32 a14, a86
  v_accvgpr_mov_b32 a15, a87
  v_accvgpr_mov_b32 a16, a88
  v_accvgpr_mov_b32 a17, a89
  v_accvgpr_mov_b32 a18, a90
  v_accvgpr_mov_b32 a19, a91
  v_accvgpr_mov_b32 a20, a92
  v_accvgpr_mov_b32 a21, a93
  v_accvgpr_mov_b32 a22, a94
  v_accvgpr_mov_b32 a23, a95
  v_accvgpr_mov_b32 a24, a96
  v_accvgpr_mov_b32 a25, a97
  v_accvgpr_mov_b32 a26, a98
  v_accvgpr_mov_b32 a27, a99
  v_accvgpr_mov_b32 a28, a100
  v_accvgpr_mov_b32 a29, a101
  v_accvgpr_mov_b32 a30, a102
  v_accvgpr_mov_b32 a31, a103
  v_accvgpr_mov_b32 a32, a104
  v_accvgpr_mov_b32 a33, a105
  v_accvgpr_mov_b32 a34, a106
  v_accvgpr_mov_b32 a35, a107
  v_accvgpr_mov_b32 a36, a108
  v_accvgpr_mov_b32 a37, a109
  v_accvgpr_mov_b32 a38, a110
  v_accvgpr_mov_b32 a39, a111
  v_accvgpr_mov_b32 a40, a112
  v_accvgpr_mov_b32 a41, a113
  v_accvgpr_mov_b32 a42, a114
  v_accvgpr_mov_b32 a43, a115
  v_accvgpr_mov_b32 a44, a116
  v_accvgpr_mov_b32 a45, a117
  v_accvgpr_mov_b32 a46, a118
  v_accvgpr_mov_b32 a47, a119
  v_accvgpr_mov_b32 a48, a120
  v_accvgpr_mov_b32 a49, a121
  v_accvgpr_mov_b32 a50, a122
  v_accvgpr_mov_b32 a51, a123
  v_accvgpr_mov_b32 a52, a124
  v_accvgpr_mov_b32 a53, a125
  v_accvgpr_mov_b32 a54, a126
  v_accvgpr_mov_b32 a55, a127
  v_accvgpr_mov_b32 a56, a128
  v_accvgpr_mov_b32 a57, a129
  v_accvgpr_mov_b32 a58, a130
  v_accvgpr_mov_b32 a59, a131
  v_accvgpr_mov_b32 a60, a132
  v_accvgpr_mov_b32 a61, a133
  v_accvgpr_mov_b32 a62, a134
  v_accvgpr_mov_b32 a63, a135
  v_accvgpr_mov_b32 a64, a136
  v_accvgpr_mov_b32 a65, a137
  v_accvgpr_mov_b32 a66, a138
  v_accvgpr_mov_b32 a67, a139
  v_accvgpr_mov_b32 a68, a140
  v_accvgpr_mov_b32 a69, a141
  v_accvgpr_mov_b32 a70, a142
  v_accvgpr_mov_b32 a71, a143
fused_kernel_hsd:
  v_mfma_f32_16x16x32_bf16 v[48:51], a[216:219], a[0:3], 0
  ds_read_b128 a[240:243], v4 offset:30720
  v_cvt_pk_f16_f32 v8, v72, v73
  v_cvt_pk_f16_f32 v10, v74, v75
  v_mfma_f32_16x16x32_bf16 v[52:55], a[216:219], a[24:27], 0
  v_cvt_pk_f16_f32 v12, v76, v77
  v_cvt_pk_f16_f32 v14, v78, v79
  v_mfma_f32_16x16x32_bf16 v[56:59], a[216:219], a[48:51], 0
  v_pk_fma_f16 v9, v8, v8, s34 neg_lo:[1,0,0] neg_hi:[1,0,0]
  v_pk_fma_f16 v11, v10, v10, s34 neg_lo:[1,0,0] neg_hi:[1,0,0]
  v_pk_fma_f16 v13, v12, v12, s34 neg_lo:[1,0,0] neg_hi:[1,0,0]
  v_mfma_f32_16x16x32_bf16 v[68:71], a[220:223], a[48:51], 0
  ds_read_b128 a[244:247], v4 offset:31744
  v_pk_fma_f16 v15, v14, v14, s34 neg_lo:[1,0,0] neg_hi:[1,0,0]
  v_pk_mul_f16 v9, v9, v8
  v_mfma_f32_16x16x32_bf16 v[64:67], a[220:223], a[24:27], 0
  v_pk_mul_f16 v11, v11, v10
  v_pk_mul_f16 v13, v13, v12
  v_mfma_f32_16x16x32_bf16 v[60:63], a[220:223], a[0:3], 0
  v_pk_mul_f16 v15, v15, v14
  v_exp_f16_sdwa v9, v9 dst_sel:WORD_0 dst_unused:UNUSED_PRESERVE src0_sel:WORD_0
  v_mfma_f32_16x16x32_bf16 v[48:51], a[224:227], a[4:7], v[48:51]
  ds_read_b128 a[216:219], v4 offset:32768
  v_exp_f16_sdwa v11, v11 dst_sel:WORD_0 dst_unused:UNUSED_PRESERVE src0_sel:WORD_0
  v_mfma_f32_16x16x32_bf16 v[52:55], a[224:227], a[28:31], v[52:55]
  v_exp_f16_sdwa v13, v13 dst_sel:WORD_0 dst_unused:UNUSED_PRESERVE src0_sel:WORD_0
  v_mfma_f32_16x16x32_bf16 v[56:59], a[224:227], a[52:55], v[56:59]
  s_waitcnt lgkmcnt(3)
  v_exp_f16_sdwa v15, v15 dst_sel:WORD_0 dst_unused:UNUSED_PRESERVE src0_sel:WORD_0
  v_mfma_f32_16x16x32_bf16 v[68:71], a[228:231], a[52:55], v[68:71]
  ds_read_b128 a[220:223], v4 offset:33792
  v_exp_f16_sdwa v9, v9 dst_sel:WORD_1 dst_unused:UNUSED_PRESERVE src0_sel:WORD_1
  v_mfma_f32_16x16x32_bf16 v[64:67], a[228:231], a[28:31], v[64:67]
  v_exp_f16_sdwa v11, v11 dst_sel:WORD_1 dst_unused:UNUSED_PRESERVE src0_sel:WORD_1
  v_mfma_f32_16x16x32_bf16 v[60:63], a[228:231], a[4:7], v[60:63]
  v_exp_f16_sdwa v13, v13 dst_sel:WORD_1 dst_unused:UNUSED_PRESERVE src0_sel:WORD_1
  v_mfma_f32_16x16x32_bf16 v[48:51], a[232:235], a[8:11], v[48:51]
  ds_read_b128 a[224:227], v4 offset:34816
  v_exp_f16_sdwa v15, v15 dst_sel:WORD_1 dst_unused:UNUSED_PRESERVE src0_sel:WORD_1
  v_mfma_f32_16x16x32_bf16 v[52:55], a[232:235], a[32:35], v[52:55]
  v_pk_fma_f16 v9, v9, s35, s35
  v_pk_fma_f16 v11, v11, s35, s35
  v_mfma_f32_16x16x32_bf16 v[56:59], a[232:235], a[56:59], v[56:59]
  v_pk_fma_f16 v13, v13, s35, s35
  v_pk_fma_f16 v15, v15, s35, s35
  v_mfma_f32_16x16x32_bf16 v[68:71], a[236:239], a[56:59], v[68:71]
  ds_read_b128 a[228:231], v4 offset:35840
  v_rcp_f16_sdwa v9, v9 dst_sel:WORD_0 dst_unused:UNUSED_PRESERVE src0_sel:WORD_0
  v_mfma_f32_16x16x32_bf16 v[64:67], a[236:239], a[32:35], v[64:67]
  v_rcp_f16_sdwa v11, v11 dst_sel:WORD_0 dst_unused:UNUSED_PRESERVE src0_sel:WORD_0
  v_mfma_f32_16x16x32_bf16 v[60:63], a[236:239], a[8:11], v[60:63]
  s_waitcnt lgkmcnt(3)
  v_rcp_f16_sdwa v13, v13 dst_sel:WORD_0 dst_unused:UNUSED_PRESERVE src0_sel:WORD_0
  v_rcp_f16_sdwa v15, v15 dst_sel:WORD_0 dst_unused:UNUSED_PRESERVE src0_sel:WORD_0
  v_mfma_f32_16x16x32_bf16 v[48:51], a[240:243], a[12:15], v[48:51]
  ds_read_b128 a[232:235], v4 offset:36864
  v_rcp_f16_sdwa v9, v9 dst_sel:WORD_1 dst_unused:UNUSED_PRESERVE src0_sel:WORD_1
  v_mfma_f32_16x16x32_bf16 v[52:55], a[240:243], a[36:39], v[52:55]
  v_rcp_f16_sdwa v11, v11 dst_sel:WORD_1 dst_unused:UNUSED_PRESERVE src0_sel:WORD_1
  v_mfma_f32_16x16x32_bf16 v[56:59], a[240:243], a[60:63], v[56:59]
  v_rcp_f16_sdwa v13, v13 dst_sel:WORD_1 dst_unused:UNUSED_PRESERVE src0_sel:WORD_1
  v_mfma_f32_16x16x32_bf16 v[68:71], a[244:247], a[60:63], v[68:71]
  ds_read_b128 a[236:239], v4 offset:37888
  v_rcp_f16_sdwa v15, v15 dst_sel:WORD_1 dst_unused:UNUSED_PRESERVE src0_sel:WORD_1
  v_mfma_f32_16x16x32_bf16 v[64:67], a[244:247], a[36:39], v[64:67]
  v_pk_mul_f16 v36, v8, v9
  v_pk_mul_f16 v37, v10, v11
  v_mfma_f32_16x16x32_bf16 v[60:63], a[244:247], a[12:15], v[60:63]
  v_pk_mul_f16 v40, v12, v13
  v_pk_mul_f16 v41, v14, v15
  v_mfma_f32_16x16x32_bf16 v[48:51], a[216:219], a[16:19], v[48:51]
  ds_read_b128 a[240:243], v4 offset:38912
  v_cvt_pk_f16_f32 v16, v80, v81
  v_cvt_pk_f16_f32 v18, v82, v83
  v_mfma_f32_16x16x32_bf16 v[52:55], a[216:219], a[40:43], v[52:55]
  v_cvt_pk_f16_f32 v20, v84, v85
  v_cvt_pk_f16_f32 v22, v86, v87
  v_mfma_f32_16x16x32_bf16 v[56:59], a[216:219], a[64:67], v[56:59]
  s_waitcnt lgkmcnt(3)
  v_pk_fma_f16 v17, v16, v16, s34 neg_lo:[1,0,0] neg_hi:[1,0,0]
  v_pk_fma_f16 v19, v18, v18, s34 neg_lo:[1,0,0] neg_hi:[1,0,0]
  v_pk_fma_f16 v21, v20, v20, s34 neg_lo:[1,0,0] neg_hi:[1,0,0]
  v_mfma_f32_16x16x32_bf16 v[68:71], a[220:223], a[64:67], v[68:71]
  ds_read_b128 a[244:247], v4 offset:39936
  v_pk_fma_f16 v23, v22, v22, s34 neg_lo:[1,0,0] neg_hi:[1,0,0]
  v_pk_mul_f16 v17, v17, v16
  v_mfma_f32_16x16x32_bf16 v[64:67], a[220:223], a[40:43], v[64:67]
  v_pk_mul_f16 v19, v19, v18
  v_pk_mul_f16 v21, v21, v20
  v_mfma_f32_16x16x32_bf16 v[60:63], a[220:223], a[16:19], v[60:63]
  v_pk_mul_f16 v23, v23, v22
  v_exp_f16_sdwa v17, v17 dst_sel:WORD_0 dst_unused:UNUSED_PRESERVE src0_sel:WORD_0
  v_mfma_f32_16x16x32_bf16 v[48:51], a[224:227], a[20:23], v[48:51]
  ds_read_b128 a[216:219], v4 offset:40960
  v_exp_f16_sdwa v19, v19 dst_sel:WORD_0 dst_unused:UNUSED_PRESERVE src0_sel:WORD_0
  v_mfma_f32_16x16x32_bf16 v[52:55], a[224:227], a[44:47], v[52:55]
  v_exp_f16_sdwa v21, v21 dst_sel:WORD_0 dst_unused:UNUSED_PRESERVE src0_sel:WORD_0
  v_mfma_f32_16x16x32_bf16 v[56:59], a[224:227], a[68:71], v[56:59]
  v_exp_f16_sdwa v23, v23 dst_sel:WORD_0 dst_unused:UNUSED_PRESERVE src0_sel:WORD_0
  v_mfma_f32_16x16x32_bf16 v[68:71], a[228:231], a[68:71], v[68:71]
  ds_read_b128 a[220:223], v4 offset:41984
  v_exp_f16_sdwa v17, v17 dst_sel:WORD_1 dst_unused:UNUSED_PRESERVE src0_sel:WORD_1
  v_mfma_f32_16x16x32_bf16 v[64:67], a[228:231], a[44:47], v[64:67]
  v_exp_f16_sdwa v19, v19 dst_sel:WORD_1 dst_unused:UNUSED_PRESERVE src0_sel:WORD_1
  v_mfma_f32_16x16x32_bf16 v[60:63], a[228:231], a[20:23], v[60:63]
  s_waitcnt lgkmcnt(3)
  v_exp_f16_sdwa v21, v21 dst_sel:WORD_1 dst_unused:UNUSED_PRESERVE src0_sel:WORD_1
  v_mfma_f32_16x16x32_f16 v[96:99], a[232:235], v[24:27], v[96:99]
  ds_read_b128 a[224:227], v4 offset:43008
  v_exp_f16_sdwa v23, v23 dst_sel:WORD_1 dst_unused:UNUSED_PRESERVE src0_sel:WORD_1
  v_mfma_f32_16x16x32_f16 v[100:103], a[232:235], v[28:31], v[100:103]
  v_pk_fma_f16 v17, v17, s35, s35
  v_pk_fma_f16 v19, v19, s35, s35
  v_mfma_f32_16x16x32_f16 v[104:107], a[232:235], v[32:35], v[104:107]
  v_pk_fma_f16 v21, v21, s35, s35
  v_pk_fma_f16 v23, v23, s35, s35
  v_mfma_f32_16x16x32_f16 v[116:119], a[236:239], v[32:35], v[116:119]
  ds_read_b128 a[228:231], v4 offset:44032
  v_rcp_f16_sdwa v17, v17 dst_sel:WORD_0 dst_unused:UNUSED_PRESERVE src0_sel:WORD_0
  v_mfma_f32_16x16x32_f16 v[112:115], a[236:239], v[28:31], v[112:115]
  v_rcp_f16_sdwa v19, v19 dst_sel:WORD_0 dst_unused:UNUSED_PRESERVE src0_sel:WORD_0
  v_mfma_f32_16x16x32_f16 v[108:111], a[236:239], v[24:27], v[108:111]
  v_rcp_f16_sdwa v21, v21 dst_sel:WORD_0 dst_unused:UNUSED_PRESERVE src0_sel:WORD_0
  v_rcp_f16_sdwa v23, v23 dst_sel:WORD_0 dst_unused:UNUSED_PRESERVE src0_sel:WORD_0
  v_mfma_f32_16x16x32_f16 v[120:123], a[240:243], v[24:27], v[120:123]
  ds_read_b128 a[232:235], v4 offset:45056
  v_rcp_f16_sdwa v17, v17 dst_sel:WORD_1 dst_unused:UNUSED_PRESERVE src0_sel:WORD_1
  v_mfma_f32_16x16x32_f16 v[124:127], a[240:243], v[28:31], v[124:127]
  v_rcp_f16_sdwa v19, v19 dst_sel:WORD_1 dst_unused:UNUSED_PRESERVE src0_sel:WORD_1
  v_mfma_f32_16x16x32_f16 v[128:131], a[240:243], v[32:35], v[128:131]
  s_waitcnt lgkmcnt(3)
  v_rcp_f16_sdwa v21, v21 dst_sel:WORD_1 dst_unused:UNUSED_PRESERVE src0_sel:WORD_1
  v_mfma_f32_16x16x32_f16 v[140:143], a[244:247], v[32:35], v[140:143]
  ds_read_b128 a[236:239], v4 offset:46080
  v_rcp_f16_sdwa v23, v23 dst_sel:WORD_1 dst_unused:UNUSED_PRESERVE src0_sel:WORD_1
  v_mfma_f32_16x16x32_f16 v[136:139], a[244:247], v[28:31], v[136:139]
  v_pk_mul_f16 v44, v16, v17
  v_pk_mul_f16 v45, v18, v19
  v_mfma_f32_16x16x32_f16 v[132:135], a[244:247], v[24:27], v[132:135]
  v_pk_mul_f16 v38, v20, v21
  v_pk_mul_f16 v39, v22, v23
  v_mfma_f32_16x16x32_f16 v[144:147], a[216:219], v[24:27], v[144:147]
  ds_read_b128 a[240:243], v4 offset:47104
  ds_read_b128 a[244:247], v4 offset:48128
  v_cvt_pk_f16_f32 v8, v88, v89
  v_cvt_pk_f16_f32 v10, v90, v91
  v_mfma_f32_16x16x32_f16 v[148:151], a[216:219], v[28:31], v[148:151]
  v_cvt_pk_f16_f32 v12, v92, v93
  v_cvt_pk_f16_f32 v14, v94, v95
  v_mfma_f32_16x16x32_f16 v[152:155], a[216:219], v[32:35], v[152:155]
  v_pk_fma_f16 v9, v8, v8, s34 neg_lo:[1,0,0] neg_hi:[1,0,0]
  v_pk_fma_f16 v11, v10, v10, s34 neg_lo:[1,0,0] neg_hi:[1,0,0]
  v_pk_fma_f16 v13, v12, v12, s34 neg_lo:[1,0,0] neg_hi:[1,0,0]
  v_mfma_f32_16x16x32_f16 v[164:167], a[220:223], v[32:35], v[164:167]
  v_pk_fma_f16 v15, v14, v14, s34 neg_lo:[1,0,0] neg_hi:[1,0,0]
  v_pk_mul_f16 v9, v9, v8
  v_mfma_f32_16x16x32_f16 v[160:163], a[220:223], v[28:31], v[160:163]
  v_pk_mul_f16 v11, v11, v10
  v_pk_mul_f16 v13, v13, v12
  v_mfma_f32_16x16x32_f16 v[156:159], a[220:223], v[24:27], v[156:159]
  s_waitcnt lgkmcnt(3)
  v_pk_mul_f16 v15, v15, v14
  v_exp_f16_sdwa v9, v9 dst_sel:WORD_0 dst_unused:UNUSED_PRESERVE src0_sel:WORD_0
  v_mfma_f32_16x16x32_f16 v[168:171], a[224:227], v[24:27], v[168:171]
  s_waitcnt lgkmcnt(0)
  s_waitcnt vmcnt(0)
  s_barrier
  ds_read_b128 a[216:219], v1 offset:0
  v_exp_f16_sdwa v11, v11 dst_sel:WORD_0 dst_unused:UNUSED_PRESERVE src0_sel:WORD_0
  v_mfma_f32_16x16x32_f16 v[172:175], a[224:227], v[28:31], v[172:175]
  v_exp_f16_sdwa v13, v13 dst_sel:WORD_0 dst_unused:UNUSED_PRESERVE src0_sel:WORD_0
  v_mfma_f32_16x16x32_f16 v[176:179], a[224:227], v[32:35], v[176:179]
  v_exp_f16_sdwa v15, v15 dst_sel:WORD_0 dst_unused:UNUSED_PRESERVE src0_sel:WORD_0
  v_mfma_f32_16x16x32_f16 v[188:191], a[228:231], v[32:35], v[188:191]
  ds_read_b128 a[220:223], v1 offset:1024
  v_exp_f16_sdwa v9, v9 dst_sel:WORD_1 dst_unused:UNUSED_PRESERVE src0_sel:WORD_1
  v_mfma_f32_16x16x32_f16 v[184:187], a[228:231], v[28:31], v[184:187]
  v_exp_f16_sdwa v11, v11 dst_sel:WORD_1 dst_unused:UNUSED_PRESERVE src0_sel:WORD_1
  v_mfma_f32_16x16x32_f16 v[180:183], a[228:231], v[24:27], v[180:183]
  v_exp_f16_sdwa v13, v13 dst_sel:WORD_1 dst_unused:UNUSED_PRESERVE src0_sel:WORD_1
  v_mfma_f32_16x16x32_f16 v[192:195], a[232:235], v[24:27], v[192:195]
  ds_read_b128 a[224:227], v1 offset:2048
  v_exp_f16_sdwa v15, v15 dst_sel:WORD_1 dst_unused:UNUSED_PRESERVE src0_sel:WORD_1
  v_mfma_f32_16x16x32_f16 v[196:199], a[232:235], v[28:31], v[196:199]
  v_pk_fma_f16 v9, v9, s35, s35
  v_pk_fma_f16 v11, v11, s35, s35
  v_mfma_f32_16x16x32_f16 v[200:203], a[232:235], v[32:35], v[200:203]
  v_pk_fma_f16 v13, v13, s35, s35
  v_pk_fma_f16 v15, v15, s35, s35
  v_mfma_f32_16x16x32_f16 v[212:215], a[236:239], v[32:35], v[212:215]
  ds_read_b128 a[228:231], v1 offset:3072
  v_rcp_f16_sdwa v9, v9 dst_sel:WORD_0 dst_unused:UNUSED_PRESERVE src0_sel:WORD_0
  v_mfma_f32_16x16x32_f16 v[208:211], a[236:239], v[28:31], v[208:211]
  v_rcp_f16_sdwa v11, v11 dst_sel:WORD_0 dst_unused:UNUSED_PRESERVE src0_sel:WORD_0
  v_mfma_f32_16x16x32_f16 v[204:207], a[236:239], v[24:27], v[204:207]
  v_rcp_f16_sdwa v13, v13 dst_sel:WORD_0 dst_unused:UNUSED_PRESERVE src0_sel:WORD_0
  v_rcp_f16_sdwa v15, v15 dst_sel:WORD_0 dst_unused:UNUSED_PRESERVE src0_sel:WORD_0
  v_mfma_f32_16x16x32_f16 v[216:219], a[240:243], v[24:27], v[216:219]
  ds_read_b128 a[232:235], v1 offset:4096
  v_rcp_f16_sdwa v9, v9 dst_sel:WORD_1 dst_unused:UNUSED_PRESERVE src0_sel:WORD_1
  v_mfma_f32_16x16x32_f16 v[220:223], a[240:243], v[28:31], v[220:223]
  v_rcp_f16_sdwa v11, v11 dst_sel:WORD_1 dst_unused:UNUSED_PRESERVE src0_sel:WORD_1
  v_mfma_f32_16x16x32_f16 v[224:227], a[240:243], v[32:35], v[224:227]
  v_rcp_f16_sdwa v13, v13 dst_sel:WORD_1 dst_unused:UNUSED_PRESERVE src0_sel:WORD_1
  v_mfma_f32_16x16x32_f16 v[236:239], a[244:247], v[32:35], v[236:239]
  ds_read_b128 a[236:239], v1 offset:5120
  v_rcp_f16_sdwa v15, v15 dst_sel:WORD_1 dst_unused:UNUSED_PRESERVE src0_sel:WORD_1
  v_mfma_f32_16x16x32_f16 v[232:235], a[244:247], v[28:31], v[232:235]
  v_pk_mul_f16 v42, v8, v9
  v_pk_mul_f16 v43, v10, v11
  v_mfma_f32_16x16x32_f16 v[228:231], a[244:247], v[24:27], v[228:231]
  s_waitcnt lgkmcnt(3)
  v_pk_mul_f16 v46, v12, v13
  v_pk_mul_f16 v47, v14, v15
  s_mov_b32 s36, s51
  s_add_u32 s30, s30, 73728
  s_add_u32 s51, s51, 49152
  s_add_u32 s24, s24, 1
  s_cmp_lt_u32 s24, 3
  s_cbranch_scc1 fused_kernel_pass
  s_waitcnt lgkmcnt(0)
  ds_read_b128 a[216:219], v1 offset:12288
  ds_read_b128 a[220:223], v1 offset:13312
  ds_read_b128 a[224:227], v1 offset:14336
  ds_read_b128 a[228:231], v1 offset:15360
  ds_read_b128 a[232:235], v1 offset:16384
  ds_read_b128 a[236:239], v1 offset:17408
  s_waitcnt lgkmcnt(4)
  v_mfma_f32_16x16x32_f16 v[96:99], a[216:219], v[36:39], v[96:99]
  v_mfma_f32_16x16x32_f16 v[100:103], a[216:219], v[40:43], v[100:103]
  v_mfma_f32_16x16x32_f16 v[104:107], a[216:219], v[44:47], v[104:107]
  ds_read_b128 a[240:243], v1 offset:18432
  v_mfma_f32_16x16x32_f16 v[116:119], a[220:223], v[44:47], v[116:119]
  v_mfma_f32_16x16x32_f16 v[112:115], a[220:223], v[40:43], v[112:115]
  v_mfma_f32_16x16x32_f16 v[108:111], a[220:223], v[36:39], v[108:111]
  ds_read_b128 a[244:247], v1 offset:19456
  s_waitcnt lgkmcnt(4)
  v_mfma_f32_16x16x32_f16 v[120:123], a[224:227], v[36:39], v[120:123]
  v_mfma_f32_16x16x32_f16 v[124:127], a[224:227], v[40:43], v[124:127]
  v_mfma_f32_16x16x32_f16 v[128:131], a[224:227], v[44:47], v[128:131]
  ds_read_b128 a[216:219], v1 offset:20480
  v_mfma_f32_16x16x32_f16 v[140:143], a[228:231], v[44:47], v[140:143]
  v_mfma_f32_16x16x32_f16 v[136:139], a[228:231], v[40:43], v[136:139]
  v_mfma_f32_16x16x32_f16 v[132:135], a[228:231], v[36:39], v[132:135]
  ds_read_b128 a[220:223], v1 offset:21504
  s_waitcnt lgkmcnt(4)
  v_mfma_f32_16x16x32_f16 v[144:147], a[232:235], v[36:39], v[144:147]
  v_mfma_f32_16x16x32_f16 v[148:151], a[232:235], v[40:43], v[148:151]
  v_mfma_f32_16x16x32_f16 v[152:155], a[232:235], v[44:47], v[152:155]
  ds_read_b128 a[224:227], v1 offset:22528
  v_mfma_f32_16x16x32_f16 v[164:167], a[236:239], v[44:47], v[164:167]
  v_mfma_f32_16x16x32_f16 v[160:163], a[236:239], v[40:43], v[160:163]
  v_mfma_f32_16x16x32_f16 v[156:159], a[236:239], v[36:39], v[156:159]
  ds_read_b128 a[228:231], v1 offset:23552
  s_waitcnt lgkmcnt(4)
  v_mfma_f32_16x16x32_f16 v[168:171], a[240:243], v[36:39], v[168:171]
  v_mfma_f32_16x16x32_f16 v[172:175], a[240:243], v[40:43], v[172:175]
  v_mfma_f32_16x16x32_f16 v[176:179], a[240:243], v[44:47], v[176:179]
  v_mfma_f32_16x16x32_f16 v[188:191], a[244:247], v[44:47], v[188:191]
  v_mfma_f32_16x16x32_f16 v[184:187], a[244:247], v[40:43], v[184:187]
  v_mfma_f32_16x16x32_f16 v[180:183], a[244:247], v[36:39], v[180:183]
  s_waitcnt lgkmcnt(2)
  v_mfma_f32_16x16x32_f16 v[192:195], a[216:219], v[36:39], v[192:195]
  v_mfma_f32_16x16x32_f16 v[196:199], a[216:219], v[40:43], v[196:199]
  v_mfma_f32_16x16x32_f16 v[200:203], a[216:219], v[44:47], v[200:203]
  v_mfma_f32_16x16x32_f16 v[212:215], a[220:223], v[44:47], v[212:215]
  v_mfma_f32_16x16x32_f16 v[208:211], a[220:223], v[40:43], v[208:211]
  v_mfma_f32_16x16x32_f16 v[204:207], a[220:223], v[36:39], v[204:207]
  s_waitcnt lgkmcnt(0)
  v_mfma_f32_16x16x32_f16 v[216:219], a[224:227], v[36:39], v[216:219]
  v_mfma_f32_16x16x32_f16 v[220:223], a[224:227], v[40:43], v[220:223]
  v_mfma_f32_16x16x32_f16 v[224:227], a[224:227], v[44:47], v[224:227]
  v_mfma_f32_16x16x32_f16 v[236:239], a[228:231], v[44:47], v[236:239]
  v_mfma_f32_16x16x32_f16 v[232:235], a[228:231], v[40:43], v[232:235]
  v_mfma_f32_16x16x32_f16 v[228:231], a[228:231], v[36:39], v[228:231]
  s_waitcnt vmcnt(12)
  s_nop 7
  v_lshrrev_b32 v7, 4, v2
  s_mul_i32 s31, s40, 12288
  s_add_u32 s31, s31, 98304
  v_and_b32 v4, 15, v7
  v_bfe_u32 v5, v7, 1, 2
  v_lshrrev_b32 v6, 4, v7
  v_xor_b32 v5, v5, v6
  v_lshlrev_b32 v4, 6, v4
  v_lshl_add_u32 v4, v5, 4, v4
  v_add_u32 v4, s31, v4
  v_bfe_u32 v5, v7, 3, 2
  v_and_b32 v6, 3, v7
  v_xor_b32 v5, v5, v6
  v_lshlrev_b32 v5, 4, v5
  v_lshrrev_b32 v6, 2, v7
  v_lshl_add_u32 v5, v6, 6, v5
  v_add_u32 v5, s31, v5
  v_mul_u32_u24 v6, 384, v6
  v_and_b32 v7, 3, v7
  v_lshl_add_u32 v6, v7, 4, v6
  v_mfma_f32_16x16x32_bf16 v[96:99], a[248:251], a[144:147], v[96:99]
  v_mfma_f32_16x16x32_bf16 v[108:111], a[252:255], a[144:147], v[108:111]
  v_mfma_f32_16x16x32_bf16 v[120:123], a[248:251], a[148:151], v[120:123]
  v_mfma_f32_16x16x32_bf16 v[132:135], a[252:255], a[148:151], v[132:135]
  s_nop 7
  v_mfma_f32_16x16x32_bf16 v[144:147], a[248:251], a[152:155], v[144:147]
  v_cvt_pk_bf16_f32 v8, v96, v97
  v_cvt_pk_bf16_f32 v9, v98, v99
  v_mfma_f32_16x16x32_bf16 v[156:159], a[252:255], a[152:155], v[156:159]
  v_cvt_pk_bf16_f32 v10, v108, v109
  v_cvt_pk_bf16_f32 v11, v110, v111
  ds_write_b128 v4, v[8:11] offset:0
  v_mfma_f32_16x16x32_bf16 v[168:171], a[248:251], a[156:159], v[168:171]
  v_cvt_pk_bf16_f32 v12, v120, v121
  v_cvt_pk_bf16_f32 v13, v122, v123
  v_mfma_f32_16x16x32_bf16 v[180:183], a[252:255], a[156:159], v[180:183]
  v_cvt_pk_bf16_f32 v14, v132, v133
  v_cvt_pk_bf16_f32 v15, v134, v135
  ds_write_b128 v4, v[12:15] offset:1024
  v_mfma_f32_16x16x32_bf16 v[192:195], a[248:251], a[160:163], v[192:195]
  v_cvt_pk_bf16_f32 v8, v144, v145
  v_cvt_pk_bf16_f32 v9, v146, v147
  v_mfma_f32_16x16x32_bf16 v[204:207], a[252:255], a[160:163], v[204:207]
  v_cvt_pk_bf16_f32 v10, v156, v157
  v_cvt_pk_bf16_f32 v11, v158, v159
  ds_write_b128 v4, v[8:11] offset:2048
  ds_read_b128 v[24:27], v5 offset:0
  v_mfma_f32_16x16x32_bf16 v[216:219], a[248:251], a[164:167], v[216:219]
  v_cvt_pk_bf16_f32 v12, v168, v169
  v_cvt_pk_bf16_f32 v13, v170, v171
  v_mfma_f32_16x16x32_bf16 v[228:231], a[252:255], a[164:167], v[228:231]
  v_cvt_pk_bf16_f32 v14, v180, v181
  v_cvt_pk_bf16_f32 v15, v182, v183
  ds_write_b128 v4, v[12:15] offset:3072
  ds_read_b128 v[28:31], v5 offset:1024
  v_mfma_f32_16x16x32_bf16 v[100:103], a[248:251], a[168:171], v[100:103]
  v_cvt_pk_bf16_f32 v8, v192, v193
  v_cvt_pk_bf16_f32 v9, v194, v195
  v_mfma_f32_16x16x32_bf16 v[112:115], a[252:255], a[168:171], v[112:115]
  v_cvt_pk_bf16_f32 v10, v204, v205
  v_cvt_pk_bf16_f32 v11, v206, v207
  ds_write_b128 v4, v[8:11] offset:4096
  ds_read_b128 v[32:35], v5 offset:2048
  s_waitcnt lgkmcnt(4)
  s_add_u32 s32, s36, 0
  buffer_store_dwordx4 v[24:27], v6, s[20:23], s32 offen offset:0 sc1
  v_mfma_f32_16x16x32_bf16 v[124:127], a[248:251], a[172:175], v[124:127]
  v_cvt_pk_bf16_f32 v12, v216, v217
  v_cvt_pk_bf16_f32 v13, v218, v219
  v_mfma_f32_16x16x32_bf16 v[136:139], a[252:255], a[172:175], v[136:139]
  v_cvt_pk_bf16_f32 v14, v228, v229
  v_cvt_pk_bf16_f32 v15, v230, v231
  ds_write_b128 v4, v[12:15] offset:5120
  ds_read_b128 v[36:39], v5 offset:3072
  s_waitcnt lgkmcnt(4)
  buffer_store_dwordx4 v[28:31], v6, s[20:23], s32 offen offset:64 sc1
  v_mfma_f32_16x16x32_bf16 v[148:151], a[248:251], a[176:179], v[148:151]
  v_cvt_pk_bf16_f32 v8, v100, v101
  v_cvt_pk_bf16_f32 v9, v102, v103
  v_mfma_f32_16x16x32_bf16 v[160:163], a[252:255], a[176:179], v[160:163]
  v_cvt_pk_bf16_f32 v10, v112, v113
  v_cvt_pk_bf16_f32 v11, v114, v115
  ds_write_b128 v4, v[8:11] offset:6144
  ds_read_b128 v[40:43], v5 offset:4096
  s_waitcnt lgkmcnt(4)
  buffer_store_dwordx4 v[32:35], v6, s[20:23], s32 offen offset:128 sc1
  v_mfma_f32_16x16x32_bf16 v[172:175], a[248:251], a[180:183], v[172:175]
  v_cvt_pk_bf16_f32 v12, v124, v125
  v_cvt_pk_bf16_f32 v13, v126, v127
  v_mfma_f32_16x16x32_bf16 v[184:187], a[252:255], a[180:183], v[184:187]
  v_cvt_pk_bf16_f32 v14, v136, v137
  v_cvt_pk_bf16_f32 v15, v138, v139
  ds_write_b128 v4, v[12:15] offset:7168
  ds_read_b128 v[44:47], v5 offset:5120
  s_waitcnt lgkmcnt(4)
  buffer_store_dwordx4 v[36:39], v6, s[20:23], s32 offen offset:192 sc1
  v_mfma_f32_16x16x32_bf16 v[196:199], a[248:251], a[184:187], v[196:199]
  v_cvt_pk_bf16_f32 v8, v148, v149
  v_cvt_pk_bf16_f32 v9, v150, v151
  v_mfma_f32_16x16x32_bf16 v[208:211], a[252:255], a[184:187], v[208:211]
  v_cvt_pk_bf16_f32 v10, v160, v161
  v_cvt_pk_bf16_f32 v11, v162, v163
  ds_write_b128 v4, v[8:11] offset:8192
  ds_read_b128 v[24:27], v5 offset:6144
  s_waitcnt lgkmcnt(4)
  buffer_store_dwordx4 v[40:43], v6, s[20:23], s32 offen offset:256 sc1
  v_mfma_f32_16x16x32_bf16 v[220:223], a[248:251], a[188:191], v[220:223]
  v_cvt_pk_bf16_f32 v12, v172, v173
  v_cvt_pk_bf16_f32 v13, v174, v175
  v_mfma_f32_16x16x32_bf16 v[232:235], a[252:255], a[188:191], v[232:235]
  v_cvt_pk_bf16_f32 v14, v184, v185
  v_cvt_pk_bf16_f32 v15, v186, v187
  ds_write_b128 v4, v[12:15] offset:9216
  ds_read_b128 v[28:31], v5 offset:7168
  s_waitcnt lgkmcnt(4)
  buffer_store_dwordx4 v[44:47], v6, s[20:23], s32 offen offset:320 sc1
  v_mfma_f32_16x16x32_bf16 v[104:107], a[248:251], a[192:195], v[104:107]
  v_cvt_pk_bf16_f32 v8, v196, v197
  v_cvt_pk_bf16_f32 v9, v198, v199
  v_mfma_f32_16x16x32_bf16 v[116:119], a[252:255], a[192:195], v[116:119]
  v_cvt_pk_bf16_f32 v10, v208, v209
  v_cvt_pk_bf16_f32 v11, v210, v211
  ds_write_b128 v4, v[8:11] offset:10240
  ds_read_b128 v[32:35], v5 offset:8192
  s_waitcnt lgkmcnt(4)
  s_add_u32 s32, s36, 147456
  buffer_store_dwordx4 v[24:27], v6, s[20:23], s32 offen offset:0 sc1
  v_mfma_f32_16x16x32_bf16 v[128:131], a[248:251], a[196:199], v[128:131]
  v_cvt_pk_bf16_f32 v12, v220, v221
  v_cvt_pk_bf16_f32 v13, v222, v223
  v_mfma_f32_16x16x32_bf16 v[140:143], a[252:255], a[196:199], v[140:143]
  v_cvt_pk_bf16_f32 v14, v232, v233
  v_cvt_pk_bf16_f32 v15, v234, v235
  ds_write_b128 v4, v[12:15] offset:11264
  ds_read_b128 v[36:39], v5 offset:9216
  s_waitcnt lgkmcnt(4)
  buffer_store_dwordx4 v[28:31], v6, s[20:23], s32 offen offset:64 sc1
  v_mfma_f32_16x16x32_bf16 v[152:155], a[248:251], a[200:203], v[152:155]
  v_cvt_pk_bf16_f32 v8, v104, v105
  v_cvt_pk_bf16_f32 v9, v106, v107
  v_mfma_f32_16x16x32_bf16 v[164:167], a[252:255], a[200:203], v[164:167]
  v_cvt_pk_bf16_f32 v10, v116, v117
  v_cvt_pk_bf16_f32 v11, v118, v119
  ds_write_b128 v4, v[8:11] offset:0
  ds_read_b128 v[40:43], v5 offset:10240
  s_waitcnt lgkmcnt(4)
  buffer_store_dwordx4 v[32:35], v6, s[20:23], s32 offen offset:128 sc1
  v_mfma_f32_16x16x32_bf16 v[176:179], a[248:251], a[204:207], v[176:179]
  v_cvt_pk_bf16_f32 v12, v128, v129
  v_cvt_pk_bf16_f32 v13, v130, v131
  v_mfma_f32_16x16x32_bf16 v[188:191], a[252:255], a[204:207], v[188:191]
  v_cvt_pk_bf16_f32 v14, v140, v141
  v_cvt_pk_bf16_f32 v15, v142, v143
  ds_write_b128 v4, v[12:15] offset:1024
  ds_read_b128 v[44:47], v5 offset:11264
  s_waitcnt lgkmcnt(4)
  buffer_store_dwordx4 v[36:39], v6, s[20:23], s32 offen offset:192 sc1
  v_mfma_f32_16x16x32_bf16 v[200:203], a[248:251], a[208:211], v[200:203]
  v_cvt_pk_bf16_f32 v8, v152, v153
  v_cvt_pk_bf16_f32 v9, v154, v155
  v_mfma_f32_16x16x32_bf16 v[212:215], a[252:255], a[208:211], v[212:215]
  v_cvt_pk_bf16_f32 v10, v164, v165
  v_cvt_pk_bf16_f32 v11, v166, v167
  ds_write_b128 v4, v[8:11] offset:2048
  ds_read_b128 v[24:27], v5 offset:0
  s_waitcnt lgkmcnt(4)
  buffer_store_dwordx4 v[40:43], v6, s[20:23], s32 offen offset:256 sc1
  v_mfma_f32_16x16x32_bf16 v[224:227], a[248:251], a[212:215], v[224:227]
  v_cvt_pk_bf16_f32 v12, v176, v177
  v_cvt_pk_bf16_f32 v13, v178, v179
  v_mfma_f32_16x16x32_bf16 v[236:239], a[252:255], a[212:215], v[236:239]
  v_cvt_pk_bf16_f32 v14, v188, v189
  v_cvt_pk_bf16_f32 v15, v190, v191
  ds_write_b128 v4, v[12:15] offset:3072
  ds_read_b128 v[28:31], v5 offset:1024
  s_waitcnt lgkmcnt(4)
  buffer_store_dwordx4 v[44:47], v6, s[20:23], s32 offen offset:320 sc1
  v_cvt_pk_bf16_f32 v8, v200, v201
  v_cvt_pk_bf16_f32 v9, v202, v203
  v_cvt_pk_bf16_f32 v10, v212, v213
  v_cvt_pk_bf16_f32 v11, v214, v215
  ds_write_b128 v4, v[8:11] offset:4096
  ds_read_b128 v[32:35], v5 offset:2048
  s_waitcnt lgkmcnt(4)
  s_add_u32 s32, s36, 294912
  buffer_store_dwordx4 v[24:27], v6, s[20:23], s32 offen offset:0 sc1
  v_cvt_pk_bf16_f32 v12, v224, v225
  v_cvt_pk_bf16_f32 v13, v226, v227
  v_cvt_pk_bf16_f32 v14, v236, v237
  v_cvt_pk_bf16_f32 v15, v238, v239
  ds_write_b128 v4, v[12:15] offset:5120
  ds_read_b128 v[36:39], v5 offset:3072
  s_waitcnt lgkmcnt(4)
  buffer_store_dwordx4 v[28:31], v6, s[20:23], s32 offen offset:64 sc1
  ds_read_b128 v[40:43], v5 offset:4096
  s_waitcnt lgkmcnt(3)
  buffer_store_dwordx4 v[32:35], v6, s[20:23], s32 offen offset:128 sc1
  ds_read_b128 v[44:47], v5 offset:5120
  s_waitcnt lgkmcnt(2)
  buffer_store_dwordx4 v[36:39], v6, s[20:23], s32 offen offset:192 sc1
  s_waitcnt lgkmcnt(1)
  buffer_store_dwordx4 v[40:43], v6, s[20:23], s32 offen offset:256 sc1
  s_waitcnt lgkmcnt(0)
  buffer_store_dwordx4 v[44:47], v6, s[20:23], s32 offen offset:320 sc1
fused_kernel_done:
  s_endpgm
.p2align 6
fused_kernel_ln:
  v_dot2_f32_bf16 v120, v144, s92, 0
  v_dot2_f32_bf16 v123, v144, v144, 0
  v_dot2_f32_bf16 v121, v168, s92, 0
  v_dot2_f32_bf16 v124, v168, v168, 0
  v_dot2_f32_bf16 v122, v192, s92, 0
  v_dot2_f32_bf16 v125, v192, v192, 0
  v_dot2_f32_bf16 v120, v145, s92, v120
  v_dot2_f32_bf16 v123, v145, v145, v123
  v_dot2_f32_bf16 v121, v169, s92, v121
  v_dot2_f32_bf16 v124, v169, v169, v124
  v_dot2_f32_bf16 v122, v193, s92, v122
  v_dot2_f32_bf16 v125, v193, v193, v125
  v_dot2_f32_bf16 v120, v146, s92, v120
  v_dot2_f32_bf16 v123, v146, v146, v123
  v_dot2_f32_bf16 v121, v170, s92, v121
  v_dot2_f32_bf16 v124, v170, v170, v124
  v_dot2_f32_bf16 v122, v194, s92, v122
  v_dot2_f32_bf16 v125, v194, v194, v125
  v_dot2_f32_bf16 v120, v147, s92, v120
  v_dot2_f32_bf16 v123, v147, v147, v123
  v_dot2_f32_bf16 v121, v171, s92, v121
  v_dot2_f32_bf16 v124, v171, v171, v124
  v_dot2_f32_bf16 v122, v195, s92, v122
  v_dot2_f32_bf16 v125, v195, v195, v125
  v_dot2_f32_bf16 v120, v148, s92, v120
  v_dot2_f32_bf16 v123, v148, v148, v123
  v_dot2_f32_bf16 v121, v172, s92, v121
  v_dot2_f32_bf16 v124, v172, v172, v124
  v_dot2_f32_bf16 v122, v196, s92, v122
  v_dot2_f32_bf16 v125, v196, v196, v125
  v_dot2_f32_bf16 v120, v149, s92, v120
  v_dot2_f32_bf16 v123, v149, v149, v123
  v_dot2_f32_bf16 v121, v173, s92, v121
  v_dot2_f32_bf16 v124, v173, v173, v124
  v_dot2_f32_bf16 v122, v197, s92, v122
  v_dot2_f32_bf16 v125, v197, v197, v125
  v_dot2_f32_bf16 v120, v150, s92, v120
  v_dot2_f32_bf16 v123, v150, v150, v123
  v_dot2_f32_bf16 v121, v174, s92, v121
  v_dot2_f32_bf16 v124, v174, v174, v124
  v_dot2_f32_bf16 v122, v198, s92, v122
  v_dot2_f32_bf16 v125, v198, v198, v125
  v_dot2_f32_bf16 v120, v151, s92, v120
  v_dot2_f32_bf16 v123, v151, v151, v123
  v_dot2_f32_bf16 v121, v175, s92, v121
  v_dot2_f32_bf16 v124, v175, v175, v124
  v_dot2_f32_bf16 v122, v199, s92, v122
  v_dot2_f32_bf16 v125, v199, v199, v125
  v_dot2_f32_bf16 v120, v152, s92, v120
  v_dot2_f32_bf16 v123, v152, v152, v123
  v_dot2_f32_bf16 v121, v176, s92, v121
  v_dot2_f32_bf16 v124, v176, v176, v124
  v_dot2_f32_bf16 v122, v200, s92, v122
  v_dot2_f32_bf16 v125, v200, v200, v125
  v_dot2_f32_bf16 v120, v153, s92, v120
  v_dot2_f32_bf16 v123, v153, v153, v123
  v_dot2_f32_bf16 v121, v177, s92, v121
  v_dot2_f32_bf16 v124, v177, v177, v124
  v_dot2_f32_bf16 v122, v201, s92, v122
  v_dot2_f32_bf16 v125, v201, v201, v125
  v_dot2_f32_bf16 v120, v154, s92, v120
  v_dot2_f32_bf16 v123, v154, v154, v123
  v_dot2_f32_bf16 v121, v178, s92, v121
  v_dot2_f32_bf16 v124, v178, v178, v124
  v_dot2_f32_bf16 v122, v202, s92, v122
  v_dot2_f32_bf16 v125, v202, v202, v125
  v_dot2_f32_bf16 v120, v155, s92, v120
  v_dot2_f32_bf16 v123, v155, v155, v123
  v_dot2_f32_bf16 v121, v179, s92, v121
  v_dot2_f32_bf16 v124, v179, v179, v124
  v_dot2_f32_bf16 v122, v203, s92, v122
  v_dot2_f32_bf16 v125, v203, v203, v125
  v_dot2_f32_bf16 v120, v156, s92, v120
  v_dot2_f32_bf16 v123, v156, v156, v123
  v_dot2_f32_bf16 v121, v180, s92, v121
  v_dot2_f32_bf16 v124, v180, v180, v124
  v_dot2_f32_bf16 v122, v204, s92, v122
  v_dot2_f32_bf16 v125, v204, v204, v125
  v_dot2_f32_bf16 v120, v157, s92, v120
  v_dot2_f32_bf16 v123, v157, v157, v123
  v_dot2_f32_bf16 v121, v181, s92, v121
  v_dot2_f32_bf16 v124, v181, v181, v124
  v_dot2_f32_bf16 v122, v205, s92, v122
  v_dot2_f32_bf16 v125, v205, v205, v125
  v_dot2_f32_bf16 v120, v158, s92, v120
  v_dot2_f32_bf16 v123, v158, v158, v123
  v_dot2_f32_bf16 v121, v182, s92, v121
  v_dot2_f32_bf16 v124, v182, v182, v124
  v_dot2_f32_bf16 v122, v206, s92, v122
  v_dot2_f32_bf16 v125, v206, v206, v125
  v_dot2_f32_bf16 v120, v159, s92, v120
  v_dot2_f32_bf16 v123, v159, v159, v123
  v_dot2_f32_bf16 v121, v183, s92, v121
  v_dot2_f32_bf16 v124, v183, v183, v124
  v_dot2_f32_bf16 v122, v207, s92, v122
  v_dot2_f32_bf16 v125, v207, v207, v125
  v_dot2_f32_bf16 v120, v160, s92, v120
  v_dot2_f32_bf16 v123, v160, v160, v123
  v_dot2_f32_bf16 v121, v184, s92, v121
  v_dot2_f32_bf16 v124, v184, v184, v124
  v_dot2_f32_bf16 v122, v208, s92, v122
  v_dot2_f32_bf16 v125, v208, v208, v125
  v_dot2_f32_bf16 v120, v161, s92, v120
  v_dot2_f32_bf16 v123, v161, v161, v123
  v_dot2_f32_bf16 v121, v185, s92, v121
  v_dot2_f32_bf16 v124, v185, v185, v124
  v_dot2_f32_bf16 v122, v209, s92, v122
  v_dot2_f32_bf16 v125, v209, v209, v125
  v_dot2_f32_bf16 v120, v162, s92, v120
  v_dot2_f32_bf16 v123, v162, v162, v123
  v_dot2_f32_bf16 v121, v186, s92, v121
  v_dot2_f32_bf16 v124, v186, v186, v124
  v_dot2_f32_bf16 v122, v210, s92, v122
  v_dot2_f32_bf16 v125, v210, v210, v125
  v_dot2_f32_bf16 v120, v163, s92, v120
  v_dot2_f32_bf16 v123, v163, v163, v123
  v_dot2_f32_bf16 v121, v187, s92, v121
  v_dot2_f32_bf16 v124, v187, v187, v124
  v_dot2_f32_bf16 v122, v211, s92, v122
  v_dot2_f32_bf16 v125, v211, v211, v125
  v_dot2_f32_bf16 v120, v164, s92, v120
  v_dot2_f32_bf16 v123, v164, v164, v123
  v_dot2_f32_bf16 v121, v188, s92, v121
  v_dot2_f32_bf16 v124, v188, v188, v124
  v_dot2_f32_bf16 v122, v212, s92, v122
  v_dot2_f32_bf16 v125, v212, v212, v125
  v_dot2_f32_bf16 v120, v165, s92, v120
  v_dot2_f32_bf16 v123, v165, v165, v123
  v_dot2_f32_bf16 v121, v189, s92, v121
  v_dot2_f32_bf16 v124, v189, v189, v124
  v_dot2_f32_bf16 v122, v213, s92, v122
  v_dot2_f32_bf16 v125, v213, v213, v125
  v_dot2_f32_bf16 v120, v166, s92, v120
  v_dot2_f32_bf16 v123, v166, v166, v123
  v_dot2_f32_bf16 v121, v190, s92, v121
  v_dot2_f32_bf16 v124, v190, v190, v124
  v_dot2_f32_bf16 v122, v214, s92, v122
  v_dot2_f32_bf16 v125, v214, v214, v125
  v_dot2_f32_bf16 v120, v167, s92, v120
  v_dot2_f32_bf16 v123, v167, v167, v123
  v_dot2_f32_bf16 v121, v191, s92, v121
  v_dot2_f32_bf16 v124, v191, v191, v124
  v_dot2_f32_bf16 v122, v215, s92, v122
  v_dot2_f32_bf16 v125, v215, v215, v125
  s_nop 2
  v_mov_b32 v132, v120
  v_mov_b32 v133, v121
  v_mov_b32 v134, v122
  v_mov_b32 v135, v123
  v_mov_b32 v136, v124
  v_mov_b32 v137, v125
  s_nop 1
  v_permlane16_swap_b32 v132, v120
  v_permlane16_swap_b32 v133, v121
  v_permlane16_swap_b32 v134, v122
  v_permlane16_swap_b32 v135, v123
  v_permlane16_swap_b32 v136, v124
  v_permlane16_swap_b32 v137, v125
  s_nop 1
  v_add_f32 v120, v120, v132
  v_add_f32 v121, v121, v133
  v_add_f32 v122, v122, v134
  v_add_f32 v123, v123, v135
  v_add_f32 v124, v124, v136
  v_add_f32 v125, v125, v137
  v_mov_b32 v132, v120
  v_mov_b32 v133, v121
  v_mov_b32 v134, v122
  v_mov_b32 v135, v123
  v_mov_b32 v136, v124
  v_mov_b32 v137, v125
  s_nop 1
  v_permlane32_swap_b32 v132, v120
  v_permlane32_swap_b32 v133, v121
  v_permlane32_swap_b32 v134, v122
  v_permlane32_swap_b32 v135, v123
  v_permlane32_swap_b32 v136, v124
  v_permlane32_swap_b32 v137, v125
  s_nop 1
  v_add_f32 v120, v120, v132
  v_add_f32 v121, v121, v133
  v_add_f32 v122, v122, v134
  v_add_f32 v123, v123, v135
  v_add_f32 v124, v124, v136
  v_add_f32 v125, v125, v137
  v_mul_f32 v120, s95, v120
  v_mul_f32 v121, s95, v121
  v_mul_f32 v122, s95, v122
  v_mul_f32 v123, s95, v123
  v_mul_f32 v124, s95, v124
  v_mul_f32 v125, s95, v125
  v_fma_f32 v123, -v120, v120, v123
  v_fma_f32 v124, -v121, v121, v124
  v_fma_f32 v125, -v122, v122, v125
  v_max_f32 v123, 0, v123
  v_max_f32 v124, 0, v124
  v_max_f32 v125, 0, v125
  v_add_f32 v123, s94, v123
  v_add_f32 v124, s94, v124
  v_add_f32 v125, s94, v125
  v_rsq_f32 v126, v123
  v_rsq_f32 v128, v124
  v_rsq_f32 v130, v125
  s_nop 0
  v_mul_f32 v126, s93, v126
  v_mul_f32 v128, s93, v128
  v_mul_f32 v130, s93, v130
  v_mul_f32 v138, -v120, v126
  v_mul_f32 v140, -v121, v128
  v_mul_f32 v142, -v122, v130
  v_lshlrev_b32 v132, 16, v144
  v_and_b32 v133, 0xffff0000, v144
  v_pk_fma_f32 v[132:133], v[132:133], v[126:127], v[138:139] op_sel_hi:[1,0,0]
  v_cvt_pk_bf16_f32 v144, v132, v133
  v_lshlrev_b32 v134, 16, v145
  v_and_b32 v135, 0xffff0000, v145
  v_pk_fma_f32 v[134:135], v[134:135], v[126:127], v[138:139] op_sel_hi:[1,0,0]
  v_cvt_pk_bf16_f32 v145, v134, v135
  v_lshlrev_b32 v136, 16, v146
  v_and_b32 v137, 0xffff0000, v146
  v_pk_fma_f32 v[136:137], v[136:137], v[126:127], v[138:139] op_sel_hi:[1,0,0]
  v_cvt_pk_bf16_f32 v146, v136, v137
  v_lshlrev_b32 v132, 16, v147
  v_and_b32 v133, 0xffff0000, v147
  v_pk_fma_f32 v[132:133], v[132:133], v[126:127], v[138:139] op_sel_hi:[1,0,0]
  v_cvt_pk_bf16_f32 v147, v132, v133
  v_lshlrev_b32 v134, 16, v148
  v_and_b32 v135, 0xffff0000, v148
  v_pk_fma_f32 v[134:135], v[134:135], v[126:127], v[138:139] op_sel_hi:[1,0,0]
  v_cvt_pk_bf16_f32 v148, v134, v135
  v_lshlrev_b32 v136, 16, v149
  v_and_b32 v137, 0xffff0000, v149
  v_pk_fma_f32 v[136:137], v[136:137], v[126:127], v[138:139] op_sel_hi:[1,0,0]
  v_cvt_pk_bf16_f32 v149, v136, v137
  v_lshlrev_b32 v132, 16, v150
  v_and_b32 v133, 0xffff0000, v150
  v_pk_fma_f32 v[132:133], v[132:133], v[126:127], v[138:139] op_sel_hi:[1,0,0]
  v_cvt_pk_bf16_f32 v150, v132, v133
  v_lshlrev_b32 v134, 16, v151
  v_and_b32 v135, 0xffff0000, v151
  v_pk_fma_f32 v[134:135], v[134:135], v[126:127], v[138:139] op_sel_hi:[1,0,0]
  v_cvt_pk_bf16_f32 v151, v134, v135
  v_lshlrev_b32 v136, 16, v152
  v_and_b32 v137, 0xffff0000, v152
  v_pk_fma_f32 v[136:137], v[136:137], v[126:127], v[138:139] op_sel_hi:[1,0,0]
  v_cvt_pk_bf16_f32 v152, v136, v137
  v_lshlrev_b32 v132, 16, v153
  v_and_b32 v133, 0xffff0000, v153
  v_pk_fma_f32 v[132:133], v[132:133], v[126:127], v[138:139] op_sel_hi:[1,0,0]
  v_cvt_pk_bf16_f32 v153, v132, v133
  v_lshlrev_b32 v134, 16, v154
  v_and_b32 v135, 0xffff0000, v154
  v_pk_fma_f32 v[134:135], v[134:135], v[126:127], v[138:139] op_sel_hi:[1,0,0]
  v_cvt_pk_bf16_f32 v154, v134, v135
  v_lshlrev_b32 v136, 16, v155
  v_and_b32 v137, 0xffff0000, v155
  v_pk_fma_f32 v[136:137], v[136:137], v[126:127], v[138:139] op_sel_hi:[1,0,0]
  v_cvt_pk_bf16_f32 v155, v136, v137
  v_lshlrev_b32 v132, 16, v156
  v_and_b32 v133, 0xffff0000, v156
  v_pk_fma_f32 v[132:133], v[132:133], v[126:127], v[138:139] op_sel_hi:[1,0,0]
  v_cvt_pk_bf16_f32 v156, v132, v133
  v_lshlrev_b32 v134, 16, v157
  v_and_b32 v135, 0xffff0000, v157
  v_pk_fma_f32 v[134:135], v[134:135], v[126:127], v[138:139] op_sel_hi:[1,0,0]
  v_cvt_pk_bf16_f32 v157, v134, v135
  v_lshlrev_b32 v136, 16, v158
  v_and_b32 v137, 0xffff0000, v158
  v_pk_fma_f32 v[136:137], v[136:137], v[126:127], v[138:139] op_sel_hi:[1,0,0]
  v_cvt_pk_bf16_f32 v158, v136, v137
  v_lshlrev_b32 v132, 16, v159
  v_and_b32 v133, 0xffff0000, v159
  v_pk_fma_f32 v[132:133], v[132:133], v[126:127], v[138:139] op_sel_hi:[1,0,0]
  v_cvt_pk_bf16_f32 v159, v132, v133
  v_lshlrev_b32 v134, 16, v160
  v_and_b32 v135, 0xffff0000, v160
  v_pk_fma_f32 v[134:135], v[134:135], v[126:127], v[138:139] op_sel_hi:[1,0,0]
  v_cvt_pk_bf16_f32 v160, v134, v135
  v_lshlrev_b32 v136, 16, v161
  v_and_b32 v137, 0xffff0000, v161
  v_pk_fma_f32 v[136:137], v[136:137], v[126:127], v[138:139] op_sel_hi:[1,0,0]
  v_cvt_pk_bf16_f32 v161, v136, v137
  v_lshlrev_b32 v132, 16, v162
  v_and_b32 v133, 0xffff0000, v162
  v_pk_fma_f32 v[132:133], v[132:133], v[126:127], v[138:139] op_sel_hi:[1,0,0]
  v_cvt_pk_bf16_f32 v162, v132, v133
  v_lshlrev_b32 v134, 16, v163
  v_and_b32 v135, 0xffff0000, v163
  v_pk_fma_f32 v[134:135], v[134:135], v[126:127], v[138:139] op_sel_hi:[1,0,0]
  v_cvt_pk_bf16_f32 v163, v134, v135
  v_lshlrev_b32 v136, 16, v164
  v_and_b32 v137, 0xffff0000, v164
  v_pk_fma_f32 v[136:137], v[136:137], v[126:127], v[138:139] op_sel_hi:[1,0,0]
  v_cvt_pk_bf16_f32 v164, v136, v137
  v_lshlrev_b32 v132, 16, v165
  v_and_b32 v133, 0xffff0000, v165
  v_pk_fma_f32 v[132:133], v[132:133], v[126:127], v[138:139] op_sel_hi:[1,0,0]
  v_cvt_pk_bf16_f32 v165, v132, v133
  v_lshlrev_b32 v134, 16, v166
  v_and_b32 v135, 0xffff0000, v166
  v_pk_fma_f32 v[134:135], v[134:135], v[126:127], v[138:139] op_sel_hi:[1,0,0]
  v_cvt_pk_bf16_f32 v166, v134, v135
  v_lshlrev_b32 v136, 16, v167
  v_and_b32 v137, 0xffff0000, v167
  v_pk_fma_f32 v[136:137], v[136:137], v[126:127], v[138:139] op_sel_hi:[1,0,0]
  v_cvt_pk_bf16_f32 v167, v136, v137
  v_lshlrev_b32 v132, 16, v168
  v_and_b32 v133, 0xffff0000, v168
  v_pk_fma_f32 v[132:133], v[132:133], v[128:129], v[140:141] op_sel_hi:[1,0,0]
  v_cvt_pk_bf16_f32 v168, v132, v133
  v_lshlrev_b32 v134, 16, v169
  v_and_b32 v135, 0xffff0000, v169
  v_pk_fma_f32 v[134:135], v[134:135], v[128:129], v[140:141] op_sel_hi:[1,0,0]
  v_cvt_pk_bf16_f32 v169, v134, v135
  v_lshlrev_b32 v136, 16, v170
  v_and_b32 v137, 0xffff0000, v170
  v_pk_fma_f32 v[136:137], v[136:137], v[128:129], v[140:141] op_sel_hi:[1,0,0]
  v_cvt_pk_bf16_f32 v170, v136, v137
  v_lshlrev_b32 v132, 16, v171
  v_and_b32 v133, 0xffff0000, v171
  v_pk_fma_f32 v[132:133], v[132:133], v[128:129], v[140:141] op_sel_hi:[1,0,0]
  v_cvt_pk_bf16_f32 v171, v132, v133
  v_lshlrev_b32 v134, 16, v172
  v_and_b32 v135, 0xffff0000, v172
  v_pk_fma_f32 v[134:135], v[134:135], v[128:129], v[140:141] op_sel_hi:[1,0,0]
  v_cvt_pk_bf16_f32 v172, v134, v135
  v_lshlrev_b32 v136, 16, v173
  v_and_b32 v137, 0xffff0000, v173
  v_pk_fma_f32 v[136:137], v[136:137], v[128:129], v[140:141] op_sel_hi:[1,0,0]
  v_cvt_pk_bf16_f32 v173, v136, v137
  v_lshlrev_b32 v132, 16, v174
  v_and_b32 v133, 0xffff0000, v174
  v_pk_fma_f32 v[132:133], v[132:133], v[128:129], v[140:141] op_sel_hi:[1,0,0]
  v_cvt_pk_bf16_f32 v174, v132, v133
  v_lshlrev_b32 v134, 16, v175
  v_and_b32 v135, 0xffff0000, v175
  v_pk_fma_f32 v[134:135], v[134:135], v[128:129], v[140:141] op_sel_hi:[1,0,0]
  v_cvt_pk_bf16_f32 v175, v134, v135
  v_lshlrev_b32 v136, 16, v176
  v_and_b32 v137, 0xffff0000, v176
  v_pk_fma_f32 v[136:137], v[136:137], v[128:129], v[140:141] op_sel_hi:[1,0,0]
  v_cvt_pk_bf16_f32 v176, v136, v137
  v_lshlrev_b32 v132, 16, v177
  v_and_b32 v133, 0xffff0000, v177
  v_pk_fma_f32 v[132:133], v[132:133], v[128:129], v[140:141] op_sel_hi:[1,0,0]
  v_cvt_pk_bf16_f32 v177, v132, v133
  v_lshlrev_b32 v134, 16, v178
  v_and_b32 v135, 0xffff0000, v178
  v_pk_fma_f32 v[134:135], v[134:135], v[128:129], v[140:141] op_sel_hi:[1,0,0]
  v_cvt_pk_bf16_f32 v178, v134, v135
  v_lshlrev_b32 v136, 16, v179
  v_and_b32 v137, 0xffff0000, v179
  v_pk_fma_f32 v[136:137], v[136:137], v[128:129], v[140:141] op_sel_hi:[1,0,0]
  v_cvt_pk_bf16_f32 v179, v136, v137
  v_lshlrev_b32 v132, 16, v180
  v_and_b32 v133, 0xffff0000, v180
  v_pk_fma_f32 v[132:133], v[132:133], v[128:129], v[140:141] op_sel_hi:[1,0,0]
  v_cvt_pk_bf16_f32 v180, v132, v133
  v_lshlrev_b32 v134, 16, v181
  v_and_b32 v135, 0xffff0000, v181
  v_pk_fma_f32 v[134:135], v[134:135], v[128:129], v[140:141] op_sel_hi:[1,0,0]
  v_cvt_pk_bf16_f32 v181, v134, v135
  v_lshlrev_b32 v136, 16, v182
  v_and_b32 v137, 0xffff0000, v182
  v_pk_fma_f32 v[136:137], v[136:137], v[128:129], v[140:141] op_sel_hi:[1,0,0]
  v_cvt_pk_bf16_f32 v182, v136, v137
  v_lshlrev_b32 v132, 16, v183
  v_and_b32 v133, 0xffff0000, v183
  v_pk_fma_f32 v[132:133], v[132:133], v[128:129], v[140:141] op_sel_hi:[1,0,0]
  v_cvt_pk_bf16_f32 v183, v132, v133
  v_lshlrev_b32 v134, 16, v184
  v_and_b32 v135, 0xffff0000, v184
  v_pk_fma_f32 v[134:135], v[134:135], v[128:129], v[140:141] op_sel_hi:[1,0,0]
  v_cvt_pk_bf16_f32 v184, v134, v135
  v_lshlrev_b32 v136, 16, v185
  v_and_b32 v137, 0xffff0000, v185
  v_pk_fma_f32 v[136:137], v[136:137], v[128:129], v[140:141] op_sel_hi:[1,0,0]
  v_cvt_pk_bf16_f32 v185, v136, v137
  v_lshlrev_b32 v132, 16, v186
  v_and_b32 v133, 0xffff0000, v186
  v_pk_fma_f32 v[132:133], v[132:133], v[128:129], v[140:141] op_sel_hi:[1,0,0]
  v_cvt_pk_bf16_f32 v186, v132, v133
  v_lshlrev_b32 v134, 16, v187
  v_and_b32 v135, 0xffff0000, v187
  v_pk_fma_f32 v[134:135], v[134:135], v[128:129], v[140:141] op_sel_hi:[1,0,0]
  v_cvt_pk_bf16_f32 v187, v134, v135
  v_lshlrev_b32 v136, 16, v188
  v_and_b32 v137, 0xffff0000, v188
  v_pk_fma_f32 v[136:137], v[136:137], v[128:129], v[140:141] op_sel_hi:[1,0,0]
  v_cvt_pk_bf16_f32 v188, v136, v137
  v_lshlrev_b32 v132, 16, v189
  v_and_b32 v133, 0xffff0000, v189
  v_pk_fma_f32 v[132:133], v[132:133], v[128:129], v[140:141] op_sel_hi:[1,0,0]
  v_cvt_pk_bf16_f32 v189, v132, v133
  v_lshlrev_b32 v134, 16, v190
  v_and_b32 v135, 0xffff0000, v190
  v_pk_fma_f32 v[134:135], v[134:135], v[128:129], v[140:141] op_sel_hi:[1,0,0]
  v_cvt_pk_bf16_f32 v190, v134, v135
  v_lshlrev_b32 v136, 16, v191
  v_and_b32 v137, 0xffff0000, v191
  v_pk_fma_f32 v[136:137], v[136:137], v[128:129], v[140:141] op_sel_hi:[1,0,0]
  v_cvt_pk_bf16_f32 v191, v136, v137
  v_lshlrev_b32 v132, 16, v192
  v_and_b32 v133, 0xffff0000, v192
  v_pk_fma_f32 v[132:133], v[132:133], v[130:131], v[142:143] op_sel_hi:[1,0,0]
  v_cvt_pk_bf16_f32 v192, v132, v133
  v_lshlrev_b32 v134, 16, v193
  v_and_b32 v135, 0xffff0000, v193
  v_pk_fma_f32 v[134:135], v[134:135], v[130:131], v[142:143] op_sel_hi:[1,0,0]
  v_cvt_pk_bf16_f32 v193, v134, v135
  v_lshlrev_b32 v136, 16, v194
  v_and_b32 v137, 0xffff0000, v194
  v_pk_fma_f32 v[136:137], v[136:137], v[130:131], v[142:143] op_sel_hi:[1,0,0]
  v_cvt_pk_bf16_f32 v194, v136, v137
  v_lshlrev_b32 v132, 16, v195
  v_and_b32 v133, 0xffff0000, v195
  v_pk_fma_f32 v[132:133], v[132:133], v[130:131], v[142:143] op_sel_hi:[1,0,0]
  v_cvt_pk_bf16_f32 v195, v132, v133
  v_lshlrev_b32 v134, 16, v196
  v_and_b32 v135, 0xffff0000, v196
  v_pk_fma_f32 v[134:135], v[134:135], v[130:131], v[142:143] op_sel_hi:[1,0,0]
  v_cvt_pk_bf16_f32 v196, v134, v135
  v_lshlrev_b32 v136, 16, v197
  v_and_b32 v137, 0xffff0000, v197
  v_pk_fma_f32 v[136:137], v[136:137], v[130:131], v[142:143] op_sel_hi:[1,0,0]
  v_cvt_pk_bf16_f32 v197, v136, v137
  v_lshlrev_b32 v132, 16, v198
  v_and_b32 v133, 0xffff0000, v198
  v_pk_fma_f32 v[132:133], v[132:133], v[130:131], v[142:143] op_sel_hi:[1,0,0]
  v_cvt_pk_bf16_f32 v198, v132, v133
  v_lshlrev_b32 v134, 16, v199
  v_and_b32 v135, 0xffff0000, v199
  v_pk_fma_f32 v[134:135], v[134:135], v[130:131], v[142:143] op_sel_hi:[1,0,0]
  v_cvt_pk_bf16_f32 v199, v134, v135
  v_lshlrev_b32 v136, 16, v200
  v_and_b32 v137, 0xffff0000, v200
  v_pk_fma_f32 v[136:137], v[136:137], v[130:131], v[142:143] op_sel_hi:[1,0,0]
  v_cvt_pk_bf16_f32 v200, v136, v137
  v_lshlrev_b32 v132, 16, v201
  v_and_b32 v133, 0xffff0000, v201
  v_pk_fma_f32 v[132:133], v[132:133], v[130:131], v[142:143] op_sel_hi:[1,0,0]
  v_cvt_pk_bf16_f32 v201, v132, v133
  v_lshlrev_b32 v134, 16, v202
  v_and_b32 v135, 0xffff0000, v202
  v_pk_fma_f32 v[134:135], v[134:135], v[130:131], v[142:143] op_sel_hi:[1,0,0]
  v_cvt_pk_bf16_f32 v202, v134, v135
  v_lshlrev_b32 v136, 16, v203
  v_and_b32 v137, 0xffff0000, v203
  v_pk_fma_f32 v[136:137], v[136:137], v[130:131], v[142:143] op_sel_hi:[1,0,0]
  v_cvt_pk_bf16_f32 v203, v136, v137
  v_lshlrev_b32 v132, 16, v204
  v_and_b32 v133, 0xffff0000, v204
  v_pk_fma_f32 v[132:133], v[132:133], v[130:131], v[142:143] op_sel_hi:[1,0,0]
  v_cvt_pk_bf16_f32 v204, v132, v133
  v_lshlrev_b32 v134, 16, v205
  v_and_b32 v135, 0xffff0000, v205
  v_pk_fma_f32 v[134:135], v[134:135], v[130:131], v[142:143] op_sel_hi:[1,0,0]
  v_cvt_pk_bf16_f32 v205, v134, v135
  v_lshlrev_b32 v136, 16, v206
  v_and_b32 v137, 0xffff0000, v206
  v_pk_fma_f32 v[136:137], v[136:137], v[130:131], v[142:143] op_sel_hi:[1,0,0]
  v_cvt_pk_bf16_f32 v206, v136, v137
  v_lshlrev_b32 v132, 16, v207
  v_and_b32 v133, 0xffff0000, v207
  v_pk_fma_f32 v[132:133], v[132:133], v[130:131], v[142:143] op_sel_hi:[1,0,0]
  v_cvt_pk_bf16_f32 v207, v132, v133
  v_lshlrev_b32 v134, 16, v208
  v_and_b32 v135, 0xffff0000, v208
  v_pk_fma_f32 v[134:135], v[134:135], v[130:131], v[142:143] op_sel_hi:[1,0,0]
  v_cvt_pk_bf16_f32 v208, v134, v135
  v_lshlrev_b32 v136, 16, v209
  v_and_b32 v137, 0xffff0000, v209
  v_pk_fma_f32 v[136:137], v[136:137], v[130:131], v[142:143] op_sel_hi:[1,0,0]
  v_cvt_pk_bf16_f32 v209, v136, v137
  v_lshlrev_b32 v132, 16, v210
  v_and_b32 v133, 0xffff0000, v210
  v_pk_fma_f32 v[132:133], v[132:133], v[130:131], v[142:143] op_sel_hi:[1,0,0]
  v_cvt_pk_bf16_f32 v210, v132, v133
  v_lshlrev_b32 v134, 16, v211
  v_and_b32 v135, 0xffff0000, v211
  v_pk_fma_f32 v[134:135], v[134:135], v[130:131], v[142:143] op_sel_hi:[1,0,0]
  v_cvt_pk_bf16_f32 v211, v134, v135
  v_lshlrev_b32 v136, 16, v212
  v_and_b32 v137, 0xffff0000, v212
  v_pk_fma_f32 v[136:137], v[136:137], v[130:131], v[142:143] op_sel_hi:[1,0,0]
  v_cvt_pk_bf16_f32 v212, v136, v137
  v_lshlrev_b32 v132, 16, v213
  v_and_b32 v133, 0xffff0000, v213
  v_pk_fma_f32 v[132:133], v[132:133], v[130:131], v[142:143] op_sel_hi:[1,0,0]
  v_cvt_pk_bf16_f32 v213, v132, v133
  v_lshlrev_b32 v134, 16, v214
  v_and_b32 v135, 0xffff0000, v214
  v_pk_fma_f32 v[134:135], v[134:135], v[130:131], v[142:143] op_sel_hi:[1,0,0]
  v_cvt_pk_bf16_f32 v214, v134, v135
  v_lshlrev_b32 v136, 16, v215
  v_and_b32 v137, 0xffff0000, v215
  v_pk_fma_f32 v[136:137], v[136:137], v[130:131], v[142:143] op_sel_hi:[1,0,0]
  v_cvt_pk_bf16_f32 v215, v136, v137
  s_setpc_b64 s[42:43]
.section .rodata,"a"
.p2align 6
.amdhsa_kernel fused_kernel
  .amdhsa_next_free_vgpr 512
  .amdhsa_next_free_sgpr 102
  .amdhsa_accum_offset 256
  .amdhsa_group_segment_fixed_size 0
  .amdhsa_kernarg_size 56
  .amdhsa_user_sgpr_count 2
  .amdhsa_user_sgpr_kernarg_segment_ptr 1
  .amdhsa_system_sgpr_workgroup_id_x 1
  .amdhsa_float_denorm_mode_32 3
.end_amdhsa_kernel
```
